```python
import torch

def _softmax(x, axis=-1):
    return torch.softmax(x, dim=axis)

def _gelu(x):
    return torch.nn.functional.gelu(x, approximate='tanh')

def _silu(x):
    return torch.nn.functional.silu(x)

def _sigmoid(x):
    return torch.sigmoid(x)

def _layernorm(x, axis=-1, eps=1e-05):
    m = x.mean(dim=axis, keepdim=True)
    v = x.var(dim=axis, keepdim=True, unbiased=False)
    return (x - m) / torch.sqrt(v + eps)

def _scatter_add(tgt, idx, src, axis=0):
    return tgt.clone().index_add_(axis, idx, src)

def _segment_sum(src, seg, n):
    out = torch.zeros((n,) + src.shape[1:], dtype=src.dtype)
    return out.index_add_(0, seg, src)

def _pad(x, pw):
    flat = tuple((v for pair in reversed(pw) for v in pair))
    return torch.nn.functional.pad(x, flat)
kernel_name = 'recurrent_scan__memory_aug_recurrent_mem_tr__dense_activation_squared_relu__prompt'

def setup_inputs():

    _w = lambda a: (lambda t: t.to(torch.bfloat16) if t.is_floating_point() else t)(torch.as_tensor(a))

    def _A_setup():
        B, S, Dm = (1, 2048, 512)
        H, Dh = (32, 128)
        M, seg = (8, 32)
        seg = min(seg, S)
        S = S // seg * seg
        return {'x': _w((lambda *s: torch.randn(*s, dtype=torch.bfloat16) * 0.05)(B, S, Dm)), 'mem0': _w((lambda *s: torch.randn(*s, dtype=torch.bfloat16) * 0.2)(B, M, Dm)), 'Wq': _w((lambda *s: torch.randn(*s, dtype=torch.bfloat16) * 1.6)(Dm, H, Dh) * Dm ** (-0.5)), 'Wk': _w((lambda *s: torch.randn(*s, dtype=torch.bfloat16) * 1.6)(Dm, H, Dh) * Dm ** (-0.5)), 'Wv': _w((lambda *s: torch.randn(*s, dtype=torch.bfloat16) * 0.2)(Dm, H, Dh) * Dm ** (-0.5)), 'Wo': _w((lambda *s: torch.randn(*s, dtype=torch.bfloat16) * 0.2)(H, Dh, Dm) * (H * Dh) ** (-0.5)), 'seg_len': seg}
    _A_in = _A_setup()

    def _B_setup():
        B, S, D, F = (1, 2048, 512, 1376)
        return {'x': _w((lambda *s: torch.randn(*s, dtype=torch.bfloat16) * 0.05)(B, S, D)), 'w1': _w((lambda *s: torch.randn(*s, dtype=torch.bfloat16) * 0.1)(D, F)), 'b1': _w((lambda *s: torch.randn(*s, dtype=torch.bfloat16) * 0.8)(F)), 'w2': _w((lambda *s: torch.randn(*s, dtype=torch.bfloat16) * 0.1)(F, D)), 'b2': _w((lambda *s: torch.randn(*s, dtype=torch.bfloat16) * 12.8)(D))}
    _B_in = _B_setup()
    return {'A_x': _A_in['x'], 'A_mem0': _A_in['mem0'], 'A_Wq': _A_in['Wq'], 'A_Wk': _A_in['Wk'], 'A_Wv': _A_in['Wv'], 'A_Wo': _A_in['Wo'], 'A_seg_len': _A_in['seg_len'], 'B_x': _B_in['x'], 'B_w1': _B_in['w1'], 'B_b1': _B_in['b1'], 'B_w2': _B_in['w2'], 'B_b2': _B_in['b2']}

def reference(A_x, A_mem0, A_Wq, A_Wk, A_Wv, A_Wo, A_seg_len, B_x, B_w1, B_b1, B_w2, B_b2):

    def _A_ref(x, mem0, Wq, Wk, Wv, Wo, seg_len):
        B, S, Dm = x.shape
        H, Dh = (Wq.shape[1], Wq.shape[2])
        M = mem0.shape[1]
        scale = Dh ** (-0.5)
        n_seg = S // seg_len
        L = M + seg_len
        idx = torch.arange(L)
        mask = (idx[:, None] < M) | (idx[:, None] >= idx[None, :])
        mem = mem0
        outs = []
        for s in range(n_seg):
            xs = x[:, s * seg_len:(s + 1) * seg_len, :].clone()
            h = torch.concatenate([mem, xs], axis=1)
            q = torch.einsum('btd,dhe->bhte', h, Wq)
            k = torch.einsum('btd,dhe->bhte', h, Wk)
            v = torch.einsum('btd,dhe->bhte', h, Wv)
            scores = torch.einsum('bhqe,bhke->bhqk', q, k) * scale
            scores = torch.where(mask[None, None], scores, -1000000000.0)
            p = _softmax(scores, axis=-1)
            o = torch.einsum('bhqk,bhke->bhqe', p, v)
            o = torch.einsum('bhte,hed->btd', o, Wo)
            mem = o[:, :M, :].clone()
            outs.append(o[:, M:, :])
        return torch.concatenate(outs, axis=1)

    def _B_ref(x, w1, b1, w2, b2):
        h = torch.einsum('bsd,df->bsf', x, w1) + b1
        zero = torch.zeros_like(h)
        r = torch.where(h > zero, h, zero)
        h = r * r
        out = torch.einsum('bsf,fd->bsd', h, w2) + b2
        return out
    x = A_x
    xn = _layernorm(x, axis=-1)
    s = _A_ref(xn, A_mem0, A_Wq, A_Wk, A_Wv, A_Wo, A_seg_len)
    g = _silu(_B_ref(xn, B_w1, B_b1, B_w2, B_b2))
    return x + s * g
```

```asm
; @launch grid=(256,1,1) block=(256,1,1) lds=163840
.amdgcn_target "amdgcn-amd-amdhsa--gfx950"
.text
.globl recurrent_scan__memory_aug_recurrent_mem_tr__dense_activation_squared_relu__prompt_kernel
.p2align 8
.type recurrent_scan__memory_aug_recurrent_mem_tr__dense_activation_squared_relu__prompt_kernel,@function
recurrent_scan__memory_aug_recurrent_mem_tr__dense_activation_squared_relu__prompt_kernel:
    s_cmp_ge_u32 s2, 256
    s_cbranch_scc1 L_end
    s_load_dwordx2 s[12:13], s[0:1], 104
    s_load_dwordx2 s[24:25], s[0:1], 16
    s_load_dwordx2 s[32:33], s[0:1], 32
    s_load_dwordx2 s[28:29], s[0:1], 24
    s_load_dwordx2 s[8:9], s[0:1], 112
    s_load_dwordx2 s[16:17], s[0:1], 0
    s_load_dwordx2 s[20:21], s[0:1], 8
    s_load_dwordx2 s[36:37], s[0:1], 40
    s_load_dwordx2 s[40:41], s[0:1], 64
    s_load_dwordx2 s[44:45], s[0:1], 72
    s_load_dwordx2 s[48:49], s[0:1], 80
    s_load_dwordx2 s[52:53], s[0:1], 88
    s_load_dwordx2 s[56:57], s[0:1], 96
    v_lshrrev_b32 v1, 6, v0
    v_lshlrev_b32 v2, 4, v0
    v_readfirstlane_b32 s60, v1
    v_and_b32 v0, 63, v0
    v_mov_b32 v1, 0
    s_getreg_b32 s62, hwreg(HW_REG_XCC_ID, 0, 4)
    s_mov_b32 s63, 0
    s_mov_b32 s14, 0x100
    s_mov_b32 s15, 0x20000
    s_mov_b32 s26, 0x400000
    s_mov_b32 s27, 0x20000
    s_mov_b32 s34, 0x400000
    s_mov_b32 s35, 0x20000
    s_mov_b32 s30, 0x400000
    s_mov_b32 s31, 0x20000
    s_mov_b32 s10, 0x10000000
    s_mov_b32 s11, 0x20000
    s_mov_b32 s18, 0x200000
    s_mov_b32 s19, 0x20000
    s_mov_b32 s22, 0x2000
    s_mov_b32 s23, 0x20000
    s_mov_b32 s38, 0x400000
    s_mov_b32 s39, 0x20000
    s_mov_b32 s42, 0x158000
    s_mov_b32 s43, 0x20000
    s_mov_b32 s46, 0xac0
    s_mov_b32 s47, 0x20000
    s_mov_b32 s50, 0x158000
    s_mov_b32 s51, 0x20000
    s_mov_b32 s54, 0x400
    s_mov_b32 s55, 0x20000
    s_mov_b32 s58, 0x200000
    s_mov_b32 s59, 0x20000
    s_waitcnt lgkmcnt(0)
    s_cmp_lg_u32 s2, 1
    s_cbranch_scc1 L_noinit
    v_mov_b32 v4, 0
    v_mov_b32 v5, 0
    v_mov_b32 v6, 0
    v_mov_b32 v7, 0
    s_movk_i32 s64, 0
    buffer_store_dwordx4 v[4:7], v2, s[8:11], s64 offen sc1
    s_movk_i32 s64, 4096
    buffer_store_dwordx4 v[4:7], v2, s[8:11], s64 offen sc1
    s_movk_i32 s64, 8192
    buffer_store_dwordx4 v[4:7], v2, s[8:11], s64 offen sc1
    s_movk_i32 s64, 12288
    buffer_store_dwordx4 v[4:7], v2, s[8:11], s64 offen sc1
    s_movk_i32 s64, 16384
    buffer_store_dwordx4 v[4:7], v2, s[8:11], s64 offen sc1
    s_movk_i32 s64, 20480
    buffer_store_dwordx4 v[4:7], v2, s[8:11], s64 offen sc1
    s_movk_i32 s64, 24576
    buffer_store_dwordx4 v[4:7], v2, s[8:11], s64 offen sc1
    s_movk_i32 s64, 28672
    buffer_store_dwordx4 v[4:7], v2, s[8:11], s64 offen sc1
    s_waitcnt vmcnt(0)
    s_barrier
    s_cmp_lg_u32 s60, 0
    s_cbranch_scc1 L_noinit
    v_mov_b32 v3, 1
    s_mov_b64 exec, 1
    buffer_store_dword v3, v1, s[12:15], 0 offen offset:192 sc1
    s_mov_b64 exec, -1
L_noinit:
    s_and_b32 s64, s62, 7
    s_lshl_b32 s64, s64, 2
    s_lshr_b32 s64, 0x76430521, s64
    s_and_b32 s64, s64, 7
    s_cmp_eq_u32 s60, 0
    s_cbranch_scc1 L_draw
    s_branch L_rolewait
L_draw:
    s_mov_b32 s65, 0
L_try:
    s_lshl_b32 s66, s64, 2
    s_add_u32 s66, s66, 128
    s_cmp_eq_u32 s64, 0
    s_cselect_b32 s66, 0, s66
    v_mov_b32 v3, 1
    s_mov_b64 exec, 1
    buffer_atomic_add v3, v1, s[12:15], s66 offen sc0
    s_waitcnt vmcnt(0)
    v_readfirstlane_b32 s67, v3
    s_mov_b64 exec, -1
    s_cmp_lt_u32 s67, 32
    s_cbranch_scc1 L_got
L_next:
    s_add_u32 s64, s64, 1
    s_and_b32 s64, s64, 7
    s_add_u32 s65, s65, 1
    s_cmp_lt_u32 s65, 8
    s_cbranch_scc1 L_try
    s_mov_b32 s64, 8
    s_mov_b32 s67, 0
L_got:
    s_lshl_b32 s64, s64, 5
    s_add_u32 s64, s64, s67
    v_mov_b32 v3, s64
    ds_write_b32 v1, v3
L_rolewait:
    s_waitcnt lgkmcnt(0)
    s_barrier
    ds_read_b32 v3, v1
    s_waitcnt lgkmcnt(0)
    v_readfirstlane_b32 s61, v3
    s_barrier
    s_cmp_lt_u32 s61, 32
    s_cbranch_scc1 L_chain
    s_cmp_lt_u32 s61, 160
    s_cbranch_scc1 L_head
    s_cmp_lt_u32 s61, 192
    s_cbranch_scc1 L_ffn
    s_cmp_lt_u32 s61, 256
    s_cbranch_scc1 L_fin
L_end:
    s_endpgm
L_ffn:
    s_sub_u32 s64, s61, 160
    v_and_b32 v2, 15, v0
    v_lshrrev_b32 v3, 4, v0
    v_lshlrev_b32 v4, 10, v2
    v_lshrrev_b32 v5, 1, v3
    v_lshl_add_u32 v4, v5, 8, v4
    v_and_b32 v5, 1, v3
    v_lshl_add_u32 v4, v5, 4, v4
    s_and_b32 s66, s60, 3
    s_lshl_b32 s65, s64, 2
    s_add_u32 s65, s65, s66
    s_lshl_b32 s67, s65, 14
    buffer_load_dwordx4 v[16:19], v4, s[16:19], s67 offen offset:0
    buffer_load_dwordx4 v[20:23], v4, s[16:19], s67 offen offset:32
    buffer_load_dwordx4 v[24:27], v4, s[16:19], s67 offen offset:512
    buffer_load_dwordx4 v[28:31], v4, s[16:19], s67 offen offset:544
    buffer_load_dwordx4 v[32:35], v4, s[16:19], s67 offen offset:64
    buffer_load_dwordx4 v[36:39], v4, s[16:19], s67 offen offset:96
    buffer_load_dwordx4 v[40:43], v4, s[16:19], s67 offen offset:576
    buffer_load_dwordx4 v[44:47], v4, s[16:19], s67 offen offset:608
    buffer_load_dwordx4 v[48:51], v4, s[16:19], s67 offen offset:128
    buffer_load_dwordx4 v[52:55], v4, s[16:19], s67 offen offset:160
    buffer_load_dwordx4 v[56:59], v4, s[16:19], s67 offen offset:640
    buffer_load_dwordx4 v[60:63], v4, s[16:19], s67 offen offset:672
    buffer_load_dwordx4 v[64:67], v4, s[16:19], s67 offen offset:192
    buffer_load_dwordx4 v[68:71], v4, s[16:19], s67 offen offset:224
    buffer_load_dwordx4 v[72:75], v4, s[16:19], s67 offen offset:704
    buffer_load_dwordx4 v[76:79], v4, s[16:19], s67 offen offset:736
    s_waitcnt vmcnt(15)
    v_lshlrev_b32 v96, 16, v16
    v_and_b32 v97, 0xffff0000, v16
    v_lshlrev_b32 v98, 16, v17
    v_and_b32 v99, 0xffff0000, v17
    v_lshlrev_b32 v100, 16, v18
    v_and_b32 v101, 0xffff0000, v18
    v_lshlrev_b32 v102, 16, v19
    v_and_b32 v103, 0xffff0000, v19
    v_mov_b32 v8, v96
    v_mov_b32 v9, v97
    v_mov_b32 v10, v98
    v_mov_b32 v11, v99
    v_add_f32 v8, v8, v100
    v_add_f32 v9, v9, v101
    v_add_f32 v10, v10, v102
    v_add_f32 v11, v11, v103
    s_waitcnt vmcnt(14)
    v_lshlrev_b32 v104, 16, v20
    v_and_b32 v105, 0xffff0000, v20
    v_lshlrev_b32 v106, 16, v21
    v_and_b32 v107, 0xffff0000, v21
    v_lshlrev_b32 v108, 16, v22
    v_and_b32 v109, 0xffff0000, v22
    v_lshlrev_b32 v110, 16, v23
    v_and_b32 v111, 0xffff0000, v23
    v_add_f32 v8, v8, v104
    v_add_f32 v9, v9, v105
    v_add_f32 v10, v10, v106
    v_add_f32 v11, v11, v107
    v_add_f32 v8, v8, v108
    v_add_f32 v9, v9, v109
    v_add_f32 v10, v10, v110
    v_add_f32 v11, v11, v111
    s_waitcnt vmcnt(13)
    v_lshlrev_b32 v112, 16, v24
    v_and_b32 v113, 0xffff0000, v24
    v_lshlrev_b32 v114, 16, v25
    v_and_b32 v115, 0xffff0000, v25
    v_lshlrev_b32 v116, 16, v26
    v_and_b32 v117, 0xffff0000, v26
    v_lshlrev_b32 v118, 16, v27
    v_and_b32 v119, 0xffff0000, v27
    v_add_f32 v8, v8, v112
    v_add_f32 v9, v9, v113
    v_add_f32 v10, v10, v114
    v_add_f32 v11, v11, v115
    v_add_f32 v8, v8, v116
    v_add_f32 v9, v9, v117
    v_add_f32 v10, v10, v118
    v_add_f32 v11, v11, v119
    s_waitcnt vmcnt(12)
    v_lshlrev_b32 v120, 16, v28
    v_and_b32 v121, 0xffff0000, v28
    v_lshlrev_b32 v122, 16, v29
    v_and_b32 v123, 0xffff0000, v29
    v_lshlrev_b32 v124, 16, v30
    v_and_b32 v125, 0xffff0000, v30
    v_lshlrev_b32 v126, 16, v31
    v_and_b32 v127, 0xffff0000, v31
    v_add_f32 v8, v8, v120
    v_add_f32 v9, v9, v121
    v_add_f32 v10, v10, v122
    v_add_f32 v11, v11, v123
    v_add_f32 v8, v8, v124
    v_add_f32 v9, v9, v125
    v_add_f32 v10, v10, v126
    v_add_f32 v11, v11, v127
    s_waitcnt vmcnt(11)
    v_lshlrev_b32 v128, 16, v32
    v_and_b32 v129, 0xffff0000, v32
    v_lshlrev_b32 v130, 16, v33
    v_and_b32 v131, 0xffff0000, v33
    v_lshlrev_b32 v132, 16, v34
    v_and_b32 v133, 0xffff0000, v34
    v_lshlrev_b32 v134, 16, v35
    v_and_b32 v135, 0xffff0000, v35
    v_add_f32 v8, v8, v128
    v_add_f32 v9, v9, v129
    v_add_f32 v10, v10, v130
    v_add_f32 v11, v11, v131
    v_add_f32 v8, v8, v132
    v_add_f32 v9, v9, v133
    v_add_f32 v10, v10, v134
    v_add_f32 v11, v11, v135
    s_waitcnt vmcnt(10)
    v_lshlrev_b32 v136, 16, v36
    v_and_b32 v137, 0xffff0000, v36
    v_lshlrev_b32 v138, 16, v37
    v_and_b32 v139, 0xffff0000, v37
    v_lshlrev_b32 v140, 16, v38
    v_and_b32 v141, 0xffff0000, v38
    v_lshlrev_b32 v142, 16, v39
    v_and_b32 v143, 0xffff0000, v39
    v_add_f32 v8, v8, v136
    v_add_f32 v9, v9, v137
    v_add_f32 v10, v10, v138
    v_add_f32 v11, v11, v139
    v_add_f32 v8, v8, v140
    v_add_f32 v9, v9, v141
    v_add_f32 v10, v10, v142
    v_add_f32 v11, v11, v143
    s_waitcnt vmcnt(9)
    v_lshlrev_b32 v144, 16, v40
    v_and_b32 v145, 0xffff0000, v40
    v_lshlrev_b32 v146, 16, v41
    v_and_b32 v147, 0xffff0000, v41
    v_lshlrev_b32 v148, 16, v42
    v_and_b32 v149, 0xffff0000, v42
    v_lshlrev_b32 v150, 16, v43
    v_and_b32 v151, 0xffff0000, v43
    v_add_f32 v8, v8, v144
    v_add_f32 v9, v9, v145
    v_add_f32 v10, v10, v146
    v_add_f32 v11, v11, v147
    v_add_f32 v8, v8, v148
    v_add_f32 v9, v9, v149
    v_add_f32 v10, v10, v150
    v_add_f32 v11, v11, v151
    s_waitcnt vmcnt(8)
    v_lshlrev_b32 v152, 16, v44
    v_and_b32 v153, 0xffff0000, v44
    v_lshlrev_b32 v154, 16, v45
    v_and_b32 v155, 0xffff0000, v45
    v_lshlrev_b32 v156, 16, v46
    v_and_b32 v157, 0xffff0000, v46
    v_lshlrev_b32 v158, 16, v47
    v_and_b32 v159, 0xffff0000, v47
    v_add_f32 v8, v8, v152
    v_add_f32 v9, v9, v153
    v_add_f32 v10, v10, v154
    v_add_f32 v11, v11, v155
    v_add_f32 v8, v8, v156
    v_add_f32 v9, v9, v157
    v_add_f32 v10, v10, v158
    v_add_f32 v11, v11, v159
    s_waitcnt vmcnt(7)
    v_lshlrev_b32 v160, 16, v48
    v_and_b32 v161, 0xffff0000, v48
    v_lshlrev_b32 v162, 16, v49
    v_and_b32 v163, 0xffff0000, v49
    v_lshlrev_b32 v164, 16, v50
    v_and_b32 v165, 0xffff0000, v50
    v_lshlrev_b32 v166, 16, v51
    v_and_b32 v167, 0xffff0000, v51
    v_add_f32 v8, v8, v160
    v_add_f32 v9, v9, v161
    v_add_f32 v10, v10, v162
    v_add_f32 v11, v11, v163
    v_add_f32 v8, v8, v164
    v_add_f32 v9, v9, v165
    v_add_f32 v10, v10, v166
    v_add_f32 v11, v11, v167
    s_waitcnt vmcnt(6)
    v_lshlrev_b32 v168, 16, v52
    v_and_b32 v169, 0xffff0000, v52
    v_lshlrev_b32 v170, 16, v53
    v_and_b32 v171, 0xffff0000, v53
    v_lshlrev_b32 v172, 16, v54
    v_and_b32 v173, 0xffff0000, v54
    v_lshlrev_b32 v174, 16, v55
    v_and_b32 v175, 0xffff0000, v55
    v_add_f32 v8, v8, v168
    v_add_f32 v9, v9, v169
    v_add_f32 v10, v10, v170
    v_add_f32 v11, v11, v171
    v_add_f32 v8, v8, v172
    v_add_f32 v9, v9, v173
    v_add_f32 v10, v10, v174
    v_add_f32 v11, v11, v175
    s_waitcnt vmcnt(5)
    v_lshlrev_b32 v176, 16, v56
    v_and_b32 v177, 0xffff0000, v56
    v_lshlrev_b32 v178, 16, v57
    v_and_b32 v179, 0xffff0000, v57
    v_lshlrev_b32 v180, 16, v58
    v_and_b32 v181, 0xffff0000, v58
    v_lshlrev_b32 v182, 16, v59
    v_and_b32 v183, 0xffff0000, v59
    v_add_f32 v8, v8, v176
    v_add_f32 v9, v9, v177
    v_add_f32 v10, v10, v178
    v_add_f32 v11, v11, v179
    v_add_f32 v8, v8, v180
    v_add_f32 v9, v9, v181
    v_add_f32 v10, v10, v182
    v_add_f32 v11, v11, v183
    s_waitcnt vmcnt(4)
    v_lshlrev_b32 v184, 16, v60
    v_and_b32 v185, 0xffff0000, v60
    v_lshlrev_b32 v186, 16, v61
    v_and_b32 v187, 0xffff0000, v61
    v_lshlrev_b32 v188, 16, v62
    v_and_b32 v189, 0xffff0000, v62
    v_lshlrev_b32 v190, 16, v63
    v_and_b32 v191, 0xffff0000, v63
    v_add_f32 v8, v8, v184
    v_add_f32 v9, v9, v185
    v_add_f32 v10, v10, v186
    v_add_f32 v11, v11, v187
    v_add_f32 v8, v8, v188
    v_add_f32 v9, v9, v189
    v_add_f32 v10, v10, v190
    v_add_f32 v11, v11, v191
    s_waitcnt vmcnt(3)
    v_lshlrev_b32 v192, 16, v64
    v_and_b32 v193, 0xffff0000, v64
    v_lshlrev_b32 v194, 16, v65
    v_and_b32 v195, 0xffff0000, v65
    v_lshlrev_b32 v196, 16, v66
    v_and_b32 v197, 0xffff0000, v66
    v_lshlrev_b32 v198, 16, v67
    v_and_b32 v199, 0xffff0000, v67
    v_add_f32 v8, v8, v192
    v_add_f32 v9, v9, v193
    v_add_f32 v10, v10, v194
    v_add_f32 v11, v11, v195
    v_add_f32 v8, v8, v196
    v_add_f32 v9, v9, v197
    v_add_f32 v10, v10, v198
    v_add_f32 v11, v11, v199
    s_waitcnt vmcnt(2)
    v_lshlrev_b32 v200, 16, v68
    v_and_b32 v201, 0xffff0000, v68
    v_lshlrev_b32 v202, 16, v69
    v_and_b32 v203, 0xffff0000, v69
    v_lshlrev_b32 v204, 16, v70
    v_and_b32 v205, 0xffff0000, v70
    v_lshlrev_b32 v206, 16, v71
    v_and_b32 v207, 0xffff0000, v71
    v_add_f32 v8, v8, v200
    v_add_f32 v9, v9, v201
    v_add_f32 v10, v10, v202
    v_add_f32 v11, v11, v203
    v_add_f32 v8, v8, v204
    v_add_f32 v9, v9, v205
    v_add_f32 v10, v10, v206
    v_add_f32 v11, v11, v207
    s_waitcnt vmcnt(1)
    v_lshlrev_b32 v208, 16, v72
    v_and_b32 v209, 0xffff0000, v72
    v_lshlrev_b32 v210, 16, v73
    v_and_b32 v211, 0xffff0000, v73
    v_lshlrev_b32 v212, 16, v74
    v_and_b32 v213, 0xffff0000, v74
    v_lshlrev_b32 v214, 16, v75
    v_and_b32 v215, 0xffff0000, v75
    v_add_f32 v8, v8, v208
    v_add_f32 v9, v9, v209
    v_add_f32 v10, v10, v210
    v_add_f32 v11, v11, v211
    v_add_f32 v8, v8, v212
    v_add_f32 v9, v9, v213
    v_add_f32 v10, v10, v214
    v_add_f32 v11, v11, v215
    s_waitcnt vmcnt(0)
    v_lshlrev_b32 v216, 16, v76
    v_and_b32 v217, 0xffff0000, v76
    v_lshlrev_b32 v218, 16, v77
    v_and_b32 v219, 0xffff0000, v77
    v_lshlrev_b32 v220, 16, v78
    v_and_b32 v221, 0xffff0000, v78
    v_lshlrev_b32 v222, 16, v79
    v_and_b32 v223, 0xffff0000, v79
    v_add_f32 v8, v8, v216
    v_add_f32 v9, v9, v217
    v_add_f32 v10, v10, v218
    v_add_f32 v11, v11, v219
    v_add_f32 v8, v8, v220
    v_add_f32 v9, v9, v221
    v_add_f32 v10, v10, v222
    v_add_f32 v11, v11, v223
    v_add_f32 v8, v8, v9
    v_add_f32 v10, v10, v11
    v_add_f32 v8, v8, v10
    v_mov_b32 v12, v8
    s_nop 1
    v_permlane32_swap_b32 v8, v12
    v_add_f32 v8, v8, v12
    v_mov_b32 v12, v8
    s_nop 1
    v_permlane16_swap_b32 v8, v12
    v_add_f32 v8, v8, v12
    v_mul_f32 v5, 0x3b000000, v8
    v_sub_f32 v12, v96, v5
    v_mul_f32 v8, v12, v12
    v_sub_f32 v13, v97, v5
    v_mul_f32 v9, v13, v13
    v_sub_f32 v14, v98, v5
    v_mul_f32 v10, v14, v14
    v_sub_f32 v15, v99, v5
    v_mul_f32 v11, v15, v15
    v_sub_f32 v12, v100, v5
    v_fmac_f32 v8, v12, v12
    v_sub_f32 v13, v101, v5
    v_fmac_f32 v9, v13, v13
    v_sub_f32 v14, v102, v5
    v_fmac_f32 v10, v14, v14
    v_sub_f32 v15, v103, v5
    v_fmac_f32 v11, v15, v15
    v_sub_f32 v12, v104, v5
    v_fmac_f32 v8, v12, v12
    v_sub_f32 v13, v105, v5
    v_fmac_f32 v9, v13, v13
    v_sub_f32 v14, v106, v5
    v_fmac_f32 v10, v14, v14
    v_sub_f32 v15, v107, v5
    v_fmac_f32 v11, v15, v15
    v_sub_f32 v12, v108, v5
    v_fmac_f32 v8, v12, v12
    v_sub_f32 v13, v109, v5
    v_fmac_f32 v9, v13, v13
    v_sub_f32 v14, v110, v5
    v_fmac_f32 v10, v14, v14
    v_sub_f32 v15, v111, v5
    v_fmac_f32 v11, v15, v15
    v_sub_f32 v12, v112, v5
    v_fmac_f32 v8, v12, v12
    v_sub_f32 v13, v113, v5
    v_fmac_f32 v9, v13, v13
    v_sub_f32 v14, v114, v5
    v_fmac_f32 v10, v14, v14
    v_sub_f32 v15, v115, v5
    v_fmac_f32 v11, v15, v15
    v_sub_f32 v12, v116, v5
    v_fmac_f32 v8, v12, v12
    v_sub_f32 v13, v117, v5
    v_fmac_f32 v9, v13, v13
    v_sub_f32 v14, v118, v5
    v_fmac_f32 v10, v14, v14
    v_sub_f32 v15, v119, v5
    v_fmac_f32 v11, v15, v15
    v_sub_f32 v12, v120, v5
    v_fmac_f32 v8, v12, v12
    v_sub_f32 v13, v121, v5
    v_fmac_f32 v9, v13, v13
    v_sub_f32 v14, v122, v5
    v_fmac_f32 v10, v14, v14
    v_sub_f32 v15, v123, v5
    v_fmac_f32 v11, v15, v15
    v_sub_f32 v12, v124, v5
    v_fmac_f32 v8, v12, v12
    v_sub_f32 v13, v125, v5
    v_fmac_f32 v9, v13, v13
    v_sub_f32 v14, v126, v5
    v_fmac_f32 v10, v14, v14
    v_sub_f32 v15, v127, v5
    v_fmac_f32 v11, v15, v15
    v_sub_f32 v12, v128, v5
    v_fmac_f32 v8, v12, v12
    v_sub_f32 v13, v129, v5
    v_fmac_f32 v9, v13, v13
    v_sub_f32 v14, v130, v5
    v_fmac_f32 v10, v14, v14
    v_sub_f32 v15, v131, v5
    v_fmac_f32 v11, v15, v15
    v_sub_f32 v12, v132, v5
    v_fmac_f32 v8, v12, v12
    v_sub_f32 v13, v133, v5
    v_fmac_f32 v9, v13, v13
    v_sub_f32 v14, v134, v5
    v_fmac_f32 v10, v14, v14
    v_sub_f32 v15, v135, v5
    v_fmac_f32 v11, v15, v15
    v_sub_f32 v12, v136, v5
    v_fmac_f32 v8, v12, v12
    v_sub_f32 v13, v137, v5
    v_fmac_f32 v9, v13, v13
    v_sub_f32 v14, v138, v5
    v_fmac_f32 v10, v14, v14
    v_sub_f32 v15, v139, v5
    v_fmac_f32 v11, v15, v15
    v_sub_f32 v12, v140, v5
    v_fmac_f32 v8, v12, v12
    v_sub_f32 v13, v141, v5
    v_fmac_f32 v9, v13, v13
    v_sub_f32 v14, v142, v5
    v_fmac_f32 v10, v14, v14
    v_sub_f32 v15, v143, v5
    v_fmac_f32 v11, v15, v15
    v_sub_f32 v12, v144, v5
    v_fmac_f32 v8, v12, v12
    v_sub_f32 v13, v145, v5
    v_fmac_f32 v9, v13, v13
    v_sub_f32 v14, v146, v5
    v_fmac_f32 v10, v14, v14
    v_sub_f32 v15, v147, v5
    v_fmac_f32 v11, v15, v15
    v_sub_f32 v12, v148, v5
    v_fmac_f32 v8, v12, v12
    v_sub_f32 v13, v149, v5
    v_fmac_f32 v9, v13, v13
    v_sub_f32 v14, v150, v5
    v_fmac_f32 v10, v14, v14
    v_sub_f32 v15, v151, v5
    v_fmac_f32 v11, v15, v15
    v_sub_f32 v12, v152, v5
    v_fmac_f32 v8, v12, v12
    v_sub_f32 v13, v153, v5
    v_fmac_f32 v9, v13, v13
    v_sub_f32 v14, v154, v5
    v_fmac_f32 v10, v14, v14
    v_sub_f32 v15, v155, v5
    v_fmac_f32 v11, v15, v15
    v_sub_f32 v12, v156, v5
    v_fmac_f32 v8, v12, v12
    v_sub_f32 v13, v157, v5
    v_fmac_f32 v9, v13, v13
    v_sub_f32 v14, v158, v5
    v_fmac_f32 v10, v14, v14
    v_sub_f32 v15, v159, v5
    v_fmac_f32 v11, v15, v15
    v_sub_f32 v12, v160, v5
    v_fmac_f32 v8, v12, v12
    v_sub_f32 v13, v161, v5
    v_fmac_f32 v9, v13, v13
    v_sub_f32 v14, v162, v5
    v_fmac_f32 v10, v14, v14
    v_sub_f32 v15, v163, v5
    v_fmac_f32 v11, v15, v15
    v_sub_f32 v12, v164, v5
    v_fmac_f32 v8, v12, v12
    v_sub_f32 v13, v165, v5
    v_fmac_f32 v9, v13, v13
    v_sub_f32 v14, v166, v5
    v_fmac_f32 v10, v14, v14
    v_sub_f32 v15, v167, v5
    v_fmac_f32 v11, v15, v15
    v_sub_f32 v12, v168, v5
    v_fmac_f32 v8, v12, v12
    v_sub_f32 v13, v169, v5
    v_fmac_f32 v9, v13, v13
    v_sub_f32 v14, v170, v5
    v_fmac_f32 v10, v14, v14
    v_sub_f32 v15, v171, v5
    v_fmac_f32 v11, v15, v15
    v_sub_f32 v12, v172, v5
    v_fmac_f32 v8, v12, v12
    v_sub_f32 v13, v173, v5
    v_fmac_f32 v9, v13, v13
    v_sub_f32 v14, v174, v5
    v_fmac_f32 v10, v14, v14
    v_sub_f32 v15, v175, v5
    v_fmac_f32 v11, v15, v15
    v_sub_f32 v12, v176, v5
    v_fmac_f32 v8, v12, v12
    v_sub_f32 v13, v177, v5
    v_fmac_f32 v9, v13, v13
    v_sub_f32 v14, v178, v5
    v_fmac_f32 v10, v14, v14
    v_sub_f32 v15, v179, v5
    v_fmac_f32 v11, v15, v15
    v_sub_f32 v12, v180, v5
    v_fmac_f32 v8, v12, v12
    v_sub_f32 v13, v181, v5
    v_fmac_f32 v9, v13, v13
    v_sub_f32 v14, v182, v5
    v_fmac_f32 v10, v14, v14
    v_sub_f32 v15, v183, v5
    v_fmac_f32 v11, v15, v15
    v_sub_f32 v12, v184, v5
    v_fmac_f32 v8, v12, v12
    v_sub_f32 v13, v185, v5
    v_fmac_f32 v9, v13, v13
    v_sub_f32 v14, v186, v5
    v_fmac_f32 v10, v14, v14
    v_sub_f32 v15, v187, v5
    v_fmac_f32 v11, v15, v15
    v_sub_f32 v12, v188, v5
    v_fmac_f32 v8, v12, v12
    v_sub_f32 v13, v189, v5
    v_fmac_f32 v9, v13, v13
    v_sub_f32 v14, v190, v5
    v_fmac_f32 v10, v14, v14
    v_sub_f32 v15, v191, v5
    v_fmac_f32 v11, v15, v15
    v_sub_f32 v12, v192, v5
    v_fmac_f32 v8, v12, v12
    v_sub_f32 v13, v193, v5
    v_fmac_f32 v9, v13, v13
    v_sub_f32 v14, v194, v5
    v_fmac_f32 v10, v14, v14
    v_sub_f32 v15, v195, v5
    v_fmac_f32 v11, v15, v15
    v_sub_f32 v12, v196, v5
    v_fmac_f32 v8, v12, v12
    v_sub_f32 v13, v197, v5
    v_fmac_f32 v9, v13, v13
    v_sub_f32 v14, v198, v5
    v_fmac_f32 v10, v14, v14
    v_sub_f32 v15, v199, v5
    v_fmac_f32 v11, v15, v15
    v_sub_f32 v12, v200, v5
    v_fmac_f32 v8, v12, v12
    v_sub_f32 v13, v201, v5
    v_fmac_f32 v9, v13, v13
    v_sub_f32 v14, v202, v5
    v_fmac_f32 v10, v14, v14
    v_sub_f32 v15, v203, v5
    v_fmac_f32 v11, v15, v15
    v_sub_f32 v12, v204, v5
    v_fmac_f32 v8, v12, v12
    v_sub_f32 v13, v205, v5
    v_fmac_f32 v9, v13, v13
    v_sub_f32 v14, v206, v5
    v_fmac_f32 v10, v14, v14
    v_sub_f32 v15, v207, v5
    v_fmac_f32 v11, v15, v15
    v_sub_f32 v12, v208, v5
    v_fmac_f32 v8, v12, v12
    v_sub_f32 v13, v209, v5
    v_fmac_f32 v9, v13, v13
    v_sub_f32 v14, v210, v5
    v_fmac_f32 v10, v14, v14
    v_sub_f32 v15, v211, v5
    v_fmac_f32 v11, v15, v15
    v_sub_f32 v12, v212, v5
    v_fmac_f32 v8, v12, v12
    v_sub_f32 v13, v213, v5
    v_fmac_f32 v9, v13, v13
    v_sub_f32 v14, v214, v5
    v_fmac_f32 v10, v14, v14
    v_sub_f32 v15, v215, v5
    v_fmac_f32 v11, v15, v15
    v_sub_f32 v12, v216, v5
    v_fmac_f32 v8, v12, v12
    v_sub_f32 v13, v217, v5
    v_fmac_f32 v9, v13, v13
    v_sub_f32 v14, v218, v5
    v_fmac_f32 v10, v14, v14
    v_sub_f32 v15, v219, v5
    v_fmac_f32 v11, v15, v15
    v_sub_f32 v12, v220, v5
    v_fmac_f32 v8, v12, v12
    v_sub_f32 v13, v221, v5
    v_fmac_f32 v9, v13, v13
    v_sub_f32 v14, v222, v5
    v_fmac_f32 v10, v14, v14
    v_sub_f32 v15, v223, v5
    v_fmac_f32 v11, v15, v15
    v_add_f32 v8, v8, v9
    v_add_f32 v10, v10, v11
    v_add_f32 v8, v8, v10
    v_mov_b32 v12, v8
    s_nop 1
    v_permlane32_swap_b32 v8, v12
    v_add_f32 v8, v8, v12
    v_mov_b32 v12, v8
    s_nop 1
    v_permlane16_swap_b32 v8, v12
    v_add_f32 v8, v8, v12
    v_mul_f32 v8, 0x3b000000, v8
    v_cvt_pk_bf16_f32 v12, v5, v8
    v_lshlrev_b32 v6, 16, v12
    v_and_b32 v7, 0xffff0000, v12
    v_add_f32 v7, 0x3727c5ac, v7
    v_cvt_pk_bf16_f32 v12, v7, v7
    v_lshlrev_b32 v7, 16, v12
    v_and_b32 v8, 0xffff0000, v12
    v_sqrt_f32 v7, v7
    s_nop 0
    v_cvt_pk_bf16_f32 v12, v7, v7
    v_lshlrev_b32 v7, 16, v12
    v_and_b32 v8, 0xffff0000, v12
    v_rcp_f32 v13, v7
    v_lshlrev_b32 v4, 4, v0
    s_add_u32 s67, s67, 0x100000
    v_sub_f32 v96, v96, v6
    v_sub_f32 v97, v97, v6
    v_cvt_pk_bf16_f32 v12, v96, v97
    v_lshlrev_b32 v96, 16, v12
    v_and_b32 v97, 0xffff0000, v12
    v_mul_f32 v96, v96, v13
    v_mul_f32 v97, v97, v13
    v_sub_f32 v98, v98, v6
    v_sub_f32 v99, v99, v6
    v_cvt_pk_bf16_f32 v12, v98, v99
    v_lshlrev_b32 v98, 16, v12
    v_and_b32 v99, 0xffff0000, v12
    v_mul_f32 v98, v98, v13
    v_mul_f32 v99, v99, v13
    v_sub_f32 v100, v100, v6
    v_sub_f32 v101, v101, v6
    v_cvt_pk_bf16_f32 v12, v100, v101
    v_lshlrev_b32 v100, 16, v12
    v_and_b32 v101, 0xffff0000, v12
    v_mul_f32 v100, v100, v13
    v_mul_f32 v101, v101, v13
    v_sub_f32 v102, v102, v6
    v_sub_f32 v103, v103, v6
    v_cvt_pk_bf16_f32 v12, v102, v103
    v_lshlrev_b32 v102, 16, v12
    v_and_b32 v103, 0xffff0000, v12
    v_mul_f32 v102, v102, v13
    v_mul_f32 v103, v103, v13
    v_sub_f32 v104, v104, v6
    v_sub_f32 v105, v105, v6
    v_cvt_pk_bf16_f32 v12, v104, v105
    v_lshlrev_b32 v104, 16, v12
    v_and_b32 v105, 0xffff0000, v12
    v_mul_f32 v104, v104, v13
    v_mul_f32 v105, v105, v13
    v_sub_f32 v106, v106, v6
    v_sub_f32 v107, v107, v6
    v_cvt_pk_bf16_f32 v12, v106, v107
    v_lshlrev_b32 v106, 16, v12
    v_and_b32 v107, 0xffff0000, v12
    v_mul_f32 v106, v106, v13
    v_mul_f32 v107, v107, v13
    v_sub_f32 v108, v108, v6
    v_sub_f32 v109, v109, v6
    v_cvt_pk_bf16_f32 v12, v108, v109
    v_lshlrev_b32 v108, 16, v12
    v_and_b32 v109, 0xffff0000, v12
    v_mul_f32 v108, v108, v13
    v_mul_f32 v109, v109, v13
    v_sub_f32 v110, v110, v6
    v_sub_f32 v111, v111, v6
    v_cvt_pk_bf16_f32 v12, v110, v111
    v_lshlrev_b32 v110, 16, v12
    v_and_b32 v111, 0xffff0000, v12
    v_mul_f32 v110, v110, v13
    v_mul_f32 v111, v111, v13
    v_cvt_pk_bf16_f32 v16, v96, v104
    v_cvt_pk_bf16_f32 v17, v98, v106
    v_cvt_pk_bf16_f32 v18, v100, v108
    v_cvt_pk_bf16_f32 v19, v102, v110
    s_add_u32 s68, s67, 0
    buffer_store_dwordx4 v[16:19], v4, s[8:11], s68 offen sc1
    v_cvt_pk_bf16_f32 v20, v97, v105
    v_cvt_pk_bf16_f32 v21, v99, v107
    v_cvt_pk_bf16_f32 v22, v101, v109
    v_cvt_pk_bf16_f32 v23, v103, v111
    s_add_u32 s68, s67, 1024
    buffer_store_dwordx4 v[20:23], v4, s[8:11], s68 offen sc1
    v_sub_f32 v112, v112, v6
    v_sub_f32 v113, v113, v6
    v_cvt_pk_bf16_f32 v12, v112, v113
    v_lshlrev_b32 v112, 16, v12
    v_and_b32 v113, 0xffff0000, v12
    v_mul_f32 v112, v112, v13
    v_mul_f32 v113, v113, v13
    v_sub_f32 v114, v114, v6
    v_sub_f32 v115, v115, v6
    v_cvt_pk_bf16_f32 v12, v114, v115
    v_lshlrev_b32 v114, 16, v12
    v_and_b32 v115, 0xffff0000, v12
    v_mul_f32 v114, v114, v13
    v_mul_f32 v115, v115, v13
    v_sub_f32 v116, v116, v6
    v_sub_f32 v117, v117, v6
    v_cvt_pk_bf16_f32 v12, v116, v117
    v_lshlrev_b32 v116, 16, v12
    v_and_b32 v117, 0xffff0000, v12
    v_mul_f32 v116, v116, v13
    v_mul_f32 v117, v117, v13
    v_sub_f32 v118, v118, v6
    v_sub_f32 v119, v119, v6
    v_cvt_pk_bf16_f32 v12, v118, v119
    v_lshlrev_b32 v118, 16, v12
    v_and_b32 v119, 0xffff0000, v12
    v_mul_f32 v118, v118, v13
    v_mul_f32 v119, v119, v13
    v_sub_f32 v120, v120, v6
    v_sub_f32 v121, v121, v6
    v_cvt_pk_bf16_f32 v12, v120, v121
    v_lshlrev_b32 v120, 16, v12
    v_and_b32 v121, 0xffff0000, v12
    v_mul_f32 v120, v120, v13
    v_mul_f32 v121, v121, v13
    v_sub_f32 v122, v122, v6
    v_sub_f32 v123, v123, v6
    v_cvt_pk_bf16_f32 v12, v122, v123
    v_lshlrev_b32 v122, 16, v12
    v_and_b32 v123, 0xffff0000, v12
    v_mul_f32 v122, v122, v13
    v_mul_f32 v123, v123, v13
    v_sub_f32 v124, v124, v6
    v_sub_f32 v125, v125, v6
    v_cvt_pk_bf16_f32 v12, v124, v125
    v_lshlrev_b32 v124, 16, v12
    v_and_b32 v125, 0xffff0000, v12
    v_mul_f32 v124, v124, v13
    v_mul_f32 v125, v125, v13
    v_sub_f32 v126, v126, v6
    v_sub_f32 v127, v127, v6
    v_cvt_pk_bf16_f32 v12, v126, v127
    v_lshlrev_b32 v126, 16, v12
    v_and_b32 v127, 0xffff0000, v12
    v_mul_f32 v126, v126, v13
    v_mul_f32 v127, v127, v13
    v_cvt_pk_bf16_f32 v24, v112, v120
    v_cvt_pk_bf16_f32 v25, v114, v122
    v_cvt_pk_bf16_f32 v26, v116, v124
    v_cvt_pk_bf16_f32 v27, v118, v126
    s_add_u32 s68, s67, 2048
    buffer_store_dwordx4 v[24:27], v4, s[8:11], s68 offen sc1
    v_cvt_pk_bf16_f32 v28, v113, v121
    v_cvt_pk_bf16_f32 v29, v115, v123
    v_cvt_pk_bf16_f32 v30, v117, v125
    v_cvt_pk_bf16_f32 v31, v119, v127
    s_add_u32 s68, s67, 3072
    buffer_store_dwordx4 v[28:31], v4, s[8:11], s68 offen sc1
    v_sub_f32 v128, v128, v6
    v_sub_f32 v129, v129, v6
    v_cvt_pk_bf16_f32 v12, v128, v129
    v_lshlrev_b32 v128, 16, v12
    v_and_b32 v129, 0xffff0000, v12
    v_mul_f32 v128, v128, v13
    v_mul_f32 v129, v129, v13
    v_sub_f32 v130, v130, v6
    v_sub_f32 v131, v131, v6
    v_cvt_pk_bf16_f32 v12, v130, v131
    v_lshlrev_b32 v130, 16, v12
    v_and_b32 v131, 0xffff0000, v12
    v_mul_f32 v130, v130, v13
    v_mul_f32 v131, v131, v13
    v_sub_f32 v132, v132, v6
    v_sub_f32 v133, v133, v6
    v_cvt_pk_bf16_f32 v12, v132, v133
    v_lshlrev_b32 v132, 16, v12
    v_and_b32 v133, 0xffff0000, v12
    v_mul_f32 v132, v132, v13
    v_mul_f32 v133, v133, v13
    v_sub_f32 v134, v134, v6
    v_sub_f32 v135, v135, v6
    v_cvt_pk_bf16_f32 v12, v134, v135
    v_lshlrev_b32 v134, 16, v12
    v_and_b32 v135, 0xffff0000, v12
    v_mul_f32 v134, v134, v13
    v_mul_f32 v135, v135, v13
    v_sub_f32 v136, v136, v6
    v_sub_f32 v137, v137, v6
    v_cvt_pk_bf16_f32 v12, v136, v137
    v_lshlrev_b32 v136, 16, v12
    v_and_b32 v137, 0xffff0000, v12
    v_mul_f32 v136, v136, v13
    v_mul_f32 v137, v137, v13
    v_sub_f32 v138, v138, v6
    v_sub_f32 v139, v139, v6
    v_cvt_pk_bf16_f32 v12, v138, v139
    v_lshlrev_b32 v138, 16, v12
    v_and_b32 v139, 0xffff0000, v12
    v_mul_f32 v138, v138, v13
    v_mul_f32 v139, v139, v13
    v_sub_f32 v140, v140, v6
    v_sub_f32 v141, v141, v6
    v_cvt_pk_bf16_f32 v12, v140, v141
    v_lshlrev_b32 v140, 16, v12
    v_and_b32 v141, 0xffff0000, v12
    v_mul_f32 v140, v140, v13
    v_mul_f32 v141, v141, v13
    v_sub_f32 v142, v142, v6
    v_sub_f32 v143, v143, v6
    v_cvt_pk_bf16_f32 v12, v142, v143
    v_lshlrev_b32 v142, 16, v12
    v_and_b32 v143, 0xffff0000, v12
    v_mul_f32 v142, v142, v13
    v_mul_f32 v143, v143, v13
    v_cvt_pk_bf16_f32 v32, v128, v136
    v_cvt_pk_bf16_f32 v33, v130, v138
    v_cvt_pk_bf16_f32 v34, v132, v140
    v_cvt_pk_bf16_f32 v35, v134, v142
    s_add_u32 s68, s67, 4096
    buffer_store_dwordx4 v[32:35], v4, s[8:11], s68 offen sc1
    v_cvt_pk_bf16_f32 v36, v129, v137
    v_cvt_pk_bf16_f32 v37, v131, v139
    v_cvt_pk_bf16_f32 v38, v133, v141
    v_cvt_pk_bf16_f32 v39, v135, v143
    s_add_u32 s68, s67, 5120
    buffer_store_dwordx4 v[36:39], v4, s[8:11], s68 offen sc1
    v_sub_f32 v144, v144, v6
    v_sub_f32 v145, v145, v6
    v_cvt_pk_bf16_f32 v12, v144, v145
    v_lshlrev_b32 v144, 16, v12
    v_and_b32 v145, 0xffff0000, v12
    v_mul_f32 v144, v144, v13
    v_mul_f32 v145, v145, v13
    v_sub_f32 v146, v146, v6
    v_sub_f32 v147, v147, v6
    v_cvt_pk_bf16_f32 v12, v146, v147
    v_lshlrev_b32 v146, 16, v12
    v_and_b32 v147, 0xffff0000, v12
    v_mul_f32 v146, v146, v13
    v_mul_f32 v147, v147, v13
    v_sub_f32 v148, v148, v6
    v_sub_f32 v149, v149, v6
    v_cvt_pk_bf16_f32 v12, v148, v149
    v_lshlrev_b32 v148, 16, v12
    v_and_b32 v149, 0xffff0000, v12
    v_mul_f32 v148, v148, v13
    v_mul_f32 v149, v149, v13
    v_sub_f32 v150, v150, v6
    v_sub_f32 v151, v151, v6
    v_cvt_pk_bf16_f32 v12, v150, v151
    v_lshlrev_b32 v150, 16, v12
    v_and_b32 v151, 0xffff0000, v12
    v_mul_f32 v150, v150, v13
    v_mul_f32 v151, v151, v13
    v_sub_f32 v152, v152, v6
    v_sub_f32 v153, v153, v6
    v_cvt_pk_bf16_f32 v12, v152, v153
    v_lshlrev_b32 v152, 16, v12
    v_and_b32 v153, 0xffff0000, v12
    v_mul_f32 v152, v152, v13
    v_mul_f32 v153, v153, v13
    v_sub_f32 v154, v154, v6
    v_sub_f32 v155, v155, v6
    v_cvt_pk_bf16_f32 v12, v154, v155
    v_lshlrev_b32 v154, 16, v12
    v_and_b32 v155, 0xffff0000, v12
    v_mul_f32 v154, v154, v13
    v_mul_f32 v155, v155, v13
    v_sub_f32 v156, v156, v6
    v_sub_f32 v157, v157, v6
    v_cvt_pk_bf16_f32 v12, v156, v157
    v_lshlrev_b32 v156, 16, v12
    v_and_b32 v157, 0xffff0000, v12
    v_mul_f32 v156, v156, v13
    v_mul_f32 v157, v157, v13
    v_sub_f32 v158, v158, v6
    v_sub_f32 v159, v159, v6
    v_cvt_pk_bf16_f32 v12, v158, v159
    v_lshlrev_b32 v158, 16, v12
    v_and_b32 v159, 0xffff0000, v12
    v_mul_f32 v158, v158, v13
    v_mul_f32 v159, v159, v13
    v_cvt_pk_bf16_f32 v40, v144, v152
    v_cvt_pk_bf16_f32 v41, v146, v154
    v_cvt_pk_bf16_f32 v42, v148, v156
    v_cvt_pk_bf16_f32 v43, v150, v158
    s_add_u32 s68, s67, 6144
    buffer_store_dwordx4 v[40:43], v4, s[8:11], s68 offen sc1
    v_cvt_pk_bf16_f32 v44, v145, v153
    v_cvt_pk_bf16_f32 v45, v147, v155
    v_cvt_pk_bf16_f32 v46, v149, v157
    v_cvt_pk_bf16_f32 v47, v151, v159
    s_add_u32 s68, s67, 7168
    buffer_store_dwordx4 v[44:47], v4, s[8:11], s68 offen sc1
L_ln_hi:
    v_sub_f32 v160, v160, v6
    v_sub_f32 v161, v161, v6
    v_cvt_pk_bf16_f32 v12, v160, v161
    v_lshlrev_b32 v160, 16, v12
    v_and_b32 v161, 0xffff0000, v12
    v_mul_f32 v160, v160, v13
    v_mul_f32 v161, v161, v13
    v_sub_f32 v162, v162, v6
    v_sub_f32 v163, v163, v6
    v_cvt_pk_bf16_f32 v12, v162, v163
    v_lshlrev_b32 v162, 16, v12
    v_and_b32 v163, 0xffff0000, v12
    v_mul_f32 v162, v162, v13
    v_mul_f32 v163, v163, v13
    v_sub_f32 v164, v164, v6
    v_sub_f32 v165, v165, v6
    v_cvt_pk_bf16_f32 v12, v164, v165
    v_lshlrev_b32 v164, 16, v12
    v_and_b32 v165, 0xffff0000, v12
    v_mul_f32 v164, v164, v13
    v_mul_f32 v165, v165, v13
    v_sub_f32 v166, v166, v6
    v_sub_f32 v167, v167, v6
    v_cvt_pk_bf16_f32 v12, v166, v167
    v_lshlrev_b32 v166, 16, v12
    v_and_b32 v167, 0xffff0000, v12
    v_mul_f32 v166, v166, v13
    v_mul_f32 v167, v167, v13
    v_sub_f32 v168, v168, v6
    v_sub_f32 v169, v169, v6
    v_cvt_pk_bf16_f32 v12, v168, v169
    v_lshlrev_b32 v168, 16, v12
    v_and_b32 v169, 0xffff0000, v12
    v_mul_f32 v168, v168, v13
    v_mul_f32 v169, v169, v13
    v_sub_f32 v170, v170, v6
    v_sub_f32 v171, v171, v6
    v_cvt_pk_bf16_f32 v12, v170, v171
    v_lshlrev_b32 v170, 16, v12
    v_and_b32 v171, 0xffff0000, v12
    v_mul_f32 v170, v170, v13
    v_mul_f32 v171, v171, v13
    v_sub_f32 v172, v172, v6
    v_sub_f32 v173, v173, v6
    v_cvt_pk_bf16_f32 v12, v172, v173
    v_lshlrev_b32 v172, 16, v12
    v_and_b32 v173, 0xffff0000, v12
    v_mul_f32 v172, v172, v13
    v_mul_f32 v173, v173, v13
    v_sub_f32 v174, v174, v6
    v_sub_f32 v175, v175, v6
    v_cvt_pk_bf16_f32 v12, v174, v175
    v_lshlrev_b32 v174, 16, v12
    v_and_b32 v175, 0xffff0000, v12
    v_mul_f32 v174, v174, v13
    v_mul_f32 v175, v175, v13
    v_cvt_pk_bf16_f32 v48, v160, v168
    v_cvt_pk_bf16_f32 v49, v162, v170
    v_cvt_pk_bf16_f32 v50, v164, v172
    v_cvt_pk_bf16_f32 v51, v166, v174
    s_add_u32 s68, s67, 8192
    buffer_store_dwordx4 v[48:51], v4, s[8:11], s68 offen sc1
    v_cvt_pk_bf16_f32 v52, v161, v169
    v_cvt_pk_bf16_f32 v53, v163, v171
    v_cvt_pk_bf16_f32 v54, v165, v173
    v_cvt_pk_bf16_f32 v55, v167, v175
    s_add_u32 s68, s67, 9216
    buffer_store_dwordx4 v[52:55], v4, s[8:11], s68 offen sc1
    v_sub_f32 v176, v176, v6
    v_sub_f32 v177, v177, v6
    v_cvt_pk_bf16_f32 v12, v176, v177
    v_lshlrev_b32 v176, 16, v12
    v_and_b32 v177, 0xffff0000, v12
    v_mul_f32 v176, v176, v13
    v_mul_f32 v177, v177, v13
    v_sub_f32 v178, v178, v6
    v_sub_f32 v179, v179, v6
    v_cvt_pk_bf16_f32 v12, v178, v179
    v_lshlrev_b32 v178, 16, v12
    v_and_b32 v179, 0xffff0000, v12
    v_mul_f32 v178, v178, v13
    v_mul_f32 v179, v179, v13
    v_sub_f32 v180, v180, v6
    v_sub_f32 v181, v181, v6
    v_cvt_pk_bf16_f32 v12, v180, v181
    v_lshlrev_b32 v180, 16, v12
    v_and_b32 v181, 0xffff0000, v12
    v_mul_f32 v180, v180, v13
    v_mul_f32 v181, v181, v13
    v_sub_f32 v182, v182, v6
    v_sub_f32 v183, v183, v6
    v_cvt_pk_bf16_f32 v12, v182, v183
    v_lshlrev_b32 v182, 16, v12
    v_and_b32 v183, 0xffff0000, v12
    v_mul_f32 v182, v182, v13
    v_mul_f32 v183, v183, v13
    v_sub_f32 v184, v184, v6
    v_sub_f32 v185, v185, v6
    v_cvt_pk_bf16_f32 v12, v184, v185
    v_lshlrev_b32 v184, 16, v12
    v_and_b32 v185, 0xffff0000, v12
    v_mul_f32 v184, v184, v13
    v_mul_f32 v185, v185, v13
    v_sub_f32 v186, v186, v6
    v_sub_f32 v187, v187, v6
    v_cvt_pk_bf16_f32 v12, v186, v187
    v_lshlrev_b32 v186, 16, v12
    v_and_b32 v187, 0xffff0000, v12
    v_mul_f32 v186, v186, v13
    v_mul_f32 v187, v187, v13
    v_sub_f32 v188, v188, v6
    v_sub_f32 v189, v189, v6
    v_cvt_pk_bf16_f32 v12, v188, v189
    v_lshlrev_b32 v188, 16, v12
    v_and_b32 v189, 0xffff0000, v12
    v_mul_f32 v188, v188, v13
    v_mul_f32 v189, v189, v13
    v_sub_f32 v190, v190, v6
    v_sub_f32 v191, v191, v6
    v_cvt_pk_bf16_f32 v12, v190, v191
    v_lshlrev_b32 v190, 16, v12
    v_and_b32 v191, 0xffff0000, v12
    v_mul_f32 v190, v190, v13
    v_mul_f32 v191, v191, v13
    v_cvt_pk_bf16_f32 v56, v176, v184
    v_cvt_pk_bf16_f32 v57, v178, v186
    v_cvt_pk_bf16_f32 v58, v180, v188
    v_cvt_pk_bf16_f32 v59, v182, v190
    s_add_u32 s68, s67, 10240
    buffer_store_dwordx4 v[56:59], v4, s[8:11], s68 offen sc1
    v_cvt_pk_bf16_f32 v60, v177, v185
    v_cvt_pk_bf16_f32 v61, v179, v187
    v_cvt_pk_bf16_f32 v62, v181, v189
    v_cvt_pk_bf16_f32 v63, v183, v191
    s_add_u32 s68, s67, 11264
    buffer_store_dwordx4 v[60:63], v4, s[8:11], s68 offen sc1
    v_sub_f32 v192, v192, v6
    v_sub_f32 v193, v193, v6
    v_cvt_pk_bf16_f32 v12, v192, v193
    v_lshlrev_b32 v192, 16, v12
    v_and_b32 v193, 0xffff0000, v12
    v_mul_f32 v192, v192, v13
    v_mul_f32 v193, v193, v13
    v_sub_f32 v194, v194, v6
    v_sub_f32 v195, v195, v6
    v_cvt_pk_bf16_f32 v12, v194, v195
    v_lshlrev_b32 v194, 16, v12
    v_and_b32 v195, 0xffff0000, v12
    v_mul_f32 v194, v194, v13
    v_mul_f32 v195, v195, v13
    v_sub_f32 v196, v196, v6
    v_sub_f32 v197, v197, v6
    v_cvt_pk_bf16_f32 v12, v196, v197
    v_lshlrev_b32 v196, 16, v12
    v_and_b32 v197, 0xffff0000, v12
    v_mul_f32 v196, v196, v13
    v_mul_f32 v197, v197, v13
    v_sub_f32 v198, v198, v6
    v_sub_f32 v199, v199, v6
    v_cvt_pk_bf16_f32 v12, v198, v199
    v_lshlrev_b32 v198, 16, v12
    v_and_b32 v199, 0xffff0000, v12
    v_mul_f32 v198, v198, v13
    v_mul_f32 v199, v199, v13
    v_sub_f32 v200, v200, v6
    v_sub_f32 v201, v201, v6
    v_cvt_pk_bf16_f32 v12, v200, v201
    v_lshlrev_b32 v200, 16, v12
    v_and_b32 v201, 0xffff0000, v12
    v_mul_f32 v200, v200, v13
    v_mul_f32 v201, v201, v13
    v_sub_f32 v202, v202, v6
    v_sub_f32 v203, v203, v6
    v_cvt_pk_bf16_f32 v12, v202, v203
    v_lshlrev_b32 v202, 16, v12
    v_and_b32 v203, 0xffff0000, v12
    v_mul_f32 v202, v202, v13
    v_mul_f32 v203, v203, v13
    v_sub_f32 v204, v204, v6
    v_sub_f32 v205, v205, v6
    v_cvt_pk_bf16_f32 v12, v204, v205
    v_lshlrev_b32 v204, 16, v12
    v_and_b32 v205, 0xffff0000, v12
    v_mul_f32 v204, v204, v13
    v_mul_f32 v205, v205, v13
    v_sub_f32 v206, v206, v6
    v_sub_f32 v207, v207, v6
    v_cvt_pk_bf16_f32 v12, v206, v207
    v_lshlrev_b32 v206, 16, v12
    v_and_b32 v207, 0xffff0000, v12
    v_mul_f32 v206, v206, v13
    v_mul_f32 v207, v207, v13
    v_cvt_pk_bf16_f32 v64, v192, v200
    v_cvt_pk_bf16_f32 v65, v194, v202
    v_cvt_pk_bf16_f32 v66, v196, v204
    v_cvt_pk_bf16_f32 v67, v198, v206
    s_add_u32 s68, s67, 12288
    buffer_store_dwordx4 v[64:67], v4, s[8:11], s68 offen sc1
    v_cvt_pk_bf16_f32 v68, v193, v201
    v_cvt_pk_bf16_f32 v69, v195, v203
    v_cvt_pk_bf16_f32 v70, v197, v205
    v_cvt_pk_bf16_f32 v71, v199, v207
    s_add_u32 s68, s67, 13312
    buffer_store_dwordx4 v[68:71], v4, s[8:11], s68 offen sc1
    v_sub_f32 v208, v208, v6
    v_sub_f32 v209, v209, v6
    v_cvt_pk_bf16_f32 v12, v208, v209
    v_lshlrev_b32 v208, 16, v12
    v_and_b32 v209, 0xffff0000, v12
    v_mul_f32 v208, v208, v13
    v_mul_f32 v209, v209, v13
    v_sub_f32 v210, v210, v6
    v_sub_f32 v211, v211, v6
    v_cvt_pk_bf16_f32 v12, v210, v211
    v_lshlrev_b32 v210, 16, v12
    v_and_b32 v211, 0xffff0000, v12
    v_mul_f32 v210, v210, v13
    v_mul_f32 v211, v211, v13
    v_sub_f32 v212, v212, v6
    v_sub_f32 v213, v213, v6
    v_cvt_pk_bf16_f32 v12, v212, v213
    v_lshlrev_b32 v212, 16, v12
    v_and_b32 v213, 0xffff0000, v12
    v_mul_f32 v212, v212, v13
    v_mul_f32 v213, v213, v13
    v_sub_f32 v214, v214, v6
    v_sub_f32 v215, v215, v6
    v_cvt_pk_bf16_f32 v12, v214, v215
    v_lshlrev_b32 v214, 16, v12
    v_and_b32 v215, 0xffff0000, v12
    v_mul_f32 v214, v214, v13
    v_mul_f32 v215, v215, v13
    v_sub_f32 v216, v216, v6
    v_sub_f32 v217, v217, v6
    v_cvt_pk_bf16_f32 v12, v216, v217
    v_lshlrev_b32 v216, 16, v12
    v_and_b32 v217, 0xffff0000, v12
    v_mul_f32 v216, v216, v13
    v_mul_f32 v217, v217, v13
    v_sub_f32 v218, v218, v6
    v_sub_f32 v219, v219, v6
    v_cvt_pk_bf16_f32 v12, v218, v219
    v_lshlrev_b32 v218, 16, v12
    v_and_b32 v219, 0xffff0000, v12
    v_mul_f32 v218, v218, v13
    v_mul_f32 v219, v219, v13
    v_sub_f32 v220, v220, v6
    v_sub_f32 v221, v221, v6
    v_cvt_pk_bf16_f32 v12, v220, v221
    v_lshlrev_b32 v220, 16, v12
    v_and_b32 v221, 0xffff0000, v12
    v_mul_f32 v220, v220, v13
    v_mul_f32 v221, v221, v13
    v_sub_f32 v222, v222, v6
    v_sub_f32 v223, v223, v6
    v_cvt_pk_bf16_f32 v12, v222, v223
    v_lshlrev_b32 v222, 16, v12
    v_and_b32 v223, 0xffff0000, v12
    v_mul_f32 v222, v222, v13
    v_mul_f32 v223, v223, v13
    v_cvt_pk_bf16_f32 v72, v208, v216
    v_cvt_pk_bf16_f32 v73, v210, v218
    v_cvt_pk_bf16_f32 v74, v212, v220
    v_cvt_pk_bf16_f32 v75, v214, v222
    s_add_u32 s68, s67, 14336
    buffer_store_dwordx4 v[72:75], v4, s[8:11], s68 offen sc1
    v_cvt_pk_bf16_f32 v76, v209, v217
    v_cvt_pk_bf16_f32 v77, v211, v219
    v_cvt_pk_bf16_f32 v78, v213, v221
    v_cvt_pk_bf16_f32 v79, v215, v223
    s_add_u32 s68, s67, 15360
    buffer_store_dwordx4 v[76:79], v4, s[8:11], s68 offen sc1
L_ln_done:
poll_1:
    buffer_load_dword v8, v1, s[12:15], 0 offen offset:192 sc1
    s_waitcnt vmcnt(0)
    v_cmp_gt_u32 vcc, 1, v8
    s_cbranch_vccz pdone_2
    s_add_u32 s63, s63, 1
    s_cmp_gt_u32 s63, 400000
    s_cbranch_scc1 pdone_2
    s_sleep 2
    s_branch poll_1
pdone_2:
    s_barrier
    s_cmp_lg_u32 s60, 0
    s_cbranch_scc1 L_ln_flagged
    s_lshl_b32 s68, s61, 7
    v_mov_b32 v8, 1
    s_mov_b64 exec, 1
    buffer_store_dword v8, v1, s[8:11], s68 offen offset:0 sc1
    s_mov_b64 exec, -1
L_ln_flagged:
    s_branch L_fend
L_fin:
    s_sub_u32 s80, s61, 192
    s_lshl_b32 s68, s80, 2
    s_add_u32 s68, s68, s60
    v_mov_b32 v80, -1
    v_mov_b32 v81, -1
    v_mov_b32 v82, -1
    v_mov_b32 v83, -1
    v_lshlrev_b32 v84, 4, v0
    s_lshl_b32 s69, s68, 11
    s_add_u32 s69, s69, 0x940000
    buffer_store_dwordx4 v[80:83], v84, s[8:11], s69 offen offset:0 sc1
    buffer_store_dwordx4 v[80:83], v84, s[8:11], s69 offen offset:1024 sc1
    s_mul_i32 s69, s68, 3072
    s_add_u32 s69, s69, 0x20000
    buffer_store_dwordx4 v[80:83], v84, s[8:11], s69 offen offset:0 sc1
    buffer_store_dwordx4 v[80:83], v84, s[8:11], s69 offen offset:1024 sc1
    buffer_store_dwordx4 v[80:83], v84, s[8:11], s69 offen offset:2048 sc1
    s_lshl_b32 s69, s68, 5
    s_add_u32 s69, s69, 0xe0000
    s_mov_b64 exec, 3
    buffer_store_dwordx4 v[80:83], v84, s[8:11], s69 offen sc1
    v_mov_b32 v76, 0
    v_mov_b32 v77, 0
    v_mov_b32 v78, 0
    v_mov_b32 v79, 0
    s_add_u32 s69, s69, 32768
    buffer_store_dwordx4 v[76:79], v84, s[8:11], s69 offen sc1
    s_mov_b64 exec, -1
    v_lshlrev_b32 v85, 7, v0
    s_lshl_b32 s69, s68, 13
    buffer_load_dword v86, v85, s[40:43], s69 offen
    buffer_load_dword v86, v85, s[48:51], s69 offen
    buffer_load_dword v27, v1, s[12:15], 0 offen offset:192 sc1
    s_sub_u32 s68, s61, 160
    s_lshr_b32 s64, s68, 2
    s_and_b32 s65, s68, 3
    s_lshl_b32 s71, s61, 7
    v_lshlrev_b32 v2, 4, v0
    v_bfe_u32 v8, v0, 3, 1
    v_mul_u32_u24 v9, 5504, v8
    v_bfe_u32 v8, v0, 4, 1
    v_mul_u32_u24 v8, 2752, v8
    v_add_u32 v9, v9, v8
    v_bfe_u32 v8, v0, 5, 1
    v_mul_u32_u24 v8, 11008, v8
    v_add_u32 v9, v9, v8
    v_and_b32 v8, 7, v0
    v_lshlrev_b32 v8, 4, v8
    v_xor_b32 v16, 0, v8
    v_add_u32 v16, v16, v9
    v_xor_b32 v17, 32, v8
    v_add_u32 v17, v17, v9
    v_xor_b32 v18, 64, v8
    v_add_u32 v18, v18, v9
    v_xor_b32 v19, 96, v8
    v_add_u32 v19, v19, v9
    s_lshl_b32 s72, s60, 15
    s_and_b32 s68, s60, 1
    s_mul_i32 s69, s68, 704512
    s_lshl_b32 s68, s68, 6
    s_and_b32 s73, s72, 0x10000
    s_add_u32 s68, s68, s73
    v_and_b32 v20, 3, v0
    v_lshlrev_b32 v20, 3, v20
    v_bfe_u32 v8, v0, 2, 1
    v_mul_u32_u24 v8, 2112, v8
    v_xor_b32 v20, v20, v8
    v_bfe_u32 v8, v0, 3, 1
    v_mul_u32_u24 v8, 128, v8
    v_xor_b32 v20, v20, v8
    v_bfe_u32 v8, v0, 4, 1
    v_mul_u32_u24 v8, 1056, v8
    v_xor_b32 v20, v20, v8
    v_bfe_u32 v8, v0, 5, 1
    v_mul_u32_u24 v8, 4096, v8
    v_xor_b32 v20, v20, v8
    v_xor_b32 v20, s68, v20
    v_xor_b32 v21, 32, v20
    v_xor_b32 v22, 0x8000, v20
    v_xor_b32 v23, 0x8020, v20
    s_mul_i32 s73, s65, 768
    s_add_u32 s69, s69, s73
    s_lshr_b32 s68, s60, 1
    s_lshl_b32 s68, s68, 7
    s_add_u32 s69, s69, s68
    s_lshl_b32 s68, s60, 6
    s_add_u32 s73, s73, s68
    v_lshrrev_b32 v8, 4, v0
    v_lshlrev_b32 v8, 3, v8
    buffer_load_dwordx2 v[28:29], v8, s[44:47], s73 offen offset:0
    buffer_load_dwordx2 v[30:31], v8, s[44:47], s73 offen offset:32
    buffer_load_dwordx2 v[32:33], v8, s[44:47], s73 offen offset:256
    buffer_load_dwordx2 v[34:35], v8, s[44:47], s73 offen offset:288
    buffer_load_dwordx2 v[36:37], v8, s[44:47], s73 offen offset:512
    buffer_load_dwordx2 v[38:39], v8, s[44:47], s73 offen offset:544
    s_add_u32 m0, s72, 0
    s_add_u32 s68, s69, 0x0
    buffer_load_dwordx4 v16, s[40:43], s68 offen lds
    s_add_u32 m0, s72, 1024
    s_add_u32 s68, s69, 0x5600
    buffer_load_dwordx4 v17, s[40:43], s68 offen lds
    s_add_u32 m0, s72, 2048
    s_add_u32 s68, s69, 0xac00
    buffer_load_dwordx4 v18, s[40:43], s68 offen lds
    s_add_u32 m0, s72, 3072
    s_add_u32 s68, s69, 0x10200
    buffer_load_dwordx4 v19, s[40:43], s68 offen lds
    s_add_u32 m0, s72, 4096
    s_add_u32 s68, s69, 0x56000
    buffer_load_dwordx4 v16, s[40:43], s68 offen lds
    s_add_u32 m0, s72, 5120
    s_add_u32 s68, s69, 0x5b600
    buffer_load_dwordx4 v17, s[40:43], s68 offen lds
    s_add_u32 m0, s72, 6144
    s_add_u32 s68, s69, 0x60c00
    buffer_load_dwordx4 v18, s[40:43], s68 offen lds
    s_add_u32 m0, s72, 7168
    s_add_u32 s68, s69, 0x66200
    buffer_load_dwordx4 v19, s[40:43], s68 offen lds
    s_add_u32 m0, s72, 8192
    s_add_u32 s68, s69, 0x100
    buffer_load_dwordx4 v16, s[40:43], s68 offen lds
    s_add_u32 m0, s72, 9216
    s_add_u32 s68, s69, 0x5700
    buffer_load_dwordx4 v17, s[40:43], s68 offen lds
    s_add_u32 m0, s72, 10240
    s_add_u32 s68, s69, 0xad00
    buffer_load_dwordx4 v18, s[40:43], s68 offen lds
    s_add_u32 m0, s72, 11264
    s_add_u32 s68, s69, 0x10300
    buffer_load_dwordx4 v19, s[40:43], s68 offen lds
    s_add_u32 m0, s72, 12288
    s_add_u32 s68, s69, 0x56100
    buffer_load_dwordx4 v16, s[40:43], s68 offen lds
    s_add_u32 m0, s72, 13312
    s_add_u32 s68, s69, 0x5b700
    buffer_load_dwordx4 v17, s[40:43], s68 offen lds
    s_add_u32 m0, s72, 14336
    s_add_u32 s68, s69, 0x60d00
    buffer_load_dwordx4 v18, s[40:43], s68 offen lds
    s_add_u32 m0, s72, 15360
    s_add_u32 s68, s69, 0x66300
    buffer_load_dwordx4 v19, s[40:43], s68 offen lds
    s_add_u32 m0, s72, 16384
    s_add_u32 s68, s69, 0x200
    buffer_load_dwordx4 v16, s[40:43], s68 offen lds
    s_add_u32 m0, s72, 17408
    s_add_u32 s68, s69, 0x5800
    buffer_load_dwordx4 v17, s[40:43], s68 offen lds
    s_add_u32 m0, s72, 18432
    s_add_u32 s68, s69, 0xae00
    buffer_load_dwordx4 v18, s[40:43], s68 offen lds
    s_add_u32 m0, s72, 19456
    s_add_u32 s68, s69, 0x10400
    buffer_load_dwordx4 v19, s[40:43], s68 offen lds
    s_add_u32 m0, s72, 20480
    s_add_u32 s68, s69, 0x56200
    buffer_load_dwordx4 v16, s[40:43], s68 offen lds
    s_add_u32 m0, s72, 21504
    s_add_u32 s68, s69, 0x5b800
    buffer_load_dwordx4 v17, s[40:43], s68 offen lds
    s_add_u32 m0, s72, 22528
    s_add_u32 s68, s69, 0x60e00
    buffer_load_dwordx4 v18, s[40:43], s68 offen lds
    s_add_u32 m0, s72, 23552
    s_add_u32 s68, s69, 0x66400
    buffer_load_dwordx4 v19, s[40:43], s68 offen lds
    s_waitcnt vmcnt(16) lgkmcnt(0)
    s_barrier
    s_add_u32 m0, s72, 24576
    s_add_u32 s68, s69, 0x15800
    buffer_load_dwordx4 v16, s[40:43], s68 offen lds
    s_add_u32 m0, s72, 25600
    s_add_u32 s68, s69, 0x1ae00
    buffer_load_dwordx4 v17, s[40:43], s68 offen lds
    s_add_u32 m0, s72, 26624
    s_add_u32 s68, s69, 0x20400
    buffer_load_dwordx4 v18, s[40:43], s68 offen lds
    s_add_u32 m0, s72, 27648
    s_add_u32 s68, s69, 0x25a00
    buffer_load_dwordx4 v19, s[40:43], s68 offen lds
    s_add_u32 m0, s72, 28672
    s_add_u32 s68, s69, 0x6b800
    buffer_load_dwordx4 v16, s[40:43], s68 offen lds
    s_add_u32 m0, s72, 29696
    s_add_u32 s68, s69, 0x70e00
    buffer_load_dwordx4 v17, s[40:43], s68 offen lds
    s_add_u32 m0, s72, 30720
    s_add_u32 s68, s69, 0x76400
    buffer_load_dwordx4 v18, s[40:43], s68 offen lds
    s_add_u32 m0, s72, 31744
    s_add_u32 s68, s69, 0x7ba00
    buffer_load_dwordx4 v19, s[40:43], s68 offen lds
    ds_read_b64_tr_b16 v[128:129], v20 offset:0
    ds_read_b64_tr_b16 v[130:131], v20 offset:512
    ds_read_b64_tr_b16 v[132:133], v20 offset:256
    ds_read_b64_tr_b16 v[134:135], v20 offset:768
    ds_read_b64_tr_b16 v[136:137], v21 offset:0
    ds_read_b64_tr_b16 v[138:139], v21 offset:512
    ds_read_b64_tr_b16 v[140:141], v21 offset:256
    ds_read_b64_tr_b16 v[142:143], v21 offset:768
    ds_read_b64_tr_b16 v[144:145], v22 offset:0
    ds_read_b64_tr_b16 v[146:147], v22 offset:512
    ds_read_b64_tr_b16 v[148:149], v22 offset:256
    ds_read_b64_tr_b16 v[150:151], v22 offset:768
    ds_read_b64_tr_b16 v[152:153], v23 offset:0
    ds_read_b64_tr_b16 v[154:155], v23 offset:512
    ds_read_b64_tr_b16 v[156:157], v23 offset:256
    ds_read_b64_tr_b16 v[158:159], v23 offset:768
    s_cmp_lg_u32 s60, 0
    s_cbranch_scc1 F_mk
    v_cmp_eq_u32 vcc, 0, v27
    s_cbranch_vccz F_mk1
poll_3:
    buffer_load_dword v8, v1, s[12:15], 0 offen offset:192 sc1
    s_waitcnt vmcnt(0)
    v_cmp_gt_u32 vcc, 1, v8
    s_cbranch_vccz pdone_4
    s_add_u32 s63, s63, 1
    s_cmp_gt_u32 s63, 400000
    s_cbranch_scc1 pdone_4
    s_sleep 2
    s_branch poll_3
pdone_4:
F_mk1:
    v_mov_b32 v8, 1
    s_mov_b64 exec, 1
    buffer_store_dword v8, v1, s[8:11], s71 offen offset:0 sc1
    s_mov_b64 exec, -1
F_mk:
    s_waitcnt vmcnt(16) lgkmcnt(0)
    s_barrier
    s_add_u32 m0, s72, 0
    s_add_u32 s68, s69, 0x15900
    buffer_load_dwordx4 v16, s[40:43], s68 offen lds
    s_add_u32 m0, s72, 1024
    s_add_u32 s68, s69, 0x1af00
    buffer_load_dwordx4 v17, s[40:43], s68 offen lds
    s_add_u32 m0, s72, 2048
    s_add_u32 s68, s69, 0x20500
    buffer_load_dwordx4 v18, s[40:43], s68 offen lds
    s_add_u32 m0, s72, 3072
    s_add_u32 s68, s69, 0x25b00
    buffer_load_dwordx4 v19, s[40:43], s68 offen lds
    s_add_u32 m0, s72, 4096
    s_add_u32 s68, s69, 0x6b900
    buffer_load_dwordx4 v16, s[40:43], s68 offen lds
    s_add_u32 m0, s72, 5120
    s_add_u32 s68, s69, 0x70f00
    buffer_load_dwordx4 v17, s[40:43], s68 offen lds
    s_add_u32 m0, s72, 6144
    s_add_u32 s68, s69, 0x76500
    buffer_load_dwordx4 v18, s[40:43], s68 offen lds
    s_add_u32 m0, s72, 7168
    s_add_u32 s68, s69, 0x7bb00
    buffer_load_dwordx4 v19, s[40:43], s68 offen lds
    ds_read_b64_tr_b16 a[0:1], v20 offset:8192
    ds_read_b64_tr_b16 a[2:3], v20 offset:8704
    ds_read_b64_tr_b16 a[4:5], v20 offset:8448
    ds_read_b64_tr_b16 a[6:7], v20 offset:8960
    ds_read_b64_tr_b16 a[8:9], v21 offset:8192
    ds_read_b64_tr_b16 a[10:11], v21 offset:8704
    ds_read_b64_tr_b16 a[12:13], v21 offset:8448
    ds_read_b64_tr_b16 a[14:15], v21 offset:8960
    ds_read_b64_tr_b16 a[16:17], v22 offset:8192
    ds_read_b64_tr_b16 a[18:19], v22 offset:8704
    ds_read_b64_tr_b16 a[20:21], v22 offset:8448
    ds_read_b64_tr_b16 a[22:23], v22 offset:8960
    ds_read_b64_tr_b16 a[24:25], v23 offset:8192
    ds_read_b64_tr_b16 a[26:27], v23 offset:8704
    ds_read_b64_tr_b16 a[28:29], v23 offset:8448
    ds_read_b64_tr_b16 a[30:31], v23 offset:8960
    s_waitcnt vmcnt(16) lgkmcnt(0)
    s_barrier
    s_add_u32 m0, s72, 8192
    s_add_u32 s68, s69, 0x15a00
    buffer_load_dwordx4 v16, s[40:43], s68 offen lds
    s_add_u32 m0, s72, 9216
    s_add_u32 s68, s69, 0x1b000
    buffer_load_dwordx4 v17, s[40:43], s68 offen lds
    s_add_u32 m0, s72, 10240
    s_add_u32 s68, s69, 0x20600
    buffer_load_dwordx4 v18, s[40:43], s68 offen lds
    s_add_u32 m0, s72, 11264
    s_add_u32 s68, s69, 0x25c00
    buffer_load_dwordx4 v19, s[40:43], s68 offen lds
    s_add_u32 m0, s72, 12288
    s_add_u32 s68, s69, 0x6ba00
    buffer_load_dwordx4 v16, s[40:43], s68 offen lds
    s_add_u32 m0, s72, 13312
    s_add_u32 s68, s69, 0x71000
    buffer_load_dwordx4 v17, s[40:43], s68 offen lds
    s_add_u32 m0, s72, 14336
    s_add_u32 s68, s69, 0x76600
    buffer_load_dwordx4 v18, s[40:43], s68 offen lds
    s_add_u32 m0, s72, 15360
    s_add_u32 s68, s69, 0x7bc00
    buffer_load_dwordx4 v19, s[40:43], s68 offen lds
    ds_read_b64_tr_b16 a[128:129], v20 offset:16384
    ds_read_b64_tr_b16 a[130:131], v20 offset:16896
    ds_read_b64_tr_b16 a[132:133], v20 offset:16640
    ds_read_b64_tr_b16 a[134:135], v20 offset:17152
    ds_read_b64_tr_b16 a[136:137], v21 offset:16384
    ds_read_b64_tr_b16 a[138:139], v21 offset:16896
    ds_read_b64_tr_b16 a[140:141], v21 offset:16640
    ds_read_b64_tr_b16 a[142:143], v21 offset:17152
    ds_read_b64_tr_b16 a[144:145], v22 offset:16384
    ds_read_b64_tr_b16 a[146:147], v22 offset:16896
    ds_read_b64_tr_b16 a[148:149], v22 offset:16640
    ds_read_b64_tr_b16 a[150:151], v22 offset:17152
    ds_read_b64_tr_b16 a[152:153], v23 offset:16384
    ds_read_b64_tr_b16 a[154:155], v23 offset:16896
    ds_read_b64_tr_b16 a[156:157], v23 offset:16640
    ds_read_b64_tr_b16 a[158:159], v23 offset:17152
    s_waitcnt vmcnt(16) lgkmcnt(0)
    s_barrier
    s_add_u32 m0, s72, 16384
    s_add_u32 s68, s69, 0x2b000
    buffer_load_dwordx4 v16, s[40:43], s68 offen lds
    s_add_u32 m0, s72, 17408
    s_add_u32 s68, s69, 0x30600
    buffer_load_dwordx4 v17, s[40:43], s68 offen lds
    s_add_u32 m0, s72, 18432
    s_add_u32 s68, s69, 0x35c00
    buffer_load_dwordx4 v18, s[40:43], s68 offen lds
    s_add_u32 m0, s72, 19456
    s_add_u32 s68, s69, 0x3b200
    buffer_load_dwordx4 v19, s[40:43], s68 offen lds
    s_add_u32 m0, s72, 20480
    s_add_u32 s68, s69, 0x81000
    buffer_load_dwordx4 v16, s[40:43], s68 offen lds
    s_add_u32 m0, s72, 21504
    s_add_u32 s68, s69, 0x86600
    buffer_load_dwordx4 v17, s[40:43], s68 offen lds
    s_add_u32 m0, s72, 22528
    s_add_u32 s68, s69, 0x8bc00
    buffer_load_dwordx4 v18, s[40:43], s68 offen lds
    s_add_u32 m0, s72, 23552
    s_add_u32 s68, s69, 0x91200
    buffer_load_dwordx4 v19, s[40:43], s68 offen lds
    ds_read_b64_tr_b16 v[160:161], v20 offset:24576
    ds_read_b64_tr_b16 v[162:163], v20 offset:25088
    ds_read_b64_tr_b16 v[164:165], v20 offset:24832
    ds_read_b64_tr_b16 v[166:167], v20 offset:25344
    ds_read_b64_tr_b16 v[168:169], v21 offset:24576
    ds_read_b64_tr_b16 v[170:171], v21 offset:25088
    ds_read_b64_tr_b16 v[172:173], v21 offset:24832
    ds_read_b64_tr_b16 v[174:175], v21 offset:25344
    ds_read_b64_tr_b16 v[176:177], v22 offset:24576
    ds_read_b64_tr_b16 v[178:179], v22 offset:25088
    ds_read_b64_tr_b16 v[180:181], v22 offset:24832
    ds_read_b64_tr_b16 v[182:183], v22 offset:25344
    ds_read_b64_tr_b16 v[184:185], v23 offset:24576
    ds_read_b64_tr_b16 v[186:187], v23 offset:25088
    ds_read_b64_tr_b16 v[188:189], v23 offset:24832
    ds_read_b64_tr_b16 v[190:191], v23 offset:25344
    s_waitcnt vmcnt(16) lgkmcnt(0)
    s_barrier
    s_add_u32 m0, s72, 24576
    s_add_u32 s68, s69, 0x2b100
    buffer_load_dwordx4 v16, s[40:43], s68 offen lds
    s_add_u32 m0, s72, 25600
    s_add_u32 s68, s69, 0x30700
    buffer_load_dwordx4 v17, s[40:43], s68 offen lds
    s_add_u32 m0, s72, 26624
    s_add_u32 s68, s69, 0x35d00
    buffer_load_dwordx4 v18, s[40:43], s68 offen lds
    s_add_u32 m0, s72, 27648
    s_add_u32 s68, s69, 0x3b300
    buffer_load_dwordx4 v19, s[40:43], s68 offen lds
    s_add_u32 m0, s72, 28672
    s_add_u32 s68, s69, 0x81100
    buffer_load_dwordx4 v16, s[40:43], s68 offen lds
    s_add_u32 m0, s72, 29696
    s_add_u32 s68, s69, 0x86700
    buffer_load_dwordx4 v17, s[40:43], s68 offen lds
    s_add_u32 m0, s72, 30720
    s_add_u32 s68, s69, 0x8bd00
    buffer_load_dwordx4 v18, s[40:43], s68 offen lds
    s_add_u32 m0, s72, 31744
    s_add_u32 s68, s69, 0x91300
    buffer_load_dwordx4 v19, s[40:43], s68 offen lds
    ds_read_b64_tr_b16 a[32:33], v20 offset:0
    ds_read_b64_tr_b16 a[34:35], v20 offset:512
    ds_read_b64_tr_b16 a[36:37], v20 offset:256
    ds_read_b64_tr_b16 a[38:39], v20 offset:768
    ds_read_b64_tr_b16 a[40:41], v21 offset:0
    ds_read_b64_tr_b16 a[42:43], v21 offset:512
    ds_read_b64_tr_b16 a[44:45], v21 offset:256
    ds_read_b64_tr_b16 a[46:47], v21 offset:768
    ds_read_b64_tr_b16 a[48:49], v22 offset:0
    ds_read_b64_tr_b16 a[50:51], v22 offset:512
    ds_read_b64_tr_b16 a[52:53], v22 offset:256
    ds_read_b64_tr_b16 a[54:55], v22 offset:768
    ds_read_b64_tr_b16 a[56:57], v23 offset:0
    ds_read_b64_tr_b16 a[58:59], v23 offset:512
    ds_read_b64_tr_b16 a[60:61], v23 offset:256
    ds_read_b64_tr_b16 a[62:63], v23 offset:768
    s_waitcnt vmcnt(16) lgkmcnt(0)
    s_barrier
    s_add_u32 m0, s72, 0
    s_add_u32 s68, s69, 0x2b200
    buffer_load_dwordx4 v16, s[40:43], s68 offen lds
    s_add_u32 m0, s72, 1024
    s_add_u32 s68, s69, 0x30800
    buffer_load_dwordx4 v17, s[40:43], s68 offen lds
    s_add_u32 m0, s72, 2048
    s_add_u32 s68, s69, 0x35e00
    buffer_load_dwordx4 v18, s[40:43], s68 offen lds
    s_add_u32 m0, s72, 3072
    s_add_u32 s68, s69, 0x3b400
    buffer_load_dwordx4 v19, s[40:43], s68 offen lds
    s_add_u32 m0, s72, 4096
    s_add_u32 s68, s69, 0x81200
    buffer_load_dwordx4 v16, s[40:43], s68 offen lds
    s_add_u32 m0, s72, 5120
    s_add_u32 s68, s69, 0x86800
    buffer_load_dwordx4 v17, s[40:43], s68 offen lds
    s_add_u32 m0, s72, 6144
    s_add_u32 s68, s69, 0x8be00
    buffer_load_dwordx4 v18, s[40:43], s68 offen lds
    s_add_u32 m0, s72, 7168
    s_add_u32 s68, s69, 0x91400
    buffer_load_dwordx4 v19, s[40:43], s68 offen lds
    ds_read_b64_tr_b16 a[160:161], v20 offset:8192
    ds_read_b64_tr_b16 a[162:163], v20 offset:8704
    ds_read_b64_tr_b16 a[164:165], v20 offset:8448
    ds_read_b64_tr_b16 a[166:167], v20 offset:8960
    ds_read_b64_tr_b16 a[168:169], v21 offset:8192
    ds_read_b64_tr_b16 a[170:171], v21 offset:8704
    ds_read_b64_tr_b16 a[172:173], v21 offset:8448
    ds_read_b64_tr_b16 a[174:175], v21 offset:8960
    ds_read_b64_tr_b16 a[176:177], v22 offset:8192
    ds_read_b64_tr_b16 a[178:179], v22 offset:8704
    ds_read_b64_tr_b16 a[180:181], v22 offset:8448
    ds_read_b64_tr_b16 a[182:183], v22 offset:8960
    ds_read_b64_tr_b16 a[184:185], v23 offset:8192
    ds_read_b64_tr_b16 a[186:187], v23 offset:8704
    ds_read_b64_tr_b16 a[188:189], v23 offset:8448
    ds_read_b64_tr_b16 a[190:191], v23 offset:8960
    s_waitcnt vmcnt(16) lgkmcnt(0)
    s_barrier
    s_add_u32 m0, s72, 8192
    s_add_u32 s68, s69, 0x40800
    buffer_load_dwordx4 v16, s[40:43], s68 offen lds
    s_add_u32 m0, s72, 9216
    s_add_u32 s68, s69, 0x45e00
    buffer_load_dwordx4 v17, s[40:43], s68 offen lds
    s_add_u32 m0, s72, 10240
    s_add_u32 s68, s69, 0x4b400
    buffer_load_dwordx4 v18, s[40:43], s68 offen lds
    s_add_u32 m0, s72, 11264
    s_add_u32 s68, s69, 0x50a00
    buffer_load_dwordx4 v19, s[40:43], s68 offen lds
    s_add_u32 m0, s72, 12288
    s_add_u32 s68, s69, 0x96800
    buffer_load_dwordx4 v16, s[40:43], s68 offen lds
    s_add_u32 m0, s72, 13312
    s_add_u32 s68, s69, 0x9be00
    buffer_load_dwordx4 v17, s[40:43], s68 offen lds
    s_add_u32 m0, s72, 14336
    s_add_u32 s68, s69, 0xa1400
    buffer_load_dwordx4 v18, s[40:43], s68 offen lds
    s_add_u32 m0, s72, 15360
    s_add_u32 s68, s69, 0xa6a00
    buffer_load_dwordx4 v19, s[40:43], s68 offen lds
    ds_read_b64_tr_b16 v[192:193], v20 offset:16384
    ds_read_b64_tr_b16 v[194:195], v20 offset:16896
    ds_read_b64_tr_b16 v[196:197], v20 offset:16640
    ds_read_b64_tr_b16 v[198:199], v20 offset:17152
    ds_read_b64_tr_b16 v[200:201], v21 offset:16384
    ds_read_b64_tr_b16 v[202:203], v21 offset:16896
    ds_read_b64_tr_b16 v[204:205], v21 offset:16640
    ds_read_b64_tr_b16 v[206:207], v21 offset:17152
    ds_read_b64_tr_b16 v[208:209], v22 offset:16384
    ds_read_b64_tr_b16 v[210:211], v22 offset:16896
    ds_read_b64_tr_b16 v[212:213], v22 offset:16640
    ds_read_b64_tr_b16 v[214:215], v22 offset:17152
    ds_read_b64_tr_b16 v[216:217], v23 offset:16384
    ds_read_b64_tr_b16 v[218:219], v23 offset:16896
    ds_read_b64_tr_b16 v[220:221], v23 offset:16640
    ds_read_b64_tr_b16 v[222:223], v23 offset:17152
    s_waitcnt vmcnt(16) lgkmcnt(0)
    s_barrier
    s_add_u32 m0, s72, 16384
    s_add_u32 s68, s69, 0x40900
    buffer_load_dwordx4 v16, s[40:43], s68 offen lds
    s_add_u32 m0, s72, 17408
    s_add_u32 s68, s69, 0x45f00
    buffer_load_dwordx4 v17, s[40:43], s68 offen lds
    s_add_u32 m0, s72, 18432
    s_add_u32 s68, s69, 0x4b500
    buffer_load_dwordx4 v18, s[40:43], s68 offen lds
    s_add_u32 m0, s72, 19456
    s_add_u32 s68, s69, 0x50b00
    buffer_load_dwordx4 v19, s[40:43], s68 offen lds
    s_add_u32 m0, s72, 20480
    s_add_u32 s68, s69, 0x96900
    buffer_load_dwordx4 v16, s[40:43], s68 offen lds
    s_add_u32 m0, s72, 21504
    s_add_u32 s68, s69, 0x9bf00
    buffer_load_dwordx4 v17, s[40:43], s68 offen lds
    s_add_u32 m0, s72, 22528
    s_add_u32 s68, s69, 0xa1500
    buffer_load_dwordx4 v18, s[40:43], s68 offen lds
    s_add_u32 m0, s72, 23552
    s_add_u32 s68, s69, 0xa6b00
    buffer_load_dwordx4 v19, s[40:43], s68 offen lds
    ds_read_b64_tr_b16 a[64:65], v20 offset:24576
    ds_read_b64_tr_b16 a[66:67], v20 offset:25088
    ds_read_b64_tr_b16 a[68:69], v20 offset:24832
    ds_read_b64_tr_b16 a[70:71], v20 offset:25344
    ds_read_b64_tr_b16 a[72:73], v21 offset:24576
    ds_read_b64_tr_b16 a[74:75], v21 offset:25088
    ds_read_b64_tr_b16 a[76:77], v21 offset:24832
    ds_read_b64_tr_b16 a[78:79], v21 offset:25344
    ds_read_b64_tr_b16 a[80:81], v22 offset:24576
    ds_read_b64_tr_b16 a[82:83], v22 offset:25088
    ds_read_b64_tr_b16 a[84:85], v22 offset:24832
    ds_read_b64_tr_b16 a[86:87], v22 offset:25344
    ds_read_b64_tr_b16 a[88:89], v23 offset:24576
    ds_read_b64_tr_b16 a[90:91], v23 offset:25088
    ds_read_b64_tr_b16 a[92:93], v23 offset:24832
    ds_read_b64_tr_b16 a[94:95], v23 offset:25344
    s_waitcnt vmcnt(16) lgkmcnt(0)
    s_barrier
    s_add_u32 m0, s72, 24576
    s_add_u32 s68, s69, 0x40a00
    buffer_load_dwordx4 v16, s[40:43], s68 offen lds
    s_add_u32 m0, s72, 25600
    s_add_u32 s68, s69, 0x46000
    buffer_load_dwordx4 v17, s[40:43], s68 offen lds
    s_add_u32 m0, s72, 26624
    s_add_u32 s68, s69, 0x4b600
    buffer_load_dwordx4 v18, s[40:43], s68 offen lds
    s_add_u32 m0, s72, 27648
    s_add_u32 s68, s69, 0x50c00
    buffer_load_dwordx4 v19, s[40:43], s68 offen lds
    s_add_u32 m0, s72, 28672
    s_add_u32 s68, s69, 0x96a00
    buffer_load_dwordx4 v16, s[40:43], s68 offen lds
    s_add_u32 m0, s72, 29696
    s_add_u32 s68, s69, 0x9c000
    buffer_load_dwordx4 v17, s[40:43], s68 offen lds
    s_add_u32 m0, s72, 30720
    s_add_u32 s68, s69, 0xa1600
    buffer_load_dwordx4 v18, s[40:43], s68 offen lds
    s_add_u32 m0, s72, 31744
    s_add_u32 s68, s69, 0xa6c00
    buffer_load_dwordx4 v19, s[40:43], s68 offen lds
    ds_read_b64_tr_b16 a[192:193], v20 offset:0
    ds_read_b64_tr_b16 a[194:195], v20 offset:512
    ds_read_b64_tr_b16 a[196:197], v20 offset:256
    ds_read_b64_tr_b16 a[198:199], v20 offset:768
    ds_read_b64_tr_b16 a[200:201], v21 offset:0
    ds_read_b64_tr_b16 a[202:203], v21 offset:512
    ds_read_b64_tr_b16 a[204:205], v21 offset:256
    ds_read_b64_tr_b16 a[206:207], v21 offset:768
    ds_read_b64_tr_b16 a[208:209], v22 offset:0
    ds_read_b64_tr_b16 a[210:211], v22 offset:512
    ds_read_b64_tr_b16 a[212:213], v22 offset:256
    ds_read_b64_tr_b16 a[214:215], v22 offset:768
    ds_read_b64_tr_b16 a[216:217], v23 offset:0
    ds_read_b64_tr_b16 a[218:219], v23 offset:512
    ds_read_b64_tr_b16 a[220:221], v23 offset:256
    ds_read_b64_tr_b16 a[222:223], v23 offset:768
    s_waitcnt vmcnt(16) lgkmcnt(0)
    s_barrier
    ds_read_b64_tr_b16 v[224:225], v20 offset:8192
    ds_read_b64_tr_b16 v[226:227], v20 offset:8704
    ds_read_b64_tr_b16 v[228:229], v20 offset:8448
    ds_read_b64_tr_b16 v[230:231], v20 offset:8960
    ds_read_b64_tr_b16 v[232:233], v21 offset:8192
    ds_read_b64_tr_b16 v[234:235], v21 offset:8704
    ds_read_b64_tr_b16 v[236:237], v21 offset:8448
    ds_read_b64_tr_b16 v[238:239], v21 offset:8960
    ds_read_b64_tr_b16 v[240:241], v22 offset:8192
    ds_read_b64_tr_b16 v[242:243], v22 offset:8704
    ds_read_b64_tr_b16 v[244:245], v22 offset:8448
    ds_read_b64_tr_b16 v[246:247], v22 offset:8960
    ds_read_b64_tr_b16 v[248:249], v23 offset:8192
    ds_read_b64_tr_b16 v[250:251], v23 offset:8704
    ds_read_b64_tr_b16 v[252:253], v23 offset:8448
    ds_read_b64_tr_b16 v[254:255], v23 offset:8960
    s_waitcnt vmcnt(8) lgkmcnt(0)
    s_barrier
    ds_read_b64_tr_b16 a[96:97], v20 offset:16384
    ds_read_b64_tr_b16 a[98:99], v20 offset:16896
    ds_read_b64_tr_b16 a[100:101], v20 offset:16640
    ds_read_b64_tr_b16 a[102:103], v20 offset:17152
    ds_read_b64_tr_b16 a[104:105], v21 offset:16384
    ds_read_b64_tr_b16 a[106:107], v21 offset:16896
    ds_read_b64_tr_b16 a[108:109], v21 offset:16640
    ds_read_b64_tr_b16 a[110:111], v21 offset:17152
    ds_read_b64_tr_b16 a[112:113], v22 offset:16384
    ds_read_b64_tr_b16 a[114:115], v22 offset:16896
    ds_read_b64_tr_b16 a[116:117], v22 offset:16640
    ds_read_b64_tr_b16 a[118:119], v22 offset:17152
    ds_read_b64_tr_b16 a[120:121], v23 offset:16384
    ds_read_b64_tr_b16 a[122:123], v23 offset:16896
    ds_read_b64_tr_b16 a[124:125], v23 offset:16640
    ds_read_b64_tr_b16 a[126:127], v23 offset:17152
    s_waitcnt vmcnt(0) lgkmcnt(0)
    s_barrier
    ds_read_b64_tr_b16 a[224:225], v20 offset:24576
    ds_read_b64_tr_b16 a[226:227], v20 offset:25088
    ds_read_b64_tr_b16 a[228:229], v20 offset:24832
    ds_read_b64_tr_b16 a[230:231], v20 offset:25344
    ds_read_b64_tr_b16 a[232:233], v21 offset:24576
    ds_read_b64_tr_b16 a[234:235], v21 offset:25088
    ds_read_b64_tr_b16 a[236:237], v21 offset:24832
    ds_read_b64_tr_b16 a[238:239], v21 offset:25344
    ds_read_b64_tr_b16 a[240:241], v22 offset:24576
    ds_read_b64_tr_b16 a[242:243], v22 offset:25088
    ds_read_b64_tr_b16 a[244:245], v22 offset:24832
    ds_read_b64_tr_b16 a[246:247], v22 offset:25344
    ds_read_b64_tr_b16 a[248:249], v23 offset:24576
    ds_read_b64_tr_b16 a[250:251], v23 offset:25088
    ds_read_b64_tr_b16 a[252:253], v23 offset:24832
    ds_read_b64_tr_b16 a[254:255], v23 offset:25344
    s_waitcnt lgkmcnt(0)
    s_barrier
    v_lshlrev_b32 v88, 16, v28
    v_and_b32 v89, 0xffff0000, v28
    v_lshlrev_b32 v90, 16, v29
    v_and_b32 v91, 0xffff0000, v29
    v_lshlrev_b32 v92, 16, v30
    v_and_b32 v93, 0xffff0000, v30
    v_lshlrev_b32 v94, 16, v31
    v_and_b32 v95, 0xffff0000, v31
    v_lshlrev_b32 v96, 16, v32
    v_and_b32 v97, 0xffff0000, v32
    v_lshlrev_b32 v98, 16, v33
    v_and_b32 v99, 0xffff0000, v33
    v_lshlrev_b32 v100, 16, v34
    v_and_b32 v101, 0xffff0000, v34
    v_lshlrev_b32 v102, 16, v35
    v_and_b32 v103, 0xffff0000, v35
    v_lshlrev_b32 v104, 16, v36
    v_and_b32 v105, 0xffff0000, v36
    v_lshlrev_b32 v106, 16, v37
    v_and_b32 v107, 0xffff0000, v37
    v_lshlrev_b32 v108, 16, v38
    v_and_b32 v109, 0xffff0000, v38
    v_lshlrev_b32 v110, 16, v39
    v_and_b32 v111, 0xffff0000, v39
poll_5:
    buffer_load_dword v8, v1, s[12:15], 0 offen offset:192 sc1
    s_waitcnt vmcnt(0)
    v_cmp_gt_u32 vcc, 1, v8
    s_cbranch_vccz pdone_6
    s_add_u32 s63, s63, 1
    s_cmp_gt_u32 s63, 400000
    s_cbranch_scc1 pdone_6
    s_sleep 2
    s_branch poll_5
pdone_6:
    v_lshlrev_b32 v9, 7, v0
    s_mov_b32 s68, 20480
poll_7:
    buffer_load_dword v8, v9, s[8:11], s68 offen offset:0 sc1
    s_waitcnt vmcnt(0)
    v_cmp_gt_u32 vcc, 1, v8
    s_cbranch_vccz pdone_8
    s_add_u32 s63, s63, 1
    s_cmp_gt_u32 s63, 400000
    s_cbranch_scc1 pdone_8
    s_sleep 2
    s_branch poll_7
pdone_8:
    s_cmp_lt_u32 s64, 8
    s_cselect_b32 s66, 0, 4
    s_cselect_b32 s74, 8, 16
    s_cselect_b32 s68, 0, -8
    s_add_u32 s67, s64, s68
    s_mov_b32 s70, 0
    s_lshl_b32 s72, s60, 13
    s_lshl_b32 s73, s67, 15
    s_add_u32 s73, s73, s72
    s_add_u32 s73, s73, 0x100000
    s_add_u32 m0, s72, 0
    s_add_u32 s68, s73, 0
    buffer_load_dwordx4 v2, s[8:11], s68 offen offset:0 sc1 lds
    buffer_load_dwordx4 v2, s[8:11], s68 offen offset:1024 sc1 lds
    buffer_load_dwordx4 v2, s[8:11], s68 offen offset:2048 sc1 lds
    buffer_load_dwordx4 v2, s[8:11], s68 offen offset:3072 sc1 lds
    s_add_u32 m0, s72, 4096
    s_add_u32 s68, s73, 4096
    buffer_load_dwordx4 v2, s[8:11], s68 offen offset:0 sc1 lds
    buffer_load_dwordx4 v2, s[8:11], s68 offen offset:1024 sc1 lds
    buffer_load_dwordx4 v2, s[8:11], s68 offen offset:2048 sc1 lds
    buffer_load_dwordx4 v2, s[8:11], s68 offen offset:3072 sc1 lds
    s_mul_i32 s65, s65, 12
    s_add_u32 s65, s65, s60
    s_waitcnt vmcnt(0)
F_loop:
    v_add_u32 v6, s70, v2
    s_xor_b32 s70, s70, 0x8000
    s_xor_b32 s72, s72, 0x8000
    s_lshl_b32 s68, s74, 15
    s_cmp_eq_u32 s66, 1
    s_cselect_b32 s68, 0, s68
    s_add_u32 s73, s73, s68
    s_waitcnt vmcnt(6)
    s_barrier
    ds_read_b128 v[64:67], v6 offset:0
    ds_read_b128 v[68:71], v6 offset:16384
    ds_read_b128 v[72:75], v6 offset:1024
    ds_read_b128 v[76:79], v6 offset:17408
    ds_read_b128 v[80:83], v6 offset:2048
    ds_read_b128 v[84:87], v6 offset:18432
    s_waitcnt lgkmcnt(4)
    v_mfma_f32_16x16x32_bf16 v[16:19], v[128:131], v[64:67], 0
    v_mfma_f32_16x16x32_bf16 v[20:23], v[128:131], v[68:71], 0
    v_mfma_f32_16x16x32_bf16 v[24:27], v[136:139], v[64:67], 0
    v_mfma_f32_16x16x32_bf16 v[28:31], v[136:139], v[68:71], 0
    v_mfma_f32_16x16x32_bf16 v[32:35], a[0:3], v[64:67], 0
    v_mfma_f32_16x16x32_bf16 v[36:39], a[0:3], v[68:71], 0
    s_add_u32 m0, s72, 0
    s_add_u32 s68, s73, 0
    buffer_load_dwordx4 v2, s[8:11], s68 offen offset:0 sc1 lds
    v_mfma_f32_16x16x32_bf16 v[40:43], a[8:11], v[64:67], 0
    v_mfma_f32_16x16x32_bf16 v[44:47], a[8:11], v[68:71], 0
    v_mfma_f32_16x16x32_bf16 v[48:51], a[128:131], v[64:67], 0
    v_mfma_f32_16x16x32_bf16 v[52:55], a[128:131], v[68:71], 0
    v_mfma_f32_16x16x32_bf16 v[56:59], a[136:139], v[64:67], 0
    v_mfma_f32_16x16x32_bf16 v[60:63], a[136:139], v[68:71], 0
    ds_read_b128 v[64:67], v6 offset:3072
    ds_read_b128 v[68:71], v6 offset:19456
    s_waitcnt lgkmcnt(4)
    v_mfma_f32_16x16x32_bf16 v[16:19], v[132:135], v[72:75], v[16:19]
    v_mfma_f32_16x16x32_bf16 v[20:23], v[132:135], v[76:79], v[20:23]
    v_mfma_f32_16x16x32_bf16 v[24:27], v[140:143], v[72:75], v[24:27]
    v_mfma_f32_16x16x32_bf16 v[28:31], v[140:143], v[76:79], v[28:31]
    v_mfma_f32_16x16x32_bf16 v[32:35], a[4:7], v[72:75], v[32:35]
    v_mfma_f32_16x16x32_bf16 v[36:39], a[4:7], v[76:79], v[36:39]
    buffer_load_dwordx4 v2, s[8:11], s68 offen offset:1024 sc1 lds
    v_mfma_f32_16x16x32_bf16 v[40:43], a[12:15], v[72:75], v[40:43]
    v_mfma_f32_16x16x32_bf16 v[44:47], a[12:15], v[76:79], v[44:47]
    v_mfma_f32_16x16x32_bf16 v[48:51], a[132:135], v[72:75], v[48:51]
    v_mfma_f32_16x16x32_bf16 v[52:55], a[132:135], v[76:79], v[52:55]
    v_mfma_f32_16x16x32_bf16 v[56:59], a[140:143], v[72:75], v[56:59]
    v_mfma_f32_16x16x32_bf16 v[60:63], a[140:143], v[76:79], v[60:63]
    ds_read_b128 v[72:75], v6 offset:4096
    ds_read_b128 v[76:79], v6 offset:20480
    s_waitcnt lgkmcnt(4)
    v_mfma_f32_16x16x32_bf16 v[16:19], v[144:147], v[80:83], v[16:19]
    v_mfma_f32_16x16x32_bf16 v[20:23], v[144:147], v[84:87], v[20:23]
    v_mfma_f32_16x16x32_bf16 v[24:27], v[152:155], v[80:83], v[24:27]
    v_mfma_f32_16x16x32_bf16 v[28:31], v[152:155], v[84:87], v[28:31]
    v_mfma_f32_16x16x32_bf16 v[32:35], a[16:19], v[80:83], v[32:35]
    v_mfma_f32_16x16x32_bf16 v[36:39], a[16:19], v[84:87], v[36:39]
    buffer_load_dwordx4 v2, s[8:11], s68 offen offset:2048 sc1 lds
    v_mfma_f32_16x16x32_bf16 v[40:43], a[24:27], v[80:83], v[40:43]
    v_mfma_f32_16x16x32_bf16 v[44:47], a[24:27], v[84:87], v[44:47]
    v_mfma_f32_16x16x32_bf16 v[48:51], a[144:147], v[80:83], v[48:51]
    v_mfma_f32_16x16x32_bf16 v[52:55], a[144:147], v[84:87], v[52:55]
    v_mfma_f32_16x16x32_bf16 v[56:59], a[152:155], v[80:83], v[56:59]
    v_mfma_f32_16x16x32_bf16 v[60:63], a[152:155], v[84:87], v[60:63]
    ds_read_b128 v[80:83], v6 offset:5120
    ds_read_b128 v[84:87], v6 offset:21504
    s_waitcnt lgkmcnt(4)
    v_mfma_f32_16x16x32_bf16 v[16:19], v[148:151], v[64:67], v[16:19]
    v_mfma_f32_16x16x32_bf16 v[20:23], v[148:151], v[68:71], v[20:23]
    v_mfma_f32_16x16x32_bf16 v[24:27], v[156:159], v[64:67], v[24:27]
    v_mfma_f32_16x16x32_bf16 v[28:31], v[156:159], v[68:71], v[28:31]
    v_mfma_f32_16x16x32_bf16 v[32:35], a[20:23], v[64:67], v[32:35]
    v_mfma_f32_16x16x32_bf16 v[36:39], a[20:23], v[68:71], v[36:39]
    buffer_load_dwordx4 v2, s[8:11], s68 offen offset:3072 sc1 lds
    v_mfma_f32_16x16x32_bf16 v[40:43], a[28:31], v[64:67], v[40:43]
    v_mfma_f32_16x16x32_bf16 v[44:47], a[28:31], v[68:71], v[44:47]
    v_mfma_f32_16x16x32_bf16 v[48:51], a[148:151], v[64:67], v[48:51]
    v_mfma_f32_16x16x32_bf16 v[52:55], a[148:151], v[68:71], v[52:55]
    v_mfma_f32_16x16x32_bf16 v[56:59], a[156:159], v[64:67], v[56:59]
    v_mfma_f32_16x16x32_bf16 v[60:63], a[156:159], v[68:71], v[60:63]
    ds_read_b128 v[64:67], v6 offset:6144
    ds_read_b128 v[68:71], v6 offset:22528
    s_waitcnt lgkmcnt(4)
    v_mfma_f32_16x16x32_bf16 v[16:19], v[160:163], v[72:75], v[16:19]
    v_mfma_f32_16x16x32_bf16 v[20:23], v[160:163], v[76:79], v[20:23]
    v_mfma_f32_16x16x32_bf16 v[24:27], v[168:171], v[72:75], v[24:27]
    v_mfma_f32_16x16x32_bf16 v[28:31], v[168:171], v[76:79], v[28:31]
    v_mfma_f32_16x16x32_bf16 v[32:35], a[32:35], v[72:75], v[32:35]
    v_mfma_f32_16x16x32_bf16 v[36:39], a[32:35], v[76:79], v[36:39]
    s_add_u32 m0, s72, 4096
    s_add_u32 s68, s73, 4096
    buffer_load_dwordx4 v2, s[8:11], s68 offen offset:0 sc1 lds
    v_mfma_f32_16x16x32_bf16 v[40:43], a[40:43], v[72:75], v[40:43]
    v_mfma_f32_16x16x32_bf16 v[44:47], a[40:43], v[76:79], v[44:47]
    v_mfma_f32_16x16x32_bf16 v[48:51], a[160:163], v[72:75], v[48:51]
    v_mfma_f32_16x16x32_bf16 v[52:55], a[160:163], v[76:79], v[52:55]
    v_mfma_f32_16x16x32_bf16 v[56:59], a[168:171], v[72:75], v[56:59]
    v_mfma_f32_16x16x32_bf16 v[60:63], a[168:171], v[76:79], v[60:63]
    ds_read_b128 v[72:75], v6 offset:7168
    ds_read_b128 v[76:79], v6 offset:23552
    s_waitcnt lgkmcnt(4)
    v_mfma_f32_16x16x32_bf16 v[16:19], v[164:167], v[80:83], v[16:19]
    v_mfma_f32_16x16x32_bf16 v[20:23], v[164:167], v[84:87], v[20:23]
    v_mfma_f32_16x16x32_bf16 v[24:27], v[172:175], v[80:83], v[24:27]
    v_mfma_f32_16x16x32_bf16 v[28:31], v[172:175], v[84:87], v[28:31]
    v_mfma_f32_16x16x32_bf16 v[32:35], a[36:39], v[80:83], v[32:35]
    v_mfma_f32_16x16x32_bf16 v[36:39], a[36:39], v[84:87], v[36:39]
    buffer_load_dwordx4 v2, s[8:11], s68 offen offset:1024 sc1 lds
    v_mfma_f32_16x16x32_bf16 v[40:43], a[44:47], v[80:83], v[40:43]
    v_mfma_f32_16x16x32_bf16 v[44:47], a[44:47], v[84:87], v[44:47]
    v_mfma_f32_16x16x32_bf16 v[48:51], a[164:167], v[80:83], v[48:51]
    v_mfma_f32_16x16x32_bf16 v[52:55], a[164:167], v[84:87], v[52:55]
    v_mfma_f32_16x16x32_bf16 v[56:59], a[172:175], v[80:83], v[56:59]
    v_mfma_f32_16x16x32_bf16 v[60:63], a[172:175], v[84:87], v[60:63]
    ds_read_b128 v[80:83], v6 offset:8192
    ds_read_b128 v[84:87], v6 offset:24576
    s_waitcnt lgkmcnt(4)
    v_mfma_f32_16x16x32_bf16 v[16:19], v[176:179], v[64:67], v[16:19]
    v_mfma_f32_16x16x32_bf16 v[20:23], v[176:179], v[68:71], v[20:23]
    v_mfma_f32_16x16x32_bf16 v[24:27], v[184:187], v[64:67], v[24:27]
    v_mfma_f32_16x16x32_bf16 v[28:31], v[184:187], v[68:71], v[28:31]
    v_mfma_f32_16x16x32_bf16 v[32:35], a[48:51], v[64:67], v[32:35]
    v_mfma_f32_16x16x32_bf16 v[36:39], a[48:51], v[68:71], v[36:39]
    buffer_load_dwordx4 v2, s[8:11], s68 offen offset:2048 sc1 lds
    v_mfma_f32_16x16x32_bf16 v[40:43], a[56:59], v[64:67], v[40:43]
    v_mfma_f32_16x16x32_bf16 v[44:47], a[56:59], v[68:71], v[44:47]
    v_mfma_f32_16x16x32_bf16 v[48:51], a[176:179], v[64:67], v[48:51]
    v_mfma_f32_16x16x32_bf16 v[52:55], a[176:179], v[68:71], v[52:55]
    v_mfma_f32_16x16x32_bf16 v[56:59], a[184:187], v[64:67], v[56:59]
    v_mfma_f32_16x16x32_bf16 v[60:63], a[184:187], v[68:71], v[60:63]
    ds_read_b128 v[64:67], v6 offset:9216
    ds_read_b128 v[68:71], v6 offset:25600
    s_waitcnt lgkmcnt(4)
    v_mfma_f32_16x16x32_bf16 v[16:19], v[180:183], v[72:75], v[16:19]
    v_mfma_f32_16x16x32_bf16 v[20:23], v[180:183], v[76:79], v[20:23]
    v_mfma_f32_16x16x32_bf16 v[24:27], v[188:191], v[72:75], v[24:27]
    v_mfma_f32_16x16x32_bf16 v[28:31], v[188:191], v[76:79], v[28:31]
    v_mfma_f32_16x16x32_bf16 v[32:35], a[52:55], v[72:75], v[32:35]
    v_mfma_f32_16x16x32_bf16 v[36:39], a[52:55], v[76:79], v[36:39]
    buffer_load_dwordx4 v2, s[8:11], s68 offen offset:3072 sc1 lds
    v_mfma_f32_16x16x32_bf16 v[40:43], a[60:63], v[72:75], v[40:43]
    v_mfma_f32_16x16x32_bf16 v[44:47], a[60:63], v[76:79], v[44:47]
    v_mfma_f32_16x16x32_bf16 v[48:51], a[180:183], v[72:75], v[48:51]
    v_mfma_f32_16x16x32_bf16 v[52:55], a[180:183], v[76:79], v[52:55]
    v_mfma_f32_16x16x32_bf16 v[56:59], a[188:191], v[72:75], v[56:59]
    v_mfma_f32_16x16x32_bf16 v[60:63], a[188:191], v[76:79], v[60:63]
    ds_read_b128 v[72:75], v6 offset:10240
    ds_read_b128 v[76:79], v6 offset:26624
    s_waitcnt lgkmcnt(4)
    v_mfma_f32_16x16x32_bf16 v[16:19], v[192:195], v[80:83], v[16:19]
    v_mfma_f32_16x16x32_bf16 v[20:23], v[192:195], v[84:87], v[20:23]
    v_mfma_f32_16x16x32_bf16 v[24:27], v[200:203], v[80:83], v[24:27]
    v_mfma_f32_16x16x32_bf16 v[28:31], v[200:203], v[84:87], v[28:31]
    v_mfma_f32_16x16x32_bf16 v[32:35], a[64:67], v[80:83], v[32:35]
    v_mfma_f32_16x16x32_bf16 v[36:39], a[64:67], v[84:87], v[36:39]
    v_mfma_f32_16x16x32_bf16 v[40:43], a[72:75], v[80:83], v[40:43]
    v_mfma_f32_16x16x32_bf16 v[44:47], a[72:75], v[84:87], v[44:47]
    v_mfma_f32_16x16x32_bf16 v[48:51], a[192:195], v[80:83], v[48:51]
    v_mfma_f32_16x16x32_bf16 v[52:55], a[192:195], v[84:87], v[52:55]
    v_mfma_f32_16x16x32_bf16 v[56:59], a[200:203], v[80:83], v[56:59]
    v_mfma_f32_16x16x32_bf16 v[60:63], a[200:203], v[84:87], v[60:63]
    ds_read_b128 v[80:83], v6 offset:11264
    ds_read_b128 v[84:87], v6 offset:27648
    s_waitcnt lgkmcnt(4)
    v_mfma_f32_16x16x32_bf16 v[16:19], v[196:199], v[64:67], v[16:19]
    v_mfma_f32_16x16x32_bf16 v[20:23], v[196:199], v[68:71], v[20:23]
    v_mfma_f32_16x16x32_bf16 v[24:27], v[204:207], v[64:67], v[24:27]
    v_mfma_f32_16x16x32_bf16 v[28:31], v[204:207], v[68:71], v[28:31]
    v_mfma_f32_16x16x32_bf16 v[32:35], a[68:71], v[64:67], v[32:35]
    v_mfma_f32_16x16x32_bf16 v[36:39], a[68:71], v[68:71], v[36:39]
    v_mfma_f32_16x16x32_bf16 v[40:43], a[76:79], v[64:67], v[40:43]
    v_mfma_f32_16x16x32_bf16 v[44:47], a[76:79], v[68:71], v[44:47]
    v_mfma_f32_16x16x32_bf16 v[48:51], a[196:199], v[64:67], v[48:51]
    v_mfma_f32_16x16x32_bf16 v[52:55], a[196:199], v[68:71], v[52:55]
    v_mfma_f32_16x16x32_bf16 v[56:59], a[204:207], v[64:67], v[56:59]
    v_mfma_f32_16x16x32_bf16 v[60:63], a[204:207], v[68:71], v[60:63]
    ds_read_b128 v[64:67], v6 offset:12288
    ds_read_b128 v[68:71], v6 offset:28672
    s_waitcnt lgkmcnt(4)
    v_mfma_f32_16x16x32_bf16 v[16:19], v[208:211], v[72:75], v[16:19]
    v_mfma_f32_16x16x32_bf16 v[20:23], v[208:211], v[76:79], v[20:23]
    v_mfma_f32_16x16x32_bf16 v[24:27], v[216:219], v[72:75], v[24:27]
    v_mfma_f32_16x16x32_bf16 v[28:31], v[216:219], v[76:79], v[28:31]
    v_mfma_f32_16x16x32_bf16 v[32:35], a[80:83], v[72:75], v[32:35]
    v_mfma_f32_16x16x32_bf16 v[36:39], a[80:83], v[76:79], v[36:39]
    v_mfma_f32_16x16x32_bf16 v[40:43], a[88:91], v[72:75], v[40:43]
    v_mfma_f32_16x16x32_bf16 v[44:47], a[88:91], v[76:79], v[44:47]
    v_mfma_f32_16x16x32_bf16 v[48:51], a[208:211], v[72:75], v[48:51]
    v_mfma_f32_16x16x32_bf16 v[52:55], a[208:211], v[76:79], v[52:55]
    v_mfma_f32_16x16x32_bf16 v[56:59], a[216:219], v[72:75], v[56:59]
    v_mfma_f32_16x16x32_bf16 v[60:63], a[216:219], v[76:79], v[60:63]
    ds_read_b128 v[72:75], v6 offset:13312
    ds_read_b128 v[76:79], v6 offset:29696
    s_waitcnt lgkmcnt(4)
    v_mfma_f32_16x16x32_bf16 v[16:19], v[212:215], v[80:83], v[16:19]
    v_mfma_f32_16x16x32_bf16 v[20:23], v[212:215], v[84:87], v[20:23]
    v_mfma_f32_16x16x32_bf16 v[24:27], v[220:223], v[80:83], v[24:27]
    v_mfma_f32_16x16x32_bf16 v[28:31], v[220:223], v[84:87], v[28:31]
    v_mfma_f32_16x16x32_bf16 v[32:35], a[84:87], v[80:83], v[32:35]
    v_mfma_f32_16x16x32_bf16 v[36:39], a[84:87], v[84:87], v[36:39]
    v_mfma_f32_16x16x32_bf16 v[40:43], a[92:95], v[80:83], v[40:43]
    v_mfma_f32_16x16x32_bf16 v[44:47], a[92:95], v[84:87], v[44:47]
    v_mfma_f32_16x16x32_bf16 v[48:51], a[212:215], v[80:83], v[48:51]
    v_mfma_f32_16x16x32_bf16 v[52:55], a[212:215], v[84:87], v[52:55]
    v_mfma_f32_16x16x32_bf16 v[56:59], a[220:223], v[80:83], v[56:59]
    v_mfma_f32_16x16x32_bf16 v[60:63], a[220:223], v[84:87], v[60:63]
    ds_read_b128 v[80:83], v6 offset:14336
    ds_read_b128 v[84:87], v6 offset:30720
    s_waitcnt lgkmcnt(4)
    v_mfma_f32_16x16x32_bf16 v[16:19], v[224:227], v[64:67], v[16:19]
    v_mfma_f32_16x16x32_bf16 v[20:23], v[224:227], v[68:71], v[20:23]
    v_mfma_f32_16x16x32_bf16 v[24:27], v[232:235], v[64:67], v[24:27]
    v_mfma_f32_16x16x32_bf16 v[28:31], v[232:235], v[68:71], v[28:31]
    v_mfma_f32_16x16x32_bf16 v[32:35], a[96:99], v[64:67], v[32:35]
    v_mfma_f32_16x16x32_bf16 v[36:39], a[96:99], v[68:71], v[36:39]
    v_mfma_f32_16x16x32_bf16 v[40:43], a[104:107], v[64:67], v[40:43]
    v_mfma_f32_16x16x32_bf16 v[44:47], a[104:107], v[68:71], v[44:47]
    v_mfma_f32_16x16x32_bf16 v[48:51], a[224:227], v[64:67], v[48:51]
    v_mfma_f32_16x16x32_bf16 v[52:55], a[224:227], v[68:71], v[52:55]
    v_mfma_f32_16x16x32_bf16 v[56:59], a[232:235], v[64:67], v[56:59]
    v_mfma_f32_16x16x32_bf16 v[60:63], a[232:235], v[68:71], v[60:63]
    ds_read_b128 v[64:67], v6 offset:15360
    ds_read_b128 v[68:71], v6 offset:31744
    s_waitcnt lgkmcnt(4)
    v_mfma_f32_16x16x32_bf16 v[16:19], v[228:231], v[72:75], v[16:19]
    v_mfma_f32_16x16x32_bf16 v[20:23], v[228:231], v[76:79], v[20:23]
    v_mfma_f32_16x16x32_bf16 v[24:27], v[236:239], v[72:75], v[24:27]
    v_mfma_f32_16x16x32_bf16 v[28:31], v[236:239], v[76:79], v[28:31]
    v_mfma_f32_16x16x32_bf16 v[32:35], a[100:103], v[72:75], v[32:35]
    v_mfma_f32_16x16x32_bf16 v[36:39], a[100:103], v[76:79], v[36:39]
    v_mfma_f32_16x16x32_bf16 v[40:43], a[108:111], v[72:75], v[40:43]
    v_mfma_f32_16x16x32_bf16 v[44:47], a[108:111], v[76:79], v[44:47]
    v_mfma_f32_16x16x32_bf16 v[48:51], a[228:231], v[72:75], v[48:51]
    v_mfma_f32_16x16x32_bf16 v[52:55], a[228:231], v[76:79], v[52:55]
    v_mfma_f32_16x16x32_bf16 v[56:59], a[236:239], v[72:75], v[56:59]
    v_mfma_f32_16x16x32_bf16 v[60:63], a[236:239], v[76:79], v[60:63]
    s_waitcnt lgkmcnt(2)
    v_mfma_f32_16x16x32_bf16 v[16:19], v[240:243], v[80:83], v[16:19]
    v_mfma_f32_16x16x32_bf16 v[20:23], v[240:243], v[84:87], v[20:23]
    v_mfma_f32_16x16x32_bf16 v[24:27], v[248:251], v[80:83], v[24:27]
    v_mfma_f32_16x16x32_bf16 v[28:31], v[248:251], v[84:87], v[28:31]
    v_mfma_f32_16x16x32_bf16 v[32:35], a[112:115], v[80:83], v[32:35]
    v_mfma_f32_16x16x32_bf16 v[36:39], a[112:115], v[84:87], v[36:39]
    v_mfma_f32_16x16x32_bf16 v[40:43], a[120:123], v[80:83], v[40:43]
    v_mfma_f32_16x16x32_bf16 v[44:47], a[120:123], v[84:87], v[44:47]
    v_mfma_f32_16x16x32_bf16 v[48:51], a[240:243], v[80:83], v[48:51]
    v_mfma_f32_16x16x32_bf16 v[52:55], a[240:243], v[84:87], v[52:55]
    v_mfma_f32_16x16x32_bf16 v[56:59], a[248:251], v[80:83], v[56:59]
    v_mfma_f32_16x16x32_bf16 v[60:63], a[248:251], v[84:87], v[60:63]
    s_waitcnt lgkmcnt(0)
    v_mfma_f32_16x16x32_bf16 v[16:19], v[244:247], v[64:67], v[16:19]
    v_mfma_f32_16x16x32_bf16 v[20:23], v[244:247], v[68:71], v[20:23]
    v_mfma_f32_16x16x32_bf16 v[24:27], v[252:255], v[64:67], v[24:27]
    v_mfma_f32_16x16x32_bf16 v[28:31], v[252:255], v[68:71], v[28:31]
    v_mfma_f32_16x16x32_bf16 v[32:35], a[116:119], v[64:67], v[32:35]
    v_mfma_f32_16x16x32_bf16 v[36:39], a[116:119], v[68:71], v[36:39]
    v_mfma_f32_16x16x32_bf16 v[40:43], a[124:127], v[64:67], v[40:43]
    v_mfma_f32_16x16x32_bf16 v[44:47], a[124:127], v[68:71], v[44:47]
    v_mfma_f32_16x16x32_bf16 v[48:51], a[244:247], v[64:67], v[48:51]
    v_mfma_f32_16x16x32_bf16 v[52:55], a[244:247], v[68:71], v[52:55]
    v_mfma_f32_16x16x32_bf16 v[56:59], a[252:255], v[64:67], v[56:59]
    v_mfma_f32_16x16x32_bf16 v[60:63], a[252:255], v[68:71], v[60:63]
    s_mul_i32 s68, s67, 96
    s_add_u32 s68, s68, s65
    s_lshl_b32 s68, s68, 10
    s_add_u32 s68, s68, 0x300000
    v_cvt_pk_bf16_f32 v8, v16, v17
    v_lshlrev_b32 v16, 16, v8
    v_and_b32 v17, 0xffff0000, v8
    v_add_f32 v16, v16, v88
    v_add_f32 v17, v17, v89
    v_cvt_pk_bf16_f32 v8, v16, v17
    v_lshlrev_b32 v16, 16, v8
    v_and_b32 v17, 0xffff0000, v8
    v_max_f32 v16, 0, v16
    v_max_f32 v17, 0, v17
    v_mul_f32 v16, v16, v16
    v_mul_f32 v17, v17, v17
    v_cvt_pk_bf16_f32 v112, v16, v17
    v_cvt_pk_bf16_f32 v8, v18, v19
    v_lshlrev_b32 v18, 16, v8
    v_and_b32 v19, 0xffff0000, v8
    v_add_f32 v18, v18, v90
    v_add_f32 v19, v19, v91
    v_cvt_pk_bf16_f32 v8, v18, v19
    v_lshlrev_b32 v18, 16, v8
    v_and_b32 v19, 0xffff0000, v8
    v_max_f32 v18, 0, v18
    v_max_f32 v19, 0, v19
    v_mul_f32 v18, v18, v18
    v_mul_f32 v19, v19, v19
    v_cvt_pk_bf16_f32 v113, v18, v19
    v_cvt_pk_bf16_f32 v8, v24, v25
    v_lshlrev_b32 v24, 16, v8
    v_and_b32 v25, 0xffff0000, v8
    v_add_f32 v24, v24, v92
    v_add_f32 v25, v25, v93
    v_cvt_pk_bf16_f32 v8, v24, v25
    v_lshlrev_b32 v24, 16, v8
    v_and_b32 v25, 0xffff0000, v8
    v_max_f32 v24, 0, v24
    v_max_f32 v25, 0, v25
    v_mul_f32 v24, v24, v24
    v_mul_f32 v25, v25, v25
    v_cvt_pk_bf16_f32 v114, v24, v25
    v_cvt_pk_bf16_f32 v8, v26, v27
    v_lshlrev_b32 v26, 16, v8
    v_and_b32 v27, 0xffff0000, v8
    v_add_f32 v26, v26, v94
    v_add_f32 v27, v27, v95
    v_cvt_pk_bf16_f32 v8, v26, v27
    v_lshlrev_b32 v26, 16, v8
    v_and_b32 v27, 0xffff0000, v8
    v_max_f32 v26, 0, v26
    v_max_f32 v27, 0, v27
    v_mul_f32 v26, v26, v26
    v_mul_f32 v27, v27, v27
    v_cvt_pk_bf16_f32 v115, v26, v27
    s_add_u32 s69, s68, 0
    buffer_store_dwordx4 v[112:115], v2, s[8:11], s69 offen sc1
    v_cvt_pk_bf16_f32 v8, v32, v33
    v_lshlrev_b32 v32, 16, v8
    v_and_b32 v33, 0xffff0000, v8
    v_add_f32 v32, v32, v96
    v_add_f32 v33, v33, v97
    v_cvt_pk_bf16_f32 v8, v32, v33
    v_lshlrev_b32 v32, 16, v8
    v_and_b32 v33, 0xffff0000, v8
    v_max_f32 v32, 0, v32
    v_max_f32 v33, 0, v33
    v_mul_f32 v32, v32, v32
    v_mul_f32 v33, v33, v33
    v_cvt_pk_bf16_f32 v116, v32, v33
    v_cvt_pk_bf16_f32 v8, v34, v35
    v_lshlrev_b32 v34, 16, v8
    v_and_b32 v35, 0xffff0000, v8
    v_add_f32 v34, v34, v98
    v_add_f32 v35, v35, v99
    v_cvt_pk_bf16_f32 v8, v34, v35
    v_lshlrev_b32 v34, 16, v8
    v_and_b32 v35, 0xffff0000, v8
    v_max_f32 v34, 0, v34
    v_max_f32 v35, 0, v35
    v_mul_f32 v34, v34, v34
    v_mul_f32 v35, v35, v35
    v_cvt_pk_bf16_f32 v117, v34, v35
    v_cvt_pk_bf16_f32 v8, v40, v41
    v_lshlrev_b32 v40, 16, v8
    v_and_b32 v41, 0xffff0000, v8
    v_add_f32 v40, v40, v100
    v_add_f32 v41, v41, v101
    v_cvt_pk_bf16_f32 v8, v40, v41
    v_lshlrev_b32 v40, 16, v8
    v_and_b32 v41, 0xffff0000, v8
    v_max_f32 v40, 0, v40
    v_max_f32 v41, 0, v41
    v_mul_f32 v40, v40, v40
    v_mul_f32 v41, v41, v41
    v_cvt_pk_bf16_f32 v118, v40, v41
    v_cvt_pk_bf16_f32 v8, v42, v43
    v_lshlrev_b32 v42, 16, v8
    v_and_b32 v43, 0xffff0000, v8
    v_add_f32 v42, v42, v102
    v_add_f32 v43, v43, v103
    v_cvt_pk_bf16_f32 v8, v42, v43
    v_lshlrev_b32 v42, 16, v8
    v_and_b32 v43, 0xffff0000, v8
    v_max_f32 v42, 0, v42
    v_max_f32 v43, 0, v43
    v_mul_f32 v42, v42, v42
    v_mul_f32 v43, v43, v43
    v_cvt_pk_bf16_f32 v119, v42, v43
    s_add_u32 s69, s68, 4096
    buffer_store_dwordx4 v[116:119], v2, s[8:11], s69 offen sc1
    v_cvt_pk_bf16_f32 v8, v48, v49
    v_lshlrev_b32 v48, 16, v8
    v_and_b32 v49, 0xffff0000, v8
    v_add_f32 v48, v48, v104
    v_add_f32 v49, v49, v105
    v_cvt_pk_bf16_f32 v8, v48, v49
    v_lshlrev_b32 v48, 16, v8
    v_and_b32 v49, 0xffff0000, v8
    v_max_f32 v48, 0, v48
    v_max_f32 v49, 0, v49
    v_mul_f32 v48, v48, v48
    v_mul_f32 v49, v49, v49
    v_cvt_pk_bf16_f32 v120, v48, v49
    v_cvt_pk_bf16_f32 v8, v50, v51
    v_lshlrev_b32 v50, 16, v8
    v_and_b32 v51, 0xffff0000, v8
    v_add_f32 v50, v50, v106
    v_add_f32 v51, v51, v107
    v_cvt_pk_bf16_f32 v8, v50, v51
    v_lshlrev_b32 v50, 16, v8
    v_and_b32 v51, 0xffff0000, v8
    v_max_f32 v50, 0, v50
    v_max_f32 v51, 0, v51
    v_mul_f32 v50, v50, v50
    v_mul_f32 v51, v51, v51
    v_cvt_pk_bf16_f32 v121, v50, v51
    v_cvt_pk_bf16_f32 v8, v56, v57
    v_lshlrev_b32 v56, 16, v8
    v_and_b32 v57, 0xffff0000, v8
    v_add_f32 v56, v56, v108
    v_add_f32 v57, v57, v109
    v_cvt_pk_bf16_f32 v8, v56, v57
    v_lshlrev_b32 v56, 16, v8
    v_and_b32 v57, 0xffff0000, v8
    v_max_f32 v56, 0, v56
    v_max_f32 v57, 0, v57
    v_mul_f32 v56, v56, v56
    v_mul_f32 v57, v57, v57
    v_cvt_pk_bf16_f32 v122, v56, v57
    v_cvt_pk_bf16_f32 v8, v58, v59
    v_lshlrev_b32 v58, 16, v8
    v_and_b32 v59, 0xffff0000, v8
    v_add_f32 v58, v58, v110
    v_add_f32 v59, v59, v111
    v_cvt_pk_bf16_f32 v8, v58, v59
    v_lshlrev_b32 v58, 16, v8
    v_and_b32 v59, 0xffff0000, v8
    v_max_f32 v58, 0, v58
    v_max_f32 v59, 0, v59
    v_mul_f32 v58, v58, v58
    v_mul_f32 v59, v59, v59
    v_cvt_pk_bf16_f32 v123, v58, v59
    s_add_u32 s69, s68, 8192
    buffer_store_dwordx4 v[120:123], v2, s[8:11], s69 offen sc1
    v_cvt_pk_bf16_f32 v8, v20, v21
    v_lshlrev_b32 v20, 16, v8
    v_and_b32 v21, 0xffff0000, v8
    v_add_f32 v20, v20, v88
    v_add_f32 v21, v21, v89
    v_cvt_pk_bf16_f32 v8, v20, v21
    v_lshlrev_b32 v20, 16, v8
    v_and_b32 v21, 0xffff0000, v8
    v_max_f32 v20, 0, v20
    v_max_f32 v21, 0, v21
    v_mul_f32 v20, v20, v20
    v_mul_f32 v21, v21, v21
    v_cvt_pk_bf16_f32 v124, v20, v21
    v_cvt_pk_bf16_f32 v8, v22, v23
    v_lshlrev_b32 v22, 16, v8
    v_and_b32 v23, 0xffff0000, v8
    v_add_f32 v22, v22, v90
    v_add_f32 v23, v23, v91
    v_cvt_pk_bf16_f32 v8, v22, v23
    v_lshlrev_b32 v22, 16, v8
    v_and_b32 v23, 0xffff0000, v8
    v_max_f32 v22, 0, v22
    v_max_f32 v23, 0, v23
    v_mul_f32 v22, v22, v22
    v_mul_f32 v23, v23, v23
    v_cvt_pk_bf16_f32 v125, v22, v23
    v_cvt_pk_bf16_f32 v8, v28, v29
    v_lshlrev_b32 v28, 16, v8
    v_and_b32 v29, 0xffff0000, v8
    v_add_f32 v28, v28, v92
    v_add_f32 v29, v29, v93
    v_cvt_pk_bf16_f32 v8, v28, v29
    v_lshlrev_b32 v28, 16, v8
    v_and_b32 v29, 0xffff0000, v8
    v_max_f32 v28, 0, v28
    v_max_f32 v29, 0, v29
    v_mul_f32 v28, v28, v28
    v_mul_f32 v29, v29, v29
    v_cvt_pk_bf16_f32 v126, v28, v29
    v_cvt_pk_bf16_f32 v8, v30, v31
    v_lshlrev_b32 v30, 16, v8
    v_and_b32 v31, 0xffff0000, v8
    v_add_f32 v30, v30, v94
    v_add_f32 v31, v31, v95
    v_cvt_pk_bf16_f32 v8, v30, v31
    v_lshlrev_b32 v30, 16, v8
    v_and_b32 v31, 0xffff0000, v8
    v_max_f32 v30, 0, v30
    v_max_f32 v31, 0, v31
    v_mul_f32 v30, v30, v30
    v_mul_f32 v31, v31, v31
    v_cvt_pk_bf16_f32 v127, v30, v31
    s_add_u32 s69, s68, 49152
    buffer_store_dwordx4 v[124:127], v2, s[8:11], s69 offen sc1
    v_cvt_pk_bf16_f32 v8, v36, v37
    v_lshlrev_b32 v36, 16, v8
    v_and_b32 v37, 0xffff0000, v8
    v_add_f32 v36, v36, v96
    v_add_f32 v37, v37, v97
    v_cvt_pk_bf16_f32 v8, v36, v37
    v_lshlrev_b32 v36, 16, v8
    v_and_b32 v37, 0xffff0000, v8
    v_max_f32 v36, 0, v36
    v_max_f32 v37, 0, v37
    v_mul_f32 v36, v36, v36
    v_mul_f32 v37, v37, v37
    v_cvt_pk_bf16_f32 v112, v36, v37
    v_cvt_pk_bf16_f32 v8, v38, v39
    v_lshlrev_b32 v38, 16, v8
    v_and_b32 v39, 0xffff0000, v8
    v_add_f32 v38, v38, v98
    v_add_f32 v39, v39, v99
    v_cvt_pk_bf16_f32 v8, v38, v39
    v_lshlrev_b32 v38, 16, v8
    v_and_b32 v39, 0xffff0000, v8
    v_max_f32 v38, 0, v38
    v_max_f32 v39, 0, v39
    v_mul_f32 v38, v38, v38
    v_mul_f32 v39, v39, v39
    v_cvt_pk_bf16_f32 v113, v38, v39
    v_cvt_pk_bf16_f32 v8, v44, v45
    v_lshlrev_b32 v44, 16, v8
    v_and_b32 v45, 0xffff0000, v8
    v_add_f32 v44, v44, v100
    v_add_f32 v45, v45, v101
    v_cvt_pk_bf16_f32 v8, v44, v45
    v_lshlrev_b32 v44, 16, v8
    v_and_b32 v45, 0xffff0000, v8
    v_max_f32 v44, 0, v44
    v_max_f32 v45, 0, v45
    v_mul_f32 v44, v44, v44
    v_mul_f32 v45, v45, v45
    v_cvt_pk_bf16_f32 v114, v44, v45
    v_cvt_pk_bf16_f32 v8, v46, v47
    v_lshlrev_b32 v46, 16, v8
    v_and_b32 v47, 0xffff0000, v8
    v_add_f32 v46, v46, v102
    v_add_f32 v47, v47, v103
    v_cvt_pk_bf16_f32 v8, v46, v47
    v_lshlrev_b32 v46, 16, v8
    v_and_b32 v47, 0xffff0000, v8
    v_max_f32 v46, 0, v46
    v_max_f32 v47, 0, v47
    v_mul_f32 v46, v46, v46
    v_mul_f32 v47, v47, v47
    v_cvt_pk_bf16_f32 v115, v46, v47
    s_add_u32 s69, s68, 53248
    buffer_store_dwordx4 v[112:115], v2, s[8:11], s69 offen sc1
    v_cvt_pk_bf16_f32 v8, v52, v53
    v_lshlrev_b32 v52, 16, v8
    v_and_b32 v53, 0xffff0000, v8
    v_add_f32 v52, v52, v104
    v_add_f32 v53, v53, v105
    v_cvt_pk_bf16_f32 v8, v52, v53
    v_lshlrev_b32 v52, 16, v8
    v_and_b32 v53, 0xffff0000, v8
    v_max_f32 v52, 0, v52
    v_max_f32 v53, 0, v53
    v_mul_f32 v52, v52, v52
    v_mul_f32 v53, v53, v53
    v_cvt_pk_bf16_f32 v116, v52, v53
    v_cvt_pk_bf16_f32 v8, v54, v55
    v_lshlrev_b32 v54, 16, v8
    v_and_b32 v55, 0xffff0000, v8
    v_add_f32 v54, v54, v106
    v_add_f32 v55, v55, v107
    v_cvt_pk_bf16_f32 v8, v54, v55
    v_lshlrev_b32 v54, 16, v8
    v_and_b32 v55, 0xffff0000, v8
    v_max_f32 v54, 0, v54
    v_max_f32 v55, 0, v55
    v_mul_f32 v54, v54, v54
    v_mul_f32 v55, v55, v55
    v_cvt_pk_bf16_f32 v117, v54, v55
    v_cvt_pk_bf16_f32 v8, v60, v61
    v_lshlrev_b32 v60, 16, v8
    v_and_b32 v61, 0xffff0000, v8
    v_add_f32 v60, v60, v108
    v_add_f32 v61, v61, v109
    v_cvt_pk_bf16_f32 v8, v60, v61
    v_lshlrev_b32 v60, 16, v8
    v_and_b32 v61, 0xffff0000, v8
    v_max_f32 v60, 0, v60
    v_max_f32 v61, 0, v61
    v_mul_f32 v60, v60, v60
    v_mul_f32 v61, v61, v61
    v_cvt_pk_bf16_f32 v118, v60, v61
    v_cvt_pk_bf16_f32 v8, v62, v63
    v_lshlrev_b32 v62, 16, v8
    v_and_b32 v63, 0xffff0000, v8
    v_add_f32 v62, v62, v110
    v_add_f32 v63, v63, v111
    v_cvt_pk_bf16_f32 v8, v62, v63
    v_lshlrev_b32 v62, 16, v8
    v_and_b32 v63, 0xffff0000, v8
    v_max_f32 v62, 0, v62
    v_max_f32 v63, 0, v63
    v_mul_f32 v62, v62, v62
    v_mul_f32 v63, v63, v63
    v_cvt_pk_bf16_f32 v119, v62, v63
    s_add_u32 s69, s68, 57344
    buffer_store_dwordx4 v[116:119], v2, s[8:11], s69 offen sc1
    s_add_u32 s67, s67, s74
    s_sub_u32 s66, s66, 1
    s_cmp_lg_u32 s66, 0
    s_cbranch_scc1 F_loop
    s_waitcnt vmcnt(0)
    s_barrier
    s_cmp_lg_u32 s60, 0
    s_cbranch_scc1 F_next
    v_mov_b32 v8, 1
    s_mov_b64 exec, 1
    buffer_store_dword v8, v1, s[8:11], s71 offen offset:8 sc1
    s_mov_b64 exec, -1
F_next:
    s_cmp_lt_u32 s61, 192
    s_cbranch_scc1 L_fend
    s_sub_u32 s68, s61, 192
    s_and_b32 s64, s68, 15
    s_lshr_b32 s65, s68, 4
    v_lshlrev_b32 v2, 4, v0
    v_lshrrev_b32 v8, 2, v0
    v_mul_u32_u24 v3, 0x400, v8
    v_and_b32 v8, 3, v0
    v_lshl_add_u32 v3, v8, 4, v3
    s_lshl_b32 s68, s60, 12
    s_add_u32 s68, s68, 0x10000
    v_and_b32 v4, 3, v0
    v_lshlrev_b32 v4, 3, v4
    v_bfe_u32 v8, v0, 2, 1
    v_mul_u32_u24 v8, 64, v8
    v_add_u32 v4, v4, v8
    v_bfe_u32 v8, v0, 3, 1
    v_mul_u32_u24 v8, 128, v8
    v_add_u32 v4, v4, v8
    v_bfe_u32 v8, v0, 4, 1
    v_mul_u32_u24 v8, 256, v8
    v_add_u32 v4, v4, v8
    v_bfe_u32 v8, v0, 5, 1
    v_mul_u32_u24 v8, 512, v8
    v_add_u32 v4, v4, v8
    v_add_u32 v4, s68, v4
    v_add_u32 v5, s68, v2
    s_lshl_b32 s68, s64, 6
    s_lshl_b32 s69, s60, 20
    s_add_u32 s69, s69, s68
    s_mul_i32 s70, s60, 360448
    s_add_u32 s70, s70, s68
    s_add_u32 s68, s70, 0x0
    buffer_load_dwordx4 v[160:163], v3, s[48:51], s68 offen
    s_add_u32 s68, s70, 0x4000
    buffer_load_dwordx4 v[164:167], v3, s[48:51], s68 offen
    s_add_u32 s68, s70, 0x8000
    buffer_load_dwordx4 v[168:171], v3, s[48:51], s68 offen
    s_add_u32 s68, s70, 0xc000
    buffer_load_dwordx4 v[172:175], v3, s[48:51], s68 offen
    s_add_u32 s68, s70, 0x10000
    buffer_load_dwordx4 v[176:179], v3, s[48:51], s68 offen
    s_add_u32 s68, s70, 0x14000
    buffer_load_dwordx4 v[180:183], v3, s[48:51], s68 offen
    s_add_u32 s68, s70, 0x18000
    buffer_load_dwordx4 v[184:187], v3, s[48:51], s68 offen
    s_add_u32 s68, s70, 0x1c000
    buffer_load_dwordx4 v[188:191], v3, s[48:51], s68 offen
    s_add_u32 s68, s70, 0x20000
    buffer_load_dwordx4 v[192:195], v3, s[48:51], s68 offen
    s_add_u32 s68, s70, 0x24000
    buffer_load_dwordx4 v[196:199], v3, s[48:51], s68 offen
    s_add_u32 s68, s70, 0x28000
    buffer_load_dwordx4 v[200:203], v3, s[48:51], s68 offen
    s_add_u32 s68, s70, 0x2c000
    buffer_load_dwordx4 v[204:207], v3, s[48:51], s68 offen
    s_add_u32 s68, s70, 0x30000
    buffer_load_dwordx4 v[208:211], v3, s[48:51], s68 offen
    s_add_u32 s68, s70, 0x34000
    buffer_load_dwordx4 v[212:215], v3, s[48:51], s68 offen
    s_add_u32 s68, s70, 0x38000
    buffer_load_dwordx4 v[216:219], v3, s[48:51], s68 offen
    s_add_u32 s68, s70, 0x3c000
    buffer_load_dwordx4 v[220:223], v3, s[48:51], s68 offen
    s_add_u32 s68, s70, 0x40000
    buffer_load_dwordx4 v[224:227], v3, s[48:51], s68 offen
    s_add_u32 s68, s70, 0x44000
    buffer_load_dwordx4 v[228:231], v3, s[48:51], s68 offen
    s_add_u32 s68, s70, 0x48000
    buffer_load_dwordx4 v[232:235], v3, s[48:51], s68 offen
    s_add_u32 s68, s70, 0x4c000
    buffer_load_dwordx4 v[236:239], v3, s[48:51], s68 offen
    s_add_u32 s68, s70, 0x50000
    buffer_load_dwordx4 v[240:243], v3, s[48:51], s68 offen
    s_add_u32 s68, s70, 0x54000
    buffer_load_dwordx4 v[244:247], v3, s[48:51], s68 offen
    s_add_u32 s68, s70, 0x58000
    buffer_load_dwordx4 v[248:251], v3, s[48:51], s68 offen
    s_add_u32 s68, s70, 0x5c000
    buffer_load_dwordx4 v[252:255], v3, s[48:51], s68 offen
    s_add_u32 s68, s69, 0x0
    buffer_load_dwordx4 a[0:3], v3, s[36:39], s68 offen
    s_add_u32 s68, s69, 0x4000
    buffer_load_dwordx4 a[4:7], v3, s[36:39], s68 offen
    s_add_u32 s68, s69, 0x8000
    buffer_load_dwordx4 a[8:11], v3, s[36:39], s68 offen
    s_add_u32 s68, s69, 0xc000
    buffer_load_dwordx4 a[12:15], v3, s[36:39], s68 offen
    s_add_u32 s68, s69, 0x10000
    buffer_load_dwordx4 a[16:19], v3, s[36:39], s68 offen
    s_add_u32 s68, s69, 0x14000
    buffer_load_dwordx4 a[20:23], v3, s[36:39], s68 offen
    s_add_u32 s68, s69, 0x18000
    buffer_load_dwordx4 a[24:27], v3, s[36:39], s68 offen
    s_add_u32 s68, s69, 0x1c000
    buffer_load_dwordx4 a[28:31], v3, s[36:39], s68 offen
    s_add_u32 s68, s69, 0x20000
    buffer_load_dwordx4 a[32:35], v3, s[36:39], s68 offen
    s_add_u32 s68, s69, 0x24000
    buffer_load_dwordx4 a[36:39], v3, s[36:39], s68 offen
    s_add_u32 s68, s69, 0x28000
    buffer_load_dwordx4 a[40:43], v3, s[36:39], s68 offen
    s_add_u32 s68, s69, 0x2c000
    buffer_load_dwordx4 a[44:47], v3, s[36:39], s68 offen
    s_add_u32 s68, s69, 0x30000
    buffer_load_dwordx4 a[48:51], v3, s[36:39], s68 offen
    s_add_u32 s68, s69, 0x34000
    buffer_load_dwordx4 a[52:55], v3, s[36:39], s68 offen
    s_add_u32 s68, s69, 0x38000
    buffer_load_dwordx4 a[56:59], v3, s[36:39], s68 offen
    s_add_u32 s68, s69, 0x3c000
    buffer_load_dwordx4 a[60:63], v3, s[36:39], s68 offen
    s_add_u32 s68, s69, 0x40000
    buffer_load_dwordx4 a[64:67], v3, s[36:39], s68 offen
    s_add_u32 s68, s69, 0x44000
    buffer_load_dwordx4 a[68:71], v3, s[36:39], s68 offen
    s_add_u32 s68, s69, 0x48000
    buffer_load_dwordx4 a[72:75], v3, s[36:39], s68 offen
    s_add_u32 s68, s69, 0x4c000
    buffer_load_dwordx4 a[76:79], v3, s[36:39], s68 offen
    s_add_u32 s68, s69, 0x50000
    buffer_load_dwordx4 a[80:83], v3, s[36:39], s68 offen
    s_add_u32 s68, s69, 0x54000
    buffer_load_dwordx4 a[84:87], v3, s[36:39], s68 offen
    s_add_u32 s68, s69, 0x58000
    buffer_load_dwordx4 a[88:91], v3, s[36:39], s68 offen
    s_add_u32 s68, s69, 0x5c000
    buffer_load_dwordx4 a[92:95], v3, s[36:39], s68 offen
    s_add_u32 s68, s69, 0x60000
    buffer_load_dwordx4 a[96:99], v3, s[36:39], s68 offen
    s_add_u32 s68, s69, 0x64000
    buffer_load_dwordx4 a[100:103], v3, s[36:39], s68 offen
    s_add_u32 s68, s69, 0x68000
    buffer_load_dwordx4 a[104:107], v3, s[36:39], s68 offen
    s_add_u32 s68, s69, 0x6c000
    buffer_load_dwordx4 a[108:111], v3, s[36:39], s68 offen
    s_add_u32 s68, s69, 0x70000
    buffer_load_dwordx4 a[112:115], v3, s[36:39], s68 offen
    s_add_u32 s68, s69, 0x74000
    buffer_load_dwordx4 a[116:119], v3, s[36:39], s68 offen
    s_add_u32 s68, s69, 0x78000
    buffer_load_dwordx4 a[120:123], v3, s[36:39], s68 offen
    s_add_u32 s68, s69, 0x7c000
    buffer_load_dwordx4 a[124:127], v3, s[36:39], s68 offen
    s_add_u32 s68, s69, 0x80000
    buffer_load_dwordx4 a[128:131], v3, s[36:39], s68 offen
    s_add_u32 s68, s69, 0x84000
    buffer_load_dwordx4 a[132:135], v3, s[36:39], s68 offen
    s_add_u32 s68, s69, 0x88000
    buffer_load_dwordx4 a[136:139], v3, s[36:39], s68 offen
    s_add_u32 s68, s69, 0x8c000
    buffer_load_dwordx4 a[140:143], v3, s[36:39], s68 offen
    s_waitcnt vmcnt(56) lgkmcnt(0)
    ds_write_b128 v5, v[160:163] offset:0
    ds_write_b128 v5, v[164:167] offset:1024
    ds_write_b128 v5, v[168:171] offset:2048
    ds_write_b128 v5, v[172:175] offset:3072
    ds_read_b64_tr_b16 v[160:161], v4 offset:0
    ds_read_b64_tr_b16 v[162:163], v4 offset:1024
    ds_read_b64_tr_b16 v[164:165], v4 offset:2048
    ds_read_b64_tr_b16 v[166:167], v4 offset:3072
    ds_read_b64_tr_b16 v[168:169], v4 offset:32
    ds_read_b64_tr_b16 v[170:171], v4 offset:1056
    ds_read_b64_tr_b16 v[172:173], v4 offset:2080
    ds_read_b64_tr_b16 v[174:175], v4 offset:3104
    s_add_u32 s68, s69, 0x90000
    buffer_load_dwordx4 a[144:147], v3, s[36:39], s68 offen
    s_add_u32 s68, s69, 0x94000
    buffer_load_dwordx4 a[148:151], v3, s[36:39], s68 offen
    s_add_u32 s68, s69, 0x98000
    buffer_load_dwordx4 a[152:155], v3, s[36:39], s68 offen
    s_add_u32 s68, s69, 0x9c000
    buffer_load_dwordx4 a[156:159], v3, s[36:39], s68 offen
    s_waitcnt vmcnt(56) lgkmcnt(0)
    ds_write_b128 v5, v[176:179] offset:0
    ds_write_b128 v5, v[180:183] offset:1024
    ds_write_b128 v5, v[184:187] offset:2048
    ds_write_b128 v5, v[188:191] offset:3072
    ds_read_b64_tr_b16 v[176:177], v4 offset:0
    ds_read_b64_tr_b16 v[178:179], v4 offset:1024
    ds_read_b64_tr_b16 v[180:181], v4 offset:2048
    ds_read_b64_tr_b16 v[182:183], v4 offset:3072
    ds_read_b64_tr_b16 v[184:185], v4 offset:32
    ds_read_b64_tr_b16 v[186:187], v4 offset:1056
    ds_read_b64_tr_b16 v[188:189], v4 offset:2080
    ds_read_b64_tr_b16 v[190:191], v4 offset:3104
    s_add_u32 s68, s69, 0xa0000
    buffer_load_dwordx4 a[160:163], v3, s[36:39], s68 offen
    s_add_u32 s68, s69, 0xa4000
    buffer_load_dwordx4 a[164:167], v3, s[36:39], s68 offen
    s_add_u32 s68, s69, 0xa8000
    buffer_load_dwordx4 a[168:171], v3, s[36:39], s68 offen
    s_add_u32 s68, s69, 0xac000
    buffer_load_dwordx4 a[172:175], v3, s[36:39], s68 offen
    s_waitcnt vmcnt(56) lgkmcnt(0)
    ds_write_b128 v5, v[192:195] offset:0
    ds_write_b128 v5, v[196:199] offset:1024
    ds_write_b128 v5, v[200:203] offset:2048
    ds_write_b128 v5, v[204:207] offset:3072
    ds_read_b64_tr_b16 v[192:193], v4 offset:0
    ds_read_b64_tr_b16 v[194:195], v4 offset:1024
    ds_read_b64_tr_b16 v[196:197], v4 offset:2048
    ds_read_b64_tr_b16 v[198:199], v4 offset:3072
    ds_read_b64_tr_b16 v[200:201], v4 offset:32
    ds_read_b64_tr_b16 v[202:203], v4 offset:1056
    ds_read_b64_tr_b16 v[204:205], v4 offset:2080
    ds_read_b64_tr_b16 v[206:207], v4 offset:3104
    s_add_u32 s68, s69, 0xb0000
    buffer_load_dwordx4 a[176:179], v3, s[36:39], s68 offen
    s_add_u32 s68, s69, 0xb4000
    buffer_load_dwordx4 a[180:183], v3, s[36:39], s68 offen
    s_add_u32 s68, s69, 0xb8000
    buffer_load_dwordx4 a[184:187], v3, s[36:39], s68 offen
    s_add_u32 s68, s69, 0xbc000
    buffer_load_dwordx4 a[188:191], v3, s[36:39], s68 offen
    s_waitcnt vmcnt(56) lgkmcnt(0)
    ds_write_b128 v5, v[208:211] offset:0
    ds_write_b128 v5, v[212:215] offset:1024
    ds_write_b128 v5, v[216:219] offset:2048
    ds_write_b128 v5, v[220:223] offset:3072
    ds_read_b64_tr_b16 v[208:209], v4 offset:0
    ds_read_b64_tr_b16 v[210:211], v4 offset:1024
    ds_read_b64_tr_b16 v[212:213], v4 offset:2048
    ds_read_b64_tr_b16 v[214:215], v4 offset:3072
    ds_read_b64_tr_b16 v[216:217], v4 offset:32
    ds_read_b64_tr_b16 v[218:219], v4 offset:1056
    ds_read_b64_tr_b16 v[220:221], v4 offset:2080
    ds_read_b64_tr_b16 v[222:223], v4 offset:3104
    s_add_u32 s68, s69, 0xc0000
    buffer_load_dwordx4 a[192:195], v3, s[36:39], s68 offen
    s_add_u32 s68, s69, 0xc4000
    buffer_load_dwordx4 a[196:199], v3, s[36:39], s68 offen
    s_add_u32 s68, s69, 0xc8000
    buffer_load_dwordx4 a[200:203], v3, s[36:39], s68 offen
    s_add_u32 s68, s69, 0xcc000
    buffer_load_dwordx4 a[204:207], v3, s[36:39], s68 offen
    s_waitcnt vmcnt(56) lgkmcnt(0)
    ds_write_b128 v5, v[224:227] offset:0
    ds_write_b128 v5, v[228:231] offset:1024
    ds_write_b128 v5, v[232:235] offset:2048
    ds_write_b128 v5, v[236:239] offset:3072
    ds_read_b64_tr_b16 v[224:225], v4 offset:0
    ds_read_b64_tr_b16 v[226:227], v4 offset:1024
    ds_read_b64_tr_b16 v[228:229], v4 offset:2048
    ds_read_b64_tr_b16 v[230:231], v4 offset:3072
    ds_read_b64_tr_b16 v[232:233], v4 offset:32
    ds_read_b64_tr_b16 v[234:235], v4 offset:1056
    ds_read_b64_tr_b16 v[236:237], v4 offset:2080
    ds_read_b64_tr_b16 v[238:239], v4 offset:3104
    s_add_u32 s68, s69, 0xd0000
    buffer_load_dwordx4 a[208:211], v3, s[36:39], s68 offen
    s_add_u32 s68, s69, 0xd4000
    buffer_load_dwordx4 a[212:215], v3, s[36:39], s68 offen
    s_add_u32 s68, s69, 0xd8000
    buffer_load_dwordx4 a[216:219], v3, s[36:39], s68 offen
    s_add_u32 s68, s69, 0xdc000
    buffer_load_dwordx4 a[220:223], v3, s[36:39], s68 offen
    s_waitcnt vmcnt(56) lgkmcnt(0)
    ds_write_b128 v5, v[240:243] offset:0
    ds_write_b128 v5, v[244:247] offset:1024
    ds_write_b128 v5, v[248:251] offset:2048
    ds_write_b128 v5, v[252:255] offset:3072
    ds_read_b64_tr_b16 v[240:241], v4 offset:0
    ds_read_b64_tr_b16 v[242:243], v4 offset:1024
    ds_read_b64_tr_b16 v[244:245], v4 offset:2048
    ds_read_b64_tr_b16 v[246:247], v4 offset:3072
    ds_read_b64_tr_b16 v[248:249], v4 offset:32
    ds_read_b64_tr_b16 v[250:251], v4 offset:1056
    ds_read_b64_tr_b16 v[252:253], v4 offset:2080
    ds_read_b64_tr_b16 v[254:255], v4 offset:3104
    s_add_u32 s68, s69, 0xe0000
    buffer_load_dwordx4 a[224:227], v3, s[36:39], s68 offen
    s_add_u32 s68, s69, 0xe4000
    buffer_load_dwordx4 a[228:231], v3, s[36:39], s68 offen
    s_add_u32 s68, s69, 0xe8000
    buffer_load_dwordx4 a[232:235], v3, s[36:39], s68 offen
    s_add_u32 s68, s69, 0xec000
    buffer_load_dwordx4 a[236:239], v3, s[36:39], s68 offen
    s_waitcnt vmcnt(56) lgkmcnt(0)
    ds_write_b128 v5, a[0:3] offset:0
    ds_write_b128 v5, a[4:7] offset:1024
    ds_write_b128 v5, a[8:11] offset:2048
    ds_write_b128 v5, a[12:15] offset:3072
    ds_read_b64_tr_b16 a[0:1], v4 offset:0
    ds_read_b64_tr_b16 a[2:3], v4 offset:1024
    ds_read_b64_tr_b16 a[4:5], v4 offset:2048
    ds_read_b64_tr_b16 a[6:7], v4 offset:3072
    ds_read_b64_tr_b16 a[8:9], v4 offset:32
    ds_read_b64_tr_b16 a[10:11], v4 offset:1056
    ds_read_b64_tr_b16 a[12:13], v4 offset:2080
    ds_read_b64_tr_b16 a[14:15], v4 offset:3104
    s_add_u32 s68, s69, 0xf0000
    buffer_load_dwordx4 a[240:243], v3, s[36:39], s68 offen
    s_add_u32 s68, s69, 0xf4000
    buffer_load_dwordx4 a[244:247], v3, s[36:39], s68 offen
    s_add_u32 s68, s69, 0xf8000
    buffer_load_dwordx4 a[248:251], v3, s[36:39], s68 offen
    s_add_u32 s68, s69, 0xfc000
    buffer_load_dwordx4 a[252:255], v3, s[36:39], s68 offen
    s_waitcnt vmcnt(56) lgkmcnt(0)
    ds_write_b128 v5, a[16:19] offset:0
    ds_write_b128 v5, a[20:23] offset:1024
    ds_write_b128 v5, a[24:27] offset:2048
    ds_write_b128 v5, a[28:31] offset:3072
    ds_read_b64_tr_b16 a[16:17], v4 offset:0
    ds_read_b64_tr_b16 a[18:19], v4 offset:1024
    ds_read_b64_tr_b16 a[20:21], v4 offset:2048
    ds_read_b64_tr_b16 a[22:23], v4 offset:3072
    ds_read_b64_tr_b16 a[24:25], v4 offset:32
    ds_read_b64_tr_b16 a[26:27], v4 offset:1056
    ds_read_b64_tr_b16 a[28:29], v4 offset:2080
    ds_read_b64_tr_b16 a[30:31], v4 offset:3104
    s_waitcnt vmcnt(52) lgkmcnt(0)
    ds_write_b128 v5, a[32:35] offset:0
    ds_write_b128 v5, a[36:39] offset:1024
    ds_write_b128 v5, a[40:43] offset:2048
    ds_write_b128 v5, a[44:47] offset:3072
    ds_read_b64_tr_b16 a[32:33], v4 offset:0
    ds_read_b64_tr_b16 a[34:35], v4 offset:1024
    ds_read_b64_tr_b16 a[36:37], v4 offset:2048
    ds_read_b64_tr_b16 a[38:39], v4 offset:3072
    ds_read_b64_tr_b16 a[40:41], v4 offset:32
    ds_read_b64_tr_b16 a[42:43], v4 offset:1056
    ds_read_b64_tr_b16 a[44:45], v4 offset:2080
    ds_read_b64_tr_b16 a[46:47], v4 offset:3104
    s_waitcnt vmcnt(48) lgkmcnt(0)
    ds_write_b128 v5, a[48:51] offset:0
    ds_write_b128 v5, a[52:55] offset:1024
    ds_write_b128 v5, a[56:59] offset:2048
    ds_write_b128 v5, a[60:63] offset:3072
    ds_read_b64_tr_b16 a[48:49], v4 offset:0
    ds_read_b64_tr_b16 a[50:51], v4 offset:1024
    ds_read_b64_tr_b16 a[52:53], v4 offset:2048
    ds_read_b64_tr_b16 a[54:55], v4 offset:3072
    ds_read_b64_tr_b16 a[56:57], v4 offset:32
    ds_read_b64_tr_b16 a[58:59], v4 offset:1056
    ds_read_b64_tr_b16 a[60:61], v4 offset:2080
    ds_read_b64_tr_b16 a[62:63], v4 offset:3104
    s_waitcnt vmcnt(44) lgkmcnt(0)
    ds_write_b128 v5, a[64:67] offset:0
    ds_write_b128 v5, a[68:71] offset:1024
    ds_write_b128 v5, a[72:75] offset:2048
    ds_write_b128 v5, a[76:79] offset:3072
    ds_read_b64_tr_b16 a[64:65], v4 offset:0
    ds_read_b64_tr_b16 a[66:67], v4 offset:1024
    ds_read_b64_tr_b16 a[68:69], v4 offset:2048
    ds_read_b64_tr_b16 a[70:71], v4 offset:3072
    ds_read_b64_tr_b16 a[72:73], v4 offset:32
    ds_read_b64_tr_b16 a[74:75], v4 offset:1056
    ds_read_b64_tr_b16 a[76:77], v4 offset:2080
    ds_read_b64_tr_b16 a[78:79], v4 offset:3104
    s_waitcnt vmcnt(40) lgkmcnt(0)
    ds_write_b128 v5, a[80:83] offset:0
    ds_write_b128 v5, a[84:87] offset:1024
    ds_write_b128 v5, a[88:91] offset:2048
    ds_write_b128 v5, a[92:95] offset:3072
    ds_read_b64_tr_b16 a[80:81], v4 offset:0
    ds_read_b64_tr_b16 a[82:83], v4 offset:1024
    ds_read_b64_tr_b16 a[84:85], v4 offset:2048
    ds_read_b64_tr_b16 a[86:87], v4 offset:3072
    ds_read_b64_tr_b16 a[88:89], v4 offset:32
    ds_read_b64_tr_b16 a[90:91], v4 offset:1056
    ds_read_b64_tr_b16 a[92:93], v4 offset:2080
    ds_read_b64_tr_b16 a[94:95], v4 offset:3104
    s_waitcnt vmcnt(36) lgkmcnt(0)
    ds_write_b128 v5, a[96:99] offset:0
    ds_write_b128 v5, a[100:103] offset:1024
    ds_write_b128 v5, a[104:107] offset:2048
    ds_write_b128 v5, a[108:111] offset:3072
    ds_read_b64_tr_b16 a[96:97], v4 offset:0
    ds_read_b64_tr_b16 a[98:99], v4 offset:1024
    ds_read_b64_tr_b16 a[100:101], v4 offset:2048
    ds_read_b64_tr_b16 a[102:103], v4 offset:3072
    ds_read_b64_tr_b16 a[104:105], v4 offset:32
    ds_read_b64_tr_b16 a[106:107], v4 offset:1056
    ds_read_b64_tr_b16 a[108:109], v4 offset:2080
    ds_read_b64_tr_b16 a[110:111], v4 offset:3104
    s_waitcnt vmcnt(32) lgkmcnt(0)
    ds_write_b128 v5, a[112:115] offset:0
    ds_write_b128 v5, a[116:119] offset:1024
    ds_write_b128 v5, a[120:123] offset:2048
    ds_write_b128 v5, a[124:127] offset:3072
    ds_read_b64_tr_b16 a[112:113], v4 offset:0
    ds_read_b64_tr_b16 a[114:115], v4 offset:1024
    ds_read_b64_tr_b16 a[116:117], v4 offset:2048
    ds_read_b64_tr_b16 a[118:119], v4 offset:3072
    ds_read_b64_tr_b16 a[120:121], v4 offset:32
    ds_read_b64_tr_b16 a[122:123], v4 offset:1056
    ds_read_b64_tr_b16 a[124:125], v4 offset:2080
    ds_read_b64_tr_b16 a[126:127], v4 offset:3104
    s_waitcnt vmcnt(28) lgkmcnt(0)
    ds_write_b128 v5, a[128:131] offset:0
    ds_write_b128 v5, a[132:135] offset:1024
    ds_write_b128 v5, a[136:139] offset:2048
    ds_write_b128 v5, a[140:143] offset:3072
    ds_read_b64_tr_b16 a[128:129], v4 offset:0
    ds_read_b64_tr_b16 a[130:131], v4 offset:1024
    ds_read_b64_tr_b16 a[132:133], v4 offset:2048
    ds_read_b64_tr_b16 a[134:135], v4 offset:3072
    ds_read_b64_tr_b16 a[136:137], v4 offset:32
    ds_read_b64_tr_b16 a[138:139], v4 offset:1056
    ds_read_b64_tr_b16 a[140:141], v4 offset:2080
    ds_read_b64_tr_b16 a[142:143], v4 offset:3104
    s_waitcnt vmcnt(24) lgkmcnt(0)
    ds_write_b128 v5, a[144:147] offset:0
    ds_write_b128 v5, a[148:151] offset:1024
    ds_write_b128 v5, a[152:155] offset:2048
    ds_write_b128 v5, a[156:159] offset:3072
    ds_read_b64_tr_b16 a[144:145], v4 offset:0
    ds_read_b64_tr_b16 a[146:147], v4 offset:1024
    ds_read_b64_tr_b16 a[148:149], v4 offset:2048
    ds_read_b64_tr_b16 a[150:151], v4 offset:3072
    ds_read_b64_tr_b16 a[152:153], v4 offset:32
    ds_read_b64_tr_b16 a[154:155], v4 offset:1056
    ds_read_b64_tr_b16 a[156:157], v4 offset:2080
    ds_read_b64_tr_b16 a[158:159], v4 offset:3104
    s_waitcnt vmcnt(20) lgkmcnt(0)
    ds_write_b128 v5, a[160:163] offset:0
    ds_write_b128 v5, a[164:167] offset:1024
    ds_write_b128 v5, a[168:171] offset:2048
    ds_write_b128 v5, a[172:175] offset:3072
    ds_read_b64_tr_b16 a[160:161], v4 offset:0
    ds_read_b64_tr_b16 a[162:163], v4 offset:1024
    ds_read_b64_tr_b16 a[164:165], v4 offset:2048
    ds_read_b64_tr_b16 a[166:167], v4 offset:3072
    ds_read_b64_tr_b16 a[168:169], v4 offset:32
    ds_read_b64_tr_b16 a[170:171], v4 offset:1056
    ds_read_b64_tr_b16 a[172:173], v4 offset:2080
    ds_read_b64_tr_b16 a[174:175], v4 offset:3104
    s_waitcnt vmcnt(16) lgkmcnt(0)
    ds_write_b128 v5, a[176:179] offset:0
    ds_write_b128 v5, a[180:183] offset:1024
    ds_write_b128 v5, a[184:187] offset:2048
    ds_write_b128 v5, a[188:191] offset:3072
    ds_read_b64_tr_b16 a[176:177], v4 offset:0
    ds_read_b64_tr_b16 a[178:179], v4 offset:1024
    ds_read_b64_tr_b16 a[180:181], v4 offset:2048
    ds_read_b64_tr_b16 a[182:183], v4 offset:3072
    ds_read_b64_tr_b16 a[184:185], v4 offset:32
    ds_read_b64_tr_b16 a[186:187], v4 offset:1056
    ds_read_b64_tr_b16 a[188:189], v4 offset:2080
    ds_read_b64_tr_b16 a[190:191], v4 offset:3104
    s_waitcnt vmcnt(12) lgkmcnt(0)
    ds_write_b128 v5, a[192:195] offset:0
    ds_write_b128 v5, a[196:199] offset:1024
    ds_write_b128 v5, a[200:203] offset:2048
    ds_write_b128 v5, a[204:207] offset:3072
    ds_read_b64_tr_b16 a[192:193], v4 offset:0
    ds_read_b64_tr_b16 a[194:195], v4 offset:1024
    ds_read_b64_tr_b16 a[196:197], v4 offset:2048
    ds_read_b64_tr_b16 a[198:199], v4 offset:3072
    ds_read_b64_tr_b16 a[200:201], v4 offset:32
    ds_read_b64_tr_b16 a[202:203], v4 offset:1056
    ds_read_b64_tr_b16 a[204:205], v4 offset:2080
    ds_read_b64_tr_b16 a[206:207], v4 offset:3104
    s_waitcnt vmcnt(8) lgkmcnt(0)
    ds_write_b128 v5, a[208:211] offset:0
    ds_write_b128 v5, a[212:215] offset:1024
    ds_write_b128 v5, a[216:219] offset:2048
    ds_write_b128 v5, a[220:223] offset:3072
    ds_read_b64_tr_b16 a[208:209], v4 offset:0
    ds_read_b64_tr_b16 a[210:211], v4 offset:1024
    ds_read_b64_tr_b16 a[212:213], v4 offset:2048
    ds_read_b64_tr_b16 a[214:215], v4 offset:3072
    ds_read_b64_tr_b16 a[216:217], v4 offset:32
    ds_read_b64_tr_b16 a[218:219], v4 offset:1056
    ds_read_b64_tr_b16 a[220:221], v4 offset:2080
    ds_read_b64_tr_b16 a[222:223], v4 offset:3104
    s_waitcnt vmcnt(4) lgkmcnt(0)
    ds_write_b128 v5, a[224:227] offset:0
    ds_write_b128 v5, a[228:231] offset:1024
    ds_write_b128 v5, a[232:235] offset:2048
    ds_write_b128 v5, a[236:239] offset:3072
    ds_read_b64_tr_b16 a[224:225], v4 offset:0
    ds_read_b64_tr_b16 a[226:227], v4 offset:1024
    ds_read_b64_tr_b16 a[228:229], v4 offset:2048
    ds_read_b64_tr_b16 a[230:231], v4 offset:3072
    ds_read_b64_tr_b16 a[232:233], v4 offset:32
    ds_read_b64_tr_b16 a[234:235], v4 offset:1056
    ds_read_b64_tr_b16 a[236:237], v4 offset:2080
    ds_read_b64_tr_b16 a[238:239], v4 offset:3104
    s_waitcnt vmcnt(0) lgkmcnt(0)
    ds_write_b128 v5, a[240:243] offset:0
    ds_write_b128 v5, a[244:247] offset:1024
    ds_write_b128 v5, a[248:251] offset:2048
    ds_write_b128 v5, a[252:255] offset:3072
    ds_read_b64_tr_b16 a[240:241], v4 offset:0
    ds_read_b64_tr_b16 a[242:243], v4 offset:1024
    ds_read_b64_tr_b16 a[244:245], v4 offset:2048
    ds_read_b64_tr_b16 a[246:247], v4 offset:3072
    ds_read_b64_tr_b16 a[248:249], v4 offset:32
    ds_read_b64_tr_b16 a[250:251], v4 offset:1056
    ds_read_b64_tr_b16 a[252:253], v4 offset:2080
    ds_read_b64_tr_b16 a[254:255], v4 offset:3104
    s_waitcnt lgkmcnt(0)
    s_barrier
    s_and_b32 s72, s60, 1
    s_lshr_b32 s73, s60, 1
    v_and_b32 v16, 15, v0
    v_lshrrev_b32 v17, 4, v0
    v_lshlrev_b32 v9, 10, v16
    v_lshl_add_u32 v9, v17, 3, v9
    s_lshl_b32 s68, s64, 6
    s_lshl_b32 s69, s73, 5
    s_add_u32 s68, s68, s69
    v_add_u32 v9, s68, v9
    v_lshlrev_b32 v8, 3, v17
    buffer_load_dwordx2 v[18:19], v8, s[52:55], s68 offen
    v_and_b32 v6, 7, v0
    v_lshlrev_b32 v6, 9, v6
    s_lshl_b32 s68, s60, 12
    s_add_u32 s68, s68, 4096
    v_add_u32 v6, s68, v6
    v_lshrrev_b32 v8, 3, v16
    v_and_b32 v20, 7, v16
    v_lshlrev_b32 v3, 10, v8
    v_lshl_add_u32 v3, v17, 8, v3
    v_lshl_add_u32 v3, v20, 4, v3
    s_and_b32 s68, s65, 1
    s_lshl_b32 s68, s68, 7
    v_add_u32 v3, s68, v3
    v_lshlrev_b32 v4, 10, v20
    v_lshl_add_u32 v4, v8, 5, v4
    v_lshl_add_u32 v4, v17, 3, v4
    s_lshl_b32 s68, s64, 6
    v_add_u32 v4, s68, v4
    s_lshl_b32 s68, s60, 14
    s_add_u32 s68, s68, 73728
    v_add_u32 v5, s68, v2
    s_lshr_b32 s76, s65, 1
    s_mov_b32 s77, 65536
    v_and_b32 v7, 3, v0
    v_lshlrev_b32 v7, 7, v7
    s_waitcnt vmcnt(0)
    v_lshlrev_b32 v12, 16, v18
    v_and_b32 v13, 0xffff0000, v18
    v_lshlrev_b32 v14, 16, v19
    v_and_b32 v15, 0xffff0000, v19
    s_cmp_eq_u32 s60, 3
    s_cselect_b32 s74, 9, 10
    s_lshl_b32 s74, s74, 10
    s_mov_b32 s75, 0xbfb8aa3b
    s_mov_b32 s66, 0
    s_mov_b32 s71, 0
    v_lshlrev_b32 v7, 7, v0
    s_mov_b32 s68, 24576
poll_9:
    buffer_load_dword v8, v7, s[8:11], s68 offen offset:8 sc1
    s_waitcnt vmcnt(0)
    v_cmp_gt_u32 vcc, 1, v8
    s_cbranch_vccz pdone_10
    s_add_u32 s63, s63, 1
    s_cmp_gt_u32 s63, 400000
    s_cbranch_scc1 pdone_10
    s_sleep 2
    s_branch poll_9
pdone_10:
O_gate:
    s_sub_u32 s68, s66, 0
    s_cmp_ge_u32 s68, 4
    s_cbranch_scc1 O_nogate
    s_bitcmp1_b32 s68, 0
    s_cbranch_scc1 O_nogate
    s_lshl_b32 s67, s68, 1
    s_add_u32 s67, s67, 56
    v_and_b32 v16, 31, v0
    v_lshlrev_b32 v16, 7, v16
    s_lshl_b32 s68, s60, 12
    s_add_u32 s68, s68, 4096
poll_11:
    buffer_load_dword v8, v16, s[8:11], s68 offen offset:4 sc1
    s_waitcnt vmcnt(0)
    v_cmp_gt_u32 vcc, 1, v8
    s_cbranch_vccz pdone_12
    s_add_u32 s63, s63, 1
    s_cmp_gt_u32 s63, 400000
    s_cbranch_scc1 pdone_12
    s_sleep 2
    s_branch poll_11
pdone_12:
    v_and_b32 v8, 1023, v4
    buffer_load_dwordx2 v[48:49], v8, s[52:55], 0 offen
    s_lshl_b32 s68, s67, 15
    s_lshl_b32 s69, s65, 13
    s_add_u32 s68, s68, s69
    buffer_load_dwordx2 v[24:25], v4, s[16:19], s68 offen
    s_add_u32 s68, s68, 32768
    buffer_load_dwordx2 v[26:27], v4, s[16:19], s68 offen
    s_add_u32 s68, s68, 32768
    buffer_load_dwordx2 v[28:29], v4, s[16:19], s68 offen
    s_add_u32 s68, s68, 32768
    buffer_load_dwordx2 v[30:31], v4, s[16:19], s68 offen
    s_add_u32 s68, s68, 32768
    s_lshl_b32 s68, s67, 1
    s_add_u32 s68, s68, s76
    s_mul_i32 s68, s68, 49152
    s_mul_i32 s69, s60, 11264
    s_add_u32 s68, s68, s69
    s_add_u32 s68, s68, 0x300000
    s_add_u32 s69, s68, 0
    buffer_load_dwordx4 v[52:55], v3, s[8:11], s69 offen offset:0 sc1
    buffer_load_dwordx4 v[56:59], v3, s[8:11], s69 offen offset:2048 sc1
    s_add_u32 s69, s68, 4096
    buffer_load_dwordx4 v[60:63], v3, s[8:11], s69 offen offset:0 sc1
    buffer_load_dwordx4 v[64:67], v3, s[8:11], s69 offen offset:2048 sc1
    s_add_u32 s69, s68, 8192
    buffer_load_dwordx4 v[68:71], v3, s[8:11], s69 offen offset:0 sc1
    s_add_u32 s69, s68, s74
    buffer_load_dwordx4 v[72:75], v3, s[8:11], s69 offen offset:0 sc1
    s_add_u32 s68, s68, 98304
    s_add_u32 s69, s68, 0
    buffer_load_dwordx4 v[76:79], v3, s[8:11], s69 offen offset:0 sc1
    buffer_load_dwordx4 v[80:83], v3, s[8:11], s69 offen offset:2048 sc1
    s_add_u32 s69, s68, 4096
    buffer_load_dwordx4 v[84:87], v3, s[8:11], s69 offen offset:0 sc1
    buffer_load_dwordx4 v[88:91], v3, s[8:11], s69 offen offset:2048 sc1
    s_add_u32 s69, s68, 8192
    buffer_load_dwordx4 v[92:95], v3, s[8:11], s69 offen offset:0 sc1
    s_add_u32 s69, s68, s74
    buffer_load_dwordx4 v[96:99], v3, s[8:11], s69 offen offset:0 sc1
    s_add_u32 s68, s68, 98304
    s_add_u32 s69, s68, 0
    buffer_load_dwordx4 v[100:103], v3, s[8:11], s69 offen offset:0 sc1
    buffer_load_dwordx4 v[104:107], v3, s[8:11], s69 offen offset:2048 sc1
    s_add_u32 s69, s68, 4096
    buffer_load_dwordx4 v[108:111], v3, s[8:11], s69 offen offset:0 sc1
    buffer_load_dwordx4 v[112:115], v3, s[8:11], s69 offen offset:2048 sc1
    s_add_u32 s69, s68, 8192
    buffer_load_dwordx4 v[116:119], v3, s[8:11], s69 offen offset:0 sc1
    s_add_u32 s69, s68, s74
    buffer_load_dwordx4 v[120:123], v3, s[8:11], s69 offen offset:0 sc1
    s_add_u32 s68, s68, 98304
    s_add_u32 s69, s68, 0
    buffer_load_dwordx4 v[124:127], v3, s[8:11], s69 offen offset:0 sc1
    buffer_load_dwordx4 v[128:131], v3, s[8:11], s69 offen offset:2048 sc1
    s_add_u32 s69, s68, 4096
    buffer_load_dwordx4 v[132:135], v3, s[8:11], s69 offen offset:0 sc1
    buffer_load_dwordx4 v[136:139], v3, s[8:11], s69 offen offset:2048 sc1
    s_add_u32 s69, s68, 8192
    buffer_load_dwordx4 v[140:143], v3, s[8:11], s69 offen offset:0 sc1
    s_add_u32 s69, s68, s74
    buffer_load_dwordx4 v[144:147], v3, s[8:11], s69 offen offset:0 sc1
    s_add_u32 s68, s68, 98304
    s_and_b32 s70, s67, 15
    s_lshl_b32 s70, s70, 10
    v_add_u32 v20, s70, v5
    s_waitcnt vmcnt(23)
    v_mfma_f32_16x16x32_bf16 v[32:35], v[160:163], v[52:55], 0
    v_mfma_f32_16x16x32_bf16 v[36:39], v[168:171], v[52:55], 0
    v_mfma_f32_16x16x32_bf16 v[40:43], v[164:167], v[52:55], 0
    v_mfma_f32_16x16x32_bf16 v[44:47], v[172:175], v[52:55], 0
    s_waitcnt vmcnt(22)
    v_mfma_f32_16x16x32_bf16 v[32:35], v[176:179], v[56:59], v[32:35]
    v_mfma_f32_16x16x32_bf16 v[36:39], v[184:187], v[56:59], v[36:39]
    v_mfma_f32_16x16x32_bf16 v[40:43], v[180:183], v[56:59], v[40:43]
    v_mfma_f32_16x16x32_bf16 v[44:47], v[188:191], v[56:59], v[44:47]
    s_waitcnt vmcnt(21)
    v_mfma_f32_16x16x32_bf16 v[32:35], v[192:195], v[60:63], v[32:35]
    v_mfma_f32_16x16x32_bf16 v[36:39], v[200:203], v[60:63], v[36:39]
    v_mfma_f32_16x16x32_bf16 v[40:43], v[196:199], v[60:63], v[40:43]
    v_mfma_f32_16x16x32_bf16 v[44:47], v[204:207], v[60:63], v[44:47]
    s_waitcnt vmcnt(20)
    v_mfma_f32_16x16x32_bf16 v[32:35], v[208:211], v[64:67], v[32:35]
    v_mfma_f32_16x16x32_bf16 v[36:39], v[216:219], v[64:67], v[36:39]
    v_mfma_f32_16x16x32_bf16 v[40:43], v[212:215], v[64:67], v[40:43]
    v_mfma_f32_16x16x32_bf16 v[44:47], v[220:223], v[64:67], v[44:47]
    s_waitcnt vmcnt(19)
    v_mfma_f32_16x16x32_bf16 v[32:35], v[224:227], v[68:71], v[32:35]
    v_mfma_f32_16x16x32_bf16 v[36:39], v[232:235], v[68:71], v[36:39]
    v_mfma_f32_16x16x32_bf16 v[40:43], v[228:231], v[68:71], v[40:43]
    v_mfma_f32_16x16x32_bf16 v[44:47], v[236:239], v[68:71], v[44:47]
    s_waitcnt vmcnt(18)
    v_mfma_f32_16x16x32_bf16 v[32:35], v[240:243], v[72:75], v[32:35]
    v_mfma_f32_16x16x32_bf16 v[36:39], v[248:251], v[72:75], v[36:39]
    v_lshlrev_b32 v16, 16, v48
    v_and_b32 v17, 0xffff0000, v48
    v_lshlrev_b32 v18, 16, v49
    v_and_b32 v19, 0xffff0000, v49
    s_lshl_b32 s68, s60, 10
    s_add_u32 s68, s68, s77
    v_add_u32 v10, s68, v2
    v_add_u32 v11, s77, v2
    s_xor_b32 s77, s77, 4096
    v_add_f32_dpp v32, v40, v32 row_ror:8 row_mask:0xf bank_mask:0x3
    v_add_f32_dpp v33, v41, v33 row_ror:8 row_mask:0xf bank_mask:0x3
    v_add_f32_dpp v34, v42, v34 row_ror:8 row_mask:0xf bank_mask:0x3
    v_add_f32_dpp v35, v43, v35 row_ror:8 row_mask:0xf bank_mask:0x3
    v_add_f32_dpp v32, v36, v44 row_ror:8 row_mask:0xf bank_mask:0xc
    v_add_f32_dpp v33, v37, v45 row_ror:8 row_mask:0xf bank_mask:0xc
    v_add_f32_dpp v34, v38, v46 row_ror:8 row_mask:0xf bank_mask:0xc
    v_add_f32_dpp v35, v39, v47 row_ror:8 row_mask:0xf bank_mask:0xc
    ds_write_b128 v10, v[32:35]
    s_waitcnt lgkmcnt(0)
    s_barrier
    ds_read_b128 v[32:35], v11 offset:0
    ds_read_b128 v[36:39], v11 offset:1024
    ds_read_b128 v[40:43], v11 offset:2048
    ds_read_b128 v[44:47], v11 offset:3072
    s_waitcnt lgkmcnt(2)
    v_pk_add_f32 v[32:33], v[32:33], v[36:37]
    v_pk_add_f32 v[34:35], v[34:35], v[38:39]
    s_waitcnt lgkmcnt(0)
    v_pk_add_f32 v[40:41], v[40:41], v[44:45]
    v_pk_add_f32 v[42:43], v[42:43], v[46:47]
    v_pk_add_f32 v[32:33], v[32:33], v[40:41]
    v_pk_add_f32 v[34:35], v[34:35], v[42:43]
    v_cvt_pk_bf16_f32 v8, v32, v33
    v_lshlrev_b32 v32, 16, v8
    v_and_b32 v33, 0xffff0000, v8
    v_cvt_pk_bf16_f32 v8, v34, v35
    v_lshlrev_b32 v34, 16, v8
    v_and_b32 v35, 0xffff0000, v8
    v_add_f32 v32, v32, v16
    v_add_f32 v33, v33, v17
    v_add_f32 v34, v34, v18
    v_add_f32 v35, v35, v19
    v_cvt_pk_bf16_f32 v8, v32, v33
    v_lshlrev_b32 v32, 16, v8
    v_and_b32 v33, 0xffff0000, v8
    v_cvt_pk_bf16_f32 v8, v34, v35
    v_lshlrev_b32 v34, 16, v8
    v_and_b32 v35, 0xffff0000, v8
    v_mul_f32 v36, s75, v32
    v_mul_f32 v37, s75, v33
    v_mul_f32 v38, s75, v34
    v_mul_f32 v39, s75, v35
    v_exp_f32 v36, v36
    v_exp_f32 v37, v37
    v_exp_f32 v38, v38
    v_exp_f32 v39, v39
    v_add_f32 v36, 1.0, v36
    v_add_f32 v37, 1.0, v37
    v_add_f32 v38, 1.0, v38
    v_add_f32 v39, 1.0, v39
    v_rcp_f32 v36, v36
    v_rcp_f32 v37, v37
    v_rcp_f32 v38, v38
    v_rcp_f32 v39, v39
    v_mul_f32 v32, v32, v36
    v_mul_f32 v33, v33, v37
    v_mul_f32 v34, v34, v38
    v_mul_f32 v35, v35, v39
    v_cvt_pk_bf16_f32 v36, v32, v33
    v_cvt_pk_bf16_f32 v37, v34, v35
    ds_write2_b64 v20, v[36:37], v[24:25] offset0:0 offset1:1
    s_waitcnt vmcnt(17)
    v_mfma_f32_16x16x32_bf16 v[32:35], v[160:163], v[76:79], 0
    v_mfma_f32_16x16x32_bf16 v[36:39], v[168:171], v[76:79], 0
    v_mfma_f32_16x16x32_bf16 v[40:43], v[164:167], v[76:79], 0
    v_mfma_f32_16x16x32_bf16 v[44:47], v[172:175], v[76:79], 0
    s_waitcnt vmcnt(16)
    v_mfma_f32_16x16x32_bf16 v[32:35], v[176:179], v[80:83], v[32:35]
    v_mfma_f32_16x16x32_bf16 v[36:39], v[184:187], v[80:83], v[36:39]
    v_mfma_f32_16x16x32_bf16 v[40:43], v[180:183], v[80:83], v[40:43]
    v_mfma_f32_16x16x32_bf16 v[44:47], v[188:191], v[80:83], v[44:47]
    s_waitcnt vmcnt(15)
    v_mfma_f32_16x16x32_bf16 v[32:35], v[192:195], v[84:87], v[32:35]
    v_mfma_f32_16x16x32_bf16 v[36:39], v[200:203], v[84:87], v[36:39]
    v_mfma_f32_16x16x32_bf16 v[40:43], v[196:199], v[84:87], v[40:43]
    v_mfma_f32_16x16x32_bf16 v[44:47], v[204:207], v[84:87], v[44:47]
    s_waitcnt vmcnt(14)
    v_mfma_f32_16x16x32_bf16 v[32:35], v[208:211], v[88:91], v[32:35]
    v_mfma_f32_16x16x32_bf16 v[36:39], v[216:219], v[88:91], v[36:39]
    v_mfma_f32_16x16x32_bf16 v[40:43], v[212:215], v[88:91], v[40:43]
    v_mfma_f32_16x16x32_bf16 v[44:47], v[220:223], v[88:91], v[44:47]
    s_waitcnt vmcnt(13)
    v_mfma_f32_16x16x32_bf16 v[32:35], v[224:227], v[92:95], v[32:35]
    v_mfma_f32_16x16x32_bf16 v[36:39], v[232:235], v[92:95], v[36:39]
    v_mfma_f32_16x16x32_bf16 v[40:43], v[228:231], v[92:95], v[40:43]
    v_mfma_f32_16x16x32_bf16 v[44:47], v[236:239], v[92:95], v[44:47]
    s_waitcnt vmcnt(12)
    v_mfma_f32_16x16x32_bf16 v[32:35], v[240:243], v[96:99], v[32:35]
    v_mfma_f32_16x16x32_bf16 v[36:39], v[248:251], v[96:99], v[36:39]
    s_lshl_b32 s68, s60, 10
    s_add_u32 s68, s68, s77
    v_add_u32 v10, s68, v2
    v_add_u32 v11, s77, v2
    s_xor_b32 s77, s77, 4096
    v_add_f32_dpp v32, v40, v32 row_ror:8 row_mask:0xf bank_mask:0x3
    v_add_f32_dpp v33, v41, v33 row_ror:8 row_mask:0xf bank_mask:0x3
    v_add_f32_dpp v34, v42, v34 row_ror:8 row_mask:0xf bank_mask:0x3
    v_add_f32_dpp v35, v43, v35 row_ror:8 row_mask:0xf bank_mask:0x3
    v_add_f32_dpp v32, v36, v44 row_ror:8 row_mask:0xf bank_mask:0xc
    v_add_f32_dpp v33, v37, v45 row_ror:8 row_mask:0xf bank_mask:0xc
    v_add_f32_dpp v34, v38, v46 row_ror:8 row_mask:0xf bank_mask:0xc
    v_add_f32_dpp v35, v39, v47 row_ror:8 row_mask:0xf bank_mask:0xc
    ds_write_b128 v10, v[32:35]
    s_waitcnt lgkmcnt(0)
    s_barrier
    ds_read_b128 v[32:35], v11 offset:0
    ds_read_b128 v[36:39], v11 offset:1024
    ds_read_b128 v[40:43], v11 offset:2048
    ds_read_b128 v[44:47], v11 offset:3072
    s_waitcnt lgkmcnt(2)
    v_pk_add_f32 v[32:33], v[32:33], v[36:37]
    v_pk_add_f32 v[34:35], v[34:35], v[38:39]
    s_waitcnt lgkmcnt(0)
    v_pk_add_f32 v[40:41], v[40:41], v[44:45]
    v_pk_add_f32 v[42:43], v[42:43], v[46:47]
    v_pk_add_f32 v[32:33], v[32:33], v[40:41]
    v_pk_add_f32 v[34:35], v[34:35], v[42:43]
    v_cvt_pk_bf16_f32 v8, v32, v33
    v_lshlrev_b32 v32, 16, v8
    v_and_b32 v33, 0xffff0000, v8
    v_cvt_pk_bf16_f32 v8, v34, v35
    v_lshlrev_b32 v34, 16, v8
    v_and_b32 v35, 0xffff0000, v8
    v_add_f32 v32, v32, v16
    v_add_f32 v33, v33, v17
    v_add_f32 v34, v34, v18
    v_add_f32 v35, v35, v19
    v_cvt_pk_bf16_f32 v8, v32, v33
    v_lshlrev_b32 v32, 16, v8
    v_and_b32 v33, 0xffff0000, v8
    v_cvt_pk_bf16_f32 v8, v34, v35
    v_lshlrev_b32 v34, 16, v8
    v_and_b32 v35, 0xffff0000, v8
    v_mul_f32 v36, s75, v32
    v_mul_f32 v37, s75, v33
    v_mul_f32 v38, s75, v34
    v_mul_f32 v39, s75, v35
    v_exp_f32 v36, v36
    v_exp_f32 v37, v37
    v_exp_f32 v38, v38
    v_exp_f32 v39, v39
    v_add_f32 v36, 1.0, v36
    v_add_f32 v37, 1.0, v37
    v_add_f32 v38, 1.0, v38
    v_add_f32 v39, 1.0, v39
    v_rcp_f32 v36, v36
    v_rcp_f32 v37, v37
    v_rcp_f32 v38, v38
    v_rcp_f32 v39, v39
    v_mul_f32 v32, v32, v36
    v_mul_f32 v33, v33, v37
    v_mul_f32 v34, v34, v38
    v_mul_f32 v35, v35, v39
    v_cvt_pk_bf16_f32 v36, v32, v33
    v_cvt_pk_bf16_f32 v37, v34, v35
    ds_write2_b64 v20, v[36:37], v[26:27] offset0:128 offset1:129
    v_add_u32 v20, 2048, v20
    s_waitcnt vmcnt(11)
    v_mfma_f32_16x16x32_bf16 v[32:35], v[160:163], v[100:103], 0
    v_mfma_f32_16x16x32_bf16 v[36:39], v[168:171], v[100:103], 0
    v_mfma_f32_16x16x32_bf16 v[40:43], v[164:167], v[100:103], 0
    v_mfma_f32_16x16x32_bf16 v[44:47], v[172:175], v[100:103], 0
    s_waitcnt vmcnt(10)
    v_mfma_f32_16x16x32_bf16 v[32:35], v[176:179], v[104:107], v[32:35]
    v_mfma_f32_16x16x32_bf16 v[36:39], v[184:187], v[104:107], v[36:39]
    v_mfma_f32_16x16x32_bf16 v[40:43], v[180:183], v[104:107], v[40:43]
    v_mfma_f32_16x16x32_bf16 v[44:47], v[188:191], v[104:107], v[44:47]
    s_waitcnt vmcnt(9)
    v_mfma_f32_16x16x32_bf16 v[32:35], v[192:195], v[108:111], v[32:35]
    v_mfma_f32_16x16x32_bf16 v[36:39], v[200:203], v[108:111], v[36:39]
    v_mfma_f32_16x16x32_bf16 v[40:43], v[196:199], v[108:111], v[40:43]
    v_mfma_f32_16x16x32_bf16 v[44:47], v[204:207], v[108:111], v[44:47]
    s_waitcnt vmcnt(8)
    v_mfma_f32_16x16x32_bf16 v[32:35], v[208:211], v[112:115], v[32:35]
    v_mfma_f32_16x16x32_bf16 v[36:39], v[216:219], v[112:115], v[36:39]
    v_mfma_f32_16x16x32_bf16 v[40:43], v[212:215], v[112:115], v[40:43]
    v_mfma_f32_16x16x32_bf16 v[44:47], v[220:223], v[112:115], v[44:47]
    s_waitcnt vmcnt(7)
    v_mfma_f32_16x16x32_bf16 v[32:35], v[224:227], v[116:119], v[32:35]
    v_mfma_f32_16x16x32_bf16 v[36:39], v[232:235], v[116:119], v[36:39]
    v_mfma_f32_16x16x32_bf16 v[40:43], v[228:231], v[116:119], v[40:43]
    v_mfma_f32_16x16x32_bf16 v[44:47], v[236:239], v[116:119], v[44:47]
    s_waitcnt vmcnt(6)
    v_mfma_f32_16x16x32_bf16 v[32:35], v[240:243], v[120:123], v[32:35]
    v_mfma_f32_16x16x32_bf16 v[36:39], v[248:251], v[120:123], v[36:39]
    s_lshl_b32 s68, s60, 10
    s_add_u32 s68, s68, s77
    v_add_u32 v10, s68, v2
    v_add_u32 v11, s77, v2
    s_xor_b32 s77, s77, 4096
    v_add_f32_dpp v32, v40, v32 row_ror:8 row_mask:0xf bank_mask:0x3
    v_add_f32_dpp v33, v41, v33 row_ror:8 row_mask:0xf bank_mask:0x3
    v_add_f32_dpp v34, v42, v34 row_ror:8 row_mask:0xf bank_mask:0x3
    v_add_f32_dpp v35, v43, v35 row_ror:8 row_mask:0xf bank_mask:0x3
    v_add_f32_dpp v32, v36, v44 row_ror:8 row_mask:0xf bank_mask:0xc
    v_add_f32_dpp v33, v37, v45 row_ror:8 row_mask:0xf bank_mask:0xc
    v_add_f32_dpp v34, v38, v46 row_ror:8 row_mask:0xf bank_mask:0xc
    v_add_f32_dpp v35, v39, v47 row_ror:8 row_mask:0xf bank_mask:0xc
    ds_write_b128 v10, v[32:35]
    s_waitcnt lgkmcnt(0)
    s_barrier
    ds_read_b128 v[32:35], v11 offset:0
    ds_read_b128 v[36:39], v11 offset:1024
    ds_read_b128 v[40:43], v11 offset:2048
    ds_read_b128 v[44:47], v11 offset:3072
    s_waitcnt lgkmcnt(2)
    v_pk_add_f32 v[32:33], v[32:33], v[36:37]
    v_pk_add_f32 v[34:35], v[34:35], v[38:39]
    s_waitcnt lgkmcnt(0)
    v_pk_add_f32 v[40:41], v[40:41], v[44:45]
    v_pk_add_f32 v[42:43], v[42:43], v[46:47]
    v_pk_add_f32 v[32:33], v[32:33], v[40:41]
    v_pk_add_f32 v[34:35], v[34:35], v[42:43]
    v_cvt_pk_bf16_f32 v8, v32, v33
    v_lshlrev_b32 v32, 16, v8
    v_and_b32 v33, 0xffff0000, v8
    v_cvt_pk_bf16_f32 v8, v34, v35
    v_lshlrev_b32 v34, 16, v8
    v_and_b32 v35, 0xffff0000, v8
    v_add_f32 v32, v32, v16
    v_add_f32 v33, v33, v17
    v_add_f32 v34, v34, v18
    v_add_f32 v35, v35, v19
    v_cvt_pk_bf16_f32 v8, v32, v33
    v_lshlrev_b32 v32, 16, v8
    v_and_b32 v33, 0xffff0000, v8
    v_cvt_pk_bf16_f32 v8, v34, v35
    v_lshlrev_b32 v34, 16, v8
    v_and_b32 v35, 0xffff0000, v8
    v_mul_f32 v36, s75, v32
    v_mul_f32 v37, s75, v33
    v_mul_f32 v38, s75, v34
    v_mul_f32 v39, s75, v35
    v_exp_f32 v36, v36
    v_exp_f32 v37, v37
    v_exp_f32 v38, v38
    v_exp_f32 v39, v39
    v_add_f32 v36, 1.0, v36
    v_add_f32 v37, 1.0, v37
    v_add_f32 v38, 1.0, v38
    v_add_f32 v39, 1.0, v39
    v_rcp_f32 v36, v36
    v_rcp_f32 v37, v37
    v_rcp_f32 v38, v38
    v_rcp_f32 v39, v39
    v_mul_f32 v32, v32, v36
    v_mul_f32 v33, v33, v37
    v_mul_f32 v34, v34, v38
    v_mul_f32 v35, v35, v39
    v_cvt_pk_bf16_f32 v36, v32, v33
    v_cvt_pk_bf16_f32 v37, v34, v35
    ds_write2_b64 v20, v[36:37], v[28:29] offset0:0 offset1:1
    s_waitcnt vmcnt(5)
    v_mfma_f32_16x16x32_bf16 v[32:35], v[160:163], v[124:127], 0
    v_mfma_f32_16x16x32_bf16 v[36:39], v[168:171], v[124:127], 0
    v_mfma_f32_16x16x32_bf16 v[40:43], v[164:167], v[124:127], 0
    v_mfma_f32_16x16x32_bf16 v[44:47], v[172:175], v[124:127], 0
    s_waitcnt vmcnt(4)
    v_mfma_f32_16x16x32_bf16 v[32:35], v[176:179], v[128:131], v[32:35]
    v_mfma_f32_16x16x32_bf16 v[36:39], v[184:187], v[128:131], v[36:39]
    v_mfma_f32_16x16x32_bf16 v[40:43], v[180:183], v[128:131], v[40:43]
    v_mfma_f32_16x16x32_bf16 v[44:47], v[188:191], v[128:131], v[44:47]
    s_waitcnt vmcnt(3)
    v_mfma_f32_16x16x32_bf16 v[32:35], v[192:195], v[132:135], v[32:35]
    v_mfma_f32_16x16x32_bf16 v[36:39], v[200:203], v[132:135], v[36:39]
    v_mfma_f32_16x16x32_bf16 v[40:43], v[196:199], v[132:135], v[40:43]
    v_mfma_f32_16x16x32_bf16 v[44:47], v[204:207], v[132:135], v[44:47]
    s_waitcnt vmcnt(2)
    v_mfma_f32_16x16x32_bf16 v[32:35], v[208:211], v[136:139], v[32:35]
    v_mfma_f32_16x16x32_bf16 v[36:39], v[216:219], v[136:139], v[36:39]
    v_mfma_f32_16x16x32_bf16 v[40:43], v[212:215], v[136:139], v[40:43]
    v_mfma_f32_16x16x32_bf16 v[44:47], v[220:223], v[136:139], v[44:47]
    s_waitcnt vmcnt(1)
    v_mfma_f32_16x16x32_bf16 v[32:35], v[224:227], v[140:143], v[32:35]
    v_mfma_f32_16x16x32_bf16 v[36:39], v[232:235], v[140:143], v[36:39]
    v_mfma_f32_16x16x32_bf16 v[40:43], v[228:231], v[140:143], v[40:43]
    v_mfma_f32_16x16x32_bf16 v[44:47], v[236:239], v[140:143], v[44:47]
    s_waitcnt vmcnt(0)
    v_mfma_f32_16x16x32_bf16 v[32:35], v[240:243], v[144:147], v[32:35]
    v_mfma_f32_16x16x32_bf16 v[36:39], v[248:251], v[144:147], v[36:39]
    s_lshl_b32 s68, s60, 10
    s_add_u32 s68, s68, s77
    v_add_u32 v10, s68, v2
    v_add_u32 v11, s77, v2
    s_xor_b32 s77, s77, 4096
    v_add_f32_dpp v32, v40, v32 row_ror:8 row_mask:0xf bank_mask:0x3
    v_add_f32_dpp v33, v41, v33 row_ror:8 row_mask:0xf bank_mask:0x3
    v_add_f32_dpp v34, v42, v34 row_ror:8 row_mask:0xf bank_mask:0x3
    v_add_f32_dpp v35, v43, v35 row_ror:8 row_mask:0xf bank_mask:0x3
    v_add_f32_dpp v32, v36, v44 row_ror:8 row_mask:0xf bank_mask:0xc
    v_add_f32_dpp v33, v37, v45 row_ror:8 row_mask:0xf bank_mask:0xc
    v_add_f32_dpp v34, v38, v46 row_ror:8 row_mask:0xf bank_mask:0xc
    v_add_f32_dpp v35, v39, v47 row_ror:8 row_mask:0xf bank_mask:0xc
    ds_write_b128 v10, v[32:35]
    s_waitcnt lgkmcnt(0)
    s_barrier
    ds_read_b128 v[32:35], v11 offset:0
    ds_read_b128 v[36:39], v11 offset:1024
    ds_read_b128 v[40:43], v11 offset:2048
    ds_read_b128 v[44:47], v11 offset:3072
    s_waitcnt lgkmcnt(2)
    v_pk_add_f32 v[32:33], v[32:33], v[36:37]
    v_pk_add_f32 v[34:35], v[34:35], v[38:39]
    s_waitcnt lgkmcnt(0)
    v_pk_add_f32 v[40:41], v[40:41], v[44:45]
    v_pk_add_f32 v[42:43], v[42:43], v[46:47]
    v_pk_add_f32 v[32:33], v[32:33], v[40:41]
    v_pk_add_f32 v[34:35], v[34:35], v[42:43]
    v_cvt_pk_bf16_f32 v8, v32, v33
    v_lshlrev_b32 v32, 16, v8
    v_and_b32 v33, 0xffff0000, v8
    v_cvt_pk_bf16_f32 v8, v34, v35
    v_lshlrev_b32 v34, 16, v8
    v_and_b32 v35, 0xffff0000, v8
    v_add_f32 v32, v32, v16
    v_add_f32 v33, v33, v17
    v_add_f32 v34, v34, v18
    v_add_f32 v35, v35, v19
    v_cvt_pk_bf16_f32 v8, v32, v33
    v_lshlrev_b32 v32, 16, v8
    v_and_b32 v33, 0xffff0000, v8
    v_cvt_pk_bf16_f32 v8, v34, v35
    v_lshlrev_b32 v34, 16, v8
    v_and_b32 v35, 0xffff0000, v8
    v_mul_f32 v36, s75, v32
    v_mul_f32 v37, s75, v33
    v_mul_f32 v38, s75, v34
    v_mul_f32 v39, s75, v35
    v_exp_f32 v36, v36
    v_exp_f32 v37, v37
    v_exp_f32 v38, v38
    v_exp_f32 v39, v39
    v_add_f32 v36, 1.0, v36
    v_add_f32 v37, 1.0, v37
    v_add_f32 v38, 1.0, v38
    v_add_f32 v39, 1.0, v39
    v_rcp_f32 v36, v36
    v_rcp_f32 v37, v37
    v_rcp_f32 v38, v38
    v_rcp_f32 v39, v39
    v_mul_f32 v32, v32, v36
    v_mul_f32 v33, v33, v37
    v_mul_f32 v34, v34, v38
    v_mul_f32 v35, v35, v39
    v_cvt_pk_bf16_f32 v36, v32, v33
    v_cvt_pk_bf16_f32 v37, v34, v35
    ds_write2_b64 v20, v[36:37], v[30:31] offset0:128 offset1:129
    s_add_u32 s66, s66, 2
    s_branch O_gate
O_nogate:
    s_mov_b32 s66, 0
    s_mov_b32 s67, s65
    s_mul_i32 s68, s67, 98304
    s_mul_i32 s69, s60, 11264
    s_add_u32 s68, s68, s69
    s_add_u32 s68, s68, 0x300000
    s_add_u32 s69, s68, 0
    buffer_load_dwordx4 v[52:55], v2, s[8:11], s69 offen offset:0 sc1
    buffer_load_dwordx4 v[56:59], v2, s[8:11], s69 offen offset:1024 sc1
    buffer_load_dwordx4 v[60:63], v2, s[8:11], s69 offen offset:2048 sc1
    buffer_load_dwordx4 v[64:67], v2, s[8:11], s69 offen offset:3072 sc1
    s_add_u32 s69, s68, 4096
    buffer_load_dwordx4 v[68:71], v2, s[8:11], s69 offen offset:0 sc1
    buffer_load_dwordx4 v[72:75], v2, s[8:11], s69 offen offset:1024 sc1
    buffer_load_dwordx4 v[76:79], v2, s[8:11], s69 offen offset:2048 sc1
    buffer_load_dwordx4 v[80:83], v2, s[8:11], s69 offen offset:3072 sc1
    s_add_u32 s69, s68, 8192
    buffer_load_dwordx4 v[84:87], v2, s[8:11], s69 offen offset:0 sc1
    buffer_load_dwordx4 v[88:91], v2, s[8:11], s69 offen offset:1024 sc1
    s_add_u32 s69, s68, s74
    buffer_load_dwordx4 v[92:95], v2, s[8:11], s69 offen offset:0 sc1
    s_add_u32 s69, s68, 49152
    buffer_load_dwordx4 v[96:99], v2, s[8:11], s69 offen offset:0 sc1
    buffer_load_dwordx4 v[100:103], v2, s[8:11], s69 offen offset:1024 sc1
    buffer_load_dwordx4 v[104:107], v2, s[8:11], s69 offen offset:2048 sc1
    buffer_load_dwordx4 v[108:111], v2, s[8:11], s69 offen offset:3072 sc1
    s_add_u32 s69, s68, 53248
    buffer_load_dwordx4 v[112:115], v2, s[8:11], s69 offen offset:0 sc1
    buffer_load_dwordx4 v[116:119], v2, s[8:11], s69 offen offset:1024 sc1
    buffer_load_dwordx4 v[120:123], v2, s[8:11], s69 offen offset:2048 sc1
    buffer_load_dwordx4 v[124:127], v2, s[8:11], s69 offen offset:3072 sc1
    s_add_u32 s69, s68, 57344
    buffer_load_dwordx4 v[128:131], v2, s[8:11], s69 offen offset:0 sc1
    buffer_load_dwordx4 v[132:135], v2, s[8:11], s69 offen offset:1024 sc1
    s_add_u32 s69, s68, s74
    s_add_u32 s69, s69, 49152
    buffer_load_dwordx4 v[136:139], v2, s[8:11], s69 offen offset:0 sc1
    s_lshl_b32 s68, s65, 7
    buffer_load_dword v7, v6, s[8:11], s68 offen offset:4 sc1
    s_waitcnt vmcnt(0)
O_loop:
    s_add_u32 s66, s66, 1
    s_waitcnt vmcnt(1)
    v_cmp_gt_u32 vcc, s66, v7
    s_cbranch_vccz O_go
    s_lshl_b32 s68, s65, 7
poll_13:
    buffer_load_dword v8, v6, s[8:11], s68 offen offset:4 sc1
    s_waitcnt vmcnt(0)
    v_cmp_gt_u32 vcc, s66, v8
    s_cbranch_vccz pdone_14
    s_add_u32 s63, s63, 1
    s_cmp_gt_u32 s63, 400000
    s_cbranch_scc1 pdone_14
    s_sleep 1
    s_branch poll_13
pdone_14:
O_go:
    s_lshl_b32 s70, s67, 15
    s_lshl_b32 s69, s72, 14
    s_add_u32 s70, s70, s69
    buffer_load_dwordx2 v[48:49], v9, s[16:19], s70 offen
    s_lshl_b32 s68, s67, 18
    s_lshl_b32 s69, s60, 15
    s_add_u32 s68, s68, s69
    s_add_u32 s68, s68, 0x1a00000
    s_add_u32 s69, s68, 0x0
    buffer_load_dwordx4 v[140:143], v2, s[8:11], s69 offen offset:0 sc1
    buffer_load_dwordx4 v[144:147], v2, s[8:11], s69 offen offset:1024 sc1
    buffer_load_dwordx4 v[148:151], v2, s[8:11], s69 offen offset:2048 sc1
    buffer_load_dwordx4 v[152:155], v2, s[8:11], s69 offen offset:3072 sc1
    s_add_u32 s69, s68, 0x1000
    buffer_load_dwordx4 v[156:159], v2, s[8:11], s69 offen offset:0 sc1
    v_mfma_f32_16x16x32_bf16 v[32:35], v[160:163], v[52:55], 0
    v_mfma_f32_16x16x32_bf16 v[36:39], v[168:171], v[52:55], 0
    buffer_load_dwordx4 v[52:55], v2, s[8:11], s69 offen offset:1024 sc1
    v_mfma_f32_16x16x32_bf16 v[32:35], v[164:167], v[56:59], v[32:35]
    v_mfma_f32_16x16x32_bf16 v[36:39], v[172:175], v[56:59], v[36:39]
    buffer_load_dwordx4 v[56:59], v2, s[8:11], s69 offen offset:2048 sc1
    v_mfma_f32_16x16x32_bf16 v[32:35], v[176:179], v[60:63], v[32:35]
    v_mfma_f32_16x16x32_bf16 v[36:39], v[184:187], v[60:63], v[36:39]
    buffer_load_dwordx4 v[60:63], v2, s[8:11], s69 offen offset:3072 sc1
    v_mfma_f32_16x16x32_bf16 v[32:35], v[180:183], v[64:67], v[32:35]
    v_mfma_f32_16x16x32_bf16 v[36:39], v[188:191], v[64:67], v[36:39]
    s_add_u32 s69, s68, 0x2000
    buffer_load_dwordx4 v[64:67], v2, s[8:11], s69 offen offset:0 sc1
    v_mfma_f32_16x16x32_bf16 v[32:35], v[192:195], v[68:71], v[32:35]
    v_mfma_f32_16x16x32_bf16 v[36:39], v[200:203], v[68:71], v[36:39]
    buffer_load_dwordx4 v[68:71], v2, s[8:11], s69 offen offset:1024 sc1
    v_mfma_f32_16x16x32_bf16 v[32:35], v[196:199], v[72:75], v[32:35]
    v_mfma_f32_16x16x32_bf16 v[36:39], v[204:207], v[72:75], v[36:39]
    buffer_load_dwordx4 v[72:75], v2, s[8:11], s69 offen offset:2048 sc1
    v_mfma_f32_16x16x32_bf16 v[32:35], v[208:211], v[76:79], v[32:35]
    v_mfma_f32_16x16x32_bf16 v[36:39], v[216:219], v[76:79], v[36:39]
    buffer_load_dwordx4 v[76:79], v2, s[8:11], s69 offen offset:3072 sc1
    v_mfma_f32_16x16x32_bf16 v[32:35], v[212:215], v[80:83], v[32:35]
    v_mfma_f32_16x16x32_bf16 v[36:39], v[220:223], v[80:83], v[36:39]
    s_add_u32 s69, s68, 0x3000
    buffer_load_dwordx4 v[80:83], v2, s[8:11], s69 offen offset:0 sc1
    v_mfma_f32_16x16x32_bf16 v[32:35], v[224:227], v[84:87], v[32:35]
    v_mfma_f32_16x16x32_bf16 v[36:39], v[232:235], v[84:87], v[36:39]
    buffer_load_dwordx4 v[84:87], v2, s[8:11], s69 offen offset:1024 sc1
    v_mfma_f32_16x16x32_bf16 v[32:35], v[228:231], v[88:91], v[32:35]
    v_mfma_f32_16x16x32_bf16 v[36:39], v[236:239], v[88:91], v[36:39]
    buffer_load_dwordx4 v[88:91], v2, s[8:11], s69 offen offset:2048 sc1
    v_mfma_f32_16x16x32_bf16 v[32:35], v[240:243], v[92:95], v[32:35]
    v_mfma_f32_16x16x32_bf16 v[36:39], v[248:251], v[92:95], v[36:39]
    buffer_load_dwordx4 v[92:95], v2, s[8:11], s69 offen offset:3072 sc1
    v_mfma_f32_16x16x32_bf16 v[40:43], v[160:163], v[96:99], 0
    v_mfma_f32_16x16x32_bf16 v[44:47], v[168:171], v[96:99], 0
    s_add_u32 s69, s68, 0x4000
    buffer_load_dwordx4 v[96:99], v2, s[8:11], s69 offen offset:0 sc1
    v_mfma_f32_16x16x32_bf16 v[40:43], v[164:167], v[100:103], v[40:43]
    v_mfma_f32_16x16x32_bf16 v[44:47], v[172:175], v[100:103], v[44:47]
    buffer_load_dwordx4 v[100:103], v2, s[8:11], s69 offen offset:1024 sc1
    v_mfma_f32_16x16x32_bf16 v[40:43], v[176:179], v[104:107], v[40:43]
    v_mfma_f32_16x16x32_bf16 v[44:47], v[184:187], v[104:107], v[44:47]
    buffer_load_dwordx4 v[104:107], v2, s[8:11], s69 offen offset:2048 sc1
    v_mfma_f32_16x16x32_bf16 v[40:43], v[180:183], v[108:111], v[40:43]
    v_mfma_f32_16x16x32_bf16 v[44:47], v[188:191], v[108:111], v[44:47]
    buffer_load_dwordx4 v[108:111], v2, s[8:11], s69 offen offset:3072 sc1
    v_mfma_f32_16x16x32_bf16 v[40:43], v[192:195], v[112:115], v[40:43]
    v_mfma_f32_16x16x32_bf16 v[44:47], v[200:203], v[112:115], v[44:47]
    s_add_u32 s69, s68, 0x5000
    buffer_load_dwordx4 v[112:115], v2, s[8:11], s69 offen offset:0 sc1
    v_mfma_f32_16x16x32_bf16 v[40:43], v[196:199], v[116:119], v[40:43]
    v_mfma_f32_16x16x32_bf16 v[44:47], v[204:207], v[116:119], v[44:47]
    buffer_load_dwordx4 v[116:119], v2, s[8:11], s69 offen offset:1024 sc1
    v_mfma_f32_16x16x32_bf16 v[40:43], v[208:211], v[120:123], v[40:43]
    v_mfma_f32_16x16x32_bf16 v[44:47], v[216:219], v[120:123], v[44:47]
    buffer_load_dwordx4 v[120:123], v2, s[8:11], s69 offen offset:2048 sc1
    v_mfma_f32_16x16x32_bf16 v[40:43], v[212:215], v[124:127], v[40:43]
    v_mfma_f32_16x16x32_bf16 v[44:47], v[220:223], v[124:127], v[44:47]
    buffer_load_dwordx4 v[124:127], v2, s[8:11], s69 offen offset:3072 sc1
    v_mfma_f32_16x16x32_bf16 v[40:43], v[224:227], v[128:131], v[40:43]
    v_mfma_f32_16x16x32_bf16 v[44:47], v[232:235], v[128:131], v[44:47]
    s_add_u32 s69, s68, 0x6000
    buffer_load_dwordx4 v[128:131], v2, s[8:11], s69 offen offset:0 sc1
    v_mfma_f32_16x16x32_bf16 v[40:43], v[228:231], v[132:135], v[40:43]
    v_mfma_f32_16x16x32_bf16 v[44:47], v[236:239], v[132:135], v[44:47]
    buffer_load_dwordx4 v[132:135], v2, s[8:11], s69 offen offset:1024 sc1
    v_mfma_f32_16x16x32_bf16 v[40:43], v[240:243], v[136:139], v[40:43]
    v_mfma_f32_16x16x32_bf16 v[44:47], v[248:251], v[136:139], v[44:47]
    buffer_load_dwordx4 v[136:139], v2, s[8:11], s69 offen offset:2048 sc1
    s_waitcnt vmcnt(26)
    v_mfma_f32_16x16x32_bf16 v[16:19], a[0:3], v[140:143], 0
    v_mfma_f32_16x16x32_bf16 v[20:23], a[8:11], v[140:143], 0
    buffer_load_dwordx4 v[140:143], v2, s[8:11], s69 offen offset:3072 sc1
    s_waitcnt vmcnt(26)
    v_mfma_f32_16x16x32_bf16 v[16:19], a[4:7], v[144:147], v[16:19]
    v_mfma_f32_16x16x32_bf16 v[20:23], a[12:15], v[144:147], v[20:23]
    s_add_u32 s69, s68, 0x7000
    buffer_load_dwordx4 v[144:147], v2, s[8:11], s69 offen offset:0 sc1
    s_waitcnt vmcnt(26)
    v_mfma_f32_16x16x32_bf16 v[16:19], a[16:19], v[148:151], v[16:19]
    v_mfma_f32_16x16x32_bf16 v[20:23], a[24:27], v[148:151], v[20:23]
    buffer_load_dwordx4 v[148:151], v2, s[8:11], s69 offen offset:1024 sc1
    s_waitcnt vmcnt(26)
    v_mfma_f32_16x16x32_bf16 v[16:19], a[20:23], v[152:155], v[16:19]
    v_mfma_f32_16x16x32_bf16 v[20:23], a[28:31], v[152:155], v[20:23]
    buffer_load_dwordx4 v[152:155], v2, s[8:11], s69 offen offset:2048 sc1
    s_waitcnt vmcnt(26)
    v_mfma_f32_16x16x32_bf16 v[16:19], a[32:35], v[156:159], v[16:19]
    v_mfma_f32_16x16x32_bf16 v[20:23], a[40:43], v[156:159], v[20:23]
    buffer_load_dwordx4 v[156:159], v2, s[8:11], s69 offen offset:3072 sc1
    s_waitcnt vmcnt(26)
    v_mfma_f32_16x16x32_bf16 v[16:19], a[36:39], v[52:55], v[16:19]
    v_mfma_f32_16x16x32_bf16 v[20:23], a[44:47], v[52:55], v[20:23]
    s_add_u32 s69, s68, 0x20000
    buffer_load_dwordx4 v[52:55], v2, s[8:11], s69 offen offset:0 sc1
    s_waitcnt vmcnt(26)
    v_mfma_f32_16x16x32_bf16 v[16:19], a[48:51], v[56:59], v[16:19]
    v_mfma_f32_16x16x32_bf16 v[20:23], a[56:59], v[56:59], v[20:23]
    buffer_load_dwordx4 v[56:59], v2, s[8:11], s69 offen offset:1024 sc1
    s_waitcnt vmcnt(26)
    v_mfma_f32_16x16x32_bf16 v[16:19], a[52:55], v[60:63], v[16:19]
    v_mfma_f32_16x16x32_bf16 v[20:23], a[60:63], v[60:63], v[20:23]
    buffer_load_dwordx4 v[60:63], v2, s[8:11], s69 offen offset:2048 sc1
    s_waitcnt vmcnt(26)
    v_mfma_f32_16x16x32_bf16 v[16:19], a[64:67], v[64:67], v[16:19]
    v_mfma_f32_16x16x32_bf16 v[20:23], a[72:75], v[64:67], v[20:23]
    buffer_load_dwordx4 v[64:67], v2, s[8:11], s69 offen offset:3072 sc1
    s_waitcnt vmcnt(26)
    v_mfma_f32_16x16x32_bf16 v[16:19], a[68:71], v[68:71], v[16:19]
    v_mfma_f32_16x16x32_bf16 v[20:23], a[76:79], v[68:71], v[20:23]
    s_add_u32 s69, s68, 0x21000
    buffer_load_dwordx4 v[68:71], v2, s[8:11], s69 offen offset:0 sc1
    s_waitcnt vmcnt(26)
    v_mfma_f32_16x16x32_bf16 v[16:19], a[80:83], v[72:75], v[16:19]
    v_mfma_f32_16x16x32_bf16 v[20:23], a[88:91], v[72:75], v[20:23]
    buffer_load_dwordx4 v[72:75], v2, s[8:11], s69 offen offset:1024 sc1
    s_waitcnt vmcnt(26)
    v_mfma_f32_16x16x32_bf16 v[16:19], a[84:87], v[76:79], v[16:19]
    v_mfma_f32_16x16x32_bf16 v[20:23], a[92:95], v[76:79], v[20:23]
    buffer_load_dwordx4 v[76:79], v2, s[8:11], s69 offen offset:2048 sc1
    s_waitcnt vmcnt(26)
    v_mfma_f32_16x16x32_bf16 v[16:19], a[96:99], v[80:83], v[16:19]
    v_mfma_f32_16x16x32_bf16 v[20:23], a[104:107], v[80:83], v[20:23]
    buffer_load_dwordx4 v[80:83], v2, s[8:11], s69 offen offset:3072 sc1
    s_waitcnt vmcnt(26)
    v_mfma_f32_16x16x32_bf16 v[16:19], a[100:103], v[84:87], v[16:19]
    v_mfma_f32_16x16x32_bf16 v[20:23], a[108:111], v[84:87], v[20:23]
    s_add_u32 s69, s68, 0x22000
    buffer_load_dwordx4 v[84:87], v2, s[8:11], s69 offen offset:0 sc1
    s_waitcnt vmcnt(26)
    v_mfma_f32_16x16x32_bf16 v[16:19], a[112:115], v[88:91], v[16:19]
    v_mfma_f32_16x16x32_bf16 v[20:23], a[120:123], v[88:91], v[20:23]
    buffer_load_dwordx4 v[88:91], v2, s[8:11], s69 offen offset:1024 sc1
    s_waitcnt vmcnt(26)
    v_mfma_f32_16x16x32_bf16 v[16:19], a[116:119], v[92:95], v[16:19]
    v_mfma_f32_16x16x32_bf16 v[20:23], a[124:127], v[92:95], v[20:23]
    buffer_load_dwordx4 v[92:95], v2, s[8:11], s69 offen offset:2048 sc1
    s_waitcnt vmcnt(26)
    v_mfma_f32_16x16x32_bf16 v[16:19], a[128:131], v[96:99], v[16:19]
    v_mfma_f32_16x16x32_bf16 v[20:23], a[136:139], v[96:99], v[20:23]
    buffer_load_dwordx4 v[96:99], v2, s[8:11], s69 offen offset:3072 sc1
    s_waitcnt vmcnt(26)
    v_mfma_f32_16x16x32_bf16 v[16:19], a[132:135], v[100:103], v[16:19]
    v_mfma_f32_16x16x32_bf16 v[20:23], a[140:143], v[100:103], v[20:23]
    s_add_u32 s69, s68, 0x23000
    buffer_load_dwordx4 v[100:103], v2, s[8:11], s69 offen offset:0 sc1
    s_waitcnt vmcnt(26)
    v_mfma_f32_16x16x32_bf16 v[16:19], a[144:147], v[104:107], v[16:19]
    v_mfma_f32_16x16x32_bf16 v[20:23], a[152:155], v[104:107], v[20:23]
    buffer_load_dwordx4 v[104:107], v2, s[8:11], s69 offen offset:1024 sc1
    s_waitcnt vmcnt(26)
    v_mfma_f32_16x16x32_bf16 v[16:19], a[148:151], v[108:111], v[16:19]
    v_mfma_f32_16x16x32_bf16 v[20:23], a[156:159], v[108:111], v[20:23]
    buffer_load_dwordx4 v[108:111], v2, s[8:11], s69 offen offset:2048 sc1
    s_waitcnt vmcnt(26)
    v_mfma_f32_16x16x32_bf16 v[16:19], a[160:163], v[112:115], v[16:19]
    v_mfma_f32_16x16x32_bf16 v[20:23], a[168:171], v[112:115], v[20:23]
    buffer_load_dwordx4 v[112:115], v2, s[8:11], s69 offen offset:3072 sc1
    s_waitcnt vmcnt(26)
    v_mfma_f32_16x16x32_bf16 v[16:19], a[164:167], v[116:119], v[16:19]
    v_mfma_f32_16x16x32_bf16 v[20:23], a[172:175], v[116:119], v[20:23]
    s_add_u32 s69, s68, 0x24000
    buffer_load_dwordx4 v[116:119], v2, s[8:11], s69 offen offset:0 sc1
    s_waitcnt vmcnt(26)
    v_mfma_f32_16x16x32_bf16 v[16:19], a[176:179], v[120:123], v[16:19]
    v_mfma_f32_16x16x32_bf16 v[20:23], a[184:187], v[120:123], v[20:23]
    buffer_load_dwordx4 v[120:123], v2, s[8:11], s69 offen offset:1024 sc1
    s_waitcnt vmcnt(26)
    v_mfma_f32_16x16x32_bf16 v[16:19], a[180:183], v[124:127], v[16:19]
    v_mfma_f32_16x16x32_bf16 v[20:23], a[188:191], v[124:127], v[20:23]
    buffer_load_dwordx4 v[124:127], v2, s[8:11], s69 offen offset:2048 sc1
    s_waitcnt vmcnt(26)
    v_mfma_f32_16x16x32_bf16 v[16:19], a[192:195], v[128:131], v[16:19]
    v_mfma_f32_16x16x32_bf16 v[20:23], a[200:203], v[128:131], v[20:23]
    buffer_load_dwordx4 v[128:131], v2, s[8:11], s69 offen offset:3072 sc1
    s_waitcnt vmcnt(26)
    v_mfma_f32_16x16x32_bf16 v[16:19], a[196:199], v[132:135], v[16:19]
    v_mfma_f32_16x16x32_bf16 v[20:23], a[204:207], v[132:135], v[20:23]
    s_add_u32 s69, s68, 0x25000
    buffer_load_dwordx4 v[132:135], v2, s[8:11], s69 offen offset:0 sc1
    s_waitcnt vmcnt(26)
    v_mfma_f32_16x16x32_bf16 v[16:19], a[208:211], v[136:139], v[16:19]
    v_mfma_f32_16x16x32_bf16 v[20:23], a[216:219], v[136:139], v[20:23]
    buffer_load_dwordx4 v[136:139], v2, s[8:11], s69 offen offset:1024 sc1
    s_waitcnt vmcnt(26)
    v_mfma_f32_16x16x32_bf16 v[16:19], a[212:215], v[140:143], v[16:19]
    v_mfma_f32_16x16x32_bf16 v[20:23], a[220:223], v[140:143], v[20:23]
    buffer_load_dwordx4 v[140:143], v2, s[8:11], s69 offen offset:2048 sc1
    s_waitcnt vmcnt(26)
    v_mfma_f32_16x16x32_bf16 v[16:19], a[224:227], v[144:147], v[16:19]
    v_mfma_f32_16x16x32_bf16 v[20:23], a[232:235], v[144:147], v[20:23]
    buffer_load_dwordx4 v[144:147], v2, s[8:11], s69 offen offset:3072 sc1
    s_waitcnt vmcnt(26)
    v_mfma_f32_16x16x32_bf16 v[16:19], a[228:231], v[148:151], v[16:19]
    v_mfma_f32_16x16x32_bf16 v[20:23], a[236:239], v[148:151], v[20:23]
    s_add_u32 s69, s68, 0x26000
    buffer_load_dwordx4 v[148:151], v2, s[8:11], s69 offen offset:0 sc1
    s_waitcnt vmcnt(26)
    v_mfma_f32_16x16x32_bf16 v[16:19], a[240:243], v[152:155], v[16:19]
    v_mfma_f32_16x16x32_bf16 v[20:23], a[248:251], v[152:155], v[20:23]
    buffer_load_dwordx4 v[152:155], v2, s[8:11], s69 offen offset:1024 sc1
    s_waitcnt vmcnt(26)
    v_mfma_f32_16x16x32_bf16 v[16:19], a[244:247], v[156:159], v[16:19]
    v_mfma_f32_16x16x32_bf16 v[20:23], a[252:255], v[156:159], v[20:23]
    buffer_load_dwordx4 v[156:159], v2, s[8:11], s69 offen offset:2048 sc1
    s_waitcnt vmcnt(26)
    v_mfma_f32_16x16x32_bf16 v[24:27], a[0:3], v[52:55], 0
    v_mfma_f32_16x16x32_bf16 v[28:31], a[8:11], v[52:55], 0
    buffer_load_dwordx4 v[52:55], v2, s[8:11], s69 offen offset:3072 sc1
    s_waitcnt vmcnt(26)
    v_mfma_f32_16x16x32_bf16 v[24:27], a[4:7], v[56:59], v[24:27]
    v_mfma_f32_16x16x32_bf16 v[28:31], a[12:15], v[56:59], v[28:31]
    s_add_u32 s69, s68, 0x27000
    buffer_load_dwordx4 v[56:59], v2, s[8:11], s69 offen offset:0 sc1
    s_waitcnt vmcnt(26)
    v_mfma_f32_16x16x32_bf16 v[24:27], a[16:19], v[60:63], v[24:27]
    v_mfma_f32_16x16x32_bf16 v[28:31], a[24:27], v[60:63], v[28:31]
    buffer_load_dwordx4 v[60:63], v2, s[8:11], s69 offen offset:1024 sc1
    s_waitcnt vmcnt(26)
    v_mfma_f32_16x16x32_bf16 v[24:27], a[20:23], v[64:67], v[24:27]
    v_mfma_f32_16x16x32_bf16 v[28:31], a[28:31], v[64:67], v[28:31]
    buffer_load_dwordx4 v[64:67], v2, s[8:11], s69 offen offset:2048 sc1
    s_waitcnt vmcnt(26)
    v_mfma_f32_16x16x32_bf16 v[24:27], a[32:35], v[68:71], v[24:27]
    v_mfma_f32_16x16x32_bf16 v[28:31], a[40:43], v[68:71], v[28:31]
    buffer_load_dwordx4 v[68:71], v2, s[8:11], s69 offen offset:3072 sc1
    s_waitcnt vmcnt(26)
    v_mfma_f32_16x16x32_bf16 v[24:27], a[36:39], v[72:75], v[24:27]
    v_mfma_f32_16x16x32_bf16 v[28:31], a[44:47], v[72:75], v[28:31]
    s_waitcnt vmcnt(25)
    v_mfma_f32_16x16x32_bf16 v[24:27], a[48:51], v[76:79], v[24:27]
    v_mfma_f32_16x16x32_bf16 v[28:31], a[56:59], v[76:79], v[28:31]
    s_waitcnt vmcnt(24)
    v_mfma_f32_16x16x32_bf16 v[24:27], a[52:55], v[80:83], v[24:27]
    v_mfma_f32_16x16x32_bf16 v[28:31], a[60:63], v[80:83], v[28:31]
    s_waitcnt vmcnt(23)
    v_mfma_f32_16x16x32_bf16 v[24:27], a[64:67], v[84:87], v[24:27]
    v_mfma_f32_16x16x32_bf16 v[28:31], a[72:75], v[84:87], v[28:31]
    s_waitcnt vmcnt(22)
    v_mfma_f32_16x16x32_bf16 v[24:27], a[68:71], v[88:91], v[24:27]
    v_mfma_f32_16x16x32_bf16 v[28:31], a[76:79], v[88:91], v[28:31]
    s_waitcnt vmcnt(21)
    v_mfma_f32_16x16x32_bf16 v[24:27], a[80:83], v[92:95], v[24:27]
    v_mfma_f32_16x16x32_bf16 v[28:31], a[88:91], v[92:95], v[28:31]
    s_waitcnt vmcnt(20)
    v_mfma_f32_16x16x32_bf16 v[24:27], a[84:87], v[96:99], v[24:27]
    v_mfma_f32_16x16x32_bf16 v[28:31], a[92:95], v[96:99], v[28:31]
    s_waitcnt vmcnt(19)
    v_mfma_f32_16x16x32_bf16 v[24:27], a[96:99], v[100:103], v[24:27]
    v_mfma_f32_16x16x32_bf16 v[28:31], a[104:107], v[100:103], v[28:31]
    s_waitcnt vmcnt(18)
    v_mfma_f32_16x16x32_bf16 v[24:27], a[100:103], v[104:107], v[24:27]
    v_mfma_f32_16x16x32_bf16 v[28:31], a[108:111], v[104:107], v[28:31]
    s_waitcnt vmcnt(17)
    v_mfma_f32_16x16x32_bf16 v[24:27], a[112:115], v[108:111], v[24:27]
    v_mfma_f32_16x16x32_bf16 v[28:31], a[120:123], v[108:111], v[28:31]
    s_waitcnt vmcnt(16)
    v_mfma_f32_16x16x32_bf16 v[24:27], a[116:119], v[112:115], v[24:27]
    v_mfma_f32_16x16x32_bf16 v[28:31], a[124:127], v[112:115], v[28:31]
    s_waitcnt vmcnt(15)
    v_mfma_f32_16x16x32_bf16 v[24:27], a[128:131], v[116:119], v[24:27]
    v_mfma_f32_16x16x32_bf16 v[28:31], a[136:139], v[116:119], v[28:31]
    s_waitcnt vmcnt(14)
    v_mfma_f32_16x16x32_bf16 v[24:27], a[132:135], v[120:123], v[24:27]
    v_mfma_f32_16x16x32_bf16 v[28:31], a[140:143], v[120:123], v[28:31]
    s_waitcnt vmcnt(13)
    v_mfma_f32_16x16x32_bf16 v[24:27], a[144:147], v[124:127], v[24:27]
    v_mfma_f32_16x16x32_bf16 v[28:31], a[152:155], v[124:127], v[28:31]
    s_waitcnt vmcnt(12)
    v_mfma_f32_16x16x32_bf16 v[24:27], a[148:151], v[128:131], v[24:27]
    v_mfma_f32_16x16x32_bf16 v[28:31], a[156:159], v[128:131], v[28:31]
    s_waitcnt vmcnt(11)
    v_mfma_f32_16x16x32_bf16 v[24:27], a[160:163], v[132:135], v[24:27]
    v_mfma_f32_16x16x32_bf16 v[28:31], a[168:171], v[132:135], v[28:31]
    s_waitcnt vmcnt(10)
    v_mfma_f32_16x16x32_bf16 v[24:27], a[164:167], v[136:139], v[24:27]
    v_mfma_f32_16x16x32_bf16 v[28:31], a[172:175], v[136:139], v[28:31]
    s_waitcnt vmcnt(9)
    v_mfma_f32_16x16x32_bf16 v[24:27], a[176:179], v[140:143], v[24:27]
    v_mfma_f32_16x16x32_bf16 v[28:31], a[184:187], v[140:143], v[28:31]
    s_waitcnt vmcnt(8)
    v_mfma_f32_16x16x32_bf16 v[24:27], a[180:183], v[144:147], v[24:27]
    v_mfma_f32_16x16x32_bf16 v[28:31], a[188:191], v[144:147], v[28:31]
    s_waitcnt vmcnt(7)
    v_mfma_f32_16x16x32_bf16 v[24:27], a[192:195], v[148:151], v[24:27]
    v_mfma_f32_16x16x32_bf16 v[28:31], a[200:203], v[148:151], v[28:31]
    s_waitcnt vmcnt(6)
    v_mfma_f32_16x16x32_bf16 v[24:27], a[196:199], v[152:155], v[24:27]
    v_mfma_f32_16x16x32_bf16 v[28:31], a[204:207], v[152:155], v[28:31]
    s_waitcnt vmcnt(5)
    v_mfma_f32_16x16x32_bf16 v[24:27], a[208:211], v[156:159], v[24:27]
    v_mfma_f32_16x16x32_bf16 v[28:31], a[216:219], v[156:159], v[28:31]
    s_waitcnt vmcnt(4)
    v_mfma_f32_16x16x32_bf16 v[24:27], a[212:215], v[52:55], v[24:27]
    v_mfma_f32_16x16x32_bf16 v[28:31], a[220:223], v[52:55], v[28:31]
    s_waitcnt vmcnt(3)
    v_mfma_f32_16x16x32_bf16 v[24:27], a[224:227], v[56:59], v[24:27]
    v_mfma_f32_16x16x32_bf16 v[28:31], a[232:235], v[56:59], v[28:31]
    s_waitcnt vmcnt(2)
    v_mfma_f32_16x16x32_bf16 v[24:27], a[228:231], v[60:63], v[24:27]
    v_mfma_f32_16x16x32_bf16 v[28:31], a[236:239], v[60:63], v[28:31]
    s_waitcnt vmcnt(1)
    v_mfma_f32_16x16x32_bf16 v[24:27], a[240:243], v[64:67], v[24:27]
    v_mfma_f32_16x16x32_bf16 v[28:31], a[248:251], v[64:67], v[28:31]
    s_waitcnt vmcnt(0)
    v_mfma_f32_16x16x32_bf16 v[24:27], a[244:247], v[68:71], v[24:27]
    v_mfma_f32_16x16x32_bf16 v[28:31], a[252:255], v[68:71], v[28:31]
    s_add_u32 s67, s67, 4
    s_cmp_ge_u32 s66, 14
    s_cbranch_scc1 O_red
    s_mul_i32 s68, s67, 98304
    s_mul_i32 s69, s60, 11264
    s_add_u32 s68, s68, s69
    s_add_u32 s68, s68, 0x300000
    s_add_u32 s69, s68, 0
    buffer_load_dwordx4 v[52:55], v2, s[8:11], s69 offen offset:0 sc1
    buffer_load_dwordx4 v[56:59], v2, s[8:11], s69 offen offset:1024 sc1
    buffer_load_dwordx4 v[60:63], v2, s[8:11], s69 offen offset:2048 sc1
    buffer_load_dwordx4 v[64:67], v2, s[8:11], s69 offen offset:3072 sc1
    s_add_u32 s69, s68, 4096
    buffer_load_dwordx4 v[68:71], v2, s[8:11], s69 offen offset:0 sc1
    buffer_load_dwordx4 v[72:75], v2, s[8:11], s69 offen offset:1024 sc1
    buffer_load_dwordx4 v[76:79], v2, s[8:11], s69 offen offset:2048 sc1
    buffer_load_dwordx4 v[80:83], v2, s[8:11], s69 offen offset:3072 sc1
    s_add_u32 s69, s68, 8192
    buffer_load_dwordx4 v[84:87], v2, s[8:11], s69 offen offset:0 sc1
    buffer_load_dwordx4 v[88:91], v2, s[8:11], s69 offen offset:1024 sc1
    s_add_u32 s69, s68, s74
    buffer_load_dwordx4 v[92:95], v2, s[8:11], s69 offen offset:0 sc1
    s_add_u32 s69, s68, 49152
    buffer_load_dwordx4 v[96:99], v2, s[8:11], s69 offen offset:0 sc1
    buffer_load_dwordx4 v[100:103], v2, s[8:11], s69 offen offset:1024 sc1
    buffer_load_dwordx4 v[104:107], v2, s[8:11], s69 offen offset:2048 sc1
    buffer_load_dwordx4 v[108:111], v2, s[8:11], s69 offen offset:3072 sc1
    s_add_u32 s69, s68, 53248
    buffer_load_dwordx4 v[112:115], v2, s[8:11], s69 offen offset:0 sc1
    buffer_load_dwordx4 v[116:119], v2, s[8:11], s69 offen offset:1024 sc1
    buffer_load_dwordx4 v[120:123], v2, s[8:11], s69 offen offset:2048 sc1
    buffer_load_dwordx4 v[124:127], v2, s[8:11], s69 offen offset:3072 sc1
    s_add_u32 s69, s68, 57344
    buffer_load_dwordx4 v[128:131], v2, s[8:11], s69 offen offset:0 sc1
    buffer_load_dwordx4 v[132:135], v2, s[8:11], s69 offen offset:1024 sc1
    s_add_u32 s69, s68, s74
    s_add_u32 s69, s69, 49152
    buffer_load_dwordx4 v[136:139], v2, s[8:11], s69 offen offset:0 sc1
    s_lshl_b32 s68, s65, 7
    buffer_load_dword v7, v6, s[8:11], s68 offen offset:4 sc1
O_red:
    s_lshl_b32 s68, s60, 13
    s_add_u32 s68, s68, s71
    v_add_u32 v10, s68, v2
    s_lshl_b32 s68, s72, 1
    s_add_u32 s68, s68, s73
    s_lshl_b32 s68, s68, 10
    s_add_u32 s68, s68, s71
    v_add_u32 v11, s68, v2
    s_xor_b32 s71, s71, 0x8000
    ds_write_b128 v10, v[32:35] offset:4096
    ds_write_b128 v10, v[36:39] offset:5120
    ds_write_b128 v10, v[40:43] offset:6144
    ds_write_b128 v10, v[44:47] offset:7168
    ds_write_b128 v10, v[16:19] offset:0
    ds_write_b128 v10, v[20:23] offset:1024
    ds_write_b128 v10, v[24:27] offset:2048
    ds_write_b128 v10, v[28:31] offset:3072
    s_waitcnt lgkmcnt(0)
    s_barrier
    ds_read_b128 v[32:35], v11 offset:4096
    ds_read_b128 v[36:39], v11 offset:12288
    ds_read_b128 v[40:43], v11 offset:20480
    ds_read_b128 v[44:47], v11 offset:28672
    ds_read_b128 v[16:19], v11 offset:0
    ds_read_b128 v[20:23], v11 offset:8192
    ds_read_b128 v[24:27], v11 offset:16384
    ds_read_b128 v[28:31], v11 offset:24576
    s_waitcnt lgkmcnt(4)
    v_add_f32 v32, v32, v36
    v_add_f32 v40, v40, v44
    v_add_f32 v33, v33, v37
    v_add_f32 v41, v41, v45
    v_add_f32 v34, v34, v38
    v_add_f32 v42, v42, v46
    v_add_f32 v35, v35, v39
    v_add_f32 v43, v43, v47
    v_add_f32 v32, v32, v40
    v_add_f32 v33, v33, v41
    v_add_f32 v34, v34, v42
    v_add_f32 v35, v35, v43
    v_cvt_pk_bf16_f32 v8, v32, v33
    v_lshlrev_b32 v32, 16, v8
    v_and_b32 v33, 0xffff0000, v8
    v_cvt_pk_bf16_f32 v8, v34, v35
    v_lshlrev_b32 v34, 16, v8
    v_and_b32 v35, 0xffff0000, v8
    v_add_f32 v32, v32, v12
    v_add_f32 v33, v33, v13
    v_add_f32 v34, v34, v14
    v_add_f32 v35, v35, v15
    v_cvt_pk_bf16_f32 v8, v32, v33
    v_lshlrev_b32 v32, 16, v8
    v_and_b32 v33, 0xffff0000, v8
    v_cvt_pk_bf16_f32 v8, v34, v35
    v_lshlrev_b32 v34, 16, v8
    v_and_b32 v35, 0xffff0000, v8
    v_mul_f32 v36, s75, v32
    v_mul_f32 v37, s75, v33
    v_mul_f32 v38, s75, v34
    v_mul_f32 v39, s75, v35
    v_exp_f32 v36, v36
    v_exp_f32 v37, v37
    v_exp_f32 v38, v38
    v_exp_f32 v39, v39
    v_add_f32 v36, 1.0, v36
    v_add_f32 v37, 1.0, v37
    v_add_f32 v38, 1.0, v38
    v_add_f32 v39, 1.0, v39
    v_rcp_f32 v36, v36
    v_rcp_f32 v37, v37
    v_rcp_f32 v38, v38
    v_rcp_f32 v39, v39
    v_mul_f32 v32, v32, v36
    v_mul_f32 v33, v33, v37
    v_mul_f32 v34, v34, v38
    v_mul_f32 v35, v35, v39
    v_cvt_pk_bf16_f32 v8, v32, v33
    v_lshlrev_b32 v32, 16, v8
    v_and_b32 v33, 0xffff0000, v8
    v_cvt_pk_bf16_f32 v8, v34, v35
    v_lshlrev_b32 v34, 16, v8
    v_and_b32 v35, 0xffff0000, v8
    s_waitcnt lgkmcnt(0)
    v_add_f32 v16, v16, v20
    v_add_f32 v24, v24, v28
    v_add_f32 v17, v17, v21
    v_add_f32 v25, v25, v29
    v_add_f32 v18, v18, v22
    v_add_f32 v26, v26, v30
    v_add_f32 v19, v19, v23
    v_add_f32 v27, v27, v31
    v_add_f32 v16, v16, v24
    v_add_f32 v17, v17, v25
    v_add_f32 v18, v18, v26
    v_add_f32 v19, v19, v27
    v_cvt_pk_bf16_f32 v8, v16, v17
    v_lshlrev_b32 v16, 16, v8
    v_and_b32 v17, 0xffff0000, v8
    v_cvt_pk_bf16_f32 v8, v18, v19
    v_lshlrev_b32 v18, 16, v8
    v_and_b32 v19, 0xffff0000, v8
    v_mul_f32 v16, v16, v32
    v_mul_f32 v17, v17, v33
    v_mul_f32 v18, v18, v34
    v_mul_f32 v19, v19, v35
    v_cvt_pk_bf16_f32 v8, v16, v17
    v_lshlrev_b32 v16, 16, v8
    v_and_b32 v17, 0xffff0000, v8
    v_lshlrev_b32 v20, 16, v48
    v_and_b32 v21, 0xffff0000, v48
    v_add_f32 v20, v20, v16
    v_add_f32 v21, v21, v17
    v_cvt_pk_bf16_f32 v50, v20, v21
    v_cvt_pk_bf16_f32 v8, v18, v19
    v_lshlrev_b32 v18, 16, v8
    v_and_b32 v19, 0xffff0000, v8
    v_lshlrev_b32 v20, 16, v49
    v_and_b32 v21, 0xffff0000, v49
    v_add_f32 v20, v20, v18
    v_add_f32 v21, v21, v19
    v_cvt_pk_bf16_f32 v51, v20, v21
    buffer_store_dwordx2 v[50:51], v9, s[56:59], s70 offen
    s_cmp_lt_u32 s66, 14
    s_cbranch_scc1 O_loop
    s_mov_b32 s67, 56
    s_lshl_b32 s66, s76, 17
    s_lshl_b32 s69, s60, 15
    s_add_u32 s66, s66, s69
    s_add_u32 s66, s66, 0x2800000
    s_and_b32 s69, s65, 1
    s_lshl_b32 s69, s69, 10
    s_add_u32 s66, s66, s69
    s_add_u32 s69, s66, 0
    buffer_load_dwordx4 v[52:55], v2, s[8:11], s69 offen offset:0 sc1
    buffer_load_dwordx4 v[56:59], v2, s[8:11], s69 offen offset:2048 sc1
    s_add_u32 s69, s66, 4096
    buffer_load_dwordx4 v[60:63], v2, s[8:11], s69 offen offset:0 sc1
    buffer_load_dwordx4 v[64:67], v2, s[8:11], s69 offen offset:2048 sc1
    s_add_u32 s69, s66, 8192
    buffer_load_dwordx4 v[68:71], v2, s[8:11], s69 offen offset:0 sc1
    buffer_load_dwordx4 v[72:75], v2, s[8:11], s69 offen offset:2048 sc1
    s_add_u32 s69, s66, 12288
    buffer_load_dwordx4 v[76:79], v2, s[8:11], s69 offen offset:0 sc1
    buffer_load_dwordx4 v[80:83], v2, s[8:11], s69 offen offset:2048 sc1
    s_add_u32 s69, s66, 16384
    buffer_load_dwordx4 v[84:87], v2, s[8:11], s69 offen offset:0 sc1
    buffer_load_dwordx4 v[88:91], v2, s[8:11], s69 offen offset:2048 sc1
    s_add_u32 s69, s66, 20480
    buffer_load_dwordx4 v[92:95], v2, s[8:11], s69 offen offset:0 sc1
    buffer_load_dwordx4 v[96:99], v2, s[8:11], s69 offen offset:2048 sc1
    s_add_u32 s69, s66, 24576
    buffer_load_dwordx4 v[100:103], v2, s[8:11], s69 offen offset:0 sc1
    buffer_load_dwordx4 v[104:107], v2, s[8:11], s69 offen offset:2048 sc1
    s_add_u32 s69, s66, 28672
    buffer_load_dwordx4 v[108:111], v2, s[8:11], s69 offen offset:0 sc1
    buffer_load_dwordx4 v[112:115], v2, s[8:11], s69 offen offset:2048 sc1
    v_bfe_u32 v8, v0, 1, 1
    v_mul_u32_u24 v7, 0xaaaa, v8
    v_add_u32 v7, 0x4444, v7
    v_and_b32 v3, 3, v0
    v_lshlrev_b32 v3, 2, v3
    v_bfe_u32 v8, v0, 2, 2
    v_lshl_add_u32 v3, v8, 8, v3
    v_lshrrev_b32 v8, 4, v0
    v_lshl_add_u32 v3, v8, 5, v3
    s_lshl_b32 s68, s60, 10
    v_add_u32 v3, s68, v3
P_loop:
    s_and_b32 s68, s67, 15
    s_lshl_b32 s68, s68, 10
    v_add_u32 v8, s68, v5
    ds_read_b128 v[46:49], v8
    s_lshl_b32 s70, s67, 15
    s_lshl_b32 s69, s65, 13
    s_add_u32 s70, s70, s69
    v_mov_b64 v[16:17], 0
    v_mov_b64 v[18:19], 0
    v_mov_b64 v[20:21], 0
    v_mov_b64 v[22:23], 0
    v_add_u32 v10, s77, v3
    v_add_u32 v11, s77, v2
    s_xor_b32 s77, s77, 4096
    s_waitcnt vmcnt(12)
    v_max3_u32 v8, v55, v59, v63
    v_max_u32 v8, v8, v67
    v_cmp_eq_u32 vcc, -1, v8
    s_cbranch_vccnz P_r0
    v_smfmac_f32_16x16x64_bf16 v[16:19], v[52:55], a[0:7], v7
    v_smfmac_f32_16x16x64_bf16 v[20:23], v[52:55], a[8:15], v7
    s_add_u32 s69, s66, 262144
    buffer_load_dwordx4 v[52:55], v2, s[8:11], s69 offen offset:0 sc1
    v_smfmac_f32_16x16x64_bf16 v[16:19], v[56:59], a[16:23], v7
    v_smfmac_f32_16x16x64_bf16 v[20:23], v[56:59], a[24:31], v7
    s_add_u32 s69, s66, 262144
    buffer_load_dwordx4 v[56:59], v2, s[8:11], s69 offen offset:2048 sc1
    v_smfmac_f32_16x16x64_bf16 v[16:19], v[60:63], a[32:39], v7
    v_smfmac_f32_16x16x64_bf16 v[20:23], v[60:63], a[40:47], v7
    s_add_u32 s69, s66, 266240
    buffer_load_dwordx4 v[60:63], v2, s[8:11], s69 offen offset:0 sc1
    v_smfmac_f32_16x16x64_bf16 v[16:19], v[64:67], a[48:55], v7
    v_smfmac_f32_16x16x64_bf16 v[20:23], v[64:67], a[56:63], v7
    s_add_u32 s69, s66, 266240
    buffer_load_dwordx4 v[64:67], v2, s[8:11], s69 offen offset:2048 sc1
    s_waitcnt vmcnt(12)
    v_max3_u32 v8, v71, v75, v79
    v_max_u32 v8, v8, v83
    v_cmp_eq_u32 vcc, -1, v8
    s_cbranch_vccnz P_r1
    v_smfmac_f32_16x16x64_bf16 v[16:19], v[68:71], a[64:71], v7
    v_smfmac_f32_16x16x64_bf16 v[20:23], v[68:71], a[72:79], v7
    s_add_u32 s69, s66, 270336
    buffer_load_dwordx4 v[68:71], v2, s[8:11], s69 offen offset:0 sc1
    v_smfmac_f32_16x16x64_bf16 v[16:19], v[72:75], a[80:87], v7
    v_smfmac_f32_16x16x64_bf16 v[20:23], v[72:75], a[88:95], v7
    s_add_u32 s69, s66, 270336
    buffer_load_dwordx4 v[72:75], v2, s[8:11], s69 offen offset:2048 sc1
    v_smfmac_f32_16x16x64_bf16 v[16:19], v[76:79], a[96:103], v7
    v_smfmac_f32_16x16x64_bf16 v[20:23], v[76:79], a[104:111], v7
    s_add_u32 s69, s66, 274432
    buffer_load_dwordx4 v[76:79], v2, s[8:11], s69 offen offset:0 sc1
    v_smfmac_f32_16x16x64_bf16 v[16:19], v[80:83], a[112:119], v7
    v_smfmac_f32_16x16x64_bf16 v[20:23], v[80:83], a[120:127], v7
    s_add_u32 s69, s66, 274432
    buffer_load_dwordx4 v[80:83], v2, s[8:11], s69 offen offset:2048 sc1
    s_waitcnt vmcnt(12)
    v_max3_u32 v8, v87, v91, v95
    v_max_u32 v8, v8, v99
    v_cmp_eq_u32 vcc, -1, v8
    s_cbranch_vccnz P_r2
    v_smfmac_f32_16x16x64_bf16 v[16:19], v[84:87], a[128:135], v7
    v_smfmac_f32_16x16x64_bf16 v[20:23], v[84:87], a[136:143], v7
    s_add_u32 s69, s66, 278528
    buffer_load_dwordx4 v[84:87], v2, s[8:11], s69 offen offset:0 sc1
    v_smfmac_f32_16x16x64_bf16 v[16:19], v[88:91], a[144:151], v7
    v_smfmac_f32_16x16x64_bf16 v[20:23], v[88:91], a[152:159], v7
    s_add_u32 s69, s66, 278528
    buffer_load_dwordx4 v[88:91], v2, s[8:11], s69 offen offset:2048 sc1
    v_smfmac_f32_16x16x64_bf16 v[16:19], v[92:95], a[160:167], v7
    v_smfmac_f32_16x16x64_bf16 v[20:23], v[92:95], a[168:175], v7
    s_add_u32 s69, s66, 282624
    buffer_load_dwordx4 v[92:95], v2, s[8:11], s69 offen offset:0 sc1
    v_smfmac_f32_16x16x64_bf16 v[16:19], v[96:99], a[176:183], v7
    v_smfmac_f32_16x16x64_bf16 v[20:23], v[96:99], a[184:191], v7
    s_add_u32 s69, s66, 282624
    buffer_load_dwordx4 v[96:99], v2, s[8:11], s69 offen offset:2048 sc1
    s_waitcnt vmcnt(12)
    v_max3_u32 v8, v103, v107, v111
    v_max_u32 v8, v8, v115
    v_cmp_eq_u32 vcc, -1, v8
    s_cbranch_vccnz P_r3
    v_smfmac_f32_16x16x64_bf16 v[16:19], v[100:103], a[192:199], v7
    v_smfmac_f32_16x16x64_bf16 v[20:23], v[100:103], a[200:207], v7
    s_add_u32 s69, s66, 286720
    buffer_load_dwordx4 v[100:103], v2, s[8:11], s69 offen offset:0 sc1
    v_smfmac_f32_16x16x64_bf16 v[16:19], v[104:107], a[208:215], v7
    v_smfmac_f32_16x16x64_bf16 v[20:23], v[104:107], a[216:223], v7
    s_add_u32 s69, s66, 286720
    buffer_load_dwordx4 v[104:107], v2, s[8:11], s69 offen offset:2048 sc1
    v_smfmac_f32_16x16x64_bf16 v[16:19], v[108:111], a[224:231], v7
    v_smfmac_f32_16x16x64_bf16 v[20:23], v[108:111], a[232:239], v7
    s_add_u32 s69, s66, 290816
    buffer_load_dwordx4 v[108:111], v2, s[8:11], s69 offen offset:0 sc1
    v_smfmac_f32_16x16x64_bf16 v[16:19], v[112:115], a[240:247], v7
    v_smfmac_f32_16x16x64_bf16 v[20:23], v[112:115], a[248:255], v7
    s_add_u32 s69, s66, 290816
    buffer_load_dwordx4 v[112:115], v2, s[8:11], s69 offen offset:2048 sc1
    s_branch P_red
P_k0:
    s_waitcnt vmcnt(12)
    v_max3_u32 v8, v55, v59, v63
    v_max_u32 v8, v8, v67
    v_cmp_eq_u32 vcc, -1, v8
    s_cbranch_vccnz P_r0
P_c0:
    v_smfmac_f32_16x16x64_bf16 v[16:19], v[52:55], a[0:7], v7
    v_smfmac_f32_16x16x64_bf16 v[20:23], v[52:55], a[8:15], v7
    v_smfmac_f32_16x16x64_bf16 v[16:19], v[56:59], a[16:23], v7
    v_smfmac_f32_16x16x64_bf16 v[20:23], v[56:59], a[24:31], v7
    v_smfmac_f32_16x16x64_bf16 v[16:19], v[60:63], a[32:39], v7
    v_smfmac_f32_16x16x64_bf16 v[20:23], v[60:63], a[40:47], v7
    v_smfmac_f32_16x16x64_bf16 v[16:19], v[64:67], a[48:55], v7
    v_smfmac_f32_16x16x64_bf16 v[20:23], v[64:67], a[56:63], v7
P_k1:
    s_waitcnt vmcnt(8)
    v_max3_u32 v8, v71, v75, v79
    v_max_u32 v8, v8, v83
    v_cmp_eq_u32 vcc, -1, v8
    s_cbranch_vccnz P_r1
P_c1:
    v_smfmac_f32_16x16x64_bf16 v[16:19], v[68:71], a[64:71], v7
    v_smfmac_f32_16x16x64_bf16 v[20:23], v[68:71], a[72:79], v7
    v_smfmac_f32_16x16x64_bf16 v[16:19], v[72:75], a[80:87], v7
    v_smfmac_f32_16x16x64_bf16 v[20:23], v[72:75], a[88:95], v7
    v_smfmac_f32_16x16x64_bf16 v[16:19], v[76:79], a[96:103], v7
    v_smfmac_f32_16x16x64_bf16 v[20:23], v[76:79], a[104:111], v7
    v_smfmac_f32_16x16x64_bf16 v[16:19], v[80:83], a[112:119], v7
    v_smfmac_f32_16x16x64_bf16 v[20:23], v[80:83], a[120:127], v7
P_k2:
    s_waitcnt vmcnt(4)
    v_max3_u32 v8, v87, v91, v95
    v_max_u32 v8, v8, v99
    v_cmp_eq_u32 vcc, -1, v8
    s_cbranch_vccnz P_r2
P_c2:
    v_smfmac_f32_16x16x64_bf16 v[16:19], v[84:87], a[128:135], v7
    v_smfmac_f32_16x16x64_bf16 v[20:23], v[84:87], a[136:143], v7
    v_smfmac_f32_16x16x64_bf16 v[16:19], v[88:91], a[144:151], v7
    v_smfmac_f32_16x16x64_bf16 v[20:23], v[88:91], a[152:159], v7
    v_smfmac_f32_16x16x64_bf16 v[16:19], v[92:95], a[160:167], v7
    v_smfmac_f32_16x16x64_bf16 v[20:23], v[92:95], a[168:175], v7
    v_smfmac_f32_16x16x64_bf16 v[16:19], v[96:99], a[176:183], v7
    v_smfmac_f32_16x16x64_bf16 v[20:23], v[96:99], a[184:191], v7
P_k3:
    s_waitcnt vmcnt(0)
    v_max3_u32 v8, v103, v107, v111
    v_max_u32 v8, v8, v115
    v_cmp_eq_u32 vcc, -1, v8
    s_cbranch_vccnz P_r3
P_c3:
    v_smfmac_f32_16x16x64_bf16 v[16:19], v[100:103], a[192:199], v7
    v_smfmac_f32_16x16x64_bf16 v[20:23], v[100:103], a[200:207], v7
    v_smfmac_f32_16x16x64_bf16 v[16:19], v[104:107], a[208:215], v7
    v_smfmac_f32_16x16x64_bf16 v[20:23], v[104:107], a[216:223], v7
    v_smfmac_f32_16x16x64_bf16 v[16:19], v[108:111], a[224:231], v7
    v_smfmac_f32_16x16x64_bf16 v[20:23], v[108:111], a[232:239], v7
    v_smfmac_f32_16x16x64_bf16 v[16:19], v[112:115], a[240:247], v7
    v_smfmac_f32_16x16x64_bf16 v[20:23], v[112:115], a[248:255], v7
    s_add_u32 s69, s66, 262144
    buffer_load_dwordx4 v[52:55], v2, s[8:11], s69 offen offset:0 sc1
    buffer_load_dwordx4 v[56:59], v2, s[8:11], s69 offen offset:2048 sc1
    s_add_u32 s69, s66, 266240
    buffer_load_dwordx4 v[60:63], v2, s[8:11], s69 offen offset:0 sc1
    buffer_load_dwordx4 v[64:67], v2, s[8:11], s69 offen offset:2048 sc1
    s_add_u32 s69, s66, 270336
    buffer_load_dwordx4 v[68:71], v2, s[8:11], s69 offen offset:0 sc1
    buffer_load_dwordx4 v[72:75], v2, s[8:11], s69 offen offset:2048 sc1
    s_add_u32 s69, s66, 274432
    buffer_load_dwordx4 v[76:79], v2, s[8:11], s69 offen offset:0 sc1
    buffer_load_dwordx4 v[80:83], v2, s[8:11], s69 offen offset:2048 sc1
    s_add_u32 s69, s66, 278528
    buffer_load_dwordx4 v[84:87], v2, s[8:11], s69 offen offset:0 sc1
    buffer_load_dwordx4 v[88:91], v2, s[8:11], s69 offen offset:2048 sc1
    s_add_u32 s69, s66, 282624
    buffer_load_dwordx4 v[92:95], v2, s[8:11], s69 offen offset:0 sc1
    buffer_load_dwordx4 v[96:99], v2, s[8:11], s69 offen offset:2048 sc1
    s_add_u32 s69, s66, 286720
    buffer_load_dwordx4 v[100:103], v2, s[8:11], s69 offen offset:0 sc1
    buffer_load_dwordx4 v[104:107], v2, s[8:11], s69 offen offset:2048 sc1
    s_add_u32 s69, s66, 290816
    buffer_load_dwordx4 v[108:111], v2, s[8:11], s69 offen offset:0 sc1
    buffer_load_dwordx4 v[112:115], v2, s[8:11], s69 offen offset:2048 sc1
P_red:
    s_waitcnt lgkmcnt(0)
    v_lshlrev_b32 v32, 16, v46
    v_and_b32 v33, 0xffff0000, v46
    v_lshlrev_b32 v34, 16, v47
    v_and_b32 v35, 0xffff0000, v47
    v_add_f32 v16, v16, v18
    v_add_f32 v17, v17, v19
    ds_write2_b32 v10, v16, v17 offset0:0 offset1:4
    v_add_f32 v20, v20, v22
    v_add_f32 v21, v21, v23
    ds_write2_b32 v10, v20, v21 offset0:32 offset1:36
    s_waitcnt lgkmcnt(0)
    s_barrier
    s_cmp_lg_u32 s60, 0
    s_cbranch_scc1 P_next
    ds_read_b128 v[16:19], v11 offset:0
    ds_read_b128 v[20:23], v11 offset:1024
    ds_read_b128 v[24:27], v11 offset:2048
    ds_read_b128 v[28:31], v11 offset:3072
    s_waitcnt lgkmcnt(2)
    v_pk_add_f32 v[16:17], v[16:17], v[20:21]
    v_pk_add_f32 v[18:19], v[18:19], v[22:23]
    s_waitcnt lgkmcnt(0)
    v_pk_add_f32 v[24:25], v[24:25], v[28:29]
    v_pk_add_f32 v[26:27], v[26:27], v[30:31]
    v_pk_add_f32 v[16:17], v[16:17], v[24:25]
    v_pk_add_f32 v[18:19], v[18:19], v[26:27]
    v_cvt_pk_bf16_f32 v8, v16, v17
    v_lshlrev_b32 v16, 16, v8
    v_and_b32 v17, 0xffff0000, v8
    v_cvt_pk_bf16_f32 v8, v18, v19
    v_lshlrev_b32 v18, 16, v8
    v_and_b32 v19, 0xffff0000, v8
    v_mul_f32 v16, v16, v32
    v_mul_f32 v17, v17, v33
    v_mul_f32 v18, v18, v34
    v_mul_f32 v19, v19, v35
    v_cvt_pk_bf16_f32 v8, v16, v17
    v_lshlrev_b32 v16, 16, v8
    v_and_b32 v17, 0xffff0000, v8
    v_lshlrev_b32 v20, 16, v48
    v_and_b32 v21, 0xffff0000, v48
    v_add_f32 v20, v20, v16
    v_add_f32 v21, v21, v17
    v_cvt_pk_bf16_f32 v50, v20, v21
    v_cvt_pk_bf16_f32 v8, v18, v19
    v_lshlrev_b32 v18, 16, v8
    v_and_b32 v19, 0xffff0000, v8
    v_lshlrev_b32 v20, 16, v49
    v_and_b32 v21, 0xffff0000, v49
    v_add_f32 v20, v20, v18
    v_add_f32 v21, v21, v19
    v_cvt_pk_bf16_f32 v51, v20, v21
    buffer_store_dwordx2 v[50:51], v4, s[56:59], s70 offen
P_next:
    s_add_u32 s67, s67, 1
    s_add_u32 s66, s66, 262144
    s_cmp_lt_u32 s67, 64
    s_cbranch_scc1 P_loop
    s_branch P_done
P_r0:
    s_add_u32 s63, s63, 1
    s_add_u32 s69, s66, 0
    buffer_load_dwordx4 v[52:55], v2, s[8:11], s69 offen offset:0 sc1
    buffer_load_dwordx4 v[56:59], v2, s[8:11], s69 offen offset:2048 sc1
    s_add_u32 s69, s66, 4096
    buffer_load_dwordx4 v[60:63], v2, s[8:11], s69 offen offset:0 sc1
    buffer_load_dwordx4 v[64:67], v2, s[8:11], s69 offen offset:2048 sc1
    s_add_u32 s69, s66, 8192
    buffer_load_dwordx4 v[68:71], v2, s[8:11], s69 offen offset:0 sc1
    buffer_load_dwordx4 v[72:75], v2, s[8:11], s69 offen offset:2048 sc1
    s_add_u32 s69, s66, 12288
    buffer_load_dwordx4 v[76:79], v2, s[8:11], s69 offen offset:0 sc1
    buffer_load_dwordx4 v[80:83], v2, s[8:11], s69 offen offset:2048 sc1
    s_add_u32 s69, s66, 16384
    buffer_load_dwordx4 v[84:87], v2, s[8:11], s69 offen offset:0 sc1
    buffer_load_dwordx4 v[88:91], v2, s[8:11], s69 offen offset:2048 sc1
    s_add_u32 s69, s66, 20480
    buffer_load_dwordx4 v[92:95], v2, s[8:11], s69 offen offset:0 sc1
    buffer_load_dwordx4 v[96:99], v2, s[8:11], s69 offen offset:2048 sc1
    s_add_u32 s69, s66, 24576
    buffer_load_dwordx4 v[100:103], v2, s[8:11], s69 offen offset:0 sc1
    buffer_load_dwordx4 v[104:107], v2, s[8:11], s69 offen offset:2048 sc1
    s_add_u32 s69, s66, 28672
    buffer_load_dwordx4 v[108:111], v2, s[8:11], s69 offen offset:0 sc1
    buffer_load_dwordx4 v[112:115], v2, s[8:11], s69 offen offset:2048 sc1
    s_cmp_gt_u32 s63, 400000
    s_cbranch_scc0 P_k0
    s_waitcnt vmcnt(0)
    s_branch P_c0
P_r1:
    s_add_u32 s63, s63, 1
    s_add_u32 s69, s66, 8192
    buffer_load_dwordx4 v[68:71], v2, s[8:11], s69 offen offset:0 sc1
    buffer_load_dwordx4 v[72:75], v2, s[8:11], s69 offen offset:2048 sc1
    s_add_u32 s69, s66, 12288
    buffer_load_dwordx4 v[76:79], v2, s[8:11], s69 offen offset:0 sc1
    buffer_load_dwordx4 v[80:83], v2, s[8:11], s69 offen offset:2048 sc1
    s_add_u32 s69, s66, 16384
    buffer_load_dwordx4 v[84:87], v2, s[8:11], s69 offen offset:0 sc1
    buffer_load_dwordx4 v[88:91], v2, s[8:11], s69 offen offset:2048 sc1
    s_add_u32 s69, s66, 20480
    buffer_load_dwordx4 v[92:95], v2, s[8:11], s69 offen offset:0 sc1
    buffer_load_dwordx4 v[96:99], v2, s[8:11], s69 offen offset:2048 sc1
    s_add_u32 s69, s66, 24576
    buffer_load_dwordx4 v[100:103], v2, s[8:11], s69 offen offset:0 sc1
    buffer_load_dwordx4 v[104:107], v2, s[8:11], s69 offen offset:2048 sc1
    s_add_u32 s69, s66, 28672
    buffer_load_dwordx4 v[108:111], v2, s[8:11], s69 offen offset:0 sc1
    buffer_load_dwordx4 v[112:115], v2, s[8:11], s69 offen offset:2048 sc1
    s_cmp_gt_u32 s63, 400000
    s_cbranch_scc0 P_k1
    s_waitcnt vmcnt(0)
    s_branch P_c1
P_r2:
    s_add_u32 s63, s63, 1
    s_add_u32 s69, s66, 16384
    buffer_load_dwordx4 v[84:87], v2, s[8:11], s69 offen offset:0 sc1
    buffer_load_dwordx4 v[88:91], v2, s[8:11], s69 offen offset:2048 sc1
    s_add_u32 s69, s66, 20480
    buffer_load_dwordx4 v[92:95], v2, s[8:11], s69 offen offset:0 sc1
    buffer_load_dwordx4 v[96:99], v2, s[8:11], s69 offen offset:2048 sc1
    s_add_u32 s69, s66, 24576
    buffer_load_dwordx4 v[100:103], v2, s[8:11], s69 offen offset:0 sc1
    buffer_load_dwordx4 v[104:107], v2, s[8:11], s69 offen offset:2048 sc1
    s_add_u32 s69, s66, 28672
    buffer_load_dwordx4 v[108:111], v2, s[8:11], s69 offen offset:0 sc1
    buffer_load_dwordx4 v[112:115], v2, s[8:11], s69 offen offset:2048 sc1
    s_cmp_gt_u32 s63, 400000
    s_cbranch_scc0 P_k2
    s_waitcnt vmcnt(0)
    s_branch P_c2
P_r3:
    s_add_u32 s63, s63, 1
    s_add_u32 s69, s66, 24576
    buffer_load_dwordx4 v[100:103], v2, s[8:11], s69 offen offset:0 sc1
    buffer_load_dwordx4 v[104:107], v2, s[8:11], s69 offen offset:2048 sc1
    s_add_u32 s69, s66, 28672
    buffer_load_dwordx4 v[108:111], v2, s[8:11], s69 offen offset:0 sc1
    buffer_load_dwordx4 v[112:115], v2, s[8:11], s69 offen offset:2048 sc1
    s_cmp_gt_u32 s63, 400000
    s_cbranch_scc0 P_k3
    s_waitcnt vmcnt(0)
    s_branch P_c3
P_done:
L_fend:
    s_cmp_gt_u32 s63, 400000
    s_cbranch_scc0 fin_15
    v_mov_b32 v1, 0
    v_mov_b32 v3, s61
    v_add_u32 v3, 1000, v3
    buffer_store_dword v3, v1, s[12:15], 0 offen offset:200 sc1
fin_15:
    s_endpgm
L_head:
    s_sub_u32 s64, s61, 32
    s_lshr_b32 s64, s64, 2
    s_and_b32 s65, s61, 3
    s_lshl_b32 s72, s61, 7
    v_lshlrev_b32 v2, 4, v0
    v_and_b32 v8, 7, v0
    v_lshlrev_b32 v16, 4, v8
    v_bfe_u32 v8, v0, 3, 1
    v_lshl_add_u32 v16, v8, 14, v16
    v_bfe_u32 v8, v0, 4, 1
    v_lshl_add_u32 v16, v8, 13, v16
    v_bfe_u32 v8, v0, 5, 1
    v_lshl_add_u32 v16, v8, 15, v16
    v_xor_b32 v17, 32, v16
    v_xor_b32 v18, 64, v16
    v_xor_b32 v19, 96, v16
    s_lshl_b32 s73, s60, 15
    s_and_b32 s68, s60, 1
    s_lshl_b32 s69, s68, 21
    s_lshl_b32 s68, s68, 6
    s_and_b32 s74, s73, 0x10000
    s_add_u32 s68, s68, s74
    v_and_b32 v20, 3, v0
    v_lshlrev_b32 v20, 3, v20
    v_bfe_u32 v8, v0, 2, 1
    v_mul_u32_u24 v8, 2112, v8
    v_xor_b32 v20, v20, v8
    v_bfe_u32 v8, v0, 3, 1
    v_mul_u32_u24 v8, 128, v8
    v_xor_b32 v20, v20, v8
    v_bfe_u32 v8, v0, 4, 1
    v_mul_u32_u24 v8, 1056, v8
    v_xor_b32 v20, v20, v8
    v_bfe_u32 v8, v0, 5, 1
    v_mul_u32_u24 v8, 4096, v8
    v_xor_b32 v20, v20, v8
    v_xor_b32 v20, s68, v20
    v_xor_b32 v21, 32, v20
    v_xor_b32 v22, 0x8000, v20
    v_xor_b32 v23, 0x8020, v20
    s_lshl_b32 s68, s64, 8
    s_add_u32 s69, s69, s68
    s_lshr_b32 s68, s60, 1
    s_lshl_b32 s68, s68, 7
    s_add_u32 s69, s69, s68
    s_add_u32 m0, s73, 0
    s_add_u32 s68, s69, 0x0
    buffer_load_dwordx4 v16, s[24:27], s68 offen lds
    s_add_u32 m0, s73, 1024
    s_add_u32 s68, s69, 0x10000
    buffer_load_dwordx4 v17, s[24:27], s68 offen lds
    s_add_u32 m0, s73, 2048
    s_add_u32 s68, s69, 0x20000
    buffer_load_dwordx4 v18, s[24:27], s68 offen lds
    s_add_u32 m0, s73, 3072
    s_add_u32 s68, s69, 0x30000
    buffer_load_dwordx4 v19, s[24:27], s68 offen lds
    s_add_u32 m0, s73, 4096
    s_add_u32 s68, s69, 0x100000
    buffer_load_dwordx4 v16, s[24:27], s68 offen lds
    s_add_u32 m0, s73, 5120
    s_add_u32 s68, s69, 0x110000
    buffer_load_dwordx4 v17, s[24:27], s68 offen lds
    s_add_u32 m0, s73, 6144
    s_add_u32 s68, s69, 0x120000
    buffer_load_dwordx4 v18, s[24:27], s68 offen lds
    s_add_u32 m0, s73, 7168
    s_add_u32 s68, s69, 0x130000
    buffer_load_dwordx4 v19, s[24:27], s68 offen lds
    s_add_u32 m0, s73, 8192
    s_add_u32 s68, s69, 0x40000
    buffer_load_dwordx4 v16, s[24:27], s68 offen lds
    s_add_u32 m0, s73, 9216
    s_add_u32 s68, s69, 0x50000
    buffer_load_dwordx4 v17, s[24:27], s68 offen lds
    s_add_u32 m0, s73, 10240
    s_add_u32 s68, s69, 0x60000
    buffer_load_dwordx4 v18, s[24:27], s68 offen lds
    s_add_u32 m0, s73, 11264
    s_add_u32 s68, s69, 0x70000
    buffer_load_dwordx4 v19, s[24:27], s68 offen lds
    s_add_u32 m0, s73, 12288
    s_add_u32 s68, s69, 0x140000
    buffer_load_dwordx4 v16, s[24:27], s68 offen lds
    s_add_u32 m0, s73, 13312
    s_add_u32 s68, s69, 0x150000
    buffer_load_dwordx4 v17, s[24:27], s68 offen lds
    s_add_u32 m0, s73, 14336
    s_add_u32 s68, s69, 0x160000
    buffer_load_dwordx4 v18, s[24:27], s68 offen lds
    s_add_u32 m0, s73, 15360
    s_add_u32 s68, s69, 0x170000
    buffer_load_dwordx4 v19, s[24:27], s68 offen lds
    s_add_u32 m0, s73, 16384
    s_add_u32 s68, s69, 0x0
    buffer_load_dwordx4 v16, s[28:31], s68 offen lds
    s_add_u32 m0, s73, 17408
    s_add_u32 s68, s69, 0x10000
    buffer_load_dwordx4 v17, s[28:31], s68 offen lds
    s_add_u32 m0, s73, 18432
    s_add_u32 s68, s69, 0x20000
    buffer_load_dwordx4 v18, s[28:31], s68 offen lds
    s_add_u32 m0, s73, 19456
    s_add_u32 s68, s69, 0x30000
    buffer_load_dwordx4 v19, s[28:31], s68 offen lds
    s_add_u32 m0, s73, 20480
    s_add_u32 s68, s69, 0x100000
    buffer_load_dwordx4 v16, s[28:31], s68 offen lds
    s_add_u32 m0, s73, 21504
    s_add_u32 s68, s69, 0x110000
    buffer_load_dwordx4 v17, s[28:31], s68 offen lds
    s_add_u32 m0, s73, 22528
    s_add_u32 s68, s69, 0x120000
    buffer_load_dwordx4 v18, s[28:31], s68 offen lds
    s_add_u32 m0, s73, 23552
    s_add_u32 s68, s69, 0x130000
    buffer_load_dwordx4 v19, s[28:31], s68 offen lds
    s_waitcnt vmcnt(16) lgkmcnt(0)
    s_barrier
    s_add_u32 m0, s73, 24576
    s_add_u32 s68, s69, 0x40000
    buffer_load_dwordx4 v16, s[28:31], s68 offen lds
    s_add_u32 m0, s73, 25600
    s_add_u32 s68, s69, 0x50000
    buffer_load_dwordx4 v17, s[28:31], s68 offen lds
    s_add_u32 m0, s73, 26624
    s_add_u32 s68, s69, 0x60000
    buffer_load_dwordx4 v18, s[28:31], s68 offen lds
    s_add_u32 m0, s73, 27648
    s_add_u32 s68, s69, 0x70000
    buffer_load_dwordx4 v19, s[28:31], s68 offen lds
    s_add_u32 m0, s73, 28672
    s_add_u32 s68, s69, 0x140000
    buffer_load_dwordx4 v16, s[28:31], s68 offen lds
    s_add_u32 m0, s73, 29696
    s_add_u32 s68, s69, 0x150000
    buffer_load_dwordx4 v17, s[28:31], s68 offen lds
    s_add_u32 m0, s73, 30720
    s_add_u32 s68, s69, 0x160000
    buffer_load_dwordx4 v18, s[28:31], s68 offen lds
    s_add_u32 m0, s73, 31744
    s_add_u32 s68, s69, 0x170000
    buffer_load_dwordx4 v19, s[28:31], s68 offen lds
    ds_read_b64_tr_b16 v[128:129], v20 offset:0
    ds_read_b64_tr_b16 v[130:131], v20 offset:512
    ds_read_b64_tr_b16 v[132:133], v20 offset:256
    ds_read_b64_tr_b16 v[134:135], v20 offset:768
    ds_read_b64_tr_b16 v[136:137], v21 offset:0
    ds_read_b64_tr_b16 v[138:139], v21 offset:512
    ds_read_b64_tr_b16 v[140:141], v21 offset:256
    ds_read_b64_tr_b16 v[142:143], v21 offset:768
    ds_read_b64_tr_b16 v[144:145], v22 offset:0
    ds_read_b64_tr_b16 v[146:147], v22 offset:512
    ds_read_b64_tr_b16 v[148:149], v22 offset:256
    ds_read_b64_tr_b16 v[150:151], v22 offset:768
    ds_read_b64_tr_b16 v[152:153], v23 offset:0
    ds_read_b64_tr_b16 v[154:155], v23 offset:512
    ds_read_b64_tr_b16 v[156:157], v23 offset:256
    ds_read_b64_tr_b16 v[158:159], v23 offset:768
    s_waitcnt vmcnt(16) lgkmcnt(0)
    s_barrier
    s_add_u32 m0, s73, 0
    s_add_u32 s68, s69, 0x0
    buffer_load_dwordx4 v16, s[32:35], s68 offen lds
    s_add_u32 m0, s73, 1024
    s_add_u32 s68, s69, 0x10000
    buffer_load_dwordx4 v17, s[32:35], s68 offen lds
    s_add_u32 m0, s73, 2048
    s_add_u32 s68, s69, 0x20000
    buffer_load_dwordx4 v18, s[32:35], s68 offen lds
    s_add_u32 m0, s73, 3072
    s_add_u32 s68, s69, 0x30000
    buffer_load_dwordx4 v19, s[32:35], s68 offen lds
    s_add_u32 m0, s73, 4096
    s_add_u32 s68, s69, 0x100000
    buffer_load_dwordx4 v16, s[32:35], s68 offen lds
    s_add_u32 m0, s73, 5120
    s_add_u32 s68, s69, 0x110000
    buffer_load_dwordx4 v17, s[32:35], s68 offen lds
    s_add_u32 m0, s73, 6144
    s_add_u32 s68, s69, 0x120000
    buffer_load_dwordx4 v18, s[32:35], s68 offen lds
    s_add_u32 m0, s73, 7168
    s_add_u32 s68, s69, 0x130000
    buffer_load_dwordx4 v19, s[32:35], s68 offen lds
    ds_read_b64_tr_b16 v[160:161], v20 offset:8192
    ds_read_b64_tr_b16 v[162:163], v20 offset:8704
    ds_read_b64_tr_b16 v[164:165], v20 offset:8448
    ds_read_b64_tr_b16 v[166:167], v20 offset:8960
    ds_read_b64_tr_b16 v[168:169], v21 offset:8192
    ds_read_b64_tr_b16 v[170:171], v21 offset:8704
    ds_read_b64_tr_b16 v[172:173], v21 offset:8448
    ds_read_b64_tr_b16 v[174:175], v21 offset:8960
    ds_read_b64_tr_b16 v[176:177], v22 offset:8192
    ds_read_b64_tr_b16 v[178:179], v22 offset:8704
    ds_read_b64_tr_b16 v[180:181], v22 offset:8448
    ds_read_b64_tr_b16 v[182:183], v22 offset:8960
    ds_read_b64_tr_b16 v[184:185], v23 offset:8192
    ds_read_b64_tr_b16 v[186:187], v23 offset:8704
    ds_read_b64_tr_b16 v[188:189], v23 offset:8448
    ds_read_b64_tr_b16 v[190:191], v23 offset:8960
    s_waitcnt vmcnt(16) lgkmcnt(0)
    s_barrier
    s_add_u32 m0, s73, 8192
    s_add_u32 s68, s69, 0x40000
    buffer_load_dwordx4 v16, s[32:35], s68 offen lds
    s_add_u32 m0, s73, 9216
    s_add_u32 s68, s69, 0x50000
    buffer_load_dwordx4 v17, s[32:35], s68 offen lds
    s_add_u32 m0, s73, 10240
    s_add_u32 s68, s69, 0x60000
    buffer_load_dwordx4 v18, s[32:35], s68 offen lds
    s_add_u32 m0, s73, 11264
    s_add_u32 s68, s69, 0x70000
    buffer_load_dwordx4 v19, s[32:35], s68 offen lds
    s_add_u32 m0, s73, 12288
    s_add_u32 s68, s69, 0x140000
    buffer_load_dwordx4 v16, s[32:35], s68 offen lds
    s_add_u32 m0, s73, 13312
    s_add_u32 s68, s69, 0x150000
    buffer_load_dwordx4 v17, s[32:35], s68 offen lds
    s_add_u32 m0, s73, 14336
    s_add_u32 s68, s69, 0x160000
    buffer_load_dwordx4 v18, s[32:35], s68 offen lds
    s_add_u32 m0, s73, 15360
    s_add_u32 s68, s69, 0x170000
    buffer_load_dwordx4 v19, s[32:35], s68 offen lds
    ds_read_b64_tr_b16 a[0:1], v20 offset:16384
    ds_read_b64_tr_b16 a[2:3], v20 offset:16896
    ds_read_b64_tr_b16 a[4:5], v20 offset:16640
    ds_read_b64_tr_b16 a[6:7], v20 offset:17152
    ds_read_b64_tr_b16 a[8:9], v21 offset:16384
    ds_read_b64_tr_b16 a[10:11], v21 offset:16896
    ds_read_b64_tr_b16 a[12:13], v21 offset:16640
    ds_read_b64_tr_b16 a[14:15], v21 offset:17152
    ds_read_b64_tr_b16 a[16:17], v22 offset:16384
    ds_read_b64_tr_b16 a[18:19], v22 offset:16896
    ds_read_b64_tr_b16 a[20:21], v22 offset:16640
    ds_read_b64_tr_b16 a[22:23], v22 offset:17152
    ds_read_b64_tr_b16 a[24:25], v23 offset:16384
    ds_read_b64_tr_b16 a[26:27], v23 offset:16896
    ds_read_b64_tr_b16 a[28:29], v23 offset:16640
    ds_read_b64_tr_b16 a[30:31], v23 offset:17152
    s_waitcnt vmcnt(16) lgkmcnt(0)
    s_barrier
    s_add_u32 m0, s73, 16384
    s_add_u32 s68, s69, 0x80000
    buffer_load_dwordx4 v16, s[24:27], s68 offen lds
    s_add_u32 m0, s73, 17408
    s_add_u32 s68, s69, 0x90000
    buffer_load_dwordx4 v17, s[24:27], s68 offen lds
    s_add_u32 m0, s73, 18432
    s_add_u32 s68, s69, 0xa0000
    buffer_load_dwordx4 v18, s[24:27], s68 offen lds
    s_add_u32 m0, s73, 19456
    s_add_u32 s68, s69, 0xb0000
    buffer_load_dwordx4 v19, s[24:27], s68 offen lds
    s_add_u32 m0, s73, 20480
    s_add_u32 s68, s69, 0x180000
    buffer_load_dwordx4 v16, s[24:27], s68 offen lds
    s_add_u32 m0, s73, 21504
    s_add_u32 s68, s69, 0x190000
    buffer_load_dwordx4 v17, s[24:27], s68 offen lds
    s_add_u32 m0, s73, 22528
    s_add_u32 s68, s69, 0x1a0000
    buffer_load_dwordx4 v18, s[24:27], s68 offen lds
    s_add_u32 m0, s73, 23552
    s_add_u32 s68, s69, 0x1b0000
    buffer_load_dwordx4 v19, s[24:27], s68 offen lds
    ds_read_b64_tr_b16 a[32:33], v20 offset:24576
    ds_read_b64_tr_b16 a[34:35], v20 offset:25088
    ds_read_b64_tr_b16 a[36:37], v20 offset:24832
    ds_read_b64_tr_b16 a[38:39], v20 offset:25344
    ds_read_b64_tr_b16 a[40:41], v21 offset:24576
    ds_read_b64_tr_b16 a[42:43], v21 offset:25088
    ds_read_b64_tr_b16 a[44:45], v21 offset:24832
    ds_read_b64_tr_b16 a[46:47], v21 offset:25344
    ds_read_b64_tr_b16 a[48:49], v22 offset:24576
    ds_read_b64_tr_b16 a[50:51], v22 offset:25088
    ds_read_b64_tr_b16 a[52:53], v22 offset:24832
    ds_read_b64_tr_b16 a[54:55], v22 offset:25344
    ds_read_b64_tr_b16 a[56:57], v23 offset:24576
    ds_read_b64_tr_b16 a[58:59], v23 offset:25088
    ds_read_b64_tr_b16 a[60:61], v23 offset:24832
    ds_read_b64_tr_b16 a[62:63], v23 offset:25344
    s_waitcnt vmcnt(16) lgkmcnt(0)
    s_barrier
    s_add_u32 m0, s73, 24576
    s_add_u32 s68, s69, 0xc0000
    buffer_load_dwordx4 v16, s[24:27], s68 offen lds
    s_add_u32 m0, s73, 25600
    s_add_u32 s68, s69, 0xd0000
    buffer_load_dwordx4 v17, s[24:27], s68 offen lds
    s_add_u32 m0, s73, 26624
    s_add_u32 s68, s69, 0xe0000
    buffer_load_dwordx4 v18, s[24:27], s68 offen lds
    s_add_u32 m0, s73, 27648
    s_add_u32 s68, s69, 0xf0000
    buffer_load_dwordx4 v19, s[24:27], s68 offen lds
    s_add_u32 m0, s73, 28672
    s_add_u32 s68, s69, 0x1c0000
    buffer_load_dwordx4 v16, s[24:27], s68 offen lds
    s_add_u32 m0, s73, 29696
    s_add_u32 s68, s69, 0x1d0000
    buffer_load_dwordx4 v17, s[24:27], s68 offen lds
    s_add_u32 m0, s73, 30720
    s_add_u32 s68, s69, 0x1e0000
    buffer_load_dwordx4 v18, s[24:27], s68 offen lds
    s_add_u32 m0, s73, 31744
    s_add_u32 s68, s69, 0x1f0000
    buffer_load_dwordx4 v19, s[24:27], s68 offen lds
    ds_read_b64_tr_b16 a[128:129], v20 offset:0
    ds_read_b64_tr_b16 a[130:131], v20 offset:512
    ds_read_b64_tr_b16 a[132:133], v20 offset:256
    ds_read_b64_tr_b16 a[134:135], v20 offset:768
    ds_read_b64_tr_b16 a[136:137], v21 offset:0
    ds_read_b64_tr_b16 a[138:139], v21 offset:512
    ds_read_b64_tr_b16 a[140:141], v21 offset:256
    ds_read_b64_tr_b16 a[142:143], v21 offset:768
    ds_read_b64_tr_b16 a[144:145], v22 offset:0
    ds_read_b64_tr_b16 a[146:147], v22 offset:512
    ds_read_b64_tr_b16 a[148:149], v22 offset:256
    ds_read_b64_tr_b16 a[150:151], v22 offset:768
    ds_read_b64_tr_b16 a[152:153], v23 offset:0
    ds_read_b64_tr_b16 a[154:155], v23 offset:512
    ds_read_b64_tr_b16 a[156:157], v23 offset:256
    ds_read_b64_tr_b16 a[158:159], v23 offset:768
    buffer_load_dword v24, v1, s[12:15], 0 offen offset:192 sc1
    s_waitcnt vmcnt(16) lgkmcnt(0)
    s_barrier
    s_add_u32 m0, s73, 0
    s_add_u32 s68, s69, 0x80000
    buffer_load_dwordx4 v16, s[28:31], s68 offen lds
    s_add_u32 m0, s73, 1024
    s_add_u32 s68, s69, 0x90000
    buffer_load_dwordx4 v17, s[28:31], s68 offen lds
    s_add_u32 m0, s73, 2048
    s_add_u32 s68, s69, 0xa0000
    buffer_load_dwordx4 v18, s[28:31], s68 offen lds
    s_add_u32 m0, s73, 3072
    s_add_u32 s68, s69, 0xb0000
    buffer_load_dwordx4 v19, s[28:31], s68 offen lds
    s_add_u32 m0, s73, 4096
    s_add_u32 s68, s69, 0x180000
    buffer_load_dwordx4 v16, s[28:31], s68 offen lds
    s_add_u32 m0, s73, 5120
    s_add_u32 s68, s69, 0x190000
    buffer_load_dwordx4 v17, s[28:31], s68 offen lds
    s_add_u32 m0, s73, 6144
    s_add_u32 s68, s69, 0x1a0000
    buffer_load_dwordx4 v18, s[28:31], s68 offen lds
    s_add_u32 m0, s73, 7168
    s_add_u32 s68, s69, 0x1b0000
    buffer_load_dwordx4 v19, s[28:31], s68 offen lds
    ds_read_b64_tr_b16 a[160:161], v20 offset:8192
    ds_read_b64_tr_b16 a[162:163], v20 offset:8704
    ds_read_b64_tr_b16 a[164:165], v20 offset:8448
    ds_read_b64_tr_b16 a[166:167], v20 offset:8960
    ds_read_b64_tr_b16 a[168:169], v21 offset:8192
    ds_read_b64_tr_b16 a[170:171], v21 offset:8704
    ds_read_b64_tr_b16 a[172:173], v21 offset:8448
    ds_read_b64_tr_b16 a[174:175], v21 offset:8960
    ds_read_b64_tr_b16 a[176:177], v22 offset:8192
    ds_read_b64_tr_b16 a[178:179], v22 offset:8704
    ds_read_b64_tr_b16 a[180:181], v22 offset:8448
    ds_read_b64_tr_b16 a[182:183], v22 offset:8960
    ds_read_b64_tr_b16 a[184:185], v23 offset:8192
    ds_read_b64_tr_b16 a[186:187], v23 offset:8704
    ds_read_b64_tr_b16 a[188:189], v23 offset:8448
    ds_read_b64_tr_b16 a[190:191], v23 offset:8960
    s_waitcnt vmcnt(16) lgkmcnt(0)
    s_barrier
    s_add_u32 m0, s73, 8192
    s_add_u32 s68, s69, 0xc0000
    buffer_load_dwordx4 v16, s[28:31], s68 offen lds
    s_add_u32 m0, s73, 9216
    s_add_u32 s68, s69, 0xd0000
    buffer_load_dwordx4 v17, s[28:31], s68 offen lds
    s_add_u32 m0, s73, 10240
    s_add_u32 s68, s69, 0xe0000
    buffer_load_dwordx4 v18, s[28:31], s68 offen lds
    s_add_u32 m0, s73, 11264
    s_add_u32 s68, s69, 0xf0000
    buffer_load_dwordx4 v19, s[28:31], s68 offen lds
    s_add_u32 m0, s73, 12288
    s_add_u32 s68, s69, 0x1c0000
    buffer_load_dwordx4 v16, s[28:31], s68 offen lds
    s_add_u32 m0, s73, 13312
    s_add_u32 s68, s69, 0x1d0000
    buffer_load_dwordx4 v17, s[28:31], s68 offen lds
    s_add_u32 m0, s73, 14336
    s_add_u32 s68, s69, 0x1e0000
    buffer_load_dwordx4 v18, s[28:31], s68 offen lds
    s_add_u32 m0, s73, 15360
    s_add_u32 s68, s69, 0x1f0000
    buffer_load_dwordx4 v19, s[28:31], s68 offen lds
    ds_read_b64_tr_b16 v[192:193], v20 offset:16384
    ds_read_b64_tr_b16 v[194:195], v20 offset:16896
    ds_read_b64_tr_b16 v[196:197], v20 offset:16640
    ds_read_b64_tr_b16 v[198:199], v20 offset:17152
    ds_read_b64_tr_b16 v[200:201], v21 offset:16384
    ds_read_b64_tr_b16 v[202:203], v21 offset:16896
    ds_read_b64_tr_b16 v[204:205], v21 offset:16640
    ds_read_b64_tr_b16 v[206:207], v21 offset:17152
    ds_read_b64_tr_b16 v[208:209], v22 offset:16384
    ds_read_b64_tr_b16 v[210:211], v22 offset:16896
    ds_read_b64_tr_b16 v[212:213], v22 offset:16640
    ds_read_b64_tr_b16 v[214:215], v22 offset:17152
    ds_read_b64_tr_b16 v[216:217], v23 offset:16384
    ds_read_b64_tr_b16 v[218:219], v23 offset:16896
    ds_read_b64_tr_b16 v[220:221], v23 offset:16640
    ds_read_b64_tr_b16 v[222:223], v23 offset:17152
    s_waitcnt vmcnt(16) lgkmcnt(0)
    s_barrier
    s_add_u32 m0, s73, 16384
    s_add_u32 s68, s69, 0x80000
    buffer_load_dwordx4 v16, s[32:35], s68 offen lds
    s_add_u32 m0, s73, 17408
    s_add_u32 s68, s69, 0x90000
    buffer_load_dwordx4 v17, s[32:35], s68 offen lds
    s_add_u32 m0, s73, 18432
    s_add_u32 s68, s69, 0xa0000
    buffer_load_dwordx4 v18, s[32:35], s68 offen lds
    s_add_u32 m0, s73, 19456
    s_add_u32 s68, s69, 0xb0000
    buffer_load_dwordx4 v19, s[32:35], s68 offen lds
    s_add_u32 m0, s73, 20480
    s_add_u32 s68, s69, 0x180000
    buffer_load_dwordx4 v16, s[32:35], s68 offen lds
    s_add_u32 m0, s73, 21504
    s_add_u32 s68, s69, 0x190000
    buffer_load_dwordx4 v17, s[32:35], s68 offen lds
    s_add_u32 m0, s73, 22528
    s_add_u32 s68, s69, 0x1a0000
    buffer_load_dwordx4 v18, s[32:35], s68 offen lds
    s_add_u32 m0, s73, 23552
    s_add_u32 s68, s69, 0x1b0000
    buffer_load_dwordx4 v19, s[32:35], s68 offen lds
    ds_read_b64_tr_b16 v[224:225], v20 offset:24576
    ds_read_b64_tr_b16 v[226:227], v20 offset:25088
    ds_read_b64_tr_b16 v[228:229], v20 offset:24832
    ds_read_b64_tr_b16 v[230:231], v20 offset:25344
    ds_read_b64_tr_b16 v[232:233], v21 offset:24576
    ds_read_b64_tr_b16 v[234:235], v21 offset:25088
    ds_read_b64_tr_b16 v[236:237], v21 offset:24832
    ds_read_b64_tr_b16 v[238:239], v21 offset:25344
    ds_read_b64_tr_b16 v[240:241], v22 offset:24576
    ds_read_b64_tr_b16 v[242:243], v22 offset:25088
    ds_read_b64_tr_b16 v[244:245], v22 offset:24832
    ds_read_b64_tr_b16 v[246:247], v22 offset:25344
    ds_read_b64_tr_b16 v[248:249], v23 offset:24576
    ds_read_b64_tr_b16 v[250:251], v23 offset:25088
    ds_read_b64_tr_b16 v[252:253], v23 offset:24832
    ds_read_b64_tr_b16 v[254:255], v23 offset:25344
    s_waitcnt vmcnt(16) lgkmcnt(0)
    s_barrier
    s_add_u32 m0, s73, 24576
    s_add_u32 s68, s69, 0xc0000
    buffer_load_dwordx4 v16, s[32:35], s68 offen lds
    s_add_u32 m0, s73, 25600
    s_add_u32 s68, s69, 0xd0000
    buffer_load_dwordx4 v17, s[32:35], s68 offen lds
    s_add_u32 m0, s73, 26624
    s_add_u32 s68, s69, 0xe0000
    buffer_load_dwordx4 v18, s[32:35], s68 offen lds
    s_add_u32 m0, s73, 27648
    s_add_u32 s68, s69, 0xf0000
    buffer_load_dwordx4 v19, s[32:35], s68 offen lds
    s_add_u32 m0, s73, 28672
    s_add_u32 s68, s69, 0x1c0000
    buffer_load_dwordx4 v16, s[32:35], s68 offen lds
    s_add_u32 m0, s73, 29696
    s_add_u32 s68, s69, 0x1d0000
    buffer_load_dwordx4 v17, s[32:35], s68 offen lds
    s_add_u32 m0, s73, 30720
    s_add_u32 s68, s69, 0x1e0000
    buffer_load_dwordx4 v18, s[32:35], s68 offen lds
    s_add_u32 m0, s73, 31744
    s_add_u32 s68, s69, 0x1f0000
    buffer_load_dwordx4 v19, s[32:35], s68 offen lds
    ds_read_b64_tr_b16 a[64:65], v20 offset:0
    ds_read_b64_tr_b16 a[66:67], v20 offset:512
    ds_read_b64_tr_b16 a[68:69], v20 offset:256
    ds_read_b64_tr_b16 a[70:71], v20 offset:768
    ds_read_b64_tr_b16 a[72:73], v21 offset:0
    ds_read_b64_tr_b16 a[74:75], v21 offset:512
    ds_read_b64_tr_b16 a[76:77], v21 offset:256
    ds_read_b64_tr_b16 a[78:79], v21 offset:768
    ds_read_b64_tr_b16 a[80:81], v22 offset:0
    ds_read_b64_tr_b16 a[82:83], v22 offset:512
    ds_read_b64_tr_b16 a[84:85], v22 offset:256
    ds_read_b64_tr_b16 a[86:87], v22 offset:768
    ds_read_b64_tr_b16 a[88:89], v23 offset:0
    ds_read_b64_tr_b16 a[90:91], v23 offset:512
    ds_read_b64_tr_b16 a[92:93], v23 offset:256
    ds_read_b64_tr_b16 a[94:95], v23 offset:768
    s_waitcnt vmcnt(16) lgkmcnt(0)
    s_barrier
    ds_read_b64_tr_b16 a[96:97], v20 offset:8192
    ds_read_b64_tr_b16 a[98:99], v20 offset:8704
    ds_read_b64_tr_b16 a[100:101], v20 offset:8448
    ds_read_b64_tr_b16 a[102:103], v20 offset:8960
    ds_read_b64_tr_b16 a[104:105], v21 offset:8192
    ds_read_b64_tr_b16 a[106:107], v21 offset:8704
    ds_read_b64_tr_b16 a[108:109], v21 offset:8448
    ds_read_b64_tr_b16 a[110:111], v21 offset:8960
    ds_read_b64_tr_b16 a[112:113], v22 offset:8192
    ds_read_b64_tr_b16 a[114:115], v22 offset:8704
    ds_read_b64_tr_b16 a[116:117], v22 offset:8448
    ds_read_b64_tr_b16 a[118:119], v22 offset:8960
    ds_read_b64_tr_b16 a[120:121], v23 offset:8192
    ds_read_b64_tr_b16 a[122:123], v23 offset:8704
    ds_read_b64_tr_b16 a[124:125], v23 offset:8448
    ds_read_b64_tr_b16 a[126:127], v23 offset:8960
    s_waitcnt vmcnt(8) lgkmcnt(0)
    s_barrier
    ds_read_b64_tr_b16 a[192:193], v20 offset:16384
    ds_read_b64_tr_b16 a[194:195], v20 offset:16896
    ds_read_b64_tr_b16 a[196:197], v20 offset:16640
    ds_read_b64_tr_b16 a[198:199], v20 offset:17152
    ds_read_b64_tr_b16 a[200:201], v21 offset:16384
    ds_read_b64_tr_b16 a[202:203], v21 offset:16896
    ds_read_b64_tr_b16 a[204:205], v21 offset:16640
    ds_read_b64_tr_b16 a[206:207], v21 offset:17152
    ds_read_b64_tr_b16 a[208:209], v22 offset:16384
    ds_read_b64_tr_b16 a[210:211], v22 offset:16896
    ds_read_b64_tr_b16 a[212:213], v22 offset:16640
    ds_read_b64_tr_b16 a[214:215], v22 offset:17152
    ds_read_b64_tr_b16 a[216:217], v23 offset:16384
    ds_read_b64_tr_b16 a[218:219], v23 offset:16896
    ds_read_b64_tr_b16 a[220:221], v23 offset:16640
    ds_read_b64_tr_b16 a[222:223], v23 offset:17152
    v_lshlrev_b32 v26, 7, v0
    s_mov_b32 s66, 24576
    buffer_load_dword v25, v26, s[8:11], s66 offen sc1
    s_mov_b32 s66, 20480
    buffer_load_dword v27, v26, s[8:11], s66 offen sc1
    s_waitcnt vmcnt(0) lgkmcnt(0)
    s_barrier
    ds_read_b64_tr_b16 a[224:225], v20 offset:24576
    ds_read_b64_tr_b16 a[226:227], v20 offset:25088
    ds_read_b64_tr_b16 a[228:229], v20 offset:24832
    ds_read_b64_tr_b16 a[230:231], v20 offset:25344
    ds_read_b64_tr_b16 a[232:233], v21 offset:24576
    ds_read_b64_tr_b16 a[234:235], v21 offset:25088
    ds_read_b64_tr_b16 a[236:237], v21 offset:24832
    ds_read_b64_tr_b16 a[238:239], v21 offset:25344
    ds_read_b64_tr_b16 a[240:241], v22 offset:24576
    ds_read_b64_tr_b16 a[242:243], v22 offset:25088
    ds_read_b64_tr_b16 a[244:245], v22 offset:24832
    ds_read_b64_tr_b16 a[246:247], v22 offset:25344
    ds_read_b64_tr_b16 a[248:249], v23 offset:24576
    ds_read_b64_tr_b16 a[250:251], v23 offset:25088
    ds_read_b64_tr_b16 a[252:253], v23 offset:24832
    ds_read_b64_tr_b16 a[254:255], v23 offset:25344
    s_waitcnt lgkmcnt(0)
    s_barrier
    s_and_b32 s92, s60, 1
    s_lshr_b32 s93, s60, 1
    v_and_b32 v9, 15, v0
    v_lshrrev_b32 v10, 4, v0
    s_lshl_b32 s68, s92, 4
    v_add_u32 v9, s68, v9
    v_lshlrev_b32 v10, 2, v10
    v_add_u32 v11, 0, v10
    v_cmp_le_u32 s[76:77], v11, v9
    v_add_u32 v11, 1, v10
    v_cmp_le_u32 s[78:79], v11, v9
    v_add_u32 v11, 2, v10
    v_cmp_le_u32 s[80:81], v11, v9
    v_add_u32 v11, 3, v10
    v_cmp_le_u32 s[82:83], v11, v9
    v_add_u32 v11, 16, v10
    v_cmp_le_u32 s[84:85], v11, v9
    v_add_u32 v11, 17, v10
    v_cmp_le_u32 s[86:87], v11, v9
    v_add_u32 v11, 18, v10
    v_cmp_le_u32 s[88:89], v11, v9
    v_add_u32 v11, 19, v10
    v_cmp_le_u32 s[90:91], v11, v9
    s_mov_b32 s94, 0x3db504f3
    v_and_b32 v12, 13, v0
    v_lshlrev_b32 v12, 4, v12
    v_bfe_u32 v8, v0, 1, 1
    v_lshl_add_u32 v12, v8, 9, v12
    v_bfe_u32 v8, v0, 5, 1
    v_lshl_add_u32 v12, v8, 8, v12
    v_bfe_u32 v8, v0, 4, 1
    v_lshl_add_u32 v12, v8, 5, v12
    s_lshl_b32 s68, s60, 11
    s_add_u32 s68, s68, 139264
    v_add_u32 v12, s68, v12
    v_bfe_u32 v8, v0, 1, 1
    v_mul_u32_u24 v10, 0xaaaa, v8
    v_add_u32 v10, 0x4444, v10
    v_and_b32 v11, 3, v0
    v_lshlrev_b32 v11, 2, v11
    v_bfe_u32 v8, v0, 2, 2
    v_lshl_add_u32 v11, v8, 8, v11
    v_lshrrev_b32 v8, 4, v0
    v_lshl_add_u32 v11, v8, 6, v11
    s_lshl_b32 s68, s60, 10
    s_add_u32 s68, s68, 147456
    v_add_u32 v11, s68, v11
    v_and_b32 v13, 1, v0
    v_lshlrev_b32 v13, 4, v13
    v_bfe_u32 v8, v0, 1, 2
    v_lshl_add_u32 v13, v8, 6, v13
    v_bfe_u32 v8, v0, 3, 1
    v_lshl_add_u32 v13, v8, 10, v13
    v_bfe_u32 v8, v0, 4, 1
    v_lshl_add_u32 v13, v8, 5, v13
    v_bfe_u32 v8, v0, 5, 1
    v_lshl_add_u32 v13, v8, 8, v13
    s_waitcnt vmcnt(0)
    v_min_u32 v24, v24, v27
    v_min_u32 v24, v24, v25
    v_cmp_eq_u32 vcc, 0, v24
    s_cbranch_vccz H_xok
poll_16:
    buffer_load_dword v8, v1, s[12:15], 0 offen offset:192 sc1
    s_waitcnt vmcnt(0)
    v_cmp_gt_u32 vcc, 1, v8
    s_cbranch_vccz pdone_17
    s_add_u32 s63, s63, 1
    s_cmp_gt_u32 s63, 400000
    s_cbranch_scc1 pdone_17
    s_sleep 2
    s_branch poll_16
pdone_17:
    v_lshlrev_b32 v9, 7, v0
    s_mov_b32 s68, 24576
poll_18:
    buffer_load_dword v8, v9, s[8:11], s68 offen offset:0 sc1
    s_waitcnt vmcnt(0)
    v_cmp_gt_u32 vcc, 1, v8
    s_cbranch_vccz pdone_19
    s_add_u32 s63, s63, 1
    s_cmp_gt_u32 s63, 400000
    s_cbranch_scc1 pdone_19
    s_sleep 2
    s_branch poll_18
pdone_19:
    s_mov_b32 s68, 20480
poll_20:
    buffer_load_dword v8, v9, s[8:11], s68 offen offset:0 sc1
    s_waitcnt vmcnt(0)
    v_cmp_gt_u32 vcc, 1, v8
    s_cbranch_vccz pdone_21
    s_add_u32 s63, s63, 1
    s_cmp_gt_u32 s63, 400000
    s_cbranch_scc1 pdone_21
    s_sleep 2
    s_branch poll_20
pdone_21:
H_xok:
    s_mov_b32 s66, 0
    s_mov_b32 s71, 0
    s_mov_b32 s70, 0
    s_lshl_b32 s73, s60, 13
    s_lshl_b32 s74, s65, 15
    s_add_u32 s74, s74, s73
    s_add_u32 s74, s74, 0x100000
    s_add_u32 m0, s73, 0
    s_add_u32 s68, s74, 0
    buffer_load_dwordx4 v2, s[8:11], s68 offen offset:0 sc1 lds
    buffer_load_dwordx4 v2, s[8:11], s68 offen offset:1024 sc1 lds
    buffer_load_dwordx4 v2, s[8:11], s68 offen offset:2048 sc1 lds
    buffer_load_dwordx4 v2, s[8:11], s68 offen offset:3072 sc1 lds
    s_add_u32 m0, s73, 4096
    s_add_u32 s68, s74, 4096
    buffer_load_dwordx4 v2, s[8:11], s68 offen offset:0 sc1 lds
    buffer_load_dwordx4 v2, s[8:11], s68 offen offset:1024 sc1 lds
    buffer_load_dwordx4 v2, s[8:11], s68 offen offset:2048 sc1 lds
    buffer_load_dwordx4 v2, s[8:11], s68 offen offset:3072 sc1 lds
H_loop:
    s_cmp_ge_u32 s66, 16
    s_cbranch_scc1 H_att
    s_lshl_b32 s67, s66, 2
    s_add_u32 s67, s67, s65
    v_add_u32 v6, s71, v2
    s_xor_b32 s71, s71, 0x8000
    s_xor_b32 s73, s73, 0x8000
    s_add_u32 s74, s74, 131072
    s_waitcnt vmcnt(0)
    s_barrier
    ds_read_b128 v[64:67], v6 offset:0
    ds_read_b128 v[68:71], v6 offset:16384
    ds_read_b128 v[72:75], v6 offset:1024
    ds_read_b128 v[76:79], v6 offset:17408
    ds_read_b128 v[80:83], v6 offset:2048
    ds_read_b128 v[84:87], v6 offset:18432
    s_waitcnt lgkmcnt(4)
    v_mfma_f32_16x16x32_bf16 v[16:19], v[128:131], v[64:67], 0
    v_mfma_f32_16x16x32_bf16 v[20:23], v[128:131], v[68:71], 0
    v_mfma_f32_16x16x32_bf16 v[24:27], v[136:139], v[64:67], 0
    v_mfma_f32_16x16x32_bf16 v[28:31], v[136:139], v[68:71], 0
    v_mfma_f32_16x16x32_bf16 v[32:35], a[0:3], v[64:67], 0
    v_mfma_f32_16x16x32_bf16 v[36:39], a[0:3], v[68:71], 0
    s_add_u32 m0, s73, 0
    s_add_u32 s68, s74, 0
    buffer_load_dwordx4 v2, s[8:11], s68 offen offset:0 sc1 lds
    v_mfma_f32_16x16x32_bf16 v[40:43], a[8:11], v[64:67], 0
    v_mfma_f32_16x16x32_bf16 v[44:47], a[8:11], v[68:71], 0
    v_mfma_f32_16x16x32_bf16 v[48:51], v[64:67], a[128:131], 0
    v_mfma_f32_16x16x32_bf16 v[52:55], v[68:71], a[128:131], 0
    v_mfma_f32_16x16x32_bf16 v[56:59], v[64:67], a[136:139], 0
    v_mfma_f32_16x16x32_bf16 v[60:63], v[68:71], a[136:139], 0
    ds_read_b128 v[64:67], v6 offset:3072
    ds_read_b128 v[68:71], v6 offset:19456
    s_waitcnt lgkmcnt(4)
    v_mfma_f32_16x16x32_bf16 v[16:19], v[132:135], v[72:75], v[16:19]
    v_mfma_f32_16x16x32_bf16 v[20:23], v[132:135], v[76:79], v[20:23]
    v_mfma_f32_16x16x32_bf16 v[24:27], v[140:143], v[72:75], v[24:27]
    v_mfma_f32_16x16x32_bf16 v[28:31], v[140:143], v[76:79], v[28:31]
    v_mfma_f32_16x16x32_bf16 v[32:35], a[4:7], v[72:75], v[32:35]
    v_mfma_f32_16x16x32_bf16 v[36:39], a[4:7], v[76:79], v[36:39]
    buffer_load_dwordx4 v2, s[8:11], s68 offen offset:1024 sc1 lds
    v_mfma_f32_16x16x32_bf16 v[40:43], a[12:15], v[72:75], v[40:43]
    v_mfma_f32_16x16x32_bf16 v[44:47], a[12:15], v[76:79], v[44:47]
    v_mfma_f32_16x16x32_bf16 v[48:51], v[72:75], a[132:135], v[48:51]
    v_mfma_f32_16x16x32_bf16 v[52:55], v[76:79], a[132:135], v[52:55]
    v_mfma_f32_16x16x32_bf16 v[56:59], v[72:75], a[140:143], v[56:59]
    v_mfma_f32_16x16x32_bf16 v[60:63], v[76:79], a[140:143], v[60:63]
    ds_read_b128 v[72:75], v6 offset:4096
    ds_read_b128 v[76:79], v6 offset:20480
    s_waitcnt lgkmcnt(4)
    v_mfma_f32_16x16x32_bf16 v[16:19], v[144:147], v[80:83], v[16:19]
    v_mfma_f32_16x16x32_bf16 v[20:23], v[144:147], v[84:87], v[20:23]
    v_mfma_f32_16x16x32_bf16 v[24:27], v[152:155], v[80:83], v[24:27]
    v_mfma_f32_16x16x32_bf16 v[28:31], v[152:155], v[84:87], v[28:31]
    v_mfma_f32_16x16x32_bf16 v[32:35], a[16:19], v[80:83], v[32:35]
    v_mfma_f32_16x16x32_bf16 v[36:39], a[16:19], v[84:87], v[36:39]
    buffer_load_dwordx4 v2, s[8:11], s68 offen offset:2048 sc1 lds
    v_mfma_f32_16x16x32_bf16 v[40:43], a[24:27], v[80:83], v[40:43]
    v_mfma_f32_16x16x32_bf16 v[44:47], a[24:27], v[84:87], v[44:47]
    v_mfma_f32_16x16x32_bf16 v[48:51], v[80:83], a[144:147], v[48:51]
    v_mfma_f32_16x16x32_bf16 v[52:55], v[84:87], a[144:147], v[52:55]
    v_mfma_f32_16x16x32_bf16 v[56:59], v[80:83], a[152:155], v[56:59]
    v_mfma_f32_16x16x32_bf16 v[60:63], v[84:87], a[152:155], v[60:63]
    ds_read_b128 v[80:83], v6 offset:5120
    ds_read_b128 v[84:87], v6 offset:21504
    s_waitcnt lgkmcnt(4)
    v_mfma_f32_16x16x32_bf16 v[16:19], v[148:151], v[64:67], v[16:19]
    v_mfma_f32_16x16x32_bf16 v[20:23], v[148:151], v[68:71], v[20:23]
    v_mfma_f32_16x16x32_bf16 v[24:27], v[156:159], v[64:67], v[24:27]
    v_mfma_f32_16x16x32_bf16 v[28:31], v[156:159], v[68:71], v[28:31]
    v_mfma_f32_16x16x32_bf16 v[32:35], a[20:23], v[64:67], v[32:35]
    v_mfma_f32_16x16x32_bf16 v[36:39], a[20:23], v[68:71], v[36:39]
    buffer_load_dwordx4 v2, s[8:11], s68 offen offset:3072 sc1 lds
    v_mfma_f32_16x16x32_bf16 v[40:43], a[28:31], v[64:67], v[40:43]
    v_mfma_f32_16x16x32_bf16 v[44:47], a[28:31], v[68:71], v[44:47]
    v_mfma_f32_16x16x32_bf16 v[48:51], v[64:67], a[148:151], v[48:51]
    v_mfma_f32_16x16x32_bf16 v[52:55], v[68:71], a[148:151], v[52:55]
    v_mfma_f32_16x16x32_bf16 v[56:59], v[64:67], a[156:159], v[56:59]
    v_mfma_f32_16x16x32_bf16 v[60:63], v[68:71], a[156:159], v[60:63]
    ds_read_b128 v[64:67], v6 offset:6144
    ds_read_b128 v[68:71], v6 offset:22528
    s_waitcnt lgkmcnt(4)
    v_mfma_f32_16x16x32_bf16 v[16:19], v[160:163], v[72:75], v[16:19]
    v_mfma_f32_16x16x32_bf16 v[20:23], v[160:163], v[76:79], v[20:23]
    v_mfma_f32_16x16x32_bf16 v[24:27], v[168:171], v[72:75], v[24:27]
    v_mfma_f32_16x16x32_bf16 v[28:31], v[168:171], v[76:79], v[28:31]
    v_mfma_f32_16x16x32_bf16 v[32:35], a[32:35], v[72:75], v[32:35]
    v_mfma_f32_16x16x32_bf16 v[36:39], a[32:35], v[76:79], v[36:39]
    s_add_u32 m0, s73, 4096
    s_add_u32 s68, s74, 4096
    buffer_load_dwordx4 v2, s[8:11], s68 offen offset:0 sc1 lds
    v_mfma_f32_16x16x32_bf16 v[40:43], a[40:43], v[72:75], v[40:43]
    v_mfma_f32_16x16x32_bf16 v[44:47], a[40:43], v[76:79], v[44:47]
    v_mfma_f32_16x16x32_bf16 v[48:51], v[72:75], a[160:163], v[48:51]
    v_mfma_f32_16x16x32_bf16 v[52:55], v[76:79], a[160:163], v[52:55]
    v_mfma_f32_16x16x32_bf16 v[56:59], v[72:75], a[168:171], v[56:59]
    v_mfma_f32_16x16x32_bf16 v[60:63], v[76:79], a[168:171], v[60:63]
    ds_read_b128 v[72:75], v6 offset:7168
    ds_read_b128 v[76:79], v6 offset:23552
    s_waitcnt lgkmcnt(4)
    v_mfma_f32_16x16x32_bf16 v[16:19], v[164:167], v[80:83], v[16:19]
    v_mfma_f32_16x16x32_bf16 v[20:23], v[164:167], v[84:87], v[20:23]
    v_mfma_f32_16x16x32_bf16 v[24:27], v[172:175], v[80:83], v[24:27]
    v_mfma_f32_16x16x32_bf16 v[28:31], v[172:175], v[84:87], v[28:31]
    v_mfma_f32_16x16x32_bf16 v[32:35], a[36:39], v[80:83], v[32:35]
    v_mfma_f32_16x16x32_bf16 v[36:39], a[36:39], v[84:87], v[36:39]
    buffer_load_dwordx4 v2, s[8:11], s68 offen offset:1024 sc1 lds
    v_mfma_f32_16x16x32_bf16 v[40:43], a[44:47], v[80:83], v[40:43]
    v_mfma_f32_16x16x32_bf16 v[44:47], a[44:47], v[84:87], v[44:47]
    v_mfma_f32_16x16x32_bf16 v[48:51], v[80:83], a[164:167], v[48:51]
    v_mfma_f32_16x16x32_bf16 v[52:55], v[84:87], a[164:167], v[52:55]
    v_mfma_f32_16x16x32_bf16 v[56:59], v[80:83], a[172:175], v[56:59]
    v_mfma_f32_16x16x32_bf16 v[60:63], v[84:87], a[172:175], v[60:63]
    ds_read_b128 v[80:83], v6 offset:8192
    ds_read_b128 v[84:87], v6 offset:24576
    s_waitcnt lgkmcnt(4)
    v_mfma_f32_16x16x32_bf16 v[16:19], v[176:179], v[64:67], v[16:19]
    v_mfma_f32_16x16x32_bf16 v[20:23], v[176:179], v[68:71], v[20:23]
    v_mfma_f32_16x16x32_bf16 v[24:27], v[184:187], v[64:67], v[24:27]
    v_mfma_f32_16x16x32_bf16 v[28:31], v[184:187], v[68:71], v[28:31]
    v_mfma_f32_16x16x32_bf16 v[32:35], a[48:51], v[64:67], v[32:35]
    v_mfma_f32_16x16x32_bf16 v[36:39], a[48:51], v[68:71], v[36:39]
    buffer_load_dwordx4 v2, s[8:11], s68 offen offset:2048 sc1 lds
    v_mfma_f32_16x16x32_bf16 v[40:43], a[56:59], v[64:67], v[40:43]
    v_mfma_f32_16x16x32_bf16 v[44:47], a[56:59], v[68:71], v[44:47]
    v_mfma_f32_16x16x32_bf16 v[48:51], v[64:67], a[176:179], v[48:51]
    v_mfma_f32_16x16x32_bf16 v[52:55], v[68:71], a[176:179], v[52:55]
    v_mfma_f32_16x16x32_bf16 v[56:59], v[64:67], a[184:187], v[56:59]
    v_mfma_f32_16x16x32_bf16 v[60:63], v[68:71], a[184:187], v[60:63]
    ds_read_b128 v[64:67], v6 offset:9216
    ds_read_b128 v[68:71], v6 offset:25600
    s_waitcnt lgkmcnt(4)
    v_mfma_f32_16x16x32_bf16 v[16:19], v[180:183], v[72:75], v[16:19]
    v_mfma_f32_16x16x32_bf16 v[20:23], v[180:183], v[76:79], v[20:23]
    v_mfma_f32_16x16x32_bf16 v[24:27], v[188:191], v[72:75], v[24:27]
    v_mfma_f32_16x16x32_bf16 v[28:31], v[188:191], v[76:79], v[28:31]
    v_mfma_f32_16x16x32_bf16 v[32:35], a[52:55], v[72:75], v[32:35]
    v_mfma_f32_16x16x32_bf16 v[36:39], a[52:55], v[76:79], v[36:39]
    buffer_load_dwordx4 v2, s[8:11], s68 offen offset:3072 sc1 lds
    v_mfma_f32_16x16x32_bf16 v[40:43], a[60:63], v[72:75], v[40:43]
    v_mfma_f32_16x16x32_bf16 v[44:47], a[60:63], v[76:79], v[44:47]
    v_mfma_f32_16x16x32_bf16 v[48:51], v[72:75], a[180:183], v[48:51]
    v_mfma_f32_16x16x32_bf16 v[52:55], v[76:79], a[180:183], v[52:55]
    v_mfma_f32_16x16x32_bf16 v[56:59], v[72:75], a[188:191], v[56:59]
    v_mfma_f32_16x16x32_bf16 v[60:63], v[76:79], a[188:191], v[60:63]
    ds_read_b128 v[72:75], v6 offset:10240
    ds_read_b128 v[76:79], v6 offset:26624
    s_waitcnt lgkmcnt(4)
    v_mfma_f32_16x16x32_bf16 v[16:19], v[192:195], v[80:83], v[16:19]
    v_mfma_f32_16x16x32_bf16 v[20:23], v[192:195], v[84:87], v[20:23]
    v_mfma_f32_16x16x32_bf16 v[24:27], v[200:203], v[80:83], v[24:27]
    v_mfma_f32_16x16x32_bf16 v[28:31], v[200:203], v[84:87], v[28:31]
    v_mfma_f32_16x16x32_bf16 v[32:35], a[64:67], v[80:83], v[32:35]
    v_mfma_f32_16x16x32_bf16 v[36:39], a[64:67], v[84:87], v[36:39]
    v_mfma_f32_16x16x32_bf16 v[40:43], a[72:75], v[80:83], v[40:43]
    v_mfma_f32_16x16x32_bf16 v[44:47], a[72:75], v[84:87], v[44:47]
    v_mfma_f32_16x16x32_bf16 v[48:51], v[80:83], a[192:195], v[48:51]
    v_mfma_f32_16x16x32_bf16 v[52:55], v[84:87], a[192:195], v[52:55]
    v_mfma_f32_16x16x32_bf16 v[56:59], v[80:83], a[200:203], v[56:59]
    v_mfma_f32_16x16x32_bf16 v[60:63], v[84:87], a[200:203], v[60:63]
    ds_read_b128 v[80:83], v6 offset:11264
    ds_read_b128 v[84:87], v6 offset:27648
    s_waitcnt lgkmcnt(4)
    v_mfma_f32_16x16x32_bf16 v[16:19], v[196:199], v[64:67], v[16:19]
    v_mfma_f32_16x16x32_bf16 v[20:23], v[196:199], v[68:71], v[20:23]
    v_mfma_f32_16x16x32_bf16 v[24:27], v[204:207], v[64:67], v[24:27]
    v_mfma_f32_16x16x32_bf16 v[28:31], v[204:207], v[68:71], v[28:31]
    v_mfma_f32_16x16x32_bf16 v[32:35], a[68:71], v[64:67], v[32:35]
    v_mfma_f32_16x16x32_bf16 v[36:39], a[68:71], v[68:71], v[36:39]
    v_mfma_f32_16x16x32_bf16 v[40:43], a[76:79], v[64:67], v[40:43]
    v_mfma_f32_16x16x32_bf16 v[44:47], a[76:79], v[68:71], v[44:47]
    v_mfma_f32_16x16x32_bf16 v[48:51], v[64:67], a[196:199], v[48:51]
    v_mfma_f32_16x16x32_bf16 v[52:55], v[68:71], a[196:199], v[52:55]
    v_mfma_f32_16x16x32_bf16 v[56:59], v[64:67], a[204:207], v[56:59]
    v_mfma_f32_16x16x32_bf16 v[60:63], v[68:71], a[204:207], v[60:63]
    ds_read_b128 v[64:67], v6 offset:12288
    ds_read_b128 v[68:71], v6 offset:28672
    s_waitcnt lgkmcnt(4)
    v_mfma_f32_16x16x32_bf16 v[16:19], v[208:211], v[72:75], v[16:19]
    v_mfma_f32_16x16x32_bf16 v[20:23], v[208:211], v[76:79], v[20:23]
    v_mfma_f32_16x16x32_bf16 v[24:27], v[216:219], v[72:75], v[24:27]
    v_mfma_f32_16x16x32_bf16 v[28:31], v[216:219], v[76:79], v[28:31]
    v_mfma_f32_16x16x32_bf16 v[32:35], a[80:83], v[72:75], v[32:35]
    v_mfma_f32_16x16x32_bf16 v[36:39], a[80:83], v[76:79], v[36:39]
    v_mfma_f32_16x16x32_bf16 v[40:43], a[88:91], v[72:75], v[40:43]
    v_mfma_f32_16x16x32_bf16 v[44:47], a[88:91], v[76:79], v[44:47]
    v_mfma_f32_16x16x32_bf16 v[48:51], v[72:75], a[208:211], v[48:51]
    v_mfma_f32_16x16x32_bf16 v[52:55], v[76:79], a[208:211], v[52:55]
    v_mfma_f32_16x16x32_bf16 v[56:59], v[72:75], a[216:219], v[56:59]
    v_mfma_f32_16x16x32_bf16 v[60:63], v[76:79], a[216:219], v[60:63]
    ds_read_b128 v[72:75], v6 offset:13312
    ds_read_b128 v[76:79], v6 offset:29696
    s_waitcnt lgkmcnt(4)
    v_mfma_f32_16x16x32_bf16 v[16:19], v[212:215], v[80:83], v[16:19]
    v_mfma_f32_16x16x32_bf16 v[20:23], v[212:215], v[84:87], v[20:23]
    v_mfma_f32_16x16x32_bf16 v[24:27], v[220:223], v[80:83], v[24:27]
    v_mfma_f32_16x16x32_bf16 v[28:31], v[220:223], v[84:87], v[28:31]
    v_mfma_f32_16x16x32_bf16 v[32:35], a[84:87], v[80:83], v[32:35]
    v_mfma_f32_16x16x32_bf16 v[36:39], a[84:87], v[84:87], v[36:39]
    v_mfma_f32_16x16x32_bf16 v[40:43], a[92:95], v[80:83], v[40:43]
    v_mfma_f32_16x16x32_bf16 v[44:47], a[92:95], v[84:87], v[44:47]
    v_mfma_f32_16x16x32_bf16 v[48:51], v[80:83], a[212:215], v[48:51]
    v_mfma_f32_16x16x32_bf16 v[52:55], v[84:87], a[212:215], v[52:55]
    v_mfma_f32_16x16x32_bf16 v[56:59], v[80:83], a[220:223], v[56:59]
    v_mfma_f32_16x16x32_bf16 v[60:63], v[84:87], a[220:223], v[60:63]
    ds_read_b128 v[80:83], v6 offset:14336
    ds_read_b128 v[84:87], v6 offset:30720
    s_waitcnt lgkmcnt(4)
    v_mfma_f32_16x16x32_bf16 v[16:19], v[224:227], v[64:67], v[16:19]
    v_mfma_f32_16x16x32_bf16 v[20:23], v[224:227], v[68:71], v[20:23]
    v_mfma_f32_16x16x32_bf16 v[24:27], v[232:235], v[64:67], v[24:27]
    v_mfma_f32_16x16x32_bf16 v[28:31], v[232:235], v[68:71], v[28:31]
    v_mfma_f32_16x16x32_bf16 v[32:35], a[96:99], v[64:67], v[32:35]
    v_mfma_f32_16x16x32_bf16 v[36:39], a[96:99], v[68:71], v[36:39]
    v_mfma_f32_16x16x32_bf16 v[40:43], a[104:107], v[64:67], v[40:43]
    v_mfma_f32_16x16x32_bf16 v[44:47], a[104:107], v[68:71], v[44:47]
    v_mfma_f32_16x16x32_bf16 v[48:51], v[64:67], a[224:227], v[48:51]
    v_mfma_f32_16x16x32_bf16 v[52:55], v[68:71], a[224:227], v[52:55]
    v_mfma_f32_16x16x32_bf16 v[56:59], v[64:67], a[232:235], v[56:59]
    v_mfma_f32_16x16x32_bf16 v[60:63], v[68:71], a[232:235], v[60:63]
    ds_read_b128 v[64:67], v6 offset:15360
    ds_read_b128 v[68:71], v6 offset:31744
    s_waitcnt lgkmcnt(4)
    v_mfma_f32_16x16x32_bf16 v[16:19], v[228:231], v[72:75], v[16:19]
    v_mfma_f32_16x16x32_bf16 v[20:23], v[228:231], v[76:79], v[20:23]
    v_mfma_f32_16x16x32_bf16 v[24:27], v[236:239], v[72:75], v[24:27]
    v_mfma_f32_16x16x32_bf16 v[28:31], v[236:239], v[76:79], v[28:31]
    v_mfma_f32_16x16x32_bf16 v[32:35], a[100:103], v[72:75], v[32:35]
    v_mfma_f32_16x16x32_bf16 v[36:39], a[100:103], v[76:79], v[36:39]
    v_mfma_f32_16x16x32_bf16 v[40:43], a[108:111], v[72:75], v[40:43]
    v_mfma_f32_16x16x32_bf16 v[44:47], a[108:111], v[76:79], v[44:47]
    v_mfma_f32_16x16x32_bf16 v[48:51], v[72:75], a[228:231], v[48:51]
    v_mfma_f32_16x16x32_bf16 v[52:55], v[76:79], a[228:231], v[52:55]
    v_mfma_f32_16x16x32_bf16 v[56:59], v[72:75], a[236:239], v[56:59]
    v_mfma_f32_16x16x32_bf16 v[60:63], v[76:79], a[236:239], v[60:63]
    s_waitcnt lgkmcnt(2)
    v_mfma_f32_16x16x32_bf16 v[16:19], v[240:243], v[80:83], v[16:19]
    v_mfma_f32_16x16x32_bf16 v[20:23], v[240:243], v[84:87], v[20:23]
    v_mfma_f32_16x16x32_bf16 v[24:27], v[248:251], v[80:83], v[24:27]
    v_mfma_f32_16x16x32_bf16 v[28:31], v[248:251], v[84:87], v[28:31]
    v_mfma_f32_16x16x32_bf16 v[32:35], a[112:115], v[80:83], v[32:35]
    v_mfma_f32_16x16x32_bf16 v[36:39], a[112:115], v[84:87], v[36:39]
    v_mfma_f32_16x16x32_bf16 v[40:43], a[120:123], v[80:83], v[40:43]
    v_mfma_f32_16x16x32_bf16 v[44:47], a[120:123], v[84:87], v[44:47]
    v_mfma_f32_16x16x32_bf16 v[48:51], v[80:83], a[240:243], v[48:51]
    v_mfma_f32_16x16x32_bf16 v[52:55], v[84:87], a[240:243], v[52:55]
    v_mfma_f32_16x16x32_bf16 v[56:59], v[80:83], a[248:251], v[56:59]
    v_mfma_f32_16x16x32_bf16 v[60:63], v[84:87], a[248:251], v[60:63]
    s_waitcnt lgkmcnt(0)
    v_mfma_f32_16x16x32_bf16 v[16:19], v[244:247], v[64:67], v[16:19]
    v_mfma_f32_16x16x32_bf16 v[20:23], v[244:247], v[68:71], v[20:23]
    v_mfma_f32_16x16x32_bf16 v[24:27], v[252:255], v[64:67], v[24:27]
    v_mfma_f32_16x16x32_bf16 v[28:31], v[252:255], v[68:71], v[28:31]
    v_mfma_f32_16x16x32_bf16 v[32:35], a[116:119], v[64:67], v[32:35]
    v_mfma_f32_16x16x32_bf16 v[36:39], a[116:119], v[68:71], v[36:39]
    v_mfma_f32_16x16x32_bf16 v[40:43], a[124:127], v[64:67], v[40:43]
    v_mfma_f32_16x16x32_bf16 v[44:47], a[124:127], v[68:71], v[44:47]
    v_mfma_f32_16x16x32_bf16 v[48:51], v[64:67], a[244:247], v[48:51]
    v_mfma_f32_16x16x32_bf16 v[52:55], v[68:71], a[244:247], v[52:55]
    v_mfma_f32_16x16x32_bf16 v[56:59], v[64:67], a[252:255], v[56:59]
    v_mfma_f32_16x16x32_bf16 v[60:63], v[68:71], a[252:255], v[60:63]
    s_add_u32 s68, s70, 0x10000
    s_lshl_b32 s69, s60, 10
    s_add_u32 s68, s68, s69
    v_add_u32 v7, s68, v2
    s_lshl_b32 s68, s67, 5
    s_add_u32 s68, s68, s64
    s_lshl_b32 s68, s68, 14
    s_add_u32 s68, s68, s69
    s_add_u32 s68, s68, 0x2a00000
    v_cvt_pk_bf16_f32 v88, v32, v40
    v_cvt_pk_bf16_f32 v89, v33, v41
    v_cvt_pk_bf16_f32 v90, v34, v42
    v_cvt_pk_bf16_f32 v91, v35, v43
    ds_write_b128 v7, v[88:91] offset:8192
    s_add_u32 s69, s68, 0
    buffer_store_dwordx4 v[88:91], v2, s[8:11], s69 offen sc1
    v_cvt_pk_bf16_f32 v92, v36, v44
    v_cvt_pk_bf16_f32 v93, v37, v45
    v_cvt_pk_bf16_f32 v94, v38, v46
    v_cvt_pk_bf16_f32 v95, v39, v47
    ds_write_b128 v7, v[92:95] offset:12288
    s_add_u32 s69, s68, 4096
    buffer_store_dwordx4 v[92:95], v2, s[8:11], s69 offen sc1
    v_cvt_pk_bf16_f32 v96, v16, v24
    v_cvt_pk_bf16_f32 v97, v17, v25
    v_cvt_pk_bf16_f32 v98, v18, v26
    v_cvt_pk_bf16_f32 v99, v19, v27
    ds_write_b128 v7, v[96:99] offset:0
    v_cvt_pk_bf16_f32 v100, v20, v28
    v_cvt_pk_bf16_f32 v101, v21, v29
    v_cvt_pk_bf16_f32 v102, v22, v30
    v_cvt_pk_bf16_f32 v103, v23, v31
    ds_write_b128 v7, v[100:103] offset:4096
    s_lshl_b32 s69, s60, 10
    v_add_u32 v8, s69, v7
    s_add_u32 s68, s68, s69
    s_add_u32 s68, s68, 8192
    v_cvt_pk_bf16_f32 v104, v48, v49
    v_cvt_pk_bf16_f32 v105, v50, v51
    v_cvt_pk_bf16_f32 v106, v52, v53
    v_cvt_pk_bf16_f32 v107, v54, v55
    ds_write_b128 v8, v[104:107] offset:16384
    buffer_store_dwordx4 v[104:107], v2, s[8:11], s68 offen offset:0 sc1
    v_cvt_pk_bf16_f32 v108, v56, v57
    v_cvt_pk_bf16_f32 v109, v58, v59
    v_cvt_pk_bf16_f32 v110, v60, v61
    v_cvt_pk_bf16_f32 v111, v62, v63
    ds_write_b128 v8, v[108:111] offset:17408
    buffer_store_dwordx4 v[108:111], v2, s[8:11], s68 offen offset:1024 sc1
    s_waitcnt vmcnt(0) lgkmcnt(0)
    s_barrier
    s_cmp_lg_u32 s60, 0
    s_cbranch_scc1 H_att
    s_add_u32 s68, s66, 1
    v_mov_b32 v8, s68
    s_mov_b64 exec, 1
    buffer_store_dword v8, v1, s[8:11], s72 offen offset:0 sc1
    s_mov_b64 exec, -1
H_att:
    s_add_u32 s70, s70, 24576
    s_cmp_eq_u32 s70, 73728
    s_cselect_b32 s70, 0, s70
    s_cmp_ge_u32 s66, 2
    s_cbranch_scc1 H_att2
    v_mov_b32 v16, -1
    v_mov_b32 v17, -1
    v_mov_b32 v18, -1
    v_mov_b32 v19, -1
    s_add_u32 s68, s65, 60
    s_lshl_b32 s68, s68, 1
    s_add_u32 s68, s68, s92
    s_lshl_b32 s68, s68, 5
    s_add_u32 s68, s68, s64
    s_lshl_b32 s68, s68, 1
    s_add_u32 s68, s68, s93
    s_lshl_b32 s68, s68, 11
    s_add_u32 s68, s68, 0x1a00000
    buffer_store_dwordx4 v[16:19], v2, s[8:11], s68 offen offset:0 sc1
    buffer_store_dwordx4 v[16:19], v2, s[8:11], s68 offen offset:1024 sc1
    s_add_u32 s68, s65, 56
    s_lshl_b32 s68, s68, 1
    s_add_u32 s68, s68, s92
    s_lshl_b32 s68, s68, 5
    s_add_u32 s68, s68, s64
    s_lshl_b32 s68, s68, 1
    s_add_u32 s68, s68, s93
    s_lshl_b32 s68, s68, 11
    s_add_u32 s68, s68, 0x1a00000
    buffer_store_dwordx4 v[16:19], v2, s[8:11], s68 offen offset:0 sc1
    buffer_store_dwordx4 v[16:19], v2, s[8:11], s68 offen offset:1024 sc1
    s_branch H_next
H_att2:
    s_sub_u32 s67, s66, 2
    s_lshl_b32 s67, s67, 2
    s_add_u32 s67, s67, s65
    s_add_u32 s68, s70, 0x10000
    v_add_u32 v7, s68, v2
    s_lshl_b32 s69, s92, 12
    v_add_u32 v8, s69, v7
    ds_read_b128 v[44:47], v8 offset:0
    ds_read_b128 v[48:51], v8 offset:1024
    ds_read_b128 v[52:55], v8 offset:2048
    ds_read_b128 v[56:59], v8 offset:3072
    ds_read_b128 v[60:63], v7 offset:8192
    ds_read_b128 v[64:67], v7 offset:9216
    ds_read_b128 v[68:71], v7 offset:10240
    ds_read_b128 v[72:75], v7 offset:11264
    ds_read_b128 v[76:79], v7 offset:12288
    ds_read_b128 v[80:83], v7 offset:13312
    ds_read_b128 v[84:87], v7 offset:14336
    ds_read_b128 v[88:91], v7 offset:15360
    s_waitcnt lgkmcnt(0)
    s_lshl_b32 s69, s93, 12
    v_add_u32 v8, s69, v7
    ds_read_b128 v[92:95], v8 offset:16384
    ds_read_b128 v[96:99], v8 offset:17408
    ds_read_b128 v[100:103], v8 offset:18432
    ds_read_b128 v[104:107], v8 offset:19456
    v_mfma_f32_16x16x32_bf16 v[112:115], v[60:63], v[44:47], 0
    v_mfma_f32_16x16x32_bf16 v[112:115], v[64:67], v[48:51], v[112:115]
    v_mfma_f32_16x16x32_bf16 v[112:115], v[68:71], v[52:55], v[112:115]
    v_mfma_f32_16x16x32_bf16 v[112:115], v[72:75], v[56:59], v[112:115]
    v_mfma_f32_16x16x32_bf16 v[116:119], v[76:79], v[44:47], 0
    v_mfma_f32_16x16x32_bf16 v[116:119], v[80:83], v[48:51], v[116:119]
    v_mfma_f32_16x16x32_bf16 v[116:119], v[84:87], v[52:55], v[116:119]
    v_mfma_f32_16x16x32_bf16 v[116:119], v[88:91], v[56:59], v[116:119]
    v_mov_b64 v[24:25], 0
    v_mov_b64 v[26:27], 0
    v_mov_b64 v[28:29], 0
    v_mov_b64 v[30:31], 0
    v_mov_b64 v[32:33], 0
    v_mov_b64 v[34:35], 0
    v_mov_b64 v[36:37], 0
    v_mov_b64 v[38:39], 0
    v_cvt_pk_bf16_f32 v60, v112, v113
    v_lshlrev_b32 v112, 16, v60
    v_and_b32 v113, 0xffff0000, v60
    v_mul_f32 v112, s94, v112
    v_mul_f32 v113, s94, v113
    v_cvt_pk_bf16_f32 v60, v112, v113
    v_lshlrev_b32 v112, 16, v60
    v_and_b32 v113, 0xffff0000, v60
    v_cvt_pk_bf16_f32 v60, v114, v115
    v_lshlrev_b32 v114, 16, v60
    v_and_b32 v115, 0xffff0000, v60
    v_mul_f32 v114, s94, v114
    v_mul_f32 v115, s94, v115
    v_cvt_pk_bf16_f32 v60, v114, v115
    v_lshlrev_b32 v114, 16, v60
    v_and_b32 v115, 0xffff0000, v60
    v_cvt_pk_bf16_f32 v60, v116, v117
    v_lshlrev_b32 v116, 16, v60
    v_and_b32 v117, 0xffff0000, v60
    v_mul_f32 v116, s94, v116
    v_mul_f32 v117, s94, v117
    v_cvt_pk_bf16_f32 v60, v116, v117
    v_lshlrev_b32 v116, 16, v60
    v_and_b32 v117, 0xffff0000, v60
    v_cvt_pk_bf16_f32 v60, v118, v119
    v_lshlrev_b32 v118, 16, v60
    v_and_b32 v119, 0xffff0000, v60
    v_mul_f32 v118, s94, v118
    v_mul_f32 v119, s94, v119
    v_cvt_pk_bf16_f32 v60, v118, v119
    v_lshlrev_b32 v118, 16, v60
    v_and_b32 v119, 0xffff0000, v60
    v_mov_b32 v61, 0xce6e0000
    v_cndmask_b32 v112, v61, v112, s[76:77]
    v_cndmask_b32 v113, v61, v113, s[78:79]
    v_cndmask_b32 v114, v61, v114, s[80:81]
    v_cndmask_b32 v115, v61, v115, s[82:83]
    v_cndmask_b32 v116, v61, v116, s[84:85]
    v_cndmask_b32 v117, v61, v117, s[86:87]
    v_cndmask_b32 v118, v61, v118, s[88:89]
    v_cndmask_b32 v119, v61, v119, s[90:91]
    v_max3_f32 v14, v112, v113, v114
    v_max3_f32 v14, v14, v115, v116
    v_max3_f32 v14, v14, v117, v118
    v_max_f32 v14, v14, v119
    v_mov_b32 v63, v14
    s_nop 1
    v_permlane32_swap_b32 v14, v63
    v_max_f32 v14, v14, v63
    v_mov_b32 v63, v14
    s_nop 1
    v_permlane16_swap_b32 v14, v63
    v_max_f32 v14, v14, v63
    v_sub_f32 v112, v112, v14
    v_mul_f32 v112, 0x3fb8aa3b, v112
    v_exp_f32 v112, v112
    v_sub_f32 v113, v113, v14
    v_mul_f32 v113, 0x3fb8aa3b, v113
    v_exp_f32 v113, v113
    v_sub_f32 v114, v114, v14
    v_mul_f32 v114, 0x3fb8aa3b, v114
    v_exp_f32 v114, v114
    v_sub_f32 v115, v115, v14
    v_mul_f32 v115, 0x3fb8aa3b, v115
    v_exp_f32 v115, v115
    v_sub_f32 v116, v116, v14
    v_mul_f32 v116, 0x3fb8aa3b, v116
    v_exp_f32 v116, v116
    v_sub_f32 v117, v117, v14
    v_mul_f32 v117, 0x3fb8aa3b, v117
    v_exp_f32 v117, v117
    v_sub_f32 v118, v118, v14
    v_mul_f32 v118, 0x3fb8aa3b, v118
    v_exp_f32 v118, v118
    v_sub_f32 v119, v119, v14
    v_mul_f32 v119, 0x3fb8aa3b, v119
    v_exp_f32 v119, v119
    v_add_f32 v15, v112, v113
    v_add_f32 v15, v15, v114
    v_add_f32 v15, v15, v115
    v_add_f32 v15, v15, v116
    v_add_f32 v15, v15, v117
    v_add_f32 v15, v15, v118
    v_add_f32 v15, v15, v119
    v_mov_b32 v63, v15
    s_nop 1
    v_permlane32_swap_b32 v15, v63
    v_add_f32 v15, v15, v63
    v_mov_b32 v63, v15
    s_nop 1
    v_permlane16_swap_b32 v15, v63
    v_add_f32 v15, v15, v63
    s_cmp_ge_u32 s67, 60
    s_subb_u32 s69, s67, 0
    s_lshl_b32 s69, s69, 13
    s_add_u32 s69, s69, 0x940000
H_lp:
    buffer_load_dword v9, v1, s[8:11], s69 offen sc1
    s_waitcnt vmcnt(0)
    v_cmp_eq_u32 vcc, -1, v9
    s_cbranch_vccz H_lpd
    s_add_u32 s63, s63, 1
    s_cmp_gt_u32 s63, 400000
    s_cbranch_scc1 H_lpd
    s_sleep 3
    s_branch H_lp
H_lpd:
    s_lshl_b32 s69, s60, 11
    s_lshl_b32 s68, s67, 13
    s_add_u32 s68, s68, s69
    s_add_u32 s68, s68, 0x940000
    v_add_u32 v8, 0x22000, v2
    buffer_load_dwordx4 v[16:19], v2, s[8:11], s68 offen offset:0 sc1
    buffer_load_dwordx4 v[20:23], v2, s[8:11], s68 offen offset:1024 sc1
    s_sleep 5
H_mp0:
    buffer_load_dwordx4 v[120:123], v2, s[8:11], s68 offen offset:0 sc1
    buffer_load_dwordx4 v[124:127], v2, s[8:11], s68 offen offset:1024 sc1
    s_waitcnt vmcnt(2)
    v_max3_u32 v9, v16, v17, v18
    v_max3_u32 v61, v19, v20, v21
    v_max3_u32 v9, v9, v22, v23
    v_max_u32 v9, v9, v61
    v_cmp_eq_u32 vcc, -1, v9
    v_swap_b32 v17, v18
    v_swap_b32 v21, v22
    s_cbranch_vccz H_mo0
    s_add_u32 s63, s63, 1
    s_cmp_gt_u32 s63, 400000
    s_cbranch_scc1 H_mo0
H_mp1:
    buffer_load_dwordx4 v[16:19], v2, s[8:11], s68 offen offset:0 sc1
    buffer_load_dwordx4 v[20:23], v2, s[8:11], s68 offen offset:1024 sc1
    s_waitcnt vmcnt(2)
    v_max3_u32 v9, v120, v121, v122
    v_max3_u32 v61, v123, v124, v125
    v_max3_u32 v9, v9, v126, v127
    v_max_u32 v9, v9, v61
    v_cmp_eq_u32 vcc, -1, v9
    v_swap_b32 v121, v122
    v_swap_b32 v125, v126
    s_cbranch_vccz H_mo1
    s_add_u32 s63, s63, 1
    s_cmp_gt_u32 s63, 400000
    s_cbranch_scc1 H_mo1
    s_branch H_mp0
H_mo0:
    v_permlane16_swap_b32 v16, v18
    v_permlane16_swap_b32 v17, v19
    v_permlane16_swap_b32 v20, v22
    v_permlane16_swap_b32 v21, v23
    ds_write_b128 v12, v[16:19] offset:0
    ds_write_b128 v12, v[20:23] offset:1024
    s_branch H_mok
H_mo1:
    v_permlane16_swap_b32 v120, v122
    v_permlane16_swap_b32 v121, v123
    v_permlane16_swap_b32 v124, v126
    v_permlane16_swap_b32 v125, v127
    ds_write_b128 v12, v[120:123] offset:0
    ds_write_b128 v12, v[124:127] offset:1024
H_mok:
    s_waitcnt lgkmcnt(0)
    s_barrier
    ds_read_b128 v[60:63], v8 offset:0
    ds_read_b128 v[64:67], v8 offset:1024
    ds_read_b128 v[68:71], v8 offset:2048
    ds_read_b128 v[72:75], v8 offset:3072
    ds_read_b128 v[76:79], v8 offset:4096
    ds_read_b128 v[80:83], v8 offset:5120
    ds_read_b128 v[84:87], v8 offset:6144
    ds_read_b128 v[88:91], v8 offset:7168
    s_lshl_b32 s68, s93, 10
    s_lshl_b32 s69, s92, 3
    s_add_u32 s69, s69, s68
    s_add_u32 s69, s69, 0x25000
    v_add_u32 v9, s69, v2
    s_waitcnt lgkmcnt(7)
    v_smfmac_f32_16x16x64_bf16 v[24:27], v[60:63], a[0:7], v10
    v_smfmac_f32_16x16x64_bf16 v[28:31], v[60:63], a[8:15], v10
    s_waitcnt lgkmcnt(6)
    v_smfmac_f32_16x16x64_bf16 v[24:27], v[64:67], a[16:23], v10
    v_smfmac_f32_16x16x64_bf16 v[28:31], v[64:67], a[24:31], v10
    s_waitcnt lgkmcnt(5)
    v_smfmac_f32_16x16x64_bf16 v[24:27], v[68:71], a[32:39], v10
    v_smfmac_f32_16x16x64_bf16 v[28:31], v[68:71], a[40:47], v10
    s_waitcnt lgkmcnt(4)
    v_smfmac_f32_16x16x64_bf16 v[24:27], v[72:75], a[48:55], v10
    v_smfmac_f32_16x16x64_bf16 v[28:31], v[72:75], a[56:63], v10
    s_waitcnt lgkmcnt(3)
    v_smfmac_f32_16x16x64_bf16 v[24:27], v[76:79], a[64:71], v10
    v_smfmac_f32_16x16x64_bf16 v[28:31], v[76:79], a[72:79], v10
    s_waitcnt lgkmcnt(2)
    v_smfmac_f32_16x16x64_bf16 v[24:27], v[80:83], a[80:87], v10
    v_smfmac_f32_16x16x64_bf16 v[28:31], v[80:83], a[88:95], v10
    s_waitcnt lgkmcnt(1)
    v_smfmac_f32_16x16x64_bf16 v[24:27], v[84:87], a[96:103], v10
    v_smfmac_f32_16x16x64_bf16 v[28:31], v[84:87], a[104:111], v10
    s_waitcnt lgkmcnt(0)
    v_smfmac_f32_16x16x64_bf16 v[24:27], v[88:91], a[112:119], v10
    v_smfmac_f32_16x16x64_bf16 v[28:31], v[88:91], a[120:127], v10
    v_smfmac_f32_16x16x64_bf16 v[32:35], v[60:63], a[128:135], v10
    v_smfmac_f32_16x16x64_bf16 v[36:39], v[60:63], a[136:143], v10
    v_smfmac_f32_16x16x64_bf16 v[32:35], v[64:67], a[144:151], v10
    v_smfmac_f32_16x16x64_bf16 v[36:39], v[64:67], a[152:159], v10
    v_add_f32 v24, v24, v26
    v_add_f32 v25, v25, v27
    v_add_f32 v28, v28, v30
    v_add_f32 v29, v29, v31
    v_smfmac_f32_16x16x64_bf16 v[32:35], v[68:71], a[160:167], v10
    v_smfmac_f32_16x16x64_bf16 v[36:39], v[68:71], a[168:175], v10
    v_cvt_pk_bf16_f32 v40, v24, v28
    v_cvt_pk_bf16_f32 v41, v25, v29
    v_smfmac_f32_16x16x64_bf16 v[32:35], v[72:75], a[176:183], v10
    v_smfmac_f32_16x16x64_bf16 v[36:39], v[72:75], a[184:191], v10
    ds_write2_b32 v11, v40, v41 offset0:0 offset1:4
    v_smfmac_f32_16x16x64_bf16 v[32:35], v[76:79], a[192:199], v10
    v_smfmac_f32_16x16x64_bf16 v[36:39], v[76:79], a[200:207], v10
    v_smfmac_f32_16x16x64_bf16 v[32:35], v[80:83], a[208:215], v10
    v_smfmac_f32_16x16x64_bf16 v[36:39], v[80:83], a[216:223], v10
    v_smfmac_f32_16x16x64_bf16 v[32:35], v[84:87], a[224:231], v10
    v_smfmac_f32_16x16x64_bf16 v[36:39], v[84:87], a[232:239], v10
    v_smfmac_f32_16x16x64_bf16 v[32:35], v[88:91], a[240:247], v10
    v_smfmac_f32_16x16x64_bf16 v[36:39], v[88:91], a[248:255], v10
    s_nop 3
    v_add_f32 v32, v32, v34
    v_add_f32 v33, v33, v35
    s_nop 1
    v_add_f32 v36, v36, v38
    v_add_f32 v37, v37, v39
    v_cvt_pk_bf16_f32 v42, v32, v33
    v_cvt_pk_bf16_f32 v43, v36, v37
    ds_write_b64 v9, v[42:43]
    v_add_u32 v9, s68, v8
    s_waitcnt lgkmcnt(0)
    s_barrier
    ds_read_b128 v[76:79], v8 offset:8192
    ds_read_b128 v[80:83], v8 offset:9216
    ds_read_b128 v[84:87], v8 offset:10240
    ds_read_b128 v[88:91], v8 offset:11264
    ds_read_b128 v[36:39], v9 offset:12288
    s_waitcnt lgkmcnt(4)
    v_mfma_f32_16x16x32_bf16 v[108:111], v[76:79], v[44:47], 0
    s_waitcnt lgkmcnt(3)
    v_mfma_f32_16x16x32_bf16 v[108:111], v[80:83], v[48:51], v[108:111]
    s_waitcnt lgkmcnt(2)
    v_mfma_f32_16x16x32_bf16 v[108:111], v[84:87], v[52:55], v[108:111]
    s_waitcnt lgkmcnt(1)
    v_mfma_f32_16x16x32_bf16 v[108:111], v[88:91], v[56:59], v[108:111]
    s_nop 7
    v_cvt_pk_bf16_f32 v60, v108, v109
    v_lshlrev_b32 v108, 16, v60
    v_and_b32 v109, 0xffff0000, v60
    v_mul_f32 v108, s94, v108
    v_mul_f32 v109, s94, v109
    v_cvt_pk_bf16_f32 v60, v108, v109
    v_lshlrev_b32 v108, 16, v60
    v_and_b32 v109, 0xffff0000, v60
    v_max3_f32 v62, v108, v109, v14
    v_mov_b32 v63, v62
    s_nop 1
    v_permlane32_swap_b32 v62, v63
    v_max_f32 v62, v62, v63
    v_mov_b32 v63, v62
    s_nop 1
    v_permlane16_swap_b32 v62, v63
    v_max_f32 v62, v62, v63
    v_sub_f32 v108, v108, v62
    v_mul_f32 v108, 0x3fb8aa3b, v108
    v_exp_f32 v108, v108
    v_sub_f32 v109, v109, v62
    v_mul_f32 v109, 0x3fb8aa3b, v109
    v_exp_f32 v109, v109
    v_sub_f32 v14, v14, v62
    v_mul_f32 v14, 0x3fb8aa3b, v14
    v_exp_f32 v14, v14
    v_add_f32 v64, v108, v109
    v_mov_b32 v63, v64
    s_nop 1
    v_permlane32_swap_b32 v64, v63
    v_add_f32 v64, v64, v63
    v_mov_b32 v63, v64
    s_nop 1
    v_permlane16_swap_b32 v64, v63
    v_add_f32 v64, v64, v63
    v_fmac_f32 v64, v14, v15
    v_rcp_f32 v64, v64
    s_nop 0
    v_mul_f32 v14, v14, v64
    v_mul_f32 v112, v112, v14
    v_mul_f32 v113, v113, v14
    v_mul_f32 v114, v114, v14
    v_mul_f32 v115, v115, v14
    v_mul_f32 v116, v116, v14
    v_mul_f32 v117, v117, v14
    v_mul_f32 v118, v118, v14
    v_mul_f32 v119, v119, v14
    v_mul_f32 v108, v108, v64
    v_mul_f32 v109, v109, v64
    v_cvt_pk_bf16_f32 v68, v112, v113
    v_cvt_pk_bf16_f32 v69, v114, v115
    v_cvt_pk_bf16_f32 v70, v116, v117
    v_cvt_pk_bf16_f32 v71, v118, v119
    v_cvt_pk_bf16_f32 v72, v108, v109
    v_mov_b32 v73, 0
    v_mov_b32 v74, 0
    v_mov_b32 v75, v72
    s_waitcnt lgkmcnt(0)
    v_mfma_f32_16x16x32_bf16 v[76:79], v[92:95], v[68:71], 0
    v_mfma_f32_16x16x32_bf16 v[80:83], v[96:99], v[68:71], 0
    v_mfma_f32_16x16x32_bf16 v[84:87], v[100:103], v[68:71], 0
    v_mfma_f32_16x16x32_bf16 v[88:91], v[104:107], v[68:71], 0
    v_mfma_f32_16x16x16_bf16 v[76:79], v[36:37], v[72:73], v[76:79]
    v_mfma_f32_16x16x16_bf16 v[80:83], v[36:37], v[74:75], v[80:83]
    v_mfma_f32_16x16x16_bf16 v[84:87], v[38:39], v[72:73], v[84:87]
    v_mfma_f32_16x16x16_bf16 v[88:91], v[38:39], v[74:75], v[88:91]
    s_lshl_b32 s68, s67, 1
    s_add_u32 s68, s68, s92
    s_lshl_b32 s68, s68, 5
    s_add_u32 s68, s68, s64
    s_lshl_b32 s68, s68, 1
    s_add_u32 s68, s68, s93
    s_lshl_b32 s68, s68, 11
    s_add_u32 s68, s68, 0x1a00000
    s_cmp_lt_u32 s67, 56
    s_cbranch_scc1 H_of
    v_cvt_pk_bf16_f32 v44, v76, v77
    v_cvt_pk_bf16_f32 v46, v78, v79
    v_cvt_pk_bf16_f32 v45, v80, v81
    v_cvt_pk_bf16_f32 v47, v82, v83
    v_cvt_pk_bf16_f32 v48, v84, v85
    v_cvt_pk_bf16_f32 v50, v86, v87
    v_cvt_pk_bf16_f32 v49, v88, v89
    v_cvt_pk_bf16_f32 v51, v90, v91
    v_permlane16_swap_b32 v45, v47
    v_permlane16_swap_b32 v44, v46
    v_min_u32 v47, -2, v47
    buffer_store_dwordx4 v[44:47], v13, s[8:11], s68 offen offset:0 sc1
    v_permlane16_swap_b32 v49, v51
    v_permlane16_swap_b32 v48, v50
    v_min_u32 v51, -2, v51
    buffer_store_dwordx4 v[48:51], v13, s[8:11], s68 offen offset:512 sc1
    s_branch H_og
H_of:
    v_cvt_pk_bf16_f32 v47, v82, v83
    v_cvt_pk_bf16_f32 v44, v76, v77
    v_cvt_pk_bf16_f32 v45, v78, v79
    v_cvt_pk_bf16_f32 v46, v80, v81
    v_min_u32 v47, -2, v47
    buffer_store_dwordx4 v[44:47], v2, s[8:11], s68 offen offset:0 sc1
    v_cvt_pk_bf16_f32 v51, v90, v91
    v_cvt_pk_bf16_f32 v48, v84, v85
    v_cvt_pk_bf16_f32 v49, v86, v87
    v_cvt_pk_bf16_f32 v50, v88, v89
    v_min_u32 v51, -2, v51
    buffer_store_dwordx4 v[48:51], v2, s[8:11], s68 offen offset:1024 sc1
H_og:
    s_waitcnt vmcnt(0)
    s_barrier
    s_cmp_lg_u32 s60, 0
    s_cbranch_scc1 H_next
    s_sub_u32 s68, s66, 1
    v_mov_b32 v8, s68
    s_mov_b64 exec, 1
    buffer_store_dword v8, v1, s[8:11], s72 offen offset:4 sc1
    s_mov_b64 exec, -1
H_next:
    s_add_u32 s66, s66, 1
    s_cmp_lt_u32 s66, 18
    s_cbranch_scc1 H_loop
    s_cmp_gt_u32 s63, 400000
    s_cbranch_scc0 fin_22
    v_mov_b32 v1, 0
    v_mov_b32 v3, s61
    v_add_u32 v3, 1000, v3
    buffer_store_dword v3, v1, s[12:15], 0 offen offset:200 sc1
fin_22:
    s_endpgm
L_chain:
    v_and_b32 v36, 7, v0
    v_lshlrev_b32 v36, 4, v36
    v_and_b32 v37, 32, v0
    v_xor_b32 v36, v36, v37
    v_lshrrev_b32 v37, 3, v0
    v_lshl_add_u32 v16, v37, 13, v36
    v_xor_b32 v17, 64, v16
    s_lshl_b32 s76, s60, 15
    s_and_b32 s66, s60, 1
    s_lshl_b32 s68, s66, 21
    s_lshr_b32 s66, s60, 1
    s_mul_i32 s66, s66, 0x40080
    s_add_u32 s68, s68, s66
    s_lshl_b32 s66, s61, 8
    s_add_u32 s68, s68, s66
    s_xor_b32 s70, s68, 0x40000
    s_add_u32 m0, s76, 0
    s_add_u32 s65, s70, 0x80000
    buffer_load_dwordx4 v16, s[24:27], s65 offen lds
    s_add_u32 m0, s76, 1024
    s_add_u32 s65, s70, 0x90000
    buffer_load_dwordx4 v16, s[24:27], s65 offen lds
    s_add_u32 m0, s76, 2048
    s_add_u32 s65, s70, 0xa0000
    buffer_load_dwordx4 v17, s[24:27], s65 offen lds
    s_add_u32 m0, s76, 3072
    s_add_u32 s65, s70, 0xb0000
    buffer_load_dwordx4 v17, s[24:27], s65 offen lds
    s_add_u32 m0, s76, 4096
    s_add_u32 s65, s70, 0x180000
    buffer_load_dwordx4 v16, s[24:27], s65 offen lds
    s_add_u32 m0, s76, 5120
    s_add_u32 s65, s70, 0x190000
    buffer_load_dwordx4 v16, s[24:27], s65 offen lds
    s_add_u32 m0, s76, 6144
    s_add_u32 s65, s70, 0x1a0000
    buffer_load_dwordx4 v17, s[24:27], s65 offen lds
    s_add_u32 m0, s76, 7168
    s_add_u32 s65, s70, 0x1b0000
    buffer_load_dwordx4 v17, s[24:27], s65 offen lds
    s_add_u32 m0, s76, 8192
    s_add_u32 s65, s68, 0x80000
    buffer_load_dwordx4 v16, s[32:35], s65 offen lds
    s_add_u32 m0, s76, 9216
    s_add_u32 s65, s68, 0x90000
    buffer_load_dwordx4 v16, s[32:35], s65 offen lds
    s_add_u32 m0, s76, 10240
    s_add_u32 s65, s68, 0xa0000
    buffer_load_dwordx4 v17, s[32:35], s65 offen lds
    s_add_u32 m0, s76, 11264
    s_add_u32 s65, s68, 0xb0000
    buffer_load_dwordx4 v17, s[32:35], s65 offen lds
    s_add_u32 m0, s76, 12288
    s_add_u32 s65, s68, 0x180000
    buffer_load_dwordx4 v16, s[32:35], s65 offen lds
    s_add_u32 m0, s76, 13312
    s_add_u32 s65, s68, 0x190000
    buffer_load_dwordx4 v16, s[32:35], s65 offen lds
    s_add_u32 m0, s76, 14336
    s_add_u32 s65, s68, 0x1a0000
    buffer_load_dwordx4 v17, s[32:35], s65 offen lds
    s_add_u32 m0, s76, 15360
    s_add_u32 s65, s68, 0x1b0000
    buffer_load_dwordx4 v17, s[32:35], s65 offen lds
    s_add_u32 m0, s76, 16384
    s_add_u32 s65, s70, 0x80000
    buffer_load_dwordx4 v16, s[28:31], s65 offen lds
    s_add_u32 m0, s76, 17408
    s_add_u32 s65, s70, 0x90000
    buffer_load_dwordx4 v16, s[28:31], s65 offen lds
    s_add_u32 m0, s76, 18432
    s_add_u32 s65, s70, 0xa0000
    buffer_load_dwordx4 v17, s[28:31], s65 offen lds
    s_add_u32 m0, s76, 19456
    s_add_u32 s65, s70, 0xb0000
    buffer_load_dwordx4 v17, s[28:31], s65 offen lds
    s_add_u32 m0, s76, 20480
    s_add_u32 s65, s70, 0x180000
    buffer_load_dwordx4 v16, s[28:31], s65 offen lds
    s_add_u32 m0, s76, 21504
    s_add_u32 s65, s70, 0x190000
    buffer_load_dwordx4 v16, s[28:31], s65 offen lds
    s_add_u32 m0, s76, 22528
    s_add_u32 s65, s70, 0x1a0000
    buffer_load_dwordx4 v17, s[28:31], s65 offen lds
    s_add_u32 m0, s76, 23552
    s_add_u32 s65, s70, 0x1b0000
    buffer_load_dwordx4 v17, s[28:31], s65 offen lds
    v_mov_b32 v32, v0
    v_mov_b32 v33, 0
    v_and_b32 v34, 15, v32
    v_lshrrev_b32 v35, 4, v32
    v_lshlrev_b32 v38, 4, v32
    v_add_u32 v0, 0x20000, v38
    s_lshl_b32 s65, s60, 15
    v_add_u32 v1, s65, v38
    v_mov_b32 v12, -1
    v_mov_b32 v13, -1
    v_mov_b32 v14, -1
    v_mov_b32 v15, -1
    v_and_b32 v37, 3, v32
    v_lshlrev_b32 v6, 4, v35
    v_lshl_add_u32 v6, v37, 2, v6
    s_lshl_b32 s65, s60, 11
    s_lshr_b32 s66, s61, 3
    s_lshl_b32 s66, s66, 9
    s_add_u32 s65, s65, s66
    s_and_b32 s66, s61, 1
    s_lshl_b32 s66, s66, 8
    s_add_u32 s65, s65, s66
    s_bfe_u32 s66, s61, 0x20001
    s_lshl_b32 s67, s66, 6
    s_add_u32 s65, s65, s67
    v_add_u32 v6, s65, v6
    v_and_b32 v36, 1, v35
    v_lshlrev_b32 v36, 10, v36
    v_lshl_add_u32 v36, v37, 2, v36
    v_lshrrev_b32 v37, 1, v35
    v_lshl_add_u32 v36, v37, 1, v36
    s_lshl_b32 s65, s66, 11
    s_lshr_b32 s66, s61, 3
    s_lshl_b32 s66, s66, 8
    s_add_u32 s65, s65, s66
    s_lshl_b32 s66, s60, 6
    s_add_u32 s65, s65, s66
    s_and_b32 s66, s61, 1
    s_lshl_b32 s66, s66, 4
    s_add_u32 s65, s65, s66
    v_add_u32 v11, s65, v36
    s_lshl_b32 s5, s61, 11
    s_lshl_b32 s65, s60, 16
    s_add_u32 s5, s5, s65
    s_sub_u32 s5, s5, 0x20000
    buffer_load_ushort v9, v11, s[20:23], 0 offen
    buffer_load_ushort v10, v11, s[20:23], 0 offen offset:32
    s_mov_b32 s85, 0xe7f80
    s_lshl_b32 s91, s61, 2
    s_add_u32 s91, s91, 0xe7f80
    s_mov_b32 s96, 0
    v_and_b32 v36, 7, v32
    v_lshlrev_b32 v36, 4, v36
    v_and_b32 v37, 32, v32
    v_xor_b32 v36, v36, v37
    v_lshrrev_b32 v37, 3, v32
    v_lshl_add_u32 v16, v37, 13, v36
    v_xor_b32 v17, 64, v16
    v_lshl_add_u32 v18, v37, 10, v36
    v_xor_b32 v19, 64, v18
    s_lshl_b32 s76, s60, 15
    s_xor_b32 s65, s60, 0
    s_and_b32 s66, s65, 1
    s_lshl_b32 s68, s66, 21
    s_lshr_b32 s66, s65, 1
    s_lshl_b32 s66, s66, 18
    s_add_u32 s68, s68, s66
    s_lshl_b32 s66, s61, 8
    s_add_u32 s68, s68, s66
    s_lshr_b32 s66, s60, 1
    s_lshl_b32 s66, s66, 7
    s_add_u32 s68, s68, s66
    s_lshl_b32 s72, s65, 15
    s_lshl_b32 s66, s61, 17
    s_add_u32 s72, s72, s66
    s_lshl_b32 s66, s60, 8
    s_add_u32 s72, s72, s66
    s_xor_b32 s65, s60, 1
    s_and_b32 s66, s65, 1
    s_lshl_b32 s69, s66, 21
    s_lshr_b32 s66, s65, 1
    s_lshl_b32 s66, s66, 18
    s_add_u32 s69, s69, s66
    s_lshl_b32 s66, s61, 8
    s_add_u32 s69, s69, s66
    s_lshr_b32 s66, s60, 1
    s_lshl_b32 s66, s66, 7
    s_add_u32 s69, s69, s66
    s_lshl_b32 s73, s65, 15
    s_lshl_b32 s66, s61, 17
    s_add_u32 s73, s73, s66
    s_lshl_b32 s66, s60, 8
    s_add_u32 s73, s73, s66
    s_xor_b32 s65, s60, 2
    s_and_b32 s66, s65, 1
    s_lshl_b32 s70, s66, 21
    s_lshr_b32 s66, s65, 1
    s_lshl_b32 s66, s66, 18
    s_add_u32 s70, s70, s66
    s_lshl_b32 s66, s61, 8
    s_add_u32 s70, s70, s66
    s_lshr_b32 s66, s60, 1
    s_lshl_b32 s66, s66, 7
    s_add_u32 s70, s70, s66
    s_lshl_b32 s74, s65, 15
    s_lshl_b32 s66, s61, 17
    s_add_u32 s74, s74, s66
    s_lshl_b32 s66, s60, 8
    s_add_u32 s74, s74, s66
    s_xor_b32 s65, s60, 3
    s_and_b32 s66, s65, 1
    s_lshl_b32 s71, s66, 21
    s_lshr_b32 s66, s65, 1
    s_lshl_b32 s66, s66, 18
    s_add_u32 s71, s71, s66
    s_lshl_b32 s66, s61, 8
    s_add_u32 s71, s71, s66
    s_lshr_b32 s66, s60, 1
    s_lshl_b32 s66, s66, 7
    s_add_u32 s71, s71, s66
    s_lshl_b32 s75, s65, 15
    s_lshl_b32 s66, s61, 17
    s_add_u32 s75, s75, s66
    s_lshl_b32 s66, s60, 8
    s_add_u32 s75, s75, s66
    s_lshl_b32 s97, s61, 9
    s_add_u32 s97, s97, 4096
    s_and_b32 s66, s60, 1
    s_lshl_b32 s66, s66, 6
    s_add_u32 s66, s66, s76
    v_and_b32 v20, 3, v32
    v_lshlrev_b32 v20, 3, v20
    v_bfe_u32 v36, v32, 2, 1
    v_mul_u32_u24 v36, 2112, v36
    v_xor_b32 v20, v20, v36
    v_bfe_u32 v36, v32, 3, 1
    v_mul_u32_u24 v36, 128, v36
    v_xor_b32 v20, v20, v36
    v_bfe_u32 v36, v32, 4, 1
    v_mul_u32_u24 v36, 544, v36
    v_xor_b32 v20, v20, v36
    v_bfe_u32 v36, v32, 5, 1
    v_mul_u32_u24 v36, 1024, v36
    v_xor_b32 v20, v20, v36
    v_xor_b32 v20, s66, v20
    v_xor_b32 v21, 32, v20
    v_xor_b32 v22, 0x8000, v20
    v_xor_b32 v23, 0x8020, v20
    v_and_b32 v26, 3, v32
    v_lshlrev_b32 v26, 3, v26
    v_bfe_u32 v36, v32, 2, 1
    v_mul_u32_u24 v36, 128, v36
    v_xor_b32 v26, v26, v36
    v_bfe_u32 v36, v32, 3, 1
    v_mul_u32_u24 v36, 32, v36
    v_xor_b32 v26, v26, v36
    v_bfe_u32 v36, v32, 4, 1
    v_mul_u32_u24 v36, 2112, v36
    v_xor_b32 v26, v26, v36
    v_bfe_u32 v36, v32, 5, 1
    v_mul_u32_u24 v36, 544, v36
    v_xor_b32 v26, v26, v36
    v_xor_b32 v26, s76, v26
    v_xor_b32 v27, 64, v26
    v_lshlrev_b32 v43, 2, v38
    s_add_u32 s65, s5, 0x20000
    s_lshl_b32 s66, s60, 13
    s_and_b32 s67, s61, 3
    s_lshl_b32 s67, s67, 11
    s_add_u32 s66, s66, s67
    v_mov_b32 v42, s65
    v_mov_b32 v36, s66
    v_cmp_eq_u32 vcc, 3, v35
    s_nop 1
    v_cndmask_b32 v42, v42, v36, vcc
    v_lshl_add_u32 v42, v35, 18, v42
    v_lshl_add_u32 v42, v34, 7, v42
    s_cmp_lg_u32 s60, 0
    s_cbranch_scc1 tc_23x
    s_call_b64 s[80:81], C_cal
    s_mov_b32 s87, s77
    s_mov_b32 s86, s40
    s_cmp_lg_u32 s61, 0
    s_cbranch_scc1 tc_23x
    s_add_u32 s66, s86, 1050
    v_mov_b32 v36, s66
    buffer_store_dword v36, v33, s[12:15], 0 offen offset:196 sc1
    s_branch tc_23x
.p2align 6
C_cal:
    s_setprio 3
    s_mov_b32 s96, 0
tc_23:
    s_memtime s[82:83]
    s_memrealtime s[40:41]
    s_nop 0
    s_memrealtime s[42:43]
    s_nop 0
    s_memrealtime s[44:45]
    s_nop 0
    s_memrealtime s[46:47]
    s_nop 0
    s_memrealtime s[48:49]
    s_nop 0
    s_memrealtime s[50:51]
    s_nop 0
    s_memrealtime s[52:53]
    s_nop 0
    s_memrealtime s[54:55]
    s_nop 0
    s_memrealtime s[56:57]
    s_nop 0
    s_memrealtime s[58:59]
    s_nop 0
    s_memrealtime s[16:17]
    s_nop 0
    s_memrealtime s[18:19]
    s_nop 0
    s_memrealtime s[88:89]
    s_nop 0
    s_memrealtime s[100:101]
    s_nop 0
    s_memtime s[98:99]
    s_mov_b32 s77, 0
    s_add_u32 s96, s96, 1
    s_waitcnt lgkmcnt(0)
    s_cmp_eq_u32 s42, s40
    s_addc_u32 s77, s77, 0
    s_cmp_eq_u32 s44, s40
    s_addc_u32 s77, s77, 0
    s_cmp_eq_u32 s46, s40
    s_addc_u32 s77, s77, 0
    s_cmp_eq_u32 s48, s40
    s_addc_u32 s77, s77, 0
    s_cmp_eq_u32 s50, s40
    s_addc_u32 s77, s77, 0
    s_cmp_eq_u32 s52, s40
    s_addc_u32 s77, s77, 0
    s_cmp_eq_u32 s54, s40
    s_addc_u32 s77, s77, 0
    s_cmp_eq_u32 s56, s40
    s_addc_u32 s77, s77, 0
    s_cmp_eq_u32 s58, s40
    s_addc_u32 s77, s77, 0
    s_cmp_eq_u32 s16, s40
    s_addc_u32 s77, s77, 0
    s_cmp_eq_u32 s18, s40
    s_addc_u32 s77, s77, 0
    s_cmp_eq_u32 s88, s40
    s_addc_u32 s77, s77, 0
    s_cmp_eq_u32 s100, s40
    s_addc_u32 s77, s77, 0
    s_cmp_gt_u32 s96, 4
    s_cbranch_scc1 tc_23d
    s_sub_u32 s84, s98, s82
    s_cmp_gt_u32 s84, 128
    s_cbranch_scc1 tc_23
tc_23d:
    s_setprio 0
    s_mul_i32 s77, s77, 8
    s_add_u32 s77, s77, s82
    s_setpc_b64 s[80:81]
tc_23x:
    s_waitcnt vmcnt(16) lgkmcnt(0)
    s_barrier
    s_add_u32 m0, s76, 24576
    s_add_u32 s65, s70, 0x80000
    buffer_load_dwordx4 v16, s[32:35], s65 offen lds
    s_add_u32 m0, s76, 25600
    s_add_u32 s65, s70, 0x90000
    buffer_load_dwordx4 v16, s[32:35], s65 offen lds
    s_add_u32 m0, s76, 26624
    s_add_u32 s65, s70, 0xa0000
    buffer_load_dwordx4 v17, s[32:35], s65 offen lds
    s_add_u32 m0, s76, 27648
    s_add_u32 s65, s70, 0xb0000
    buffer_load_dwordx4 v17, s[32:35], s65 offen lds
    s_add_u32 m0, s76, 28672
    s_add_u32 s65, s70, 0x180000
    buffer_load_dwordx4 v16, s[32:35], s65 offen lds
    s_add_u32 m0, s76, 29696
    s_add_u32 s65, s70, 0x190000
    buffer_load_dwordx4 v16, s[32:35], s65 offen lds
    s_add_u32 m0, s76, 30720
    s_add_u32 s65, s70, 0x1a0000
    buffer_load_dwordx4 v17, s[32:35], s65 offen lds
    s_add_u32 m0, s76, 31744
    s_add_u32 s65, s70, 0x1b0000
    buffer_load_dwordx4 v17, s[32:35], s65 offen lds
    ds_read_b64_tr_b16 v[192:193], v20 offset:0
    ds_read_b64_tr_b16 v[194:195], v20 offset:256
    ds_read_b64_tr_b16 v[196:197], v20 offset:4096
    ds_read_b64_tr_b16 v[198:199], v20 offset:4352
    ds_read_b64_tr_b16 v[200:201], v21 offset:0
    ds_read_b64_tr_b16 v[202:203], v21 offset:256
    ds_read_b64_tr_b16 v[204:205], v21 offset:4096
    ds_read_b64_tr_b16 v[206:207], v21 offset:4352
    ds_read_b64_tr_b16 v[208:209], v22 offset:0
    ds_read_b64_tr_b16 v[210:211], v22 offset:256
    ds_read_b64_tr_b16 v[212:213], v22 offset:4096
    ds_read_b64_tr_b16 v[214:215], v22 offset:4352
    ds_read_b64_tr_b16 v[216:217], v23 offset:0
    ds_read_b64_tr_b16 v[218:219], v23 offset:256
    ds_read_b64_tr_b16 v[220:221], v23 offset:4096
    ds_read_b64_tr_b16 v[222:223], v23 offset:4352
    s_waitcnt vmcnt(16) lgkmcnt(0)
    s_barrier
    s_add_u32 m0, s76, 0
    s_add_u32 s65, s68, 0x80000
    buffer_load_dwordx4 v16, s[24:27], s65 offen lds
    s_add_u32 m0, s76, 1024
    s_add_u32 s65, s68, 0x90000
    buffer_load_dwordx4 v16, s[24:27], s65 offen lds
    s_add_u32 m0, s76, 2048
    s_add_u32 s65, s68, 0xa0000
    buffer_load_dwordx4 v17, s[24:27], s65 offen lds
    s_add_u32 m0, s76, 3072
    s_add_u32 s65, s68, 0xb0000
    buffer_load_dwordx4 v17, s[24:27], s65 offen lds
    s_add_u32 m0, s76, 4096
    s_add_u32 s65, s68, 0x180000
    buffer_load_dwordx4 v16, s[24:27], s65 offen lds
    s_add_u32 m0, s76, 5120
    s_add_u32 s65, s68, 0x190000
    buffer_load_dwordx4 v16, s[24:27], s65 offen lds
    s_add_u32 m0, s76, 6144
    s_add_u32 s65, s68, 0x1a0000
    buffer_load_dwordx4 v17, s[24:27], s65 offen lds
    s_add_u32 m0, s76, 7168
    s_add_u32 s65, s68, 0x1b0000
    buffer_load_dwordx4 v17, s[24:27], s65 offen lds
    ds_read_b64_tr_b16 a[96:97], v20 offset:8192
    ds_read_b64_tr_b16 a[98:99], v20 offset:8448
    ds_read_b64_tr_b16 a[100:101], v20 offset:12288
    ds_read_b64_tr_b16 a[102:103], v20 offset:12544
    ds_read_b64_tr_b16 a[104:105], v21 offset:8192
    ds_read_b64_tr_b16 a[106:107], v21 offset:8448
    ds_read_b64_tr_b16 a[108:109], v21 offset:12288
    ds_read_b64_tr_b16 a[110:111], v21 offset:12544
    ds_read_b64_tr_b16 a[112:113], v22 offset:8192
    ds_read_b64_tr_b16 a[114:115], v22 offset:8448
    ds_read_b64_tr_b16 a[116:117], v22 offset:12288
    ds_read_b64_tr_b16 a[118:119], v22 offset:12544
    ds_read_b64_tr_b16 a[120:121], v23 offset:8192
    ds_read_b64_tr_b16 a[122:123], v23 offset:8448
    ds_read_b64_tr_b16 a[124:125], v23 offset:12288
    ds_read_b64_tr_b16 a[126:127], v23 offset:12544
    s_waitcnt vmcnt(16) lgkmcnt(0)
    s_barrier
    s_add_u32 m0, s76, 8192
    s_add_u32 s65, s72, 0x0
    buffer_load_dwordx4 v18, s[36:39], s65 offen lds
    s_add_u32 m0, s76, 9216
    s_add_u32 s65, s72, 0x2000
    buffer_load_dwordx4 v18, s[36:39], s65 offen lds
    s_add_u32 m0, s76, 10240
    s_add_u32 s65, s72, 0x4000
    buffer_load_dwordx4 v19, s[36:39], s65 offen lds
    s_add_u32 m0, s76, 11264
    s_add_u32 s65, s72, 0x6000
    buffer_load_dwordx4 v19, s[36:39], s65 offen lds
    s_add_u32 m0, s76, 12288
    s_add_u32 s65, s73, 0x0
    buffer_load_dwordx4 v18, s[36:39], s65 offen lds
    s_add_u32 m0, s76, 13312
    s_add_u32 s65, s73, 0x2000
    buffer_load_dwordx4 v18, s[36:39], s65 offen lds
    s_add_u32 m0, s76, 14336
    s_add_u32 s65, s73, 0x4000
    buffer_load_dwordx4 v19, s[36:39], s65 offen lds
    s_add_u32 m0, s76, 15360
    s_add_u32 s65, s73, 0x6000
    buffer_load_dwordx4 v19, s[36:39], s65 offen lds
    ds_read_b64_tr_b16 a[32:33], v20 offset:16384
    ds_read_b64_tr_b16 a[34:35], v20 offset:16640
    ds_read_b64_tr_b16 a[36:37], v20 offset:20480
    ds_read_b64_tr_b16 a[38:39], v20 offset:20736
    ds_read_b64_tr_b16 a[40:41], v21 offset:16384
    ds_read_b64_tr_b16 a[42:43], v21 offset:16640
    ds_read_b64_tr_b16 a[44:45], v21 offset:20480
    ds_read_b64_tr_b16 a[46:47], v21 offset:20736
    ds_read_b64_tr_b16 a[48:49], v22 offset:16384
    ds_read_b64_tr_b16 a[50:51], v22 offset:16640
    ds_read_b64_tr_b16 a[52:53], v22 offset:20480
    ds_read_b64_tr_b16 a[54:55], v22 offset:20736
    ds_read_b64_tr_b16 a[56:57], v23 offset:16384
    ds_read_b64_tr_b16 a[58:59], v23 offset:16640
    ds_read_b64_tr_b16 a[60:61], v23 offset:20480
    ds_read_b64_tr_b16 a[62:63], v23 offset:20736
    v_lshl_or_b32 v9, v10, 16, v9
    v_min_u32 v9, 0xffbfffff, v9
    s_mov_b32 s66, 0xe4000
    buffer_store_dword v9, v6, s[8:11], s66 offen sc1
    v_mov_b32 v24, v9
    s_waitcnt vmcnt(16) lgkmcnt(0)
    s_barrier
    s_add_u32 m0, s76, 16384
    s_add_u32 s65, s74, 0x0
    buffer_load_dwordx4 v18, s[36:39], s65 offen lds
    s_add_u32 m0, s76, 17408
    s_add_u32 s65, s74, 0x2000
    buffer_load_dwordx4 v18, s[36:39], s65 offen lds
    s_add_u32 m0, s76, 18432
    s_add_u32 s65, s74, 0x4000
    buffer_load_dwordx4 v19, s[36:39], s65 offen lds
    s_add_u32 m0, s76, 19456
    s_add_u32 s65, s74, 0x6000
    buffer_load_dwordx4 v19, s[36:39], s65 offen lds
    s_add_u32 m0, s76, 20480
    s_add_u32 s65, s75, 0x0
    buffer_load_dwordx4 v18, s[36:39], s65 offen lds
    s_add_u32 m0, s76, 21504
    s_add_u32 s65, s75, 0x2000
    buffer_load_dwordx4 v18, s[36:39], s65 offen lds
    s_add_u32 m0, s76, 22528
    s_add_u32 s65, s75, 0x4000
    buffer_load_dwordx4 v19, s[36:39], s65 offen lds
    s_add_u32 m0, s76, 23552
    s_add_u32 s65, s75, 0x6000
    buffer_load_dwordx4 v19, s[36:39], s65 offen lds
    ds_read_b64_tr_b16 a[128:129], v20 offset:24576
    ds_read_b64_tr_b16 a[130:131], v20 offset:24832
    ds_read_b64_tr_b16 a[132:133], v20 offset:28672
    ds_read_b64_tr_b16 a[134:135], v20 offset:28928
    ds_read_b64_tr_b16 a[136:137], v21 offset:24576
    ds_read_b64_tr_b16 a[138:139], v21 offset:24832
    ds_read_b64_tr_b16 a[140:141], v21 offset:28672
    ds_read_b64_tr_b16 a[142:143], v21 offset:28928
    ds_read_b64_tr_b16 a[144:145], v22 offset:24576
    ds_read_b64_tr_b16 a[146:147], v22 offset:24832
    ds_read_b64_tr_b16 a[148:149], v22 offset:28672
    ds_read_b64_tr_b16 a[150:151], v22 offset:28928
    ds_read_b64_tr_b16 a[152:153], v23 offset:24576
    ds_read_b64_tr_b16 a[154:155], v23 offset:24832
    ds_read_b64_tr_b16 a[156:157], v23 offset:28672
    ds_read_b64_tr_b16 a[158:159], v23 offset:28928
    s_waitcnt vmcnt(16) lgkmcnt(0)
    s_barrier
    s_add_u32 m0, s76, 24576
    s_add_u32 s65, s74, 0x80
    buffer_load_dwordx4 v18, s[36:39], s65 offen lds
    s_add_u32 m0, s76, 25600
    s_add_u32 s65, s74, 0x2080
    buffer_load_dwordx4 v18, s[36:39], s65 offen lds
    s_add_u32 m0, s76, 26624
    s_add_u32 s65, s74, 0x4080
    buffer_load_dwordx4 v19, s[36:39], s65 offen lds
    s_add_u32 m0, s76, 27648
    s_add_u32 s65, s74, 0x6080
    buffer_load_dwordx4 v19, s[36:39], s65 offen lds
    s_add_u32 m0, s76, 28672
    s_add_u32 s65, s75, 0x80
    buffer_load_dwordx4 v18, s[36:39], s65 offen lds
    s_add_u32 m0, s76, 29696
    s_add_u32 s65, s75, 0x2080
    buffer_load_dwordx4 v18, s[36:39], s65 offen lds
    s_add_u32 m0, s76, 30720
    s_add_u32 s65, s75, 0x4080
    buffer_load_dwordx4 v19, s[36:39], s65 offen lds
    s_add_u32 m0, s76, 31744
    s_add_u32 s65, s75, 0x6080
    buffer_load_dwordx4 v19, s[36:39], s65 offen lds
    ds_read_b64_tr_b16 v[160:161], v20 offset:0
    ds_read_b64_tr_b16 v[162:163], v20 offset:256
    ds_read_b64_tr_b16 v[164:165], v20 offset:4096
    ds_read_b64_tr_b16 v[166:167], v20 offset:4352
    ds_read_b64_tr_b16 v[168:169], v21 offset:0
    ds_read_b64_tr_b16 v[170:171], v21 offset:256
    ds_read_b64_tr_b16 v[172:173], v21 offset:4096
    ds_read_b64_tr_b16 v[174:175], v21 offset:4352
    ds_read_b64_tr_b16 v[176:177], v22 offset:0
    ds_read_b64_tr_b16 v[178:179], v22 offset:256
    ds_read_b64_tr_b16 v[180:181], v22 offset:4096
    ds_read_b64_tr_b16 v[182:183], v22 offset:4352
    ds_read_b64_tr_b16 v[184:185], v23 offset:0
    ds_read_b64_tr_b16 v[186:187], v23 offset:256
    ds_read_b64_tr_b16 v[188:189], v23 offset:4096
    ds_read_b64_tr_b16 v[190:191], v23 offset:4352
    s_cmp_lg_u32 s61, 2
    s_cbranch_scc1 pc_24x
    s_getpc_b64 s[82:83]
pc_24:
    s_add_u32 s82, s82, CF0_step-pc_24
    s_addc_u32 s83, s83, 0
    s_lshl_b32 s66, s60, 12
    v_add_u32 v36, s66, v43
    global_load_dword v10, v36, s[82:83]
pc_24x:
    s_waitcnt vmcnt(16) lgkmcnt(0)
    s_barrier
    s_add_u32 m0, s76, 0
    s_add_u32 s65, s70, 0x0
    buffer_load_dwordx4 v16, s[28:31], s65 offen lds
    s_add_u32 m0, s76, 1024
    s_add_u32 s65, s70, 0x10000
    buffer_load_dwordx4 v16, s[28:31], s65 offen lds
    s_add_u32 m0, s76, 2048
    s_add_u32 s65, s70, 0x20000
    buffer_load_dwordx4 v17, s[28:31], s65 offen lds
    s_add_u32 m0, s76, 3072
    s_add_u32 s65, s70, 0x30000
    buffer_load_dwordx4 v17, s[28:31], s65 offen lds
    s_add_u32 m0, s76, 4096
    s_add_u32 s65, s70, 0x100000
    buffer_load_dwordx4 v16, s[28:31], s65 offen lds
    s_add_u32 m0, s76, 5120
    s_add_u32 s65, s70, 0x110000
    buffer_load_dwordx4 v16, s[28:31], s65 offen lds
    s_add_u32 m0, s76, 6144
    s_add_u32 s65, s70, 0x120000
    buffer_load_dwordx4 v17, s[28:31], s65 offen lds
    s_add_u32 m0, s76, 7168
    s_add_u32 s65, s70, 0x130000
    buffer_load_dwordx4 v17, s[28:31], s65 offen lds
    ds_read_b64_tr_b16 a[160:161], v26 offset:8192
    ds_read_b64_tr_b16 a[162:163], v26 offset:8448
    ds_read_b64_tr_b16 a[164:165], v26 offset:9216
    ds_read_b64_tr_b16 a[166:167], v26 offset:9472
    ds_read_b64_tr_b16 a[168:169], v26 offset:12288
    ds_read_b64_tr_b16 a[170:171], v26 offset:12544
    ds_read_b64_tr_b16 a[172:173], v26 offset:13312
    ds_read_b64_tr_b16 a[174:175], v26 offset:13568
    ds_read_b64_tr_b16 a[176:177], v27 offset:8192
    ds_read_b64_tr_b16 a[178:179], v27 offset:8448
    ds_read_b64_tr_b16 a[180:181], v27 offset:9216
    ds_read_b64_tr_b16 a[182:183], v27 offset:9472
    ds_read_b64_tr_b16 a[184:185], v27 offset:12288
    ds_read_b64_tr_b16 a[186:187], v27 offset:12544
    ds_read_b64_tr_b16 a[188:189], v27 offset:13312
    ds_read_b64_tr_b16 a[190:191], v27 offset:13568
    s_cmp_eq_u32 s62, 3
    s_cselect_b32 s66, 4, 0x10004
    v_mov_b32 v36, s66
    s_cmp_eq_u32 s60, 0
    s_cselect_b64 exec, 1, 0
    buffer_atomic_add v36, v33, s[12:15], 0 offen offset:4 sc1
    s_mov_b64 exec, -1
    buffer_load_dword v41, v33, s[12:15], 0 offen offset:192 sc1
    s_cmp_lg_u32 s60, 0
    s_cbranch_scc1 C_ldx
    buffer_load_dword v45, v33, s[12:15], 0 offen offset:196 sc1
C_ldx:
    s_waitcnt vmcnt(16) lgkmcnt(0)
    s_barrier
    s_add_u32 m0, s76, 8192
    s_add_u32 s65, s68, 0x0
    buffer_load_dwordx4 v16, s[24:27], s65 offen lds
    s_add_u32 m0, s76, 9216
    s_add_u32 s65, s68, 0x10000
    buffer_load_dwordx4 v16, s[24:27], s65 offen lds
    s_add_u32 m0, s76, 10240
    s_add_u32 s65, s68, 0x20000
    buffer_load_dwordx4 v17, s[24:27], s65 offen lds
    s_add_u32 m0, s76, 11264
    s_add_u32 s65, s68, 0x30000
    buffer_load_dwordx4 v17, s[24:27], s65 offen lds
    s_add_u32 m0, s76, 12288
    s_add_u32 s65, s68, 0x100000
    buffer_load_dwordx4 v16, s[24:27], s65 offen lds
    s_add_u32 m0, s76, 13312
    s_add_u32 s65, s68, 0x110000
    buffer_load_dwordx4 v16, s[24:27], s65 offen lds
    s_add_u32 m0, s76, 14336
    s_add_u32 s65, s68, 0x120000
    buffer_load_dwordx4 v17, s[24:27], s65 offen lds
    s_add_u32 m0, s76, 15360
    s_add_u32 s65, s68, 0x130000
    buffer_load_dwordx4 v17, s[24:27], s65 offen lds
    ds_read_b64_tr_b16 a[192:193], v26 offset:16384
    ds_read_b64_tr_b16 a[194:195], v26 offset:16640
    ds_read_b64_tr_b16 a[196:197], v26 offset:17408
    ds_read_b64_tr_b16 a[198:199], v26 offset:17664
    ds_read_b64_tr_b16 a[200:201], v26 offset:20480
    ds_read_b64_tr_b16 a[202:203], v26 offset:20736
    ds_read_b64_tr_b16 a[204:205], v26 offset:21504
    ds_read_b64_tr_b16 a[206:207], v26 offset:21760
    ds_read_b64_tr_b16 a[208:209], v27 offset:16384
    ds_read_b64_tr_b16 a[210:211], v27 offset:16640
    ds_read_b64_tr_b16 a[212:213], v27 offset:17408
    ds_read_b64_tr_b16 a[214:215], v27 offset:17664
    ds_read_b64_tr_b16 a[216:217], v27 offset:20480
    ds_read_b64_tr_b16 a[218:219], v27 offset:20736
    ds_read_b64_tr_b16 a[220:221], v27 offset:21504
    ds_read_b64_tr_b16 a[222:223], v27 offset:21760
    s_waitcnt vmcnt(16) lgkmcnt(0)
    s_barrier
    s_add_u32 m0, s76, 16384
    s_add_u32 s65, s68, 0x0
    buffer_load_dwordx4 v16, s[28:31], s65 offen lds
    s_add_u32 m0, s76, 17408
    s_add_u32 s65, s68, 0x10000
    buffer_load_dwordx4 v16, s[28:31], s65 offen lds
    s_add_u32 m0, s76, 18432
    s_add_u32 s65, s68, 0x20000
    buffer_load_dwordx4 v17, s[28:31], s65 offen lds
    s_add_u32 m0, s76, 19456
    s_add_u32 s65, s68, 0x30000
    buffer_load_dwordx4 v17, s[28:31], s65 offen lds
    s_add_u32 m0, s76, 20480
    s_add_u32 s65, s68, 0x100000
    buffer_load_dwordx4 v16, s[28:31], s65 offen lds
    s_add_u32 m0, s76, 21504
    s_add_u32 s65, s68, 0x110000
    buffer_load_dwordx4 v16, s[28:31], s65 offen lds
    s_add_u32 m0, s76, 22528
    s_add_u32 s65, s68, 0x120000
    buffer_load_dwordx4 v17, s[28:31], s65 offen lds
    s_add_u32 m0, s76, 23552
    s_add_u32 s65, s68, 0x130000
    buffer_load_dwordx4 v17, s[28:31], s65 offen lds
    ds_read_b64_tr_b16 a[224:225], v26 offset:24576
    ds_read_b64_tr_b16 a[226:227], v26 offset:24832
    ds_read_b64_tr_b16 a[228:229], v26 offset:25600
    ds_read_b64_tr_b16 a[230:231], v26 offset:25856
    ds_read_b64_tr_b16 a[232:233], v26 offset:28672
    ds_read_b64_tr_b16 a[234:235], v26 offset:28928
    ds_read_b64_tr_b16 a[236:237], v26 offset:29696
    ds_read_b64_tr_b16 a[238:239], v26 offset:29952
    ds_read_b64_tr_b16 a[240:241], v27 offset:24576
    ds_read_b64_tr_b16 a[242:243], v27 offset:24832
    ds_read_b64_tr_b16 a[244:245], v27 offset:25600
    ds_read_b64_tr_b16 a[246:247], v27 offset:25856
    ds_read_b64_tr_b16 a[248:249], v27 offset:28672
    ds_read_b64_tr_b16 a[250:251], v27 offset:28928
    ds_read_b64_tr_b16 a[252:253], v27 offset:29696
    ds_read_b64_tr_b16 a[254:255], v27 offset:29952
    s_waitcnt vmcnt(16) lgkmcnt(0)
    s_barrier
    s_add_u32 m0, s76, 24576
    s_add_u32 s65, s68, 0x0
    buffer_load_dwordx4 v16, s[32:35], s65 offen lds
    s_add_u32 m0, s76, 25600
    s_add_u32 s65, s68, 0x10000
    buffer_load_dwordx4 v16, s[32:35], s65 offen lds
    s_add_u32 m0, s76, 26624
    s_add_u32 s65, s68, 0x20000
    buffer_load_dwordx4 v17, s[32:35], s65 offen lds
    s_add_u32 m0, s76, 27648
    s_add_u32 s65, s68, 0x30000
    buffer_load_dwordx4 v17, s[32:35], s65 offen lds
    s_add_u32 m0, s76, 28672
    s_add_u32 s65, s68, 0x100000
    buffer_load_dwordx4 v16, s[32:35], s65 offen lds
    s_add_u32 m0, s76, 29696
    s_add_u32 s65, s68, 0x110000
    buffer_load_dwordx4 v16, s[32:35], s65 offen lds
    s_add_u32 m0, s76, 30720
    s_add_u32 s65, s68, 0x120000
    buffer_load_dwordx4 v17, s[32:35], s65 offen lds
    s_add_u32 m0, s76, 31744
    s_add_u32 s65, s68, 0x130000
    buffer_load_dwordx4 v17, s[32:35], s65 offen lds
    ds_read_b64_tr_b16 v[240:241], v20 offset:0
    ds_read_b64_tr_b16 v[242:243], v20 offset:256
    ds_read_b64_tr_b16 v[244:245], v20 offset:4096
    ds_read_b64_tr_b16 v[246:247], v20 offset:4352
    ds_read_b64_tr_b16 v[248:249], v21 offset:0
    ds_read_b64_tr_b16 v[250:251], v21 offset:256
    ds_read_b64_tr_b16 v[252:253], v21 offset:4096
    ds_read_b64_tr_b16 v[254:255], v21 offset:4352
    ds_read_b64_tr_b16 a[0:1], v22 offset:0
    ds_read_b64_tr_b16 a[2:3], v22 offset:256
    ds_read_b64_tr_b16 a[4:5], v22 offset:4096
    ds_read_b64_tr_b16 a[6:7], v22 offset:4352
    ds_read_b64_tr_b16 a[8:9], v23 offset:0
    ds_read_b64_tr_b16 a[10:11], v23 offset:256
    ds_read_b64_tr_b16 a[12:13], v23 offset:4096
    ds_read_b64_tr_b16 a[14:15], v23 offset:4352
    s_cmp_lg_u32 s60, 0
    s_cbranch_scc1 tc_25x
    s_call_b64 s[80:81], C_cal
    s_mov_b32 s87, s77
    s_mov_b32 s86, s40
tc_25x:
    s_mov_b32 s79, 0
    s_waitcnt vmcnt(16) lgkmcnt(0)
    s_barrier
    s_add_u32 m0, s76, 0
    s_add_u32 s65, s70, 0x0
    buffer_load_dwordx4 v16, s[24:27], s65 offen lds
    s_add_u32 m0, s76, 1024
    s_add_u32 s65, s70, 0x10000
    buffer_load_dwordx4 v16, s[24:27], s65 offen lds
    s_add_u32 m0, s76, 2048
    s_add_u32 s65, s70, 0x20000
    buffer_load_dwordx4 v17, s[24:27], s65 offen lds
    s_add_u32 m0, s76, 3072
    s_add_u32 s65, s70, 0x30000
    buffer_load_dwordx4 v17, s[24:27], s65 offen lds
    s_add_u32 m0, s76, 4096
    s_add_u32 s65, s70, 0x100000
    buffer_load_dwordx4 v16, s[24:27], s65 offen lds
    s_add_u32 m0, s76, 5120
    s_add_u32 s65, s70, 0x110000
    buffer_load_dwordx4 v16, s[24:27], s65 offen lds
    s_add_u32 m0, s76, 6144
    s_add_u32 s65, s70, 0x120000
    buffer_load_dwordx4 v17, s[24:27], s65 offen lds
    s_add_u32 m0, s76, 7168
    s_add_u32 s65, s70, 0x130000
    buffer_load_dwordx4 v17, s[24:27], s65 offen lds
    ds_read_b64_tr_b16 v[48:49], v20 offset:8192
    ds_read_b64_tr_b16 v[50:51], v20 offset:8448
    ds_read_b64_tr_b16 v[52:53], v20 offset:12288
    ds_read_b64_tr_b16 v[54:55], v20 offset:12544
    ds_read_b64_tr_b16 v[56:57], v21 offset:8192
    ds_read_b64_tr_b16 v[58:59], v21 offset:8448
    ds_read_b64_tr_b16 v[60:61], v21 offset:12288
    ds_read_b64_tr_b16 v[62:63], v21 offset:12544
    ds_read_b64_tr_b16 v[128:129], v22 offset:8192
    ds_read_b64_tr_b16 v[130:131], v22 offset:8448
    ds_read_b64_tr_b16 v[132:133], v22 offset:12288
    ds_read_b64_tr_b16 v[134:135], v22 offset:12544
    ds_read_b64_tr_b16 v[136:137], v23 offset:8192
    ds_read_b64_tr_b16 v[138:139], v23 offset:8448
    ds_read_b64_tr_b16 v[140:141], v23 offset:12288
    ds_read_b64_tr_b16 v[142:143], v23 offset:12544
    s_or_b32 s66, s79, s60
    s_cbranch_scc1 bk_26x
    s_memrealtime s[82:83]
    v_readfirstlane_b32 s66, v45
    s_waitcnt lgkmcnt(0)
    s_sub_u32 s66, s66, s82
    s_cmp_gt_i32 s66, 150
    s_cbranch_scc1 bk_26x
    s_call_b64 s[80:81], C_cal
    v_readfirstlane_b32 s66, v45
    s_nop 0
    s_sub_u32 s66, s40, s66
    s_cmp_gt_i32 s66, 0
    s_cbranch_scc1 bk_26b
    s_mov_b32 s86, s40
    s_mov_b32 s87, s77
    s_branch bk_26x
bk_26b:
    s_mov_b32 s88, s40
    s_mov_b32 s89, s77
    s_mov_b32 s79, 1
bk_26x:
    s_waitcnt vmcnt(16) lgkmcnt(0)
    s_barrier
    s_add_u32 m0, s76, 8192
    s_add_u32 s65, s70, 0x0
    buffer_load_dwordx4 v16, s[32:35], s65 offen lds
    s_add_u32 m0, s76, 9216
    s_add_u32 s65, s70, 0x10000
    buffer_load_dwordx4 v16, s[32:35], s65 offen lds
    s_add_u32 m0, s76, 10240
    s_add_u32 s65, s70, 0x20000
    buffer_load_dwordx4 v17, s[32:35], s65 offen lds
    s_add_u32 m0, s76, 11264
    s_add_u32 s65, s70, 0x30000
    buffer_load_dwordx4 v17, s[32:35], s65 offen lds
    s_add_u32 m0, s76, 12288
    s_add_u32 s65, s70, 0x100000
    buffer_load_dwordx4 v16, s[32:35], s65 offen lds
    s_add_u32 m0, s76, 13312
    s_add_u32 s65, s70, 0x110000
    buffer_load_dwordx4 v16, s[32:35], s65 offen lds
    s_add_u32 m0, s76, 14336
    s_add_u32 s65, s70, 0x120000
    buffer_load_dwordx4 v17, s[32:35], s65 offen lds
    s_add_u32 m0, s76, 15360
    s_add_u32 s65, s70, 0x130000
    buffer_load_dwordx4 v17, s[32:35], s65 offen lds
    ds_read_b64_tr_b16 v[64:65], v20 offset:16384
    ds_read_b64_tr_b16 v[66:67], v20 offset:16640
    ds_read_b64_tr_b16 v[68:69], v20 offset:20480
    ds_read_b64_tr_b16 v[70:71], v20 offset:20736
    ds_read_b64_tr_b16 v[72:73], v21 offset:16384
    ds_read_b64_tr_b16 v[74:75], v21 offset:16640
    ds_read_b64_tr_b16 v[76:77], v21 offset:20480
    ds_read_b64_tr_b16 v[78:79], v21 offset:20736
    ds_read_b64_tr_b16 v[224:225], v22 offset:16384
    ds_read_b64_tr_b16 v[226:227], v22 offset:16640
    ds_read_b64_tr_b16 v[228:229], v22 offset:20480
    ds_read_b64_tr_b16 v[230:231], v22 offset:20736
    ds_read_b64_tr_b16 v[232:233], v23 offset:16384
    ds_read_b64_tr_b16 v[234:235], v23 offset:16640
    ds_read_b64_tr_b16 v[236:237], v23 offset:20480
    ds_read_b64_tr_b16 v[238:239], v23 offset:20736
    s_or_b32 s66, s79, s60
    s_cbranch_scc1 bk_27x
    s_memrealtime s[82:83]
    v_readfirstlane_b32 s66, v45
    s_waitcnt lgkmcnt(0)
    s_sub_u32 s66, s66, s82
    s_cmp_gt_i32 s66, 150
    s_cbranch_scc1 bk_27x
    s_call_b64 s[80:81], C_cal
    v_readfirstlane_b32 s66, v45
    s_nop 0
    s_sub_u32 s66, s40, s66
    s_cmp_gt_i32 s66, 0
    s_cbranch_scc1 bk_27b
    s_mov_b32 s86, s40
    s_mov_b32 s87, s77
    s_branch bk_27x
bk_27b:
    s_mov_b32 s88, s40
    s_mov_b32 s89, s77
    s_mov_b32 s79, 1
bk_27x:
    s_waitcnt vmcnt(16) lgkmcnt(0)
    s_barrier
    s_add_u32 m0, s76, 16384
    s_add_u32 s65, s68, 0x80000
    buffer_load_dwordx4 v16, s[28:31], s65 offen lds
    s_add_u32 m0, s76, 17408
    s_add_u32 s65, s68, 0x90000
    buffer_load_dwordx4 v16, s[28:31], s65 offen lds
    s_add_u32 m0, s76, 18432
    s_add_u32 s65, s68, 0xa0000
    buffer_load_dwordx4 v17, s[28:31], s65 offen lds
    s_add_u32 m0, s76, 19456
    s_add_u32 s65, s68, 0xb0000
    buffer_load_dwordx4 v17, s[28:31], s65 offen lds
    s_add_u32 m0, s76, 20480
    s_add_u32 s65, s68, 0x180000
    buffer_load_dwordx4 v16, s[28:31], s65 offen lds
    s_add_u32 m0, s76, 21504
    s_add_u32 s65, s68, 0x190000
    buffer_load_dwordx4 v16, s[28:31], s65 offen lds
    s_add_u32 m0, s76, 22528
    s_add_u32 s65, s68, 0x1a0000
    buffer_load_dwordx4 v17, s[28:31], s65 offen lds
    s_add_u32 m0, s76, 23552
    s_add_u32 s65, s68, 0x1b0000
    buffer_load_dwordx4 v17, s[28:31], s65 offen lds
    ds_read_b64_tr_b16 v[80:81], v20 offset:24576
    ds_read_b64_tr_b16 v[82:83], v20 offset:24832
    ds_read_b64_tr_b16 v[84:85], v20 offset:28672
    ds_read_b64_tr_b16 v[86:87], v20 offset:28928
    ds_read_b64_tr_b16 v[88:89], v21 offset:24576
    ds_read_b64_tr_b16 v[90:91], v21 offset:24832
    ds_read_b64_tr_b16 v[92:93], v21 offset:28672
    ds_read_b64_tr_b16 v[94:95], v21 offset:28928
    ds_read_b64_tr_b16 a[64:65], v22 offset:24576
    ds_read_b64_tr_b16 a[66:67], v22 offset:24832
    ds_read_b64_tr_b16 a[68:69], v22 offset:28672
    ds_read_b64_tr_b16 a[70:71], v22 offset:28928
    ds_read_b64_tr_b16 a[72:73], v23 offset:24576
    ds_read_b64_tr_b16 a[74:75], v23 offset:24832
    ds_read_b64_tr_b16 a[76:77], v23 offset:28672
    ds_read_b64_tr_b16 a[78:79], v23 offset:28928
    s_or_b32 s66, s79, s60
    s_cbranch_scc1 bk_28x
    s_memrealtime s[82:83]
    v_readfirstlane_b32 s66, v45
    s_waitcnt lgkmcnt(0)
    s_sub_u32 s66, s66, s82
    s_cmp_gt_i32 s66, 150
    s_cbranch_scc1 bk_28x
    s_call_b64 s[80:81], C_cal
    v_readfirstlane_b32 s66, v45
    s_nop 0
    s_sub_u32 s66, s40, s66
    s_cmp_gt_i32 s66, 0
    s_cbranch_scc1 bk_28b
    s_mov_b32 s86, s40
    s_mov_b32 s87, s77
    s_branch bk_28x
bk_28b:
    s_mov_b32 s88, s40
    s_mov_b32 s89, s77
    s_mov_b32 s79, 1
bk_28x:
    s_waitcnt vmcnt(16) lgkmcnt(0)
    s_barrier
    s_add_u32 m0, s76, 24576
    s_add_u32 s65, s72, 0x80
    buffer_load_dwordx4 v18, s[36:39], s65 offen lds
    s_add_u32 m0, s76, 25600
    s_add_u32 s65, s72, 0x2080
    buffer_load_dwordx4 v18, s[36:39], s65 offen lds
    s_add_u32 m0, s76, 26624
    s_add_u32 s65, s72, 0x4080
    buffer_load_dwordx4 v19, s[36:39], s65 offen lds
    s_add_u32 m0, s76, 27648
    s_add_u32 s65, s72, 0x6080
    buffer_load_dwordx4 v19, s[36:39], s65 offen lds
    s_add_u32 m0, s76, 28672
    s_add_u32 s65, s73, 0x80
    buffer_load_dwordx4 v18, s[36:39], s65 offen lds
    s_add_u32 m0, s76, 29696
    s_add_u32 s65, s73, 0x2080
    buffer_load_dwordx4 v18, s[36:39], s65 offen lds
    s_add_u32 m0, s76, 30720
    s_add_u32 s65, s73, 0x4080
    buffer_load_dwordx4 v19, s[36:39], s65 offen lds
    s_add_u32 m0, s76, 31744
    s_add_u32 s65, s73, 0x6080
    buffer_load_dwordx4 v19, s[36:39], s65 offen lds
    ds_read_b64_tr_b16 v[96:97], v20 offset:0
    ds_read_b64_tr_b16 v[98:99], v20 offset:256
    ds_read_b64_tr_b16 v[100:101], v20 offset:4096
    ds_read_b64_tr_b16 v[102:103], v20 offset:4352
    ds_read_b64_tr_b16 v[104:105], v21 offset:0
    ds_read_b64_tr_b16 v[106:107], v21 offset:256
    ds_read_b64_tr_b16 v[108:109], v21 offset:4096
    ds_read_b64_tr_b16 v[110:111], v21 offset:4352
    ds_read_b64_tr_b16 v[144:145], v22 offset:0
    ds_read_b64_tr_b16 v[146:147], v22 offset:256
    ds_read_b64_tr_b16 v[148:149], v22 offset:4096
    ds_read_b64_tr_b16 v[150:151], v22 offset:4352
    ds_read_b64_tr_b16 v[152:153], v23 offset:0
    ds_read_b64_tr_b16 v[154:155], v23 offset:256
    ds_read_b64_tr_b16 v[156:157], v23 offset:4096
    ds_read_b64_tr_b16 v[158:159], v23 offset:4352
    s_or_b32 s66, s79, s60
    s_cbranch_scc1 bk_29x
    s_memrealtime s[82:83]
    v_readfirstlane_b32 s66, v45
    s_waitcnt lgkmcnt(0)
    s_sub_u32 s66, s66, s82
    s_cmp_gt_i32 s66, 150
    s_cbranch_scc1 bk_29x
    s_call_b64 s[80:81], C_cal
    v_readfirstlane_b32 s66, v45
    s_nop 0
    s_sub_u32 s66, s40, s66
    s_cmp_gt_i32 s66, 0
    s_cbranch_scc1 bk_29b
    s_mov_b32 s86, s40
    s_mov_b32 s87, s77
    s_branch bk_29x
bk_29b:
    s_mov_b32 s88, s40
    s_mov_b32 s89, s77
    s_mov_b32 s79, 1
bk_29x:
    s_lshl_b32 s66, s61, 2
    s_add_u32 s66, s66, s60
    s_cmp_lg_u32 s66, 11
    s_cbranch_scc1 C_btx
    buffer_load_dword v10, off, s[8:11], s85 offset:128
    buffer_load_dword v10, off, s[8:11], s85 offset:256
C_btx:
    s_waitcnt vmcnt(16) lgkmcnt(0)
    s_barrier
    ds_read_b64_tr_b16 v[112:113], v20 offset:8192
    ds_read_b64_tr_b16 v[114:115], v20 offset:8448
    ds_read_b64_tr_b16 v[116:117], v20 offset:12288
    ds_read_b64_tr_b16 v[118:119], v20 offset:12544
    ds_read_b64_tr_b16 v[120:121], v21 offset:8192
    ds_read_b64_tr_b16 v[122:123], v21 offset:8448
    ds_read_b64_tr_b16 v[124:125], v21 offset:12288
    ds_read_b64_tr_b16 v[126:127], v21 offset:12544
    ds_read_b64_tr_b16 a[80:81], v22 offset:8192
    ds_read_b64_tr_b16 a[82:83], v22 offset:8448
    ds_read_b64_tr_b16 a[84:85], v22 offset:12288
    ds_read_b64_tr_b16 a[86:87], v22 offset:12544
    ds_read_b64_tr_b16 a[88:89], v23 offset:8192
    ds_read_b64_tr_b16 a[90:91], v23 offset:8448
    ds_read_b64_tr_b16 a[92:93], v23 offset:12288
    ds_read_b64_tr_b16 a[94:95], v23 offset:12544
    ds_write_b128 v1, v[48:51] offset:0
    ds_write_b128 v1, v[52:55] offset:1024
    ds_write_b128 v1, v[56:59] offset:2048
    ds_write_b128 v1, v[60:63] offset:3072
    ds_write_b128 v1, v[64:67] offset:4096
    ds_write_b128 v1, v[68:71] offset:5120
    ds_write_b128 v1, v[72:75] offset:6144
    ds_write_b128 v1, v[76:79] offset:7168
    s_or_b32 s66, s79, s60
    s_cbranch_scc1 bk_30x
    s_call_b64 s[80:81], C_cal
    v_readfirstlane_b32 s66, v45
    s_nop 0
    s_sub_u32 s66, s40, s66
    s_cmp_gt_i32 s66, 0
    s_cbranch_scc1 bk_30b
    s_mov_b32 s86, s40
    s_mov_b32 s87, s77
    s_branch bk_30x
bk_30b:
    s_mov_b32 s88, s40
    s_mov_b32 s89, s77
    s_mov_b32 s79, 1
bk_30x:
    s_waitcnt vmcnt(8) lgkmcnt(0)
    s_barrier
    ds_read_b64_tr_b16 v[48:49], v20 offset:16384
    ds_read_b64_tr_b16 v[50:51], v20 offset:16640
    ds_read_b64_tr_b16 v[52:53], v20 offset:20480
    ds_read_b64_tr_b16 v[54:55], v20 offset:20736
    ds_read_b64_tr_b16 v[56:57], v21 offset:16384
    ds_read_b64_tr_b16 v[58:59], v21 offset:16640
    ds_read_b64_tr_b16 v[60:61], v21 offset:20480
    ds_read_b64_tr_b16 v[62:63], v21 offset:20736
    ds_read_b64_tr_b16 a[16:17], v22 offset:16384
    ds_read_b64_tr_b16 a[18:19], v22 offset:16640
    ds_read_b64_tr_b16 a[20:21], v22 offset:20480
    ds_read_b64_tr_b16 a[22:23], v22 offset:20736
    ds_read_b64_tr_b16 a[24:25], v23 offset:16384
    ds_read_b64_tr_b16 a[26:27], v23 offset:16640
    ds_read_b64_tr_b16 a[28:29], v23 offset:20480
    ds_read_b64_tr_b16 a[30:31], v23 offset:20736
    ds_write_b128 v1, v[80:83] offset:8192
    ds_write_b128 v1, v[84:87] offset:9216
    ds_write_b128 v1, v[88:91] offset:10240
    ds_write_b128 v1, v[92:95] offset:11264
    ds_write_b128 v1, v[96:99] offset:12288
    ds_write_b128 v1, v[100:103] offset:13312
    ds_write_b128 v1, v[104:107] offset:14336
    ds_write_b128 v1, v[108:111] offset:15360
    buffer_load_dword v40, v33, s[12:15], 0 offen offset:4 sc1
    buffer_load_dword v8, v33, s[8:11], s97 offen sc1
    s_or_b32 s66, s79, s60
    s_cbranch_scc1 bk_31x
    s_call_b64 s[80:81], C_cal
    s_mov_b32 s88, s40
    s_mov_b32 s89, s77
    s_mov_b32 s79, 1
bk_31x:
    s_sub_u32 s66, s89, s87
    v_cvt_f32_u32 v36, s66
    s_sub_u32 s66, s88, s86
    v_cvt_f32_u32 v37, s66
    v_rcp_f32 v37, v37
    s_nop 1
    v_mul_f32 v36, v36, v37
    v_sub_u32 v37, s86, v45
    v_cvt_f32_i32 v37, v37
    v_mul_f32 v36, v36, v37
    v_cvt_i32_f32 v36, v36
    v_sub_u32 v36, s87, v36
    s_cmp_lg_u32 s60, 0
    s_cbranch_scc1 C_tox
    ds_write_b32 v0, v36 offset:2048
    s_waitcnt lgkmcnt(0)
C_tox:
    s_waitcnt vmcnt(0) lgkmcnt(0)
    s_barrier
    ds_read_b64_tr_b16 v[64:65], v26 offset:24576
    ds_read_b64_tr_b16 v[66:67], v26 offset:24832
    ds_read_b64_tr_b16 v[68:69], v26 offset:25600
    ds_read_b64_tr_b16 v[70:71], v26 offset:25856
    ds_read_b64_tr_b16 v[72:73], v26 offset:28672
    ds_read_b64_tr_b16 v[74:75], v26 offset:28928
    ds_read_b64_tr_b16 v[76:77], v26 offset:29696
    ds_read_b64_tr_b16 v[78:79], v26 offset:29952
    ds_read_b64_tr_b16 v[80:81], v27 offset:24576
    ds_read_b64_tr_b16 v[82:83], v27 offset:24832
    ds_read_b64_tr_b16 v[84:85], v27 offset:25600
    ds_read_b64_tr_b16 v[86:87], v27 offset:25856
    ds_read_b64_tr_b16 v[88:89], v27 offset:28672
    ds_read_b64_tr_b16 v[90:91], v27 offset:28928
    ds_read_b64_tr_b16 v[92:93], v27 offset:29696
    ds_read_b64_tr_b16 v[94:95], v27 offset:29952
    ds_write_b128 v1, v[112:115] offset:16384
    ds_write_b128 v1, v[116:119] offset:17408
    ds_write_b128 v1, v[120:123] offset:18432
    ds_write_b128 v1, v[124:127] offset:19456
    ds_write_b128 v1, v[48:51] offset:20480
    ds_write_b128 v1, v[52:55] offset:21504
    ds_write_b128 v1, v[56:59] offset:22528
    ds_write_b128 v1, v[60:63] offset:23552
    v_readfirstlane_b32 s65, v41
    v_readfirstlane_b32 s66, v8
    s_cmp_eq_u32 s65, 0
    s_cselect_b32 s66, 0, s66
    s_cmp_lg_u32 s66, 0
    s_cbranch_scc1 C_kv0
poll_32:
    buffer_load_dword v36, v33, s[12:15], 0 offen offset:192 sc1
    s_waitcnt vmcnt(0)
    v_cmp_gt_u32 vcc, 1, v36
    s_cbranch_vccz pdone_33
    s_add_u32 s63, s63, 1
    s_cmp_gt_u32 s63, 400000
    s_cbranch_scc1 pdone_33
    s_sleep 2
    s_branch poll_32
pdone_33:
poll_34:
    buffer_load_dword v8, v33, s[8:11], s97 offen offset:0 sc1
    s_waitcnt vmcnt(0)
    v_cmp_gt_u32 vcc, 1, v8
    s_cbranch_vccz pdone_35
    s_add_u32 s63, s63, 1
    s_cmp_gt_u32 s63, 400000
    s_cbranch_scc1 pdone_35
    s_sleep 2
    s_branch poll_34
pdone_35:
C_kv0:
    s_lshl_b32 s65, s60, 11
    s_sub_u32 s66, s65, 0x20000
    s_lshl_b32 s74, s61, 14
    s_add_u32 s74, s74, s66
    s_add_u32 s74, s74, 0x2a00000
    s_add_u32 s94, s65, 0x24000
    s_lshl_b32 s95, s60, 12
    s_add_u32 s95, s95, 0x20000
    v_xor_b32 v25, 8192, v0
    s_mov_b32 m0, s94
    s_nop 0
    buffer_load_dwordx4 v0, s[8:11], s74 offen offset:0 sc1 lds
    buffer_load_dwordx4 v0, s[8:11], s74 offen offset:1024 sc1 lds
    s_mov_b32 m0, s95
    s_add_u32 s76, s74, 8192
    buffer_load_dwordx4 v0, s[8:11], s76 offen offset:0 sc1 lds
    buffer_load_dwordx4 v0, s[8:11], s76 offen offset:1024 sc1 lds
    buffer_load_dword v8, v33, s[8:11], s97 offen offset:128 sc1
cst_36:
    v_readfirstlane_b32 s67, v40
    s_nop 0
    s_and_b32 s65, s67, 0xffff
    s_cmp_ge_u32 s65, 128
    s_cbranch_scc1 cstd_37
    buffer_load_dword v40, v33, s[12:15], 0 offen offset:4 sc1
    s_waitcnt vmcnt(0)
    s_add_u32 s63, s63, 1
    s_cmp_gt_u32 s63, 400000
    s_cbranch_scc1 cstd_37
    s_sleep 1
    s_branch cst_36
cstd_37:
    s_lshl_b32 s65, s60, 10
    s_add_u32 s79, s65, 0xc3400
    buffer_load_dwordx4 v[96:99], v0, s[8:11], s79 offen offset:3072 sc1
    s_and_b32 s66, s61, 1
    s_cbranch_scc1 nowarm_38
    s_mov_b32 s66, 0x20000
    buffer_load_dword v10, v42, s[8:11], s66 offen offset:0 sc1
    buffer_load_dword v10, v42, s[8:11], s66 offen offset:2048 sc1
nowarm_38:
    s_waitcnt lgkmcnt(0)
    ds_write_b128 v1, v[64:67] offset:24576
    ds_write_b128 v1, v[68:71] offset:25600
    ds_write_b128 v1, v[72:75] offset:26624
    ds_write_b128 v1, v[76:79] offset:27648
    ds_write_b128 v1, v[80:83] offset:28672
    ds_write_b128 v1, v[84:87] offset:29696
    ds_write_b128 v1, v[88:91] offset:30720
    ds_write_b128 v1, v[92:95] offset:31744
    v_lshrrev_b32 v36, 2, v34
    v_and_b32 v37, 3, v34
    v_xor_b32 v4, v36, v35
    v_lshlrev_b32 v2, 8, v36
    v_lshl_add_u32 v2, v4, 6, v2
    v_lshl_add_u32 v2, v37, 2, v2
    s_lshr_b32 s65, s60, 1
    s_lshl_b32 s65, s65, 12
    s_and_b32 s67, s60, 1
    s_lshl_b32 s66, s67, 5
    s_add_u32 s66, s66, s65
    s_add_u32 s66, s66, 0x20c00
    v_add_u32 v2, s66, v2
    s_lshl_b32 s67, s67, 9
    s_add_u32 s65, s65, s67
    v_and_b32 v37, 1, v34
    v_lshlrev_b32 v4, 6, v35
    v_xor_b32 v4, v4, v0
    v_and_b32 v4, 0xffffffdf, v4
    v_lshrrev_b32 v36, 3, v34
    v_lshlrev_b32 v3, 8, v36
    v_lshl_add_u32 v3, v35, 6, v3
    v_lshl_add_u32 v3, v37, 5, v3
    v_lshl_add_u32 v5, v35, 1, v36
    v_lshlrev_b32 v5, 11, v5
    v_bfe_u32 v36, v34, 1, 2
    v_lshl_add_u32 v3, v36, 2, v3
    s_add_u32 s66, s65, 0x22c00
    v_add_u32 v3, s66, v3
    v_and_b32 v36, 7, v34
    v_lshl_add_u32 v5, v36, 3, v5
    s_lshl_b32 s65, s60, 14
    s_lshl_b32 s66, s61, 6
    s_add_u32 s65, s65, s66
    v_add_u32 v5, s65, v5
    v_bfe_u32 v37, v34, 1, 1
    v_mul_u32_u24 v7, 0xaaaa, v37
    v_add_u32 v7, 0x4444, v7
    s_mov_b32 s48, 0x3f803f80
    s_mov_b32 s49, s48
    v_mov_b32 v28, 0
    v_mov_b32 v29, 0
    v_mov_b32 v30, 0
    v_mov_b32 v31, 0
    s_mov_b32 s98, 0x3e0293ee
    s_mov_b32 s99, s98
    v_bfe_u32 v36, v34, 2, 1
    v_mul_u32_u24 v11, 0xaaaa, v36
    v_add_u32 v11, 0x4444, v11
    v_and_b32 v36, 1, v34
    v_lshlrev_b32 v36, 4, v36
    v_mov_b32 v37, 0x3f80
    v_lshlrev_b32 v37, v36, v37
    v_cmp_gt_u32 vcc, 8, v34
    s_nop 1
    v_cndmask_b32 v26, 0, v37, vcc
    v_cndmask_b32 v27, v37, 0, vcc
    s_mov_b32 s78, 0xffc00000
    v_readfirstlane_b32 s67, v40
    s_mov_b32 s64, -1
    s_mov_b32 s68, 0xa0000
    s_add_u32 s93, s68, s5
    s_mov_b32 s71, 0xe4000
    s_mov_b32 s72, 0xe2000
    s_lshl_b32 s65, s60, 10
    s_add_u32 s73, s65, 0xc3400
    s_add_u32 s4, s73, 5120
    s_mov_b32 s6, 0x62000
    s_mov_b32 s96, 0
    s_add_u32 s92, s97, 128
    s_mov_b32 s75, 0x93e000
    ds_read_b128 v[64:67], v1 offset:0
    ds_read_b128 v[68:71], v1 offset:1024
    ds_read_b128 v[72:75], v1 offset:2048
    ds_read_b128 v[76:79], v1 offset:3072
    ds_read_b128 v[80:83], v1 offset:4096
    ds_read_b128 v[84:87], v1 offset:5120
    ds_read_b128 v[88:91], v1 offset:6144
    ds_read_b128 v[92:95], v1 offset:7168
    ds_read_b128 v[56:59], v1 offset:8192
    ds_read_b128 v[60:63], v1 offset:9216
    ds_read_b128 v[104:107], v1 offset:10240
    ds_read_b128 v[108:111], v1 offset:11264
    ds_read_b32 v9, v0 offset:2048
    v_mov_b64 v[32:33], 0
    v_mov_b64 v[34:35], 0
    v_mov_b64 v[36:37], 0
    v_mov_b64 v[38:39], 0
    v_mov_b64 v[40:41], 0
    v_mov_b64 v[42:43], 0
    v_mov_b64 v[44:45], 0
    v_mov_b64 v[46:47], 0
    v_mov_b64 v[48:49], 0
    v_mov_b64 v[50:51], 0
    v_mov_b64 v[52:53], 0
    v_mov_b64 v[54:55], 0
    s_waitcnt vmcnt(0) lgkmcnt(0)
    s_lshr_b32 s67, s67, 16
    v_readfirstlane_b32 s79, v9
    s_nop 0
    s_mov_b32 s82, s79
    s_mov_b32 s6, s79
    s_mov_b32 s3, 1
    s_mov_b32 s86, 490
    s_cmp_eq_u32 s60, 2
    s_cselect_b32 s86, 470, s86
    s_mov_b32 s87, 1
    s_barrier
    s_cmp_lg_u32 s67, 0
    s_cselect_b32 s65, 4, 0
    s_add_u32 s65, s65, s60
    s_cmp_eq_u32 s65, 0
    s_cbranch_scc1 CF0_entry
    s_cmp_eq_u32 s65, 1
    s_cbranch_scc1 CF1_entry
    s_cmp_eq_u32 s65, 2
    s_cbranch_scc1 CF2_entry
    s_cmp_eq_u32 s65, 3
    s_cbranch_scc1 CF3_entry
    s_cmp_eq_u32 s65, 4
    s_cbranch_scc1 CS0_entry
    s_cmp_eq_u32 s65, 5
    s_cbranch_scc1 CS1_entry
    s_cmp_eq_u32 s65, 6
    s_cbranch_scc1 CS2_entry
    s_branch CS3_entry
CF0_p1w:
    s_waitcnt vmcnt(2)
    s_memtime s[82:83]
    v_smfmac_f32_16x16x64_bf16 v[124:127], v[112:115], v[116:123], v11
    s_nop 7
    v_add_f32_dpp v100, v124, v124 row_ror:8 row_mask:0xf bank_mask:0xf
    v_add_f32_dpp v101, v125, v125 row_ror:8 row_mask:0xf bank_mask:0xf
    s_nop 0
    v_add_f32_dpp v102, v100, v100 row_ror:4 row_mask:0xf bank_mask:0xf
    v_add_f32_dpp v103, v101, v101 row_ror:4 row_mask:0xf bank_mask:0xf
    v_cvt_pk_bf16_f32 v24, v102, v103
    buffer_store_dword v24, v6, s[8:11], s71 offen
    v_cmp_le_u32 vcc, s78, v24
    s_cbranch_vccnz CF0_p1retry
    s_waitcnt lgkmcnt(0)
    s_sub_u32 s84, s77, s82
    s_add_u32 s84, s84, 520
    s_max_i32 s84, s84, 0
    s_sub_u32 s84, s84, 16
    s_cbranch_scc1 CF0_go2
    s_sub_u32 s84, s84, 16
    s_cbranch_scc1 CF0_go2
    s_sub_u32 s84, s84, 16
    s_cbranch_scc1 CF0_go2
    s_sub_u32 s84, s84, 16
    s_cbranch_scc1 CF0_go2
    s_sub_u32 s84, s84, 16
    s_cbranch_scc1 CF0_go2
    s_sub_u32 s84, s84, 16
    s_cbranch_scc1 CF0_go2
    s_sub_u32 s84, s84, 16
    s_cbranch_scc1 CF0_go2
    s_sub_u32 s84, s84, 16
    s_cbranch_scc1 CF0_go2
    s_sub_u32 s84, s84, 16
    s_cbranch_scc1 CF0_go2
    s_sub_u32 s84, s84, 16
    s_cbranch_scc1 CF0_go2
    s_sub_u32 s84, s84, 16
    s_cbranch_scc1 CF0_go2
    s_sub_u32 s84, s84, 16
    s_cbranch_scc1 CF0_go2
    s_sub_u32 s84, s84, 16
    s_cbranch_scc1 CF0_go2
    s_sub_u32 s84, s84, 16
    s_cbranch_scc1 CF0_go2
    s_sub_u32 s84, s84, 16
    s_cbranch_scc1 CF0_go2
    s_sub_u32 s84, s84, 16
    s_cbranch_scc1 CF0_go2
CF0_go2:
    buffer_load_dwordx4 v[96:99], v0, s[8:11], s73 offen offset:3072 sc1
CF0_post:
    ds_read_b128 v[80:83], v1 offset:4096
    ds_read_b128 v[84:87], v1 offset:5120
    ds_read_b128 v[88:91], v1 offset:6144
    ds_read_b128 v[92:95], v1 offset:7168
    ds_read_b128 v[104:107], v1 offset:10240
    ds_read_b128 v[108:111], v1 offset:11264
    ds_read_b128 v[56:59], v1 offset:8192
    ds_read_b128 v[60:63], v1 offset:9216
    ds_write_b128 v0, v[16:19] offset:0
    ds_write_b128 v0, v[20:23] offset:1024
    s_waitcnt lgkmcnt(0)
CF0_post2:
    v_readfirstlane_b32 s66, v8
    s_add_u32 s65, s64, 2
    s_cmp_gt_u32 s66, s96
    s_cbranch_scc0 CF0_kvslow
CF0_kvok:
    s_lshr_b32 s96, s65, 2
    s_and_b32 s65, s65, 3
    s_lshl_b32 s65, s65, 7
    s_add_u32 s92, s97, s65
    s_branch CF0_step
.p2align 6
    s_nop 0
    s_nop 0
    s_nop 0
    s_nop 0
    s_nop 0
    s_nop 0
    s_nop 0
    s_nop 0
CF0_step:
    s_waitcnt vmcnt(0)
CF0_step2:
    v_max3_u32 v9, v96, v97, v98
    v_max_u32 v9, v9, v99
    ds_write_b128 v0, v[96:99] offset:3072
    v_smfmac_f32_16x16x64_bf16 v[32:35], v[96:99], v[64:71], v7
    v_cmp_le_u32 vcc, s78, v9
    v_smfmac_f32_16x16x64_bf16 v[36:39], v[96:99], v[72:79], v7
    s_cbranch_vccnz CF0_p2retry
    v_smfmac_f32_16x16x64_bf16 v[48:51], v[96:99], v[80:87], v7
    v_smfmac_f32_16x16x64_bf16 v[52:55], v[96:99], v[88:95], v7
    s_waitcnt lgkmcnt(0)
    s_barrier
    ds_read_b128 v[100:103], v0 offset:7168
    buffer_load_dwordx4 v[112:115], v0, s[8:11], s4 offen offset:2048 sc1
    v_smfmac_f32_16x16x64_bf16 v[40:43], v[96:99], v[56:63], v7
    buffer_load_dwordx4 v0, s[8:11], s4 offen offset:2048 sc1 lds
    ds_read_b128 v[64:67], v1 offset:12288
    v_smfmac_f32_16x16x64_bf16 v[44:47], v[96:99], v[104:111], v7
    ds_read_b128 v[68:71], v1 offset:13312
    s_waitcnt lgkmcnt(2)
    v_smfmac_f32_16x16x64_bf16 v[32:35], v[100:103], v[128:135], v7
    ds_read_b128 v[104:107], v0 offset:11264
    ds_read_b128 v[72:75], v1 offset:14336
    v_smfmac_f32_16x16x64_bf16 v[36:39], v[100:103], v[136:143], v7
    s_mov_b32 m0, s94
    ds_read_b128 v[76:79], v1 offset:15360
    v_smfmac_f32_16x16x64_bf16 v[48:51], v[100:103], v[224:231], v7
    buffer_load_dwordx4 v0, s[8:11], s74 offen offset:0 sc1 lds
    ds_read_b128 v[80:83], v1 offset:16384
    v_smfmac_f32_16x16x64_bf16 v[52:55], v[100:103], v[232:239], v7
    buffer_load_dwordx4 v0, s[8:11], s74 offen offset:1024 sc1 lds
    v_smfmac_f32_16x16x64_bf16 v[40:43], v[100:103], a[64:71], v7
    ds_read_b128 v[108:111], v0 offset:15360
    buffer_load_dwordx4 v[16:19], v0, s[8:11], s76 offen offset:0 sc1
    v_smfmac_f32_16x16x64_bf16 v[44:47], v[100:103], a[72:79], v7
    ds_read_b128 v[84:87], v1 offset:17408
    s_waitcnt lgkmcnt(5)
    v_smfmac_f32_16x16x64_bf16 v[48:51], v[104:107], v[240:247], v7
    buffer_load_dwordx4 v[20:23], v0, s[8:11], s76 offen offset:1024 sc1
    v_smfmac_f32_16x16x64_bf16 v[52:55], v[104:107], v[248:255], v7
    ds_read_b128 v[88:91], v1 offset:18432
    s_waitcnt lgkmcnt(4)
    v_smfmac_f32_16x16x64_bf16 v[32:35], v[104:107], v[64:71], v7
    buffer_store_dword v24, v6, s[8:11], s75 offen sc1
    v_smfmac_f32_16x16x64_bf16 v[36:39], v[104:107], v[72:79], v7
    ds_read_b128 v[92:95], v1 offset:19456
    s_waitcnt lgkmcnt(3)
    v_smfmac_f32_16x16x64_bf16 v[32:35], v[108:111], v[144:151], v7
    buffer_load_dword v8, off, s[8:11], s92 sc1
    ds_read_b128 v[64:67], v1 offset:20480
    v_smfmac_f32_16x16x64_bf16 v[36:39], v[108:111], v[152:159], v7
    ds_read_b128 v[68:71], v1 offset:21504
    v_smfmac_f32_16x16x64_bf16 v[48:51], v[108:111], a[0:7], v7
    s_waitcnt vmcnt(6)
    v_max3_u32 v9, v112, v113, v114
    v_max_u32 v9, v9, v115
    v_smfmac_f32_16x16x64_bf16 v[52:55], v[108:111], a[8:15], v7
    ds_read_b128 v[72:75], v1 offset:22528
    s_waitcnt lgkmcnt(3)
    v_cmp_le_u32 vcc, s78, v9
    v_smfmac_f32_16x16x64_bf16 v[40:43], v[104:107], v[80:87], v7
    ds_read_b128 v[76:79], v1 offset:23552
    v_smfmac_f32_16x16x64_bf16 v[44:47], v[104:107], v[88:95], v7
    s_cbranch_vccnz CF0_ownretry
CF0_ownok:
    s_barrier
    v_smfmac_f32_16x16x64_bf16 v[32:35], v[112:115], v[160:167], v7
    ds_read_b128 v[116:119], v0 offset:6144
    ds_read_b128 v[120:123], v0 offset:10240
    v_smfmac_f32_16x16x64_bf16 v[36:39], v[112:115], v[168:175], v7
    ds_read_b128 v[124:127], v0 offset:14336
    s_waitcnt lgkmcnt(3)
    v_smfmac_f32_16x16x64_bf16 v[48:51], v[112:115], v[64:71], v7
    buffer_store_dwordx4 v[12:15], v0, s[8:11], s70 offen offset:0
    v_smfmac_f32_16x16x64_bf16 v[52:55], v[112:115], v[72:79], v7
    ds_read_b128 v[80:83], v25 offset:19456
    s_waitcnt lgkmcnt(3)
    v_smfmac_f32_16x16x64_bf16 v[32:35], v[116:119], v[176:183], v7
    ds_read_b128 v[84:87], v25 offset:21504
    s_waitcnt lgkmcnt(2)
    v_smfmac_f32_16x16x64_bf16 v[32:35], v[120:123], v[192:199], v7
    ds_read_b128 v[88:91], v25 offset:22528
    v_smfmac_f32_16x16x64_bf16 v[32:35], v[124:127], v[208:215], v7
    ds_read_b128 v[92:95], v25 offset:23552
    v_smfmac_f32_16x16x64_bf16 v[36:39], v[116:119], v[184:191], v7
    ds_read_b128 v[64:67], v25 offset:16384
    v_smfmac_f32_16x16x64_bf16 v[36:39], v[120:123], v[200:207], v7
    ds_read_b128 v[68:71], v25 offset:20480
    v_add_f32 v32, v32, v34
    v_smfmac_f32_16x16x64_bf16 v[36:39], v[124:127], v[216:223], v7
    ds_read_b128 v[72:75], v25 offset:17408
    v_add_f32 v33, v33, v35
    v_smfmac_f32_16x16x64_bf16 v[48:51], v[116:119], a[16:23], v7
    buffer_store_dwordx4 v[12:15], v0, s[8:11], s70 offen offset:1024
    v_smfmac_f32_16x16x64_bf16 v[48:51], v[120:123], a[32:39], v7
    ds_read_b128 v[76:79], v25 offset:18432
    v_add_f32 v36, v36, v38
    v_add_f32 v37, v37, v39
    v_smfmac_f32_16x16x64_bf16 v[48:51], v[124:127], a[48:55], v7
    v_cvt_pk_bf16_f32 v34, v32, v36
    v_cvt_pk_bf16_f32 v35, v33, v37
    v_smfmac_f32_16x16x64_bf16 v[52:55], v[116:119], a[24:31], v7
    ds_write2_b32 v2, v34, v35 offset0:0 offset1:4
    v_mov_b64 v[36:37], 0
    v_smfmac_f32_16x16x64_bf16 v[52:55], v[120:123], a[40:47], v7
    buffer_store_dword v12, v6, s[8:11], s72 offen
    v_add_f32 v48, v48, v50
    v_smfmac_f32_16x16x64_bf16 v[52:55], v[124:127], a[56:63], v7
    v_add_f32 v49, v49, v51
    v_smfmac_f32_16x16x64_bf16 v[40:43], v[108:111], a[80:87], v7
    v_mov_b64 v[38:39], 0
    v_smfmac_f32_16x16x64_bf16 v[44:47], v[108:111], a[88:95], v7
    v_add_f32 v52, v52, v54
    v_add_f32 v53, v53, v55
    v_cvt_pk_bf16_f32 v32, v48, v52
    v_cvt_pk_bf16_f32 v33, v49, v53
    v_smfmac_f32_16x16x64_bf16 v[40:43], v[112:115], a[96:103], v7
    ds_write2_b32 v3, v32, v33 offset0:0 offset1:4
    v_mov_b64 v[48:49], 0
    v_smfmac_f32_16x16x64_bf16 v[44:47], v[112:115], a[104:111], v7
    v_mov_b64 v[50:51], 0
    v_smfmac_f32_16x16x64_bf16 v[40:43], v[116:119], a[112:119], v7
    ds_read_b128 v[96:99], v4 offset:3072
    v_mov_b64 v[52:53], 0
    v_smfmac_f32_16x16x64_bf16 v[44:47], v[116:119], a[120:127], v7
    v_mov_b64 v[54:55], 0
    v_smfmac_f32_16x16x64_bf16 v[40:43], v[120:123], a[128:135], v7
    s_waitcnt lgkmcnt(1)
    s_barrier
    ds_read_b128 v[100:103], v4 offset:3104
    v_smfmac_f32_16x16x64_bf16 v[44:47], v[120:123], a[136:143], v7
    ds_read_b128 v[104:107], v4 offset:7168
    v_smfmac_f32_16x16x64_bf16 v[40:43], v[124:127], a[144:151], v7
    ds_read_b128 v[108:111], v4 offset:7200
    v_smfmac_f32_16x16x64_bf16 v[44:47], v[124:127], a[152:159], v7
    ds_read_b128 v[112:115], v0 offset:11264
    s_waitcnt lgkmcnt(4)
    v_mfma_f32_16x16x32_bf16 v[56:59], v[64:67], v[96:99], 0
    ds_read_b128 v[116:119], v0 offset:15360
    v_mfma_f32_16x16x32_bf16 v[60:63], v[68:71], v[96:99], 0
    s_waitcnt lgkmcnt(4)
    v_mfma_f32_16x16x32_bf16 v[56:59], v[72:75], v[100:103], v[56:59]
    s_waitcnt lgkmcnt(3)
    v_mfma_f32_16x16x32_bf16 v[56:59], v[76:79], v[104:107], v[56:59]
    ds_read_b128 v[64:67], v1 offset:24576
    s_waitcnt lgkmcnt(3)
    v_mfma_f32_16x16x32_bf16 v[56:59], v[80:83], v[108:111], v[56:59]
    ds_read_b128 v[68:71], v1 offset:25600
    v_add_f32 v40, v40, v42
    v_add_f32 v41, v41, v43
    v_mfma_f32_16x16x32_bf16 v[60:63], v[84:87], v[100:103], v[60:63]
    s_waitcnt lgkmcnt(2)
    v_add_f32 v44, v44, v46
    v_add_f32 v45, v45, v47
    v_smfmac_f32_16x16x64_bf16 v[36:39], v[112:115], v[96:103], v7
    ds_read_b128 v[80:83], v1 offset:28672
    v_max3_f32 v9, v56, v57, v58
    v_smfmac_f32_16x16x64_bf16 v[36:39], v[116:119], v[104:111], v7
    ds_read_b128 v[96:99], v0 offset:0
    v_max_f32 v9, v9, v59
    v_mfma_f32_16x16x32_bf16 v[60:63], v[88:91], v[104:107], v[60:63]
    ds_read_b128 v[100:103], v0 offset:1024
    v_cvt_pk_bf16_f32 v42, v40, v41
    v_cvt_pk_bf16_f32 v43, v44, v45
    v_mfma_f32_16x16x32_bf16 v[60:63], v[92:95], v[108:111], v[60:63]
    ds_read_b128 v[84:87], v1 offset:29696
    v_add_f32 v36, v36, v38
    v_add_f32 v37, v37, v39
    v_max3_f32 v9, v9, v36, v37
    v_mov_b64 v[44:45], s[48:49]
    v_mov_b64 v[46:47], s[48:49]
    v_mov_b64 v[104:105], 0
    s_nop 0
    v_max3_f32 v10, v60, v61, v62
    v_max3_f32 v32, v9, v10, v63
    v_max3_f32 v33, v9, v10, v63
    v_mov_b64 v[106:107], 0
    v_mov_b64 v[108:109], 0
    v_permlane32_swap_b32 v32, v33
    v_max_f32 v34, v32, v33
    v_max_f32 v35, v32, v33
    v_mov_b64 v[110:111], 0
    v_mov_b64 v[40:41], 0
    v_permlane16_swap_b32 v34, v35
    v_max_f32 v32, v34, v35
    v_mul_f32 v32, s98, v32
    v_pk_fma_f32 v[36:37], v[36:37], s[98:99], v[32:33] op_sel_hi:[1,1,0] neg_lo:[0,0,1] neg_hi:[0,0,1]
    v_pk_fma_f32 v[56:57], v[56:57], s[98:99], v[32:33] op_sel_hi:[1,1,0] neg_lo:[0,0,1] neg_hi:[0,0,1]
    v_exp_f32 v36, v36
    v_exp_f32 v37, v37
    s_waitcnt lgkmcnt(0)
    s_buffer_load_dwordx16 s[16:31], s[8:11], s85
    s_buffer_load_dwordx16 s[32:47], s[8:11], s85 offset:64
    v_pk_fma_f32 v[58:59], v[58:59], s[98:99], v[32:33] op_sel_hi:[1,1,0] neg_lo:[0,0,1] neg_hi:[0,0,1]
    v_pk_fma_f32 v[60:61], v[60:61], s[98:99], v[32:33] op_sel_hi:[1,1,0] neg_lo:[0,0,1] neg_hi:[0,0,1]
    v_pk_fma_f32 v[62:63], v[62:63], s[98:99], v[32:33] op_sel_hi:[1,1,0] neg_lo:[0,0,1] neg_hi:[0,0,1]
    v_cvt_pk_bf16_f32 v28, v36, v37
    v_cvt_pk_bf16_f32 v31, v36, v37
    v_exp_f32 v56, v56
    v_exp_f32 v57, v57
    v_mfma_f32_16x16x16_bf16 v[124:127], v[44:45], v[28:29], 0
    v_exp_f32 v58, v58
    v_exp_f32 v59, v59
    v_mfma_f32_16x16x16_bf16 v[112:115], v[42:43], v[28:29], 0
    v_exp_f32 v60, v60
    v_exp_f32 v61, v61
    v_mfma_f32_16x16x16_bf16 v[116:119], v[42:43], v[30:31], 0
    v_exp_f32 v62, v62
    v_exp_f32 v63, v63
    v_cvt_pk_bf16_f32 v120, v56, v57
    v_cvt_pk_bf16_f32 v121, v58, v59
    v_cvt_pk_bf16_f32 v122, v60, v61
    v_cvt_pk_bf16_f32 v123, v62, v63
    s_nop 1
    v_mfma_f32_16x16x32_bf16 v[124:127], v[44:47], v[120:123], v[124:127]
    ds_read_b128 v[72:75], v1 offset:26624
    ds_read_b128 v[76:79], v1 offset:27648
    v_mfma_f32_16x16x32_bf16 v[112:115], v[96:99], v[120:123], v[112:115]
    ds_read_b128 v[88:91], v1 offset:30720
    ds_read_b128 v[92:95], v1 offset:31744
    v_mfma_f32_16x16x32_bf16 v[116:119], v[100:103], v[120:123], v[116:119]
    v_rcp_f32 v124, v124
    v_mov_b64 v[42:43], 0
    s_nop 1
    v_pk_mul_f32 v[112:113], v[112:113], v[124:125] op_sel_hi:[1,0]
    v_pk_mul_f32 v[114:115], v[114:115], v[124:125] op_sel_hi:[1,0]
    v_cvt_pk_bf16_f32 v32, v112, v113
    v_cvt_pk_bf16_f32 v33, v114, v115
    v_pk_mul_f32 v[116:117], v[116:117], v[124:125] op_sel_hi:[1,0]
    s_nop 0
    v_pk_mul_f32 v[118:119], v[118:119], v[124:125] op_sel_hi:[1,0]
    v_cvt_pk_bf16_f32 v34, v116, v117
    v_cvt_pk_bf16_f32 v35, v118, v119
    ds_write_b128 v0, v[32:35] offset:2048
    s_nop 0
    v_smfmac_f32_16x16x64_bf16 v[48:51], v[32:35], a[160:167], v7
    s_add_u32 s77, s79, 1865
    v_smfmac_f32_16x16x64_bf16 v[52:55], v[32:35], a[176:183], v7
    s_add_u32 s65, s68, 65536
    s_add_u32 s66, s69, 65536
    v_smfmac_f32_16x16x64_bf16 v[104:107], v[32:35], v[64:71], v7
    v_smfmac_f32_16x16x64_bf16 v[108:111], v[32:35], v[80:87], v7
    s_waitcnt lgkmcnt(0)
    s_barrier
    ds_read_b128 v[36:39], v0 offset:6144
    v_mov_b64 v[124:125], 0
    ds_read_b128 v[96:99], v0 offset:10240
    v_mov_b64 v[126:127], 0
    ds_read_b128 v[100:103], v0 offset:14336
    v_mov_b64 v[32:33], 0
    s_max_u32 s16, s16, s17
    s_max_u32 s16, s16, s18
    s_max_u32 s16, s16, s19
    v_mov_b64 v[34:35], 0
    s_max_u32 s16, s16, s20
    s_max_u32 s16, s16, s21
    s_max_u32 s16, s16, s22
    v_mov_b64 v[44:45], 0
    s_waitcnt lgkmcnt(2)
    v_smfmac_f32_16x16x64_bf16 v[48:51], v[36:39], a[168:175], v7
    s_max_u32 s16, s16, s23
    s_max_u32 s16, s16, s24
    s_waitcnt lgkmcnt(0)
    v_smfmac_f32_16x16x64_bf16 v[48:51], v[96:99], a[192:199], v7
    s_max_u32 s16, s16, s25
    s_max_u32 s16, s16, s26
    s_max_u32 s16, s16, s27
    v_smfmac_f32_16x16x64_bf16 v[48:51], v[100:103], a[200:207], v7
    s_max_u32 s16, s16, s28
    s_max_u32 s16, s16, s29
    s_max_u32 s16, s16, s30
    v_smfmac_f32_16x16x64_bf16 v[52:55], v[36:39], a[184:191], v7
    s_max_u32 s16, s16, s31
    s_max_u32 s16, s16, s32
    s_max_u32 s16, s16, s33
    v_smfmac_f32_16x16x64_bf16 v[52:55], v[96:99], a[208:215], v7
    v_cvt_pk_bf16_f32 v56, v48, v50
    v_cvt_pk_bf16_f32 v57, v49, v51
    v_smfmac_f32_16x16x64_bf16 v[52:55], v[100:103], a[216:223], v7
    buffer_store_dwordx2 v[56:57], v5, s[8:11], s68 offen
    s_max_u32 s16, s16, s34
    s_max_u32 s16, s16, s35
    v_smfmac_f32_16x16x64_bf16 v[104:107], v[36:39], v[72:79], v7
    s_max_u32 s16, s16, s36
    s_max_u32 s16, s16, s37
    s_max_u32 s16, s16, s38
    v_smfmac_f32_16x16x64_bf16 v[104:107], v[96:99], a[224:231], v7
    v_cvt_pk_bf16_f32 v58, v52, v54
    v_cvt_pk_bf16_f32 v59, v53, v55
    v_smfmac_f32_16x16x64_bf16 v[104:107], v[100:103], a[232:239], v7
    buffer_store_dwordx2 v[58:59], v5, s[8:11], s65 offen
    s_memtime s[82:83]
    s_max_u32 s16, s16, s39
    v_smfmac_f32_16x16x64_bf16 v[108:111], v[36:39], v[88:95], v7
    s_max_u32 s16, s16, s40
    s_max_u32 s16, s16, s41
    s_max_u32 s16, s16, s42
    v_smfmac_f32_16x16x64_bf16 v[108:111], v[96:99], a[240:247], v7
    s_max_u32 s16, s16, s43
    v_cvt_pk_bf16_f32 v60, v104, v106
    v_cvt_pk_bf16_f32 v61, v105, v107
    v_smfmac_f32_16x16x64_bf16 v[108:111], v[100:103], a[248:255], v7
    s_max_u32 s16, s16, s44
    s_max_u32 s16, s16, s45
    s_max_u32 s16, s16, s46
    s_max_u32 s16, s16, s47
    s_waitcnt lgkmcnt(0)
    s_add_u32 s77, s16, s77
    s_sub_u32 s84, s77, s82
    s_cmp_lt_i32 s84, 24
    v_cvt_pk_bf16_f32 v62, v108, v110
    v_cvt_pk_bf16_f32 v63, v109, v111
    s_cbranch_scc0 CF0_wait
CF0_go:
    v_mov_b64 v[36:37], 0
    v_mov_b64 v[38:39], 0
    v_mov_b64 v[46:47], 0
    v_mov_b64 v[48:49], 0
    v_mov_b64 v[50:51], 0
    v_mov_b64 v[52:53], 0
    v_mov_b64 v[54:55], 0
    buffer_load_dwordx4 v[116:119], v0, s[8:11], s93 offen offset:0 sc1
    buffer_load_dwordx4 v[120:123], v0, s[8:11], s93 offen offset:1024 sc1
    ds_read_b128 v[64:67], v1 offset:0
    ds_read_b128 v[68:71], v1 offset:1024
    ds_read_b128 v[72:75], v1 offset:2048
    ds_read_b128 v[76:79], v1 offset:3072
    v_mov_b64 v[112:113], v[26:27]
    v_mov_b64 v[114:115], v[26:27]
    s_mov_b32 s72, s71
    s_add_u32 s71, s71, 8192
    s_cmp_eq_u32 s71, 0xe6000
    s_cselect_b32 s71, 0xe0000, s71
    s_add_u32 s73, s71, 0xfffdf400
    s_add_u32 s4, s73, 5120
    s_mov_b32 m0, s95
    v_xor_b32 v25, 8192, v25
    s_add_u32 s76, s74, 0x82000
    s_add_u32 s74, s74, 0x80000
    s_xor_b32 s94, s94, 8192
    s_add_u32 s85, s85, 128
    s_add_u32 s91, s91, 128
    s_add_u32 s75, s75, 8192
    s_mov_b32 s70, s93
    s_add_u32 s64, s64, 1
    s_add_u32 s68, s68, 262144
    buffer_store_dwordx2 v[60:61], v5, s[8:11], s69 offen
    buffer_store_dwordx2 v[62:63], v5, s[8:11], s66 offen
    s_cmp_eq_u32 s68, 0xe0000
    s_cselect_b32 s68, 0x20000, s68
    s_cmp_eq_u32 s64, 63
    s_cbranch_scc1 CF0_last
    s_add_u32 s93, s68, s5
    s_add_u32 s69, s68, 131072
    s_branch CF0_p1w
CF0_entry:
    v_xor_b32 v25, 8192, v25
    s_add_u32 s76, s74, 0x82000
    s_add_u32 s74, s74, 0x80000
    s_xor_b32 s94, s94, 8192
    s_add_u32 s85, s85, 128
    s_add_u32 s91, s91, 128
    s_add_u32 s75, s75, 8192
    s_mov_b32 s70, s93
    s_add_u32 s64, s64, 1
    s_add_u32 s68, s68, 262144
    s_cmp_eq_u32 s68, 0xe0000
    s_cselect_b32 s68, 0x20000, s68
    s_add_u32 s93, s68, s5
    s_add_u32 s69, s68, 131072
    s_branch CF0_post2
CF0_last:
    s_waitcnt vmcnt(2)
    s_branch C_last1
CF0_p2retry:
    s_add_u32 s63, s63, 1
    s_cmp_gt_u32 s63, 400000
    s_cbranch_scc1 C_last
    v_cmp_le_u32 vcc, s78, v24
    s_cbranch_vccnz CF0_p1retry
    buffer_load_dwordx4 v[96:99], v0, s[8:11], s73 offen offset:3072 sc1
    buffer_load_dwordx4 v[112:115], v0, s[8:11], s4 offen offset:2048 sc1
    v_mov_b64 v[32:33], 0
    v_mov_b64 v[34:35], 0
    v_mov_b64 v[36:37], 0
    v_mov_b64 v[38:39], 0
    s_waitcnt vmcnt(0) lgkmcnt(0)
    v_max3_u32 v9, v112, v113, v114
    v_max_u32 v9, v9, v115
    v_cmp_le_u32 vcc, s78, v9
    s_cbranch_vccnz CF0_p2retry
    s_branch CF0_step2
CF0_wait:
    s_sub_u32 s84, s84, 64
    s_cbranch_scc1 CF0_go
CF0_twl:
    s_sub_u32 s84, s84, 16
    s_cbranch_scc1 CF0_go
    s_sub_u32 s84, s84, 16
    s_cbranch_scc1 CF0_go
    s_sub_u32 s84, s84, 16
    s_cbranch_scc1 CF0_go
    s_sub_u32 s84, s84, 16
    s_cbranch_scc1 CF0_go
    s_sub_u32 s84, s84, 16
    s_cbranch_scc1 CF0_go
    s_sub_u32 s84, s84, 16
    s_cbranch_scc1 CF0_go
    s_sub_u32 s84, s84, 16
    s_cbranch_scc1 CF0_go
    s_sub_u32 s84, s84, 16
    s_cbranch_scc1 CF0_go
    s_sub_u32 s84, s84, 16
    s_cbranch_scc1 CF0_go
    s_sub_u32 s84, s84, 16
    s_cbranch_scc1 CF0_go
    s_sub_u32 s84, s84, 16
    s_cbranch_scc1 CF0_go
    s_sub_u32 s84, s84, 16
    s_cbranch_scc1 CF0_go
    s_min_u32 s84, s84, 2000
    s_sub_u32 s84, s84, 36
    s_cbranch_scc0 CF0_twl
    s_branch CF0_go
CF0_ownretry:
    s_add_u32 s87, s64, 1
    buffer_load_dwordx4 v[112:115], v0, s[8:11], s4 offen offset:2048 sc1
    s_waitcnt vmcnt(0)
    v_max3_u32 v9, v112, v113, v114
    v_max_u32 v9, v9, v115
    ds_write_b128 v0, v[112:115] offset:2048
    v_cmp_le_u32 vcc, s78, v9
    s_add_u32 s63, s63, 1
    s_cmp_gt_u32 s63, 400000
    s_waitcnt lgkmcnt(0)
    s_cbranch_scc1 CF0_ownok
    s_cbranch_vccz CF0_ownok
    s_branch CF0_ownretry
CF0_p1retry:
    v_max3_u32 v9, v116, v117, v118
    v_max3_u32 v100, v119, v120, v121
    v_max3_u32 v9, v9, v122, v123
    v_max_u32 v9, v9, v100
    v_cmp_eq_u32 vcc, -1, v9
    v_mov_b64 v[124:125], 0
    v_mov_b64 v[126:127], 0
    v_mov_b64 v[112:113], v[26:27]
    v_mov_b64 v[114:115], v[26:27]
    s_cbranch_vccz CF0_p1nan
    buffer_load_dwordx4 v[116:119], v0, s[8:11], s70 offen offset:0 sc1
    buffer_load_dwordx4 v[120:123], v0, s[8:11], s70 offen offset:1024 sc1
    s_add_u32 s63, s63, 1
    s_waitcnt vmcnt(0)
    s_cmp_gt_u32 s63, 400000
    s_cbranch_scc0 CF0_p1retry
CF0_p1nan:
    s_nop 0
    v_smfmac_f32_16x16x64_bf16 v[124:127], v[112:115], v[116:123], v11
    s_nop 7
    v_add_f32_dpp v100, v124, v124 row_ror:8 row_mask:0xf bank_mask:0xf
    v_add_f32_dpp v101, v125, v125 row_ror:8 row_mask:0xf bank_mask:0xf
    s_nop 0
    v_add_f32_dpp v102, v100, v100 row_ror:4 row_mask:0xf bank_mask:0xf
    v_add_f32_dpp v103, v101, v101 row_ror:4 row_mask:0xf bank_mask:0xf
    v_cvt_pk_bf16_f32 v24, v102, v103
    v_min_u32 v24, 0xffbfffff, v24
    buffer_store_dword v24, v6, s[8:11], s71 offen
    v_mov_b32 v96, -1
    s_branch CF0_post
CF0_kvslow:
    buffer_load_dword v8, off, s[8:11], s92 sc1
    s_waitcnt vmcnt(0)
    v_readfirstlane_b32 s66, v8
    s_nop 0
    s_cmp_gt_u32 s66, s96
    s_cbranch_scc1 CF0_kvok
    s_add_u32 s63, s63, 1
    s_cmp_gt_u32 s63, 400000
    s_cbranch_scc1 CF0_kvok
    s_sleep 1
    s_branch CF0_kvslow
CF1_p1w:
    s_waitcnt vmcnt(2)
    s_memtime s[82:83]
    v_smfmac_f32_16x16x64_bf16 v[124:127], v[112:115], v[116:123], v11
    s_nop 7
    v_add_f32_dpp v100, v124, v124 row_ror:8 row_mask:0xf bank_mask:0xf
    v_add_f32_dpp v101, v125, v125 row_ror:8 row_mask:0xf bank_mask:0xf
    s_nop 0
    v_add_f32_dpp v102, v100, v100 row_ror:4 row_mask:0xf bank_mask:0xf
    s_nop 0
    v_add_f32_dpp v103, v101, v101 row_ror:4 row_mask:0xf bank_mask:0xf
    v_cvt_pk_bf16_f32 v24, v102, v103
    buffer_store_dword v24, v6, s[8:11], s71 offen
    v_cmp_le_u32 vcc, s78, v24
    s_cbranch_vccnz CF1_p1retry
    s_waitcnt lgkmcnt(0)
    s_sub_u32 s84, s77, s82
    s_add_u32 s84, s84, 530
    s_max_i32 s84, s84, 0
    s_sub_u32 s84, s84, 16
    s_cbranch_scc1 CF1_go2
    s_sub_u32 s84, s84, 16
    s_cbranch_scc1 CF1_go2
    s_sub_u32 s84, s84, 16
    s_cbranch_scc1 CF1_go2
    s_sub_u32 s84, s84, 16
    s_cbranch_scc1 CF1_go2
    s_sub_u32 s84, s84, 16
    s_cbranch_scc1 CF1_go2
    s_sub_u32 s84, s84, 16
    s_cbranch_scc1 CF1_go2
    s_sub_u32 s84, s84, 16
    s_cbranch_scc1 CF1_go2
    s_sub_u32 s84, s84, 16
    s_cbranch_scc1 CF1_go2
    s_sub_u32 s84, s84, 16
    s_cbranch_scc1 CF1_go2
    s_sub_u32 s84, s84, 16
    s_cbranch_scc1 CF1_go2
    s_sub_u32 s84, s84, 16
    s_cbranch_scc1 CF1_go2
    s_sub_u32 s84, s84, 16
    s_cbranch_scc1 CF1_go2
    s_sub_u32 s84, s84, 16
    s_cbranch_scc1 CF1_go2
    s_sub_u32 s84, s84, 16
    s_cbranch_scc1 CF1_go2
    s_sub_u32 s84, s84, 16
    s_cbranch_scc1 CF1_go2
    s_sub_u32 s84, s84, 16
    s_cbranch_scc1 CF1_go2
CF1_go2:
    buffer_load_dwordx4 v[96:99], v0, s[8:11], s73 offen offset:3072 sc1
CF1_post:
    ds_read_b128 v[80:83], v1 offset:4096
    ds_read_b128 v[84:87], v1 offset:5120
    ds_read_b128 v[88:91], v1 offset:6144
    ds_read_b128 v[92:95], v1 offset:7168
    ds_read_b128 v[104:107], v1 offset:10240
    ds_read_b128 v[108:111], v1 offset:11264
    ds_read_b128 v[56:59], v1 offset:8192
    ds_read_b128 v[60:63], v1 offset:9216
    ds_write_b128 v0, v[16:19] offset:4096
    ds_write_b128 v0, v[20:23] offset:5120
    s_waitcnt lgkmcnt(0)
CF1_post2:
    s_branch CF1_step
.p2align 6
    s_nop 0
    s_nop 0
    s_nop 0
    s_nop 0
    s_nop 0
    s_nop 0
    s_nop 0
    s_nop 0
CF1_step:
    s_waitcnt vmcnt(0)
CF1_step2:
    v_max3_u32 v9, v96, v97, v98
    v_max_u32 v9, v9, v99
    ds_write_b128 v0, v[96:99] offset:7168
    v_smfmac_f32_16x16x64_bf16 v[32:35], v[96:99], v[64:71], v7
    v_cmp_le_u32 vcc, s78, v9
    v_smfmac_f32_16x16x64_bf16 v[36:39], v[96:99], v[72:79], v7
    s_cbranch_vccnz CF1_p2retry
    v_smfmac_f32_16x16x64_bf16 v[48:51], v[96:99], v[80:87], v7
    v_smfmac_f32_16x16x64_bf16 v[52:55], v[96:99], v[88:95], v7
    s_waitcnt lgkmcnt(0)
    s_barrier
    ds_read_b128 v[100:103], v0 offset:3072
    buffer_load_dwordx4 v[112:115], v0, s[8:11], s4 offen offset:2048 sc1
    v_smfmac_f32_16x16x64_bf16 v[40:43], v[96:99], v[56:63], v7
    buffer_load_dwordx4 v0, s[8:11], s4 offen offset:2048 sc1 lds
    ds_read_b128 v[64:67], v1 offset:12288
    v_smfmac_f32_16x16x64_bf16 v[44:47], v[96:99], v[104:111], v7
    ds_read_b128 v[68:71], v1 offset:13312
    s_waitcnt lgkmcnt(2)
    v_smfmac_f32_16x16x64_bf16 v[32:35], v[100:103], v[128:135], v7
    ds_read_b128 v[104:107], v0 offset:15360
    ds_read_b128 v[72:75], v1 offset:14336
    v_smfmac_f32_16x16x64_bf16 v[36:39], v[100:103], v[136:143], v7
    s_mov_b32 m0, s94
    ds_read_b128 v[76:79], v1 offset:15360
    v_smfmac_f32_16x16x64_bf16 v[48:51], v[100:103], v[224:231], v7
    buffer_load_dwordx4 v0, s[8:11], s74 offen offset:0 sc1 lds
    ds_read_b128 v[80:83], v1 offset:16384
    v_smfmac_f32_16x16x64_bf16 v[52:55], v[100:103], v[232:239], v7
    buffer_load_dwordx4 v0, s[8:11], s74 offen offset:1024 sc1 lds
    ds_read_b128 v[84:87], v1 offset:17408
    v_smfmac_f32_16x16x64_bf16 v[40:43], v[100:103], a[64:71], v7
    ds_read_b128 v[108:111], v0 offset:11264
    v_smfmac_f32_16x16x64_bf16 v[44:47], v[100:103], a[72:79], v7
    buffer_load_dwordx4 v[16:19], v0, s[8:11], s76 offen offset:0 sc1
    s_waitcnt lgkmcnt(5)
    v_smfmac_f32_16x16x64_bf16 v[48:51], v[104:107], v[240:247], v7
    ds_read_b128 v[88:91], v1 offset:18432
    v_smfmac_f32_16x16x64_bf16 v[52:55], v[104:107], v[248:255], v7
    buffer_load_dwordx4 v[20:23], v0, s[8:11], s76 offen offset:1024 sc1
    s_waitcnt lgkmcnt(4)
    v_smfmac_f32_16x16x64_bf16 v[32:35], v[104:107], v[64:71], v7
    ds_read_b128 v[92:95], v1 offset:19456
    v_smfmac_f32_16x16x64_bf16 v[36:39], v[104:107], v[72:79], v7
    buffer_store_dword v24, v6, s[8:11], s75 offen sc1
    s_waitcnt lgkmcnt(2)
    v_smfmac_f32_16x16x64_bf16 v[32:35], v[108:111], v[144:151], v7
    ds_read_b128 v[64:67], v1 offset:20480
    v_smfmac_f32_16x16x64_bf16 v[36:39], v[108:111], v[152:159], v7
    ds_read_b128 v[68:71], v1 offset:21504
    v_smfmac_f32_16x16x64_bf16 v[48:51], v[108:111], a[0:7], v7
    s_waitcnt vmcnt(5)
    v_max3_u32 v9, v112, v113, v114
    v_max_u32 v9, v9, v115
    v_smfmac_f32_16x16x64_bf16 v[52:55], v[108:111], a[8:15], v7
    ds_read_b128 v[72:75], v1 offset:22528
    s_waitcnt lgkmcnt(3)
    v_cmp_le_u32 vcc, s78, v9
    v_smfmac_f32_16x16x64_bf16 v[40:43], v[104:107], v[80:87], v7
    ds_read_b128 v[76:79], v1 offset:23552
    v_smfmac_f32_16x16x64_bf16 v[44:47], v[104:107], v[88:95], v7
    s_cbranch_vccnz CF1_ownretry
CF1_ownok:
    s_barrier
    v_smfmac_f32_16x16x64_bf16 v[32:35], v[112:115], v[160:167], v7
    ds_read_b128 v[116:119], v0 offset:2048
    ds_read_b128 v[120:123], v0 offset:14336
    v_smfmac_f32_16x16x64_bf16 v[36:39], v[112:115], v[168:175], v7
    ds_read_b128 v[124:127], v0 offset:10240
    s_waitcnt lgkmcnt(3)
    v_smfmac_f32_16x16x64_bf16 v[48:51], v[112:115], v[64:71], v7
    ds_read_b128 v[80:83], v25 offset:18432
    v_smfmac_f32_16x16x64_bf16 v[52:55], v[112:115], v[72:79], v7
    buffer_store_dwordx4 v[12:15], v0, s[8:11], s70 offen offset:0
    s_waitcnt lgkmcnt(3)
    v_smfmac_f32_16x16x64_bf16 v[32:35], v[116:119], v[176:183], v7
    ds_read_b128 v[84:87], v25 offset:20480
    s_waitcnt lgkmcnt(2)
    v_smfmac_f32_16x16x64_bf16 v[32:35], v[120:123], v[192:199], v7
    ds_read_b128 v[88:91], v25 offset:23552
    v_smfmac_f32_16x16x64_bf16 v[32:35], v[124:127], v[208:215], v7
    ds_read_b128 v[92:95], v25 offset:22528
    v_smfmac_f32_16x16x64_bf16 v[36:39], v[116:119], v[184:191], v7
    ds_read_b128 v[64:67], v25 offset:17408
    v_smfmac_f32_16x16x64_bf16 v[36:39], v[120:123], v[200:207], v7
    ds_read_b128 v[68:71], v25 offset:21504
    v_add_f32 v32, v32, v34
    v_smfmac_f32_16x16x64_bf16 v[36:39], v[124:127], v[216:223], v7
    ds_read_b128 v[72:75], v25 offset:16384
    v_add_f32 v33, v33, v35
    v_smfmac_f32_16x16x64_bf16 v[48:51], v[116:119], a[16:23], v7
    ds_read_b128 v[76:79], v25 offset:19456
    v_smfmac_f32_16x16x64_bf16 v[48:51], v[120:123], a[32:39], v7
    buffer_store_dwordx4 v[12:15], v0, s[8:11], s70 offen offset:1024
    v_add_f32 v36, v36, v38
    v_add_f32 v37, v37, v39
    v_smfmac_f32_16x16x64_bf16 v[48:51], v[124:127], a[48:55], v7
    v_cvt_pk_bf16_f32 v34, v32, v36
    v_cvt_pk_bf16_f32 v35, v33, v37
    v_smfmac_f32_16x16x64_bf16 v[52:55], v[116:119], a[24:31], v7
    ds_write2_b32 v2, v34, v35 offset0:0 offset1:4
    v_mov_b64 v[36:37], 0
    v_smfmac_f32_16x16x64_bf16 v[52:55], v[120:123], a[40:47], v7
    v_add_f32 v48, v48, v50
    v_smfmac_f32_16x16x64_bf16 v[52:55], v[124:127], a[56:63], v7
    buffer_store_dword v12, v6, s[8:11], s72 offen
    v_add_f32 v49, v49, v51
    v_smfmac_f32_16x16x64_bf16 v[40:43], v[108:111], a[80:87], v7
    v_mov_b64 v[38:39], 0
    v_smfmac_f32_16x16x64_bf16 v[44:47], v[108:111], a[88:95], v7
    v_add_f32 v52, v52, v54
    v_add_f32 v53, v53, v55
    v_cvt_pk_bf16_f32 v32, v48, v52
    v_cvt_pk_bf16_f32 v33, v49, v53
    v_smfmac_f32_16x16x64_bf16 v[40:43], v[112:115], a[96:103], v7
    ds_write2_b32 v3, v32, v33 offset0:0 offset1:4
    v_mov_b64 v[48:49], 0
    v_smfmac_f32_16x16x64_bf16 v[44:47], v[112:115], a[104:111], v7
    v_mov_b64 v[50:51], 0
    v_smfmac_f32_16x16x64_bf16 v[40:43], v[116:119], a[112:119], v7
    ds_read_b128 v[100:103], v4 offset:3104
    v_mov_b64 v[52:53], 0
    v_smfmac_f32_16x16x64_bf16 v[44:47], v[116:119], a[120:127], v7
    v_mov_b64 v[54:55], 0
    v_smfmac_f32_16x16x64_bf16 v[40:43], v[120:123], a[128:135], v7
    s_waitcnt lgkmcnt(1)
    s_barrier
    ds_read_b128 v[96:99], v4 offset:3072
    v_smfmac_f32_16x16x64_bf16 v[44:47], v[120:123], a[136:143], v7
    ds_read_b128 v[108:111], v4 offset:7200
    v_smfmac_f32_16x16x64_bf16 v[40:43], v[124:127], a[144:151], v7
    ds_read_b128 v[104:107], v4 offset:7168
    v_smfmac_f32_16x16x64_bf16 v[44:47], v[124:127], a[152:159], v7
    ds_read_b128 v[112:115], v0 offset:11264
    s_waitcnt lgkmcnt(4)
    v_mfma_f32_16x16x32_bf16 v[56:59], v[64:67], v[100:103], 0
    ds_read_b128 v[116:119], v0 offset:15360
    v_mfma_f32_16x16x32_bf16 v[60:63], v[68:71], v[100:103], 0
    s_waitcnt lgkmcnt(4)
    v_mfma_f32_16x16x32_bf16 v[56:59], v[72:75], v[96:99], v[56:59]
    s_waitcnt lgkmcnt(3)
    v_mfma_f32_16x16x32_bf16 v[56:59], v[76:79], v[108:111], v[56:59]
    ds_read_b128 v[64:67], v1 offset:24576
    s_waitcnt lgkmcnt(3)
    v_mfma_f32_16x16x32_bf16 v[56:59], v[80:83], v[104:107], v[56:59]
    ds_read_b128 v[68:71], v1 offset:25600
    v_add_f32 v40, v40, v42
    v_add_f32 v41, v41, v43
    v_mfma_f32_16x16x32_bf16 v[60:63], v[84:87], v[96:99], v[60:63]
    s_waitcnt lgkmcnt(2)
    v_add_f32 v44, v44, v46
    v_add_f32 v45, v45, v47
    v_smfmac_f32_16x16x64_bf16 v[36:39], v[112:115], v[96:103], v7
    ds_read_b128 v[80:83], v1 offset:28672
    v_max3_f32 v9, v56, v57, v58
    v_smfmac_f32_16x16x64_bf16 v[36:39], v[116:119], v[104:111], v7
    ds_read_b128 v[96:99], v0 offset:4096
    v_max_f32 v9, v9, v59
    v_mfma_f32_16x16x32_bf16 v[60:63], v[88:91], v[108:111], v[60:63]
    ds_read_b128 v[100:103], v0 offset:5120
    v_cvt_pk_bf16_f32 v42, v40, v41
    v_cvt_pk_bf16_f32 v43, v44, v45
    v_mfma_f32_16x16x32_bf16 v[60:63], v[92:95], v[104:107], v[60:63]
    ds_read_b128 v[84:87], v1 offset:29696
    v_add_f32 v36, v36, v38
    v_add_f32 v37, v37, v39
    v_max3_f32 v9, v9, v36, v37
    v_mov_b64 v[44:45], s[48:49]
    v_mov_b64 v[46:47], s[48:49]
    v_mov_b64 v[104:105], 0
    s_nop 0
    v_max3_f32 v10, v60, v61, v62
    v_max3_f32 v32, v9, v10, v63
    v_max3_f32 v33, v9, v10, v63
    v_mov_b64 v[106:107], 0
    v_mov_b64 v[108:109], 0
    v_permlane32_swap_b32 v32, v33
    v_max_f32 v34, v32, v33
    v_max_f32 v35, v32, v33
    v_mov_b64 v[110:111], 0
    v_mov_b64 v[40:41], 0
    v_permlane16_swap_b32 v34, v35
    v_max_f32 v32, v34, v35
    v_mul_f32 v32, s98, v32
    v_pk_fma_f32 v[36:37], v[36:37], s[98:99], v[32:33] op_sel_hi:[1,1,0] neg_lo:[0,0,1] neg_hi:[0,0,1]
    v_pk_fma_f32 v[56:57], v[56:57], s[98:99], v[32:33] op_sel_hi:[1,1,0] neg_lo:[0,0,1] neg_hi:[0,0,1]
    v_exp_f32 v36, v36
    v_exp_f32 v37, v37
    s_waitcnt lgkmcnt(0)
    s_buffer_load_dwordx16 s[16:31], s[8:11], s85
    s_buffer_load_dwordx16 s[32:47], s[8:11], s85 offset:64
    v_pk_fma_f32 v[58:59], v[58:59], s[98:99], v[32:33] op_sel_hi:[1,1,0] neg_lo:[0,0,1] neg_hi:[0,0,1]
    v_pk_fma_f32 v[60:61], v[60:61], s[98:99], v[32:33] op_sel_hi:[1,1,0] neg_lo:[0,0,1] neg_hi:[0,0,1]
    v_pk_fma_f32 v[62:63], v[62:63], s[98:99], v[32:33] op_sel_hi:[1,1,0] neg_lo:[0,0,1] neg_hi:[0,0,1]
    v_cvt_pk_bf16_f32 v28, v36, v37
    v_cvt_pk_bf16_f32 v31, v36, v37
    v_exp_f32 v56, v56
    v_exp_f32 v57, v57
    v_mfma_f32_16x16x16_bf16 v[124:127], v[44:45], v[28:29], 0
    v_exp_f32 v58, v58
    v_exp_f32 v59, v59
    v_mfma_f32_16x16x16_bf16 v[112:115], v[42:43], v[28:29], 0
    v_exp_f32 v60, v60
    v_exp_f32 v61, v61
    v_mfma_f32_16x16x16_bf16 v[116:119], v[42:43], v[30:31], 0
    v_exp_f32 v62, v62
    v_exp_f32 v63, v63
    v_cvt_pk_bf16_f32 v120, v56, v57
    v_cvt_pk_bf16_f32 v121, v58, v59
    v_cvt_pk_bf16_f32 v122, v60, v61
    v_cvt_pk_bf16_f32 v123, v62, v63
    s_nop 1
    v_mfma_f32_16x16x32_bf16 v[124:127], v[44:47], v[120:123], v[124:127]
    ds_read_b128 v[72:75], v1 offset:26624
    ds_read_b128 v[76:79], v1 offset:27648
    v_mfma_f32_16x16x32_bf16 v[112:115], v[96:99], v[120:123], v[112:115]
    ds_read_b128 v[88:91], v1 offset:30720
    ds_read_b128 v[92:95], v1 offset:31744
    v_mfma_f32_16x16x32_bf16 v[116:119], v[100:103], v[120:123], v[116:119]
    v_rcp_f32 v124, v124
    v_mov_b64 v[42:43], 0
    s_nop 1
    v_pk_mul_f32 v[112:113], v[112:113], v[124:125] op_sel_hi:[1,0]
    v_pk_mul_f32 v[114:115], v[114:115], v[124:125] op_sel_hi:[1,0]
    v_cvt_pk_bf16_f32 v32, v112, v113
    v_cvt_pk_bf16_f32 v33, v114, v115
    v_pk_mul_f32 v[116:117], v[116:117], v[124:125] op_sel_hi:[1,0]
    s_nop 0
    v_pk_mul_f32 v[118:119], v[118:119], v[124:125] op_sel_hi:[1,0]
    v_cvt_pk_bf16_f32 v34, v116, v117
    v_cvt_pk_bf16_f32 v35, v118, v119
    ds_write_b128 v0, v[32:35] offset:6144
    s_nop 0
    v_smfmac_f32_16x16x64_bf16 v[48:51], v[32:35], a[160:167], v7
    s_add_u32 s77, s79, 1865
    v_smfmac_f32_16x16x64_bf16 v[52:55], v[32:35], a[176:183], v7
    s_add_u32 s65, s68, 65536
    s_add_u32 s66, s69, 65536
    v_smfmac_f32_16x16x64_bf16 v[104:107], v[32:35], v[64:71], v7
    v_smfmac_f32_16x16x64_bf16 v[108:111], v[32:35], v[80:87], v7
    s_waitcnt lgkmcnt(0)
    s_barrier
    ds_read_b128 v[36:39], v0 offset:2048
    v_mov_b64 v[124:125], 0
    ds_read_b128 v[96:99], v0 offset:14336
    v_mov_b64 v[126:127], 0
    ds_read_b128 v[100:103], v0 offset:10240
    v_mov_b64 v[32:33], 0
    s_max_u32 s16, s16, s17
    s_max_u32 s16, s16, s18
    s_max_u32 s16, s16, s19
    v_mov_b64 v[34:35], 0
    s_max_u32 s16, s16, s20
    s_max_u32 s16, s16, s21
    s_max_u32 s16, s16, s22
    v_mov_b64 v[44:45], 0
    s_waitcnt lgkmcnt(2)
    v_smfmac_f32_16x16x64_bf16 v[48:51], v[36:39], a[168:175], v7
    s_max_u32 s16, s16, s23
    s_max_u32 s16, s16, s24
    s_waitcnt lgkmcnt(0)
    v_smfmac_f32_16x16x64_bf16 v[48:51], v[96:99], a[192:199], v7
    s_max_u32 s16, s16, s25
    s_max_u32 s16, s16, s26
    s_max_u32 s16, s16, s27
    v_smfmac_f32_16x16x64_bf16 v[48:51], v[100:103], a[200:207], v7
    s_max_u32 s16, s16, s28
    s_max_u32 s16, s16, s29
    s_max_u32 s16, s16, s30
    v_smfmac_f32_16x16x64_bf16 v[52:55], v[36:39], a[184:191], v7
    s_max_u32 s16, s16, s31
    s_max_u32 s16, s16, s32
    s_max_u32 s16, s16, s33
    v_smfmac_f32_16x16x64_bf16 v[52:55], v[96:99], a[208:215], v7
    v_cvt_pk_bf16_f32 v56, v48, v50
    v_cvt_pk_bf16_f32 v57, v49, v51
    v_smfmac_f32_16x16x64_bf16 v[52:55], v[100:103], a[216:223], v7
    buffer_store_dwordx2 v[56:57], v5, s[8:11], s68 offen
    s_max_u32 s16, s16, s34
    s_max_u32 s16, s16, s35
    v_smfmac_f32_16x16x64_bf16 v[104:107], v[36:39], v[72:79], v7
    s_max_u32 s16, s16, s36
    s_max_u32 s16, s16, s37
    s_max_u32 s16, s16, s38
    v_smfmac_f32_16x16x64_bf16 v[104:107], v[96:99], a[224:231], v7
    v_cvt_pk_bf16_f32 v58, v52, v54
    v_cvt_pk_bf16_f32 v59, v53, v55
    v_smfmac_f32_16x16x64_bf16 v[104:107], v[100:103], a[232:239], v7
    buffer_store_dwordx2 v[58:59], v5, s[8:11], s65 offen
    s_memtime s[82:83]
    s_max_u32 s16, s16, s39
    v_smfmac_f32_16x16x64_bf16 v[108:111], v[36:39], v[88:95], v7
    s_max_u32 s16, s16, s40
    s_max_u32 s16, s16, s41
    s_max_u32 s16, s16, s42
    v_smfmac_f32_16x16x64_bf16 v[108:111], v[96:99], a[240:247], v7
    s_max_u32 s16, s16, s43
    v_cvt_pk_bf16_f32 v60, v104, v106
    v_cvt_pk_bf16_f32 v61, v105, v107
    v_smfmac_f32_16x16x64_bf16 v[108:111], v[100:103], a[248:255], v7
    s_max_u32 s16, s16, s44
    s_max_u32 s16, s16, s45
    s_max_u32 s16, s16, s46
    s_max_u32 s16, s16, s47
    s_waitcnt lgkmcnt(0)
    s_add_u32 s77, s16, s77
    s_sub_u32 s84, s77, s82
    s_cmp_lt_i32 s84, 24
    v_cvt_pk_bf16_f32 v62, v108, v110
    v_cvt_pk_bf16_f32 v63, v109, v111
    s_cbranch_scc0 CF1_wait
CF1_go:
    v_mov_b64 v[36:37], 0
    v_mov_b64 v[38:39], 0
    v_mov_b64 v[46:47], 0
    v_mov_b64 v[48:49], 0
    v_mov_b64 v[50:51], 0
    v_mov_b64 v[52:53], 0
    v_mov_b64 v[54:55], 0
    v_mov_b64 v[112:113], v[26:27]
    v_mov_b64 v[114:115], v[26:27]
    s_mov_b32 s72, s71
    s_add_u32 s71, s71, 8192
    s_cmp_eq_u32 s71, 0xe6000
    s_cselect_b32 s71, 0xe0000, s71
    s_add_u32 s73, s71, 0xfffdf800
    s_add_u32 s4, s73, 5120
    s_mov_b32 m0, s95
    v_xor_b32 v25, 8192, v25
    s_add_u32 s76, s74, 0x82000
    s_add_u32 s74, s74, 0x80000
    s_xor_b32 s94, s94, 8192
    buffer_load_dwordx4 v[116:119], v0, s[8:11], s93 offen offset:0 sc1
    buffer_load_dwordx4 v[120:123], v0, s[8:11], s93 offen offset:1024 sc1
    ds_read_b128 v[64:67], v1 offset:0
    ds_read_b128 v[68:71], v1 offset:1024
    ds_read_b128 v[72:75], v1 offset:2048
    ds_read_b128 v[76:79], v1 offset:3072
    s_add_u32 s85, s85, 128
    s_add_u32 s91, s91, 128
    s_add_u32 s75, s75, 8192
    s_mov_b32 s70, s93
    s_add_u32 s64, s64, 1
    s_add_u32 s68, s68, 262144
    buffer_store_dwordx2 v[60:61], v5, s[8:11], s69 offen
    buffer_store_dwordx2 v[62:63], v5, s[8:11], s66 offen
    s_cmp_eq_u32 s68, 0xe0000
    s_cselect_b32 s68, 0x20000, s68
    s_cmp_eq_u32 s64, 63
    s_cbranch_scc1 CF1_last
    s_add_u32 s93, s68, s5
    s_add_u32 s69, s68, 131072
    s_branch CF1_p1w
CF1_entry:
    v_xor_b32 v25, 8192, v25
    s_add_u32 s76, s74, 0x82000
    s_add_u32 s74, s74, 0x80000
    s_xor_b32 s94, s94, 8192
    s_add_u32 s85, s85, 128
    s_add_u32 s91, s91, 128
    s_add_u32 s75, s75, 8192
    s_mov_b32 s70, s93
    s_add_u32 s64, s64, 1
    s_add_u32 s68, s68, 262144
    s_cmp_eq_u32 s68, 0xe0000
    s_cselect_b32 s68, 0x20000, s68
    s_add_u32 s93, s68, s5
    s_add_u32 s69, s68, 131072
    s_branch CF1_step2
CF1_last:
    s_waitcnt vmcnt(2)
    s_branch C_last1
CF1_p2retry:
    s_add_u32 s63, s63, 1
    s_cmp_gt_u32 s63, 400000
    s_cbranch_scc1 C_last
    v_cmp_le_u32 vcc, s78, v24
    s_cbranch_vccnz CF1_p1retry
    buffer_load_dwordx4 v[96:99], v0, s[8:11], s73 offen offset:3072 sc1
    buffer_load_dwordx4 v[112:115], v0, s[8:11], s4 offen offset:2048 sc1
    v_mov_b64 v[32:33], 0
    v_mov_b64 v[34:35], 0
    v_mov_b64 v[36:37], 0
    v_mov_b64 v[38:39], 0
    s_waitcnt vmcnt(0) lgkmcnt(0)
    v_max3_u32 v9, v112, v113, v114
    v_max_u32 v9, v9, v115
    v_cmp_le_u32 vcc, s78, v9
    s_cbranch_vccnz CF1_p2retry
    s_branch CF1_step2
CF1_wait:
    s_sub_u32 s84, s84, 64
    s_cbranch_scc1 CF1_go
CF1_twl:
    s_sub_u32 s84, s84, 16
    s_cbranch_scc1 CF1_go
    s_sub_u32 s84, s84, 16
    s_cbranch_scc1 CF1_go
    s_sub_u32 s84, s84, 16
    s_cbranch_scc1 CF1_go
    s_sub_u32 s84, s84, 16
    s_cbranch_scc1 CF1_go
    s_sub_u32 s84, s84, 16
    s_cbranch_scc1 CF1_go
    s_sub_u32 s84, s84, 16
    s_cbranch_scc1 CF1_go
    s_sub_u32 s84, s84, 16
    s_cbranch_scc1 CF1_go
    s_sub_u32 s84, s84, 16
    s_cbranch_scc1 CF1_go
    s_sub_u32 s84, s84, 16
    s_cbranch_scc1 CF1_go
    s_sub_u32 s84, s84, 16
    s_cbranch_scc1 CF1_go
    s_sub_u32 s84, s84, 16
    s_cbranch_scc1 CF1_go
    s_sub_u32 s84, s84, 16
    s_cbranch_scc1 CF1_go
    s_min_u32 s84, s84, 2000
    s_sub_u32 s84, s84, 36
    s_cbranch_scc0 CF1_twl
    s_branch CF1_go
CF1_ownretry:
    s_add_u32 s87, s64, 1
    buffer_load_dwordx4 v[112:115], v0, s[8:11], s4 offen offset:2048 sc1
    s_waitcnt vmcnt(0)
    v_max3_u32 v9, v112, v113, v114
    v_max_u32 v9, v9, v115
    ds_write_b128 v0, v[112:115] offset:6144
    v_cmp_le_u32 vcc, s78, v9
    s_add_u32 s63, s63, 1
    s_cmp_gt_u32 s63, 400000
    s_waitcnt lgkmcnt(0)
    s_cbranch_scc1 CF1_ownok
    s_cbranch_vccz CF1_ownok
    s_branch CF1_ownretry
CF1_p1retry:
    v_max3_u32 v9, v116, v117, v118
    v_max3_u32 v100, v119, v120, v121
    v_max3_u32 v9, v9, v122, v123
    v_max_u32 v9, v9, v100
    v_cmp_eq_u32 vcc, -1, v9
    v_mov_b64 v[124:125], 0
    v_mov_b64 v[126:127], 0
    v_mov_b64 v[112:113], v[26:27]
    v_mov_b64 v[114:115], v[26:27]
    s_cbranch_vccz CF1_p1nan
    buffer_load_dwordx4 v[116:119], v0, s[8:11], s70 offen offset:0 sc1
    buffer_load_dwordx4 v[120:123], v0, s[8:11], s70 offen offset:1024 sc1
    s_add_u32 s63, s63, 1
    s_waitcnt vmcnt(0)
    s_cmp_gt_u32 s63, 400000
    s_cbranch_scc0 CF1_p1retry
CF1_p1nan:
    s_nop 0
    v_smfmac_f32_16x16x64_bf16 v[124:127], v[112:115], v[116:123], v11
    s_nop 7
    v_add_f32_dpp v100, v124, v124 row_ror:8 row_mask:0xf bank_mask:0xf
    v_add_f32_dpp v101, v125, v125 row_ror:8 row_mask:0xf bank_mask:0xf
    s_nop 0
    v_add_f32_dpp v102, v100, v100 row_ror:4 row_mask:0xf bank_mask:0xf
    v_add_f32_dpp v103, v101, v101 row_ror:4 row_mask:0xf bank_mask:0xf
    v_cvt_pk_bf16_f32 v24, v102, v103
    v_min_u32 v24, 0xffbfffff, v24
    buffer_store_dword v24, v6, s[8:11], s71 offen
    v_mov_b32 v96, -1
    s_branch CF1_post
.p2align 6
    s_nop 0
    s_nop 0
    s_nop 0
    s_nop 0
    s_nop 0
    s_nop 0
    s_nop 0
    s_nop 0
CF2_p1w:
    s_waitcnt vmcnt(1)
    v_smfmac_f32_16x16x64_bf16 v[124:127], v[112:115], v[116:123], v11
    s_nop 7
    v_add_f32_dpp v100, v124, v124 row_ror:8 row_mask:0xf bank_mask:0xf
    v_add_f32_dpp v101, v125, v125 row_ror:8 row_mask:0xf bank_mask:0xf
    s_nop 0
    v_add_f32_dpp v102, v100, v100 row_ror:4 row_mask:0xf bank_mask:0xf
    v_add_f32_dpp v103, v101, v101 row_ror:4 row_mask:0xf bank_mask:0xf
    v_cvt_pk_bf16_f32 v24, v102, v103
    buffer_store_dword v24, v6, s[8:11], s71 offen
    v_cmp_le_u32 vcc, s78, v24
    s_cbranch_vccnz CF2_p1retry
CF2_step:
    s_waitcnt vmcnt(1)
CF2_step2:
    v_max3_u32 v9, v96, v97, v98
    v_max_u32 v9, v9, v99
    ds_write_b128 v0, v[96:99] offset:11264
    v_smfmac_f32_16x16x64_bf16 v[32:35], v[96:99], v[64:71], v7
    v_cmp_le_u32 vcc, s78, v9
    v_smfmac_f32_16x16x64_bf16 v[36:39], v[96:99], v[72:79], v7
    s_cbranch_vccnz CF2_p2retry
    v_smfmac_f32_16x16x64_bf16 v[48:51], v[96:99], v[80:87], v7
    v_smfmac_f32_16x16x64_bf16 v[52:55], v[96:99], v[88:95], v7
    s_waitcnt lgkmcnt(0)
    s_barrier
    s_memtime s[82:83]
    ds_read_b128 v[100:103], v0 offset:15360
    buffer_load_dwordx4 v[112:115], v0, s[8:11], s4 offen offset:2048 sc1
    v_smfmac_f32_16x16x64_bf16 v[40:43], v[96:99], v[56:63], v7
    buffer_load_dwordx4 v0, s[8:11], s4 offen offset:2048 sc1 lds
    ds_read_b128 v[64:67], v1 offset:12288
    v_smfmac_f32_16x16x64_bf16 v[44:47], v[96:99], v[104:111], v7
    ds_read_b128 v[68:71], v1 offset:13312
    s_waitcnt lgkmcnt(2)
    v_smfmac_f32_16x16x64_bf16 v[32:35], v[100:103], v[128:135], v7
    ds_read_b128 v[104:107], v0 offset:3072
    s_sub_u32 s84, s82, s6
    ds_read_b128 v[72:75], v1 offset:14336
    v_mov_b32 v9, s84
    v_smfmac_f32_16x16x64_bf16 v[36:39], v[100:103], v[136:143], v7
    buffer_store_dword v9, off, s[8:11], s91
    s_mov_b32 m0, s94
    ds_read_b128 v[76:79], v1 offset:15360
    v_smfmac_f32_16x16x64_bf16 v[48:51], v[100:103], v[224:231], v7
    buffer_load_dwordx4 v0, s[8:11], s74 offen offset:0 sc1 lds
    ds_read_b128 v[80:83], v1 offset:16384
    v_smfmac_f32_16x16x64_bf16 v[52:55], v[100:103], v[232:239], v7
    buffer_load_dwordx4 v0, s[8:11], s74 offen offset:1024 sc1 lds
    v_smfmac_f32_16x16x64_bf16 v[40:43], v[100:103], a[64:71], v7
    ds_read_b128 v[108:111], v0 offset:7168
    buffer_load_dwordx4 v[16:19], v0, s[8:11], s76 offen offset:0 sc1
    v_smfmac_f32_16x16x64_bf16 v[44:47], v[100:103], a[72:79], v7
    ds_read_b128 v[84:87], v1 offset:17408
    s_waitcnt lgkmcnt(5)
    v_smfmac_f32_16x16x64_bf16 v[48:51], v[104:107], v[240:247], v7
    buffer_load_dwordx4 v[20:23], v0, s[8:11], s76 offen offset:1024 sc1
    v_smfmac_f32_16x16x64_bf16 v[52:55], v[104:107], v[248:255], v7
    ds_read_b128 v[88:91], v1 offset:18432
    s_waitcnt lgkmcnt(4)
    v_smfmac_f32_16x16x64_bf16 v[32:35], v[104:107], v[64:71], v7
    buffer_store_dword v24, v6, s[8:11], s75 offen sc1
    v_smfmac_f32_16x16x64_bf16 v[36:39], v[104:107], v[72:79], v7
    ds_read_b128 v[92:95], v1 offset:19456
    s_waitcnt lgkmcnt(3)
    v_smfmac_f32_16x16x64_bf16 v[32:35], v[108:111], v[144:151], v7
    ds_read_b128 v[64:67], v1 offset:20480
    v_smfmac_f32_16x16x64_bf16 v[36:39], v[108:111], v[152:159], v7
    ds_read_b128 v[68:71], v1 offset:21504
    v_smfmac_f32_16x16x64_bf16 v[48:51], v[108:111], a[0:7], v7
    s_waitcnt vmcnt(6)
    v_max3_u32 v9, v112, v113, v114
    v_max_u32 v9, v9, v115
    v_smfmac_f32_16x16x64_bf16 v[52:55], v[108:111], a[8:15], v7
    ds_read_b128 v[72:75], v1 offset:22528
    s_waitcnt lgkmcnt(3)
    v_cmp_le_u32 vcc, s78, v9
    v_smfmac_f32_16x16x64_bf16 v[40:43], v[104:107], v[80:87], v7
    ds_read_b128 v[76:79], v1 offset:23552
    v_smfmac_f32_16x16x64_bf16 v[44:47], v[104:107], v[88:95], v7
    s_cbranch_vccnz CF2_ownretry
CF2_ownok:
    s_barrier
    v_smfmac_f32_16x16x64_bf16 v[32:35], v[112:115], v[160:167], v7
    ds_read_b128 v[116:119], v0 offset:14336
    ds_read_b128 v[120:123], v0 offset:2048
    v_smfmac_f32_16x16x64_bf16 v[36:39], v[112:115], v[168:175], v7
    ds_read_b128 v[124:127], v0 offset:6144
    s_waitcnt lgkmcnt(3)
    v_smfmac_f32_16x16x64_bf16 v[48:51], v[112:115], v[64:71], v7
    ds_read_b128 v[80:83], v25 offset:17408
    v_smfmac_f32_16x16x64_bf16 v[52:55], v[112:115], v[72:79], v7
    ds_read_b128 v[84:87], v25 offset:23552
    s_waitcnt lgkmcnt(4)
    v_smfmac_f32_16x16x64_bf16 v[32:35], v[116:119], v[176:183], v7
    buffer_store_dwordx4 v[12:15], v0, s[8:11], s70 offen offset:0
    s_waitcnt lgkmcnt(2)
    v_smfmac_f32_16x16x64_bf16 v[32:35], v[120:123], v[192:199], v7
    ds_read_b128 v[88:91], v25 offset:20480
    v_smfmac_f32_16x16x64_bf16 v[32:35], v[124:127], v[208:215], v7
    ds_read_b128 v[92:95], v25 offset:21504
    v_smfmac_f32_16x16x64_bf16 v[36:39], v[116:119], v[184:191], v7
    ds_read_b128 v[64:67], v25 offset:18432
    v_smfmac_f32_16x16x64_bf16 v[36:39], v[120:123], v[200:207], v7
    ds_read_b128 v[68:71], v25 offset:22528
    v_add_f32 v32, v32, v34
    v_smfmac_f32_16x16x64_bf16 v[36:39], v[124:127], v[216:223], v7
    ds_read_b128 v[72:75], v25 offset:19456
    v_add_f32 v33, v33, v35
    v_smfmac_f32_16x16x64_bf16 v[48:51], v[116:119], a[16:23], v7
    ds_read_b128 v[76:79], v25 offset:16384
    v_smfmac_f32_16x16x64_bf16 v[48:51], v[120:123], a[32:39], v7
    v_add_f32 v36, v36, v38
    v_add_f32 v37, v37, v39
    v_smfmac_f32_16x16x64_bf16 v[48:51], v[124:127], a[48:55], v7
    buffer_store_dwordx4 v[12:15], v0, s[8:11], s70 offen offset:1024
    v_cvt_pk_bf16_f32 v34, v32, v36
    v_cvt_pk_bf16_f32 v35, v33, v37
    v_smfmac_f32_16x16x64_bf16 v[52:55], v[116:119], a[24:31], v7
    ds_write2_b32 v2, v34, v35 offset0:0 offset1:4
    v_mov_b64 v[36:37], 0
    v_smfmac_f32_16x16x64_bf16 v[52:55], v[120:123], a[40:47], v7
    v_add_f32 v48, v48, v50
    v_smfmac_f32_16x16x64_bf16 v[52:55], v[124:127], a[56:63], v7
    v_add_f32 v49, v49, v51
    v_smfmac_f32_16x16x64_bf16 v[40:43], v[108:111], a[80:87], v7
    buffer_store_dword v12, v6, s[8:11], s72 offen
    v_mov_b64 v[38:39], 0
    v_smfmac_f32_16x16x64_bf16 v[44:47], v[108:111], a[88:95], v7
    v_add_f32 v52, v52, v54
    v_add_f32 v53, v53, v55
    v_cvt_pk_bf16_f32 v32, v48, v52
    v_cvt_pk_bf16_f32 v33, v49, v53
    v_smfmac_f32_16x16x64_bf16 v[40:43], v[112:115], a[96:103], v7
    ds_write2_b32 v3, v32, v33 offset0:0 offset1:4
    v_mov_b64 v[48:49], 0
    v_smfmac_f32_16x16x64_bf16 v[44:47], v[112:115], a[104:111], v7
    v_mov_b64 v[50:51], 0
    v_smfmac_f32_16x16x64_bf16 v[40:43], v[116:119], a[112:119], v7
    ds_read_b128 v[104:107], v4 offset:7168
    v_mov_b64 v[52:53], 0
    v_smfmac_f32_16x16x64_bf16 v[44:47], v[116:119], a[120:127], v7
    v_mov_b64 v[54:55], 0
    v_smfmac_f32_16x16x64_bf16 v[40:43], v[120:123], a[128:135], v7
    s_waitcnt lgkmcnt(1)
    s_barrier
    ds_read_b128 v[108:111], v4 offset:7200
    v_smfmac_f32_16x16x64_bf16 v[44:47], v[120:123], a[136:143], v7
    ds_read_b128 v[96:99], v4 offset:3072
    v_smfmac_f32_16x16x64_bf16 v[40:43], v[124:127], a[144:151], v7
    ds_read_b128 v[100:103], v4 offset:3104
    v_smfmac_f32_16x16x64_bf16 v[44:47], v[124:127], a[152:159], v7
    ds_read_b128 v[112:115], v0 offset:11264
    s_waitcnt lgkmcnt(4)
    v_mfma_f32_16x16x32_bf16 v[56:59], v[64:67], v[104:107], 0
    ds_read_b128 v[116:119], v0 offset:15360
    v_mfma_f32_16x16x32_bf16 v[60:63], v[68:71], v[104:107], 0
    s_waitcnt lgkmcnt(4)
    v_mfma_f32_16x16x32_bf16 v[56:59], v[72:75], v[108:111], v[56:59]
    s_waitcnt lgkmcnt(3)
    v_mfma_f32_16x16x32_bf16 v[56:59], v[76:79], v[96:99], v[56:59]
    ds_read_b128 v[64:67], v1 offset:24576
    s_waitcnt lgkmcnt(3)
    v_mfma_f32_16x16x32_bf16 v[56:59], v[80:83], v[100:103], v[56:59]
    ds_read_b128 v[68:71], v1 offset:25600
    v_add_f32 v40, v40, v42
    v_add_f32 v41, v41, v43
    v_mfma_f32_16x16x32_bf16 v[60:63], v[84:87], v[108:111], v[60:63]
    s_waitcnt lgkmcnt(2)
    v_add_f32 v44, v44, v46
    v_add_f32 v45, v45, v47
    v_smfmac_f32_16x16x64_bf16 v[36:39], v[112:115], v[96:103], v7
    ds_read_b128 v[80:83], v1 offset:28672
    v_max3_f32 v9, v56, v57, v58
    v_smfmac_f32_16x16x64_bf16 v[36:39], v[116:119], v[104:111], v7
    v_max_f32 v9, v9, v59
    v_mfma_f32_16x16x32_bf16 v[60:63], v[88:91], v[96:99], v[60:63]
    ds_read_b128 v[96:99], v0 offset:8192
    v_cvt_pk_bf16_f32 v42, v40, v41
    v_cvt_pk_bf16_f32 v43, v44, v45
    v_mfma_f32_16x16x32_bf16 v[60:63], v[92:95], v[100:103], v[60:63]
    ds_read_b128 v[100:103], v0 offset:9216
    ds_read_b128 v[84:87], v1 offset:29696
    v_add_f32 v36, v36, v38
    v_add_f32 v37, v37, v39
    v_max3_f32 v9, v9, v36, v37
    v_mov_b64 v[44:45], s[48:49]
    v_mov_b64 v[46:47], s[48:49]
    v_mov_b64 v[104:105], 0
    v_max3_f32 v10, v60, v61, v62
    v_max3_f32 v32, v9, v10, v63
    v_max3_f32 v33, v9, v10, v63
    v_mov_b64 v[106:107], 0
    v_mov_b64 v[108:109], 0
    v_permlane32_swap_b32 v32, v33
    v_max_f32 v34, v32, v33
    v_max_f32 v35, v32, v33
    v_mov_b64 v[110:111], 0
    v_mov_b64 v[40:41], 0
    v_permlane16_swap_b32 v34, v35
    v_max_f32 v32, v34, v35
    v_mul_f32 v32, s98, v32
    v_pk_fma_f32 v[36:37], v[36:37], s[98:99], v[32:33] op_sel_hi:[1,1,0] neg_lo:[0,0,1] neg_hi:[0,0,1]
    v_pk_fma_f32 v[56:57], v[56:57], s[98:99], v[32:33] op_sel_hi:[1,1,0] neg_lo:[0,0,1] neg_hi:[0,0,1]
    v_exp_f32 v36, v36
    v_exp_f32 v37, v37
    s_waitcnt lgkmcnt(0)
    s_buffer_load_dwordx16 s[16:31], s[8:11], s85
    s_buffer_load_dwordx16 s[32:47], s[8:11], s85 offset:64
    v_pk_fma_f32 v[58:59], v[58:59], s[98:99], v[32:33] op_sel_hi:[1,1,0] neg_lo:[0,0,1] neg_hi:[0,0,1]
    v_pk_fma_f32 v[60:61], v[60:61], s[98:99], v[32:33] op_sel_hi:[1,1,0] neg_lo:[0,0,1] neg_hi:[0,0,1]
    v_pk_fma_f32 v[62:63], v[62:63], s[98:99], v[32:33] op_sel_hi:[1,1,0] neg_lo:[0,0,1] neg_hi:[0,0,1]
    v_cvt_pk_bf16_f32 v28, v36, v37
    v_cvt_pk_bf16_f32 v31, v36, v37
    v_exp_f32 v56, v56
    v_exp_f32 v57, v57
    v_mfma_f32_16x16x16_bf16 v[124:127], v[44:45], v[28:29], 0
    v_exp_f32 v58, v58
    v_exp_f32 v59, v59
    v_mfma_f32_16x16x16_bf16 v[112:115], v[42:43], v[28:29], 0
    v_exp_f32 v60, v60
    v_exp_f32 v61, v61
    v_mfma_f32_16x16x16_bf16 v[116:119], v[42:43], v[30:31], 0
    v_exp_f32 v62, v62
    v_exp_f32 v63, v63
    v_cvt_pk_bf16_f32 v120, v56, v57
    v_cvt_pk_bf16_f32 v121, v58, v59
    v_cvt_pk_bf16_f32 v122, v60, v61
    v_cvt_pk_bf16_f32 v123, v62, v63
    s_nop 1
    v_mfma_f32_16x16x32_bf16 v[124:127], v[44:47], v[120:123], v[124:127]
    ds_read_b128 v[72:75], v1 offset:26624
    ds_read_b128 v[76:79], v1 offset:27648
    v_mfma_f32_16x16x32_bf16 v[112:115], v[96:99], v[120:123], v[112:115]
    ds_read_b128 v[88:91], v1 offset:30720
    ds_read_b128 v[92:95], v1 offset:31744
    v_mfma_f32_16x16x32_bf16 v[116:119], v[100:103], v[120:123], v[116:119]
    v_rcp_f32 v124, v124
    v_mov_b64 v[42:43], 0
    s_nop 1
    v_pk_mul_f32 v[112:113], v[112:113], v[124:125] op_sel_hi:[1,0]
    v_pk_mul_f32 v[114:115], v[114:115], v[124:125] op_sel_hi:[1,0]
    v_cvt_pk_bf16_f32 v32, v112, v113
    v_cvt_pk_bf16_f32 v33, v114, v115
    v_pk_mul_f32 v[116:117], v[116:117], v[124:125] op_sel_hi:[1,0]
    s_nop 0
    v_pk_mul_f32 v[118:119], v[118:119], v[124:125] op_sel_hi:[1,0]
    v_cvt_pk_bf16_f32 v34, v116, v117
    v_cvt_pk_bf16_f32 v35, v118, v119
    ds_write_b128 v0, v[32:35] offset:10240
    s_nop 0
    v_smfmac_f32_16x16x64_bf16 v[48:51], v[32:35], a[160:167], v7
    s_add_u32 s77, s79, 1865
    v_smfmac_f32_16x16x64_bf16 v[52:55], v[32:35], a[176:183], v7
    s_add_u32 s65, s68, 65536
    s_add_u32 s66, s69, 65536
    v_smfmac_f32_16x16x64_bf16 v[104:107], v[32:35], v[64:71], v7
    v_smfmac_f32_16x16x64_bf16 v[108:111], v[32:35], v[80:87], v7
    s_waitcnt lgkmcnt(0)
    s_barrier
    ds_read_b128 v[36:39], v0 offset:14336
    v_mov_b64 v[124:125], 0
    ds_read_b128 v[96:99], v0 offset:2048
    v_mov_b64 v[126:127], 0
    ds_read_b128 v[100:103], v0 offset:6144
    v_mov_b64 v[32:33], 0
    s_max_u32 s16, s16, s17
    s_max_u32 s16, s16, s18
    s_max_u32 s16, s16, s19
    v_mov_b64 v[34:35], 0
    s_max_u32 s16, s16, s20
    s_max_u32 s16, s16, s21
    s_max_u32 s16, s16, s22
    v_mov_b64 v[44:45], 0
    s_waitcnt lgkmcnt(2)
    v_smfmac_f32_16x16x64_bf16 v[48:51], v[36:39], a[168:175], v7
    s_max_u32 s16, s16, s23
    s_max_u32 s16, s16, s24
    s_waitcnt lgkmcnt(0)
    v_smfmac_f32_16x16x64_bf16 v[48:51], v[96:99], a[192:199], v7
    s_max_u32 s16, s16, s25
    s_max_u32 s16, s16, s26
    s_max_u32 s16, s16, s27
    v_smfmac_f32_16x16x64_bf16 v[48:51], v[100:103], a[200:207], v7
    s_max_u32 s16, s16, s28
    s_max_u32 s16, s16, s29
    s_max_u32 s16, s16, s30
    v_smfmac_f32_16x16x64_bf16 v[52:55], v[36:39], a[184:191], v7
    s_max_u32 s16, s16, s31
    s_max_u32 s16, s16, s32
    s_max_u32 s16, s16, s33
    v_smfmac_f32_16x16x64_bf16 v[52:55], v[96:99], a[208:215], v7
    v_cvt_pk_bf16_f32 v56, v48, v50
    v_cvt_pk_bf16_f32 v57, v49, v51
    v_smfmac_f32_16x16x64_bf16 v[52:55], v[100:103], a[216:223], v7
    buffer_store_dwordx2 v[56:57], v5, s[8:11], s68 offen
    s_max_u32 s16, s16, s34
    s_max_u32 s16, s16, s35
    v_smfmac_f32_16x16x64_bf16 v[104:107], v[36:39], v[72:79], v7
    s_max_u32 s16, s16, s36
    s_max_u32 s16, s16, s37
    s_max_u32 s16, s16, s38
    v_smfmac_f32_16x16x64_bf16 v[104:107], v[96:99], a[224:231], v7
    v_cvt_pk_bf16_f32 v58, v52, v54
    v_cvt_pk_bf16_f32 v59, v53, v55
    v_smfmac_f32_16x16x64_bf16 v[104:107], v[100:103], a[232:239], v7
    buffer_store_dwordx2 v[58:59], v5, s[8:11], s65 offen
    s_memtime s[82:83]
    s_max_u32 s16, s16, s39
    v_smfmac_f32_16x16x64_bf16 v[108:111], v[36:39], v[88:95], v7
    s_max_u32 s16, s16, s40
    s_max_u32 s16, s16, s41
    s_max_u32 s16, s16, s42
    v_smfmac_f32_16x16x64_bf16 v[108:111], v[96:99], a[240:247], v7
    s_max_u32 s16, s16, s43
    v_cvt_pk_bf16_f32 v60, v104, v106
    v_cvt_pk_bf16_f32 v61, v105, v107
    v_smfmac_f32_16x16x64_bf16 v[108:111], v[100:103], a[248:255], v7
    s_max_u32 s16, s16, s44
    s_max_u32 s16, s16, s45
    s_max_u32 s16, s16, s46
    s_max_u32 s16, s16, s47
    s_waitcnt lgkmcnt(0)
    s_add_u32 s77, s16, s77
    s_sub_u32 s84, s77, s82
    s_cmp_lt_i32 s84, 24
    v_cvt_pk_bf16_f32 v62, v108, v110
    v_cvt_pk_bf16_f32 v63, v109, v111
    s_cbranch_scc0 CF2_wait
CF2_go:
    s_waitcnt vmcnt(6)
    ds_write_b128 v0, v[16:19] offset:8192
    ds_write_b128 v0, v[20:23] offset:9216
    ds_read_b128 v[64:67], v1 offset:0
    ds_read_b128 v[68:71], v1 offset:1024
    ds_read_b128 v[72:75], v1 offset:2048
    ds_read_b128 v[76:79], v1 offset:3072
    ds_read_b128 v[80:83], v1 offset:4096
    ds_read_b128 v[84:87], v1 offset:5120
    ds_read_b128 v[88:91], v1 offset:6144
    ds_read_b128 v[92:95], v1 offset:7168
    ds_read_b128 v[104:107], v1 offset:10240
    ds_read_b128 v[108:111], v1 offset:11264
    v_mov_b64 v[36:37], 0
    v_mov_b64 v[38:39], 0
    v_mov_b64 v[46:47], 0
    v_mov_b64 v[48:49], 0
    v_mov_b64 v[50:51], 0
    v_mov_b64 v[52:53], 0
    v_mov_b64 v[54:55], 0
    v_mov_b64 v[112:113], v[26:27]
    v_mov_b64 v[114:115], v[26:27]
    s_mov_b32 s72, s71
    s_add_u32 s71, s71, 8192
    s_cmp_eq_u32 s71, 0xe6000
    s_cselect_b32 s71, 0xe0000, s71
    s_add_u32 s73, s71, 0xfffdfc00
    s_add_u32 s4, s73, 5120
    s_mov_b32 m0, s95
    v_xor_b32 v25, 8192, v25
    s_add_u32 s76, s74, 0x82000
    s_add_u32 s74, s74, 0x80000
    buffer_store_dwordx2 v[60:61], v5, s[8:11], s69 offen
    buffer_store_dwordx2 v[62:63], v5, s[8:11], s66 offen
    s_xor_b32 s94, s94, 8192
    s_add_u32 s85, s85, 128
    s_add_u32 s91, s91, 128
    s_add_u32 s75, s75, 8192
    s_mov_b32 s70, s93
    s_add_u32 s64, s64, 1
    s_add_u32 s68, s68, 262144
    s_cmp_eq_u32 s68, 0xe0000
    s_cselect_b32 s68, 0x20000, s68
    ds_read_b128 v[56:59], v1 offset:8192
    ds_read_b128 v[60:63], v1 offset:9216
    s_waitcnt lgkmcnt(0)
    s_memtime s[82:83]
    s_waitcnt lgkmcnt(0)
    s_sub_u32 s84, s77, s82
    s_add_u32 s84, s84, s86
    s_max_i32 s84, s84, 0
    s_sub_u32 s84, s84, 16
    s_cbranch_scc1 CF2_go1
    s_sub_u32 s84, s84, 16
    s_cbranch_scc1 CF2_go1
    s_sub_u32 s84, s84, 16
    s_cbranch_scc1 CF2_go1
    s_sub_u32 s84, s84, 16
    s_cbranch_scc1 CF2_go1
    s_sub_u32 s84, s84, 16
    s_cbranch_scc1 CF2_go1
    s_sub_u32 s84, s84, 16
    s_cbranch_scc1 CF2_go1
    s_sub_u32 s84, s84, 16
    s_cbranch_scc1 CF2_go1
    s_sub_u32 s84, s84, 16
    s_cbranch_scc1 CF2_go1
    s_sub_u32 s84, s84, 16
    s_cbranch_scc1 CF2_go1
    s_sub_u32 s84, s84, 16
    s_cbranch_scc1 CF2_go1
    s_sub_u32 s84, s84, 16
    s_cbranch_scc1 CF2_go1
    s_sub_u32 s84, s84, 16
    s_cbranch_scc1 CF2_go1
    s_sub_u32 s84, s84, 16
    s_cbranch_scc1 CF2_go1
    s_sub_u32 s84, s84, 16
    s_cbranch_scc1 CF2_go1
    s_sub_u32 s84, s84, 16
    s_cbranch_scc1 CF2_go1
    s_sub_u32 s84, s84, 16
    s_cbranch_scc1 CF2_go1
CF2_go1:
    buffer_load_dwordx4 v[116:119], v0, s[8:11], s93 offen offset:0 sc1
    buffer_load_dwordx4 v[120:123], v0, s[8:11], s93 offen offset:1024 sc1
    s_cmp_eq_u32 s64, 63
    s_cbranch_scc1 CF2_last
    s_add_u32 s93, s68, s5
    s_add_u32 s69, s68, 131072
    s_nop 15
    s_nop 15
    buffer_load_dwordx4 v[96:99], v0, s[8:11], s73 offen offset:3072 sc1
    s_branch CF2_p1w
CF2_entry:
    v_xor_b32 v25, 8192, v25
    s_add_u32 s76, s74, 0x82000
    s_add_u32 s74, s74, 0x80000
    s_xor_b32 s94, s94, 8192
    s_add_u32 s85, s85, 128
    s_add_u32 s91, s91, 128
    s_add_u32 s75, s75, 8192
    s_mov_b32 s70, s93
    s_add_u32 s64, s64, 1
    s_add_u32 s68, s68, 262144
    s_cmp_eq_u32 s68, 0xe0000
    s_cselect_b32 s68, 0x20000, s68
    s_add_u32 s93, s68, s5
    s_add_u32 s69, s68, 131072
    s_branch CF2_step2
CF2_last:
    s_waitcnt vmcnt(0)
    s_branch C_last1
CF2_p2retry:
    s_add_u32 s63, s63, 1
    s_cmp_gt_u32 s63, 400000
    s_cbranch_scc1 C_last
    s_cmp_le_u32 s64, s3
    s_cbranch_scc1 CF2_noada
    s_mov_b32 s3, s64
    s_sub_u32 s84, s79, s6
    s_cmp_ge_u32 s84, 120
    s_cbranch_scc1 CF2_noada
    s_sub_u32 s6, s6, 12
CF2_noada:
    v_cmp_le_u32 vcc, s78, v24
    s_cbranch_vccnz CF2_p1retry
    buffer_load_dwordx4 v[96:99], v0, s[8:11], s73 offen offset:3072 sc1
    buffer_load_dwordx4 v[112:115], v0, s[8:11], s4 offen offset:2048 sc1
    v_mov_b64 v[32:33], 0
    v_mov_b64 v[34:35], 0
    v_mov_b64 v[36:37], 0
    v_mov_b64 v[38:39], 0
    s_waitcnt vmcnt(0) lgkmcnt(0)
    v_max3_u32 v9, v112, v113, v114
    v_max_u32 v9, v9, v115
    v_cmp_le_u32 vcc, s78, v9
    s_cbranch_vccnz CF2_p2retry
    s_branch CF2_step2
CF2_wait:
    s_sub_u32 s84, s84, 64
    s_cbranch_scc1 CF2_go
CF2_twl:
    s_sub_u32 s84, s84, 16
    s_cbranch_scc1 CF2_go
    s_sub_u32 s84, s84, 16
    s_cbranch_scc1 CF2_go
    s_sub_u32 s84, s84, 16
    s_cbranch_scc1 CF2_go
    s_sub_u32 s84, s84, 16
    s_cbranch_scc1 CF2_go
    s_sub_u32 s84, s84, 16
    s_cbranch_scc1 CF2_go
    s_sub_u32 s84, s84, 16
    s_cbranch_scc1 CF2_go
    s_sub_u32 s84, s84, 16
    s_cbranch_scc1 CF2_go
    s_sub_u32 s84, s84, 16
    s_cbranch_scc1 CF2_go
    s_sub_u32 s84, s84, 16
    s_cbranch_scc1 CF2_go
    s_sub_u32 s84, s84, 16
    s_cbranch_scc1 CF2_go
    s_sub_u32 s84, s84, 16
    s_cbranch_scc1 CF2_go
    s_sub_u32 s84, s84, 16
    s_cbranch_scc1 CF2_go
    s_min_u32 s84, s84, 2000
    s_sub_u32 s84, s84, 36
    s_cbranch_scc0 CF2_twl
    s_branch CF2_go
CF2_ownretry:
    s_add_u32 s87, s64, 1
    buffer_load_dwordx4 v[112:115], v0, s[8:11], s4 offen offset:2048 sc1
    s_waitcnt vmcnt(0)
    v_max3_u32 v9, v112, v113, v114
    v_max_u32 v9, v9, v115
    ds_write_b128 v0, v[112:115] offset:10240
    v_cmp_le_u32 vcc, s78, v9
    s_add_u32 s63, s63, 1
    s_cmp_gt_u32 s63, 400000
    s_waitcnt lgkmcnt(0)
    s_cbranch_scc1 CF2_ownok
    s_cbranch_vccz CF2_ownok
    s_branch CF2_ownretry
CF2_p1retry:
    v_max3_u32 v9, v116, v117, v118
    v_max3_u32 v100, v119, v120, v121
    v_max3_u32 v9, v9, v122, v123
    v_max_u32 v9, v9, v100
    v_cmp_eq_u32 vcc, -1, v9
    v_mov_b64 v[124:125], 0
    v_mov_b64 v[126:127], 0
    v_mov_b64 v[112:113], v[26:27]
    v_mov_b64 v[114:115], v[26:27]
    s_cbranch_vccz CF2_p1nan
    buffer_load_dwordx4 v[116:119], v0, s[8:11], s70 offen offset:0 sc1
    buffer_load_dwordx4 v[120:123], v0, s[8:11], s70 offen offset:1024 sc1
    s_add_u32 s63, s63, 1
    s_waitcnt vmcnt(0)
    s_cmp_gt_u32 s63, 400000
    s_cbranch_scc0 CF2_p1retry
CF2_p1nan:
    s_nop 0
    v_smfmac_f32_16x16x64_bf16 v[124:127], v[112:115], v[116:123], v11
    s_nop 7
    v_add_f32_dpp v100, v124, v124 row_ror:8 row_mask:0xf bank_mask:0xf
    v_add_f32_dpp v101, v125, v125 row_ror:8 row_mask:0xf bank_mask:0xf
    s_nop 0
    v_add_f32_dpp v102, v100, v100 row_ror:4 row_mask:0xf bank_mask:0xf
    v_add_f32_dpp v103, v101, v101 row_ror:4 row_mask:0xf bank_mask:0xf
    v_cvt_pk_bf16_f32 v24, v102, v103
    v_min_u32 v24, 0xffbfffff, v24
    buffer_store_dword v24, v6, s[8:11], s71 offen
    s_branch CF2_p2retry
.p2align 6
    s_nop 0
    s_nop 0
    s_nop 0
    s_nop 0
    s_nop 0
    s_nop 0
    s_nop 0
    s_nop 0
CF3_p1w:
    s_waitcnt vmcnt(1)
    v_smfmac_f32_16x16x64_bf16 v[124:127], v[112:115], v[116:123], v11
    s_nop 7
    v_add_f32_dpp v100, v124, v124 row_ror:8 row_mask:0xf bank_mask:0xf
    v_add_f32_dpp v101, v125, v125 row_ror:8 row_mask:0xf bank_mask:0xf
    s_nop 0
    v_add_f32_dpp v102, v100, v100 row_ror:4 row_mask:0xf bank_mask:0xf
    v_add_f32_dpp v103, v101, v101 row_ror:4 row_mask:0xf bank_mask:0xf
    v_cvt_pk_bf16_f32 v24, v102, v103
    buffer_store_dword v24, v6, s[8:11], s71 offen
    v_cmp_le_u32 vcc, s78, v24
    s_cbranch_vccnz CF3_p1retry
CF3_step:
    s_waitcnt vmcnt(1)
CF3_step2:
    v_max3_u32 v9, v96, v97, v98
    v_max_u32 v9, v9, v99
    ds_write_b128 v0, v[96:99] offset:15360
    v_smfmac_f32_16x16x64_bf16 v[32:35], v[96:99], v[64:71], v7
    v_cmp_le_u32 vcc, s78, v9
    v_smfmac_f32_16x16x64_bf16 v[36:39], v[96:99], v[72:79], v7
    s_cbranch_vccnz CF3_p2retry
    v_smfmac_f32_16x16x64_bf16 v[48:51], v[96:99], v[80:87], v7
    v_smfmac_f32_16x16x64_bf16 v[52:55], v[96:99], v[88:95], v7
    s_waitcnt lgkmcnt(0)
    s_barrier
    ds_read_b128 v[100:103], v0 offset:11264
    buffer_load_dwordx4 v[112:115], v0, s[8:11], s4 offen offset:2048 sc1
    v_smfmac_f32_16x16x64_bf16 v[40:43], v[96:99], v[56:63], v7
    buffer_load_dwordx4 v0, s[8:11], s4 offen offset:2048 sc1 lds
    ds_read_b128 v[64:67], v1 offset:12288
    v_smfmac_f32_16x16x64_bf16 v[44:47], v[96:99], v[104:111], v7
    ds_read_b128 v[68:71], v1 offset:13312
    s_waitcnt lgkmcnt(2)
    v_smfmac_f32_16x16x64_bf16 v[32:35], v[100:103], v[128:135], v7
    ds_read_b128 v[104:107], v0 offset:7168
    ds_read_b128 v[72:75], v1 offset:14336
    v_smfmac_f32_16x16x64_bf16 v[36:39], v[100:103], v[136:143], v7
    s_mov_b32 m0, s94
    ds_read_b128 v[76:79], v1 offset:15360
    v_smfmac_f32_16x16x64_bf16 v[48:51], v[100:103], v[224:231], v7
    buffer_load_dwordx4 v0, s[8:11], s74 offen offset:0 sc1 lds
    ds_read_b128 v[80:83], v1 offset:16384
    v_smfmac_f32_16x16x64_bf16 v[52:55], v[100:103], v[232:239], v7
    buffer_load_dwordx4 v0, s[8:11], s74 offen offset:1024 sc1 lds
    ds_read_b128 v[84:87], v1 offset:17408
    v_smfmac_f32_16x16x64_bf16 v[40:43], v[100:103], a[64:71], v7
    ds_read_b128 v[108:111], v0 offset:3072
    v_smfmac_f32_16x16x64_bf16 v[44:47], v[100:103], a[72:79], v7
    buffer_load_dwordx4 v[16:19], v0, s[8:11], s76 offen offset:0 sc1
    s_waitcnt lgkmcnt(5)
    v_smfmac_f32_16x16x64_bf16 v[48:51], v[104:107], v[240:247], v7
    ds_read_b128 v[88:91], v1 offset:18432
    v_smfmac_f32_16x16x64_bf16 v[52:55], v[104:107], v[248:255], v7
    buffer_load_dwordx4 v[20:23], v0, s[8:11], s76 offen offset:1024 sc1
    s_waitcnt lgkmcnt(4)
    v_smfmac_f32_16x16x64_bf16 v[32:35], v[104:107], v[64:71], v7
    ds_read_b128 v[92:95], v1 offset:19456
    v_smfmac_f32_16x16x64_bf16 v[36:39], v[104:107], v[72:79], v7
    buffer_store_dword v24, v6, s[8:11], s75 offen sc1
    s_waitcnt lgkmcnt(2)
    v_smfmac_f32_16x16x64_bf16 v[32:35], v[108:111], v[144:151], v7
    buffer_load_dword v8, off, s[8:11], s85 offset:256
    ds_read_b128 v[64:67], v1 offset:20480
    v_smfmac_f32_16x16x64_bf16 v[36:39], v[108:111], v[152:159], v7
    ds_read_b128 v[68:71], v1 offset:21504
    v_smfmac_f32_16x16x64_bf16 v[48:51], v[108:111], a[0:7], v7
    s_waitcnt vmcnt(6)
    v_max3_u32 v9, v112, v113, v114
    v_max_u32 v9, v9, v115
    v_smfmac_f32_16x16x64_bf16 v[52:55], v[108:111], a[8:15], v7
    ds_read_b128 v[72:75], v1 offset:22528
    s_waitcnt lgkmcnt(3)
    v_cmp_le_u32 vcc, s78, v9
    v_smfmac_f32_16x16x64_bf16 v[40:43], v[104:107], v[80:87], v7
    ds_read_b128 v[76:79], v1 offset:23552
    v_smfmac_f32_16x16x64_bf16 v[44:47], v[104:107], v[88:95], v7
    s_cbranch_vccnz CF3_ownretry
CF3_ownok:
    s_barrier
    v_smfmac_f32_16x16x64_bf16 v[32:35], v[112:115], v[160:167], v7
    ds_read_b128 v[116:119], v0 offset:10240
    ds_read_b128 v[120:123], v0 offset:6144
    v_smfmac_f32_16x16x64_bf16 v[36:39], v[112:115], v[168:175], v7
    ds_read_b128 v[124:127], v0 offset:2048
    s_waitcnt lgkmcnt(3)
    v_smfmac_f32_16x16x64_bf16 v[48:51], v[112:115], v[64:71], v7
    ds_read_b128 v[80:83], v25 offset:16384
    v_smfmac_f32_16x16x64_bf16 v[52:55], v[112:115], v[72:79], v7
    ds_read_b128 v[84:87], v25 offset:22528
    s_waitcnt lgkmcnt(4)
    v_smfmac_f32_16x16x64_bf16 v[32:35], v[116:119], v[176:183], v7
    ds_read_b128 v[88:91], v25 offset:21504
    s_waitcnt lgkmcnt(3)
    v_smfmac_f32_16x16x64_bf16 v[32:35], v[120:123], v[192:199], v7
    buffer_store_dwordx4 v[12:15], v0, s[8:11], s70 offen offset:0
    v_smfmac_f32_16x16x64_bf16 v[32:35], v[124:127], v[208:215], v7
    ds_read_b128 v[92:95], v25 offset:20480
    v_smfmac_f32_16x16x64_bf16 v[36:39], v[116:119], v[184:191], v7
    ds_read_b128 v[64:67], v25 offset:19456
    v_smfmac_f32_16x16x64_bf16 v[36:39], v[120:123], v[200:207], v7
    ds_read_b128 v[68:71], v25 offset:23552
    v_add_f32 v32, v32, v34
    v_smfmac_f32_16x16x64_bf16 v[36:39], v[124:127], v[216:223], v7
    ds_read_b128 v[72:75], v25 offset:18432
    v_add_f32 v33, v33, v35
    v_smfmac_f32_16x16x64_bf16 v[48:51], v[116:119], a[16:23], v7
    ds_read_b128 v[76:79], v25 offset:17408
    v_smfmac_f32_16x16x64_bf16 v[48:51], v[120:123], a[32:39], v7
    v_add_f32 v36, v36, v38
    v_add_f32 v37, v37, v39
    v_smfmac_f32_16x16x64_bf16 v[48:51], v[124:127], a[48:55], v7
    v_cvt_pk_bf16_f32 v34, v32, v36
    v_cvt_pk_bf16_f32 v35, v33, v37
    v_smfmac_f32_16x16x64_bf16 v[52:55], v[116:119], a[24:31], v7
    buffer_store_dwordx4 v[12:15], v0, s[8:11], s70 offen offset:1024
    ds_write2_b32 v2, v34, v35 offset0:0 offset1:4
    v_mov_b64 v[36:37], 0
    v_smfmac_f32_16x16x64_bf16 v[52:55], v[120:123], a[40:47], v7
    v_add_f32 v48, v48, v50
    v_smfmac_f32_16x16x64_bf16 v[52:55], v[124:127], a[56:63], v7
    v_add_f32 v49, v49, v51
    v_smfmac_f32_16x16x64_bf16 v[40:43], v[108:111], a[80:87], v7
    v_mov_b64 v[38:39], 0
    v_smfmac_f32_16x16x64_bf16 v[44:47], v[108:111], a[88:95], v7
    v_add_f32 v52, v52, v54
    v_add_f32 v53, v53, v55
    v_cvt_pk_bf16_f32 v32, v48, v52
    v_cvt_pk_bf16_f32 v33, v49, v53
    v_smfmac_f32_16x16x64_bf16 v[40:43], v[112:115], a[96:103], v7
    ds_write2_b32 v3, v32, v33 offset0:0 offset1:4
    v_mov_b64 v[48:49], 0
    v_smfmac_f32_16x16x64_bf16 v[44:47], v[112:115], a[104:111], v7
    buffer_store_dword v12, v6, s[8:11], s72 offen
    v_mov_b64 v[50:51], 0
    v_smfmac_f32_16x16x64_bf16 v[40:43], v[116:119], a[112:119], v7
    ds_read_b128 v[108:111], v4 offset:7200
    v_mov_b64 v[52:53], 0
    v_smfmac_f32_16x16x64_bf16 v[44:47], v[116:119], a[120:127], v7
    v_mov_b64 v[54:55], 0
    v_smfmac_f32_16x16x64_bf16 v[40:43], v[120:123], a[128:135], v7
    s_waitcnt lgkmcnt(1)
    s_barrier
    ds_read_b128 v[104:107], v4 offset:7168
    v_smfmac_f32_16x16x64_bf16 v[44:47], v[120:123], a[136:143], v7
    ds_read_b128 v[100:103], v4 offset:3104
    v_smfmac_f32_16x16x64_bf16 v[40:43], v[124:127], a[144:151], v7
    ds_read_b128 v[96:99], v4 offset:3072
    v_smfmac_f32_16x16x64_bf16 v[44:47], v[124:127], a[152:159], v7
    ds_read_b128 v[112:115], v0 offset:11264
    s_waitcnt lgkmcnt(4)
    v_mfma_f32_16x16x32_bf16 v[56:59], v[64:67], v[108:111], 0
    ds_read_b128 v[116:119], v0 offset:15360
    v_mfma_f32_16x16x32_bf16 v[60:63], v[68:71], v[108:111], 0
    s_waitcnt lgkmcnt(4)
    v_mfma_f32_16x16x32_bf16 v[56:59], v[72:75], v[104:107], v[56:59]
    s_waitcnt lgkmcnt(3)
    v_mfma_f32_16x16x32_bf16 v[56:59], v[76:79], v[100:103], v[56:59]
    ds_read_b128 v[64:67], v1 offset:24576
    s_waitcnt lgkmcnt(3)
    v_mfma_f32_16x16x32_bf16 v[56:59], v[80:83], v[96:99], v[56:59]
    ds_read_b128 v[68:71], v1 offset:25600
    v_add_f32 v40, v40, v42
    v_add_f32 v41, v41, v43
    v_mfma_f32_16x16x32_bf16 v[60:63], v[84:87], v[104:107], v[60:63]
    s_waitcnt lgkmcnt(2)
    v_add_f32 v44, v44, v46
    v_add_f32 v45, v45, v47
    v_smfmac_f32_16x16x64_bf16 v[36:39], v[112:115], v[96:103], v7
    ds_read_b128 v[80:83], v1 offset:28672
    v_max3_f32 v9, v56, v57, v58
    v_smfmac_f32_16x16x64_bf16 v[36:39], v[116:119], v[104:111], v7
    v_max_f32 v9, v9, v59
    v_mfma_f32_16x16x32_bf16 v[60:63], v[88:91], v[100:103], v[60:63]
    ds_read_b128 v[100:103], v0 offset:13312
    v_cvt_pk_bf16_f32 v42, v40, v41
    v_cvt_pk_bf16_f32 v43, v44, v45
    v_mfma_f32_16x16x32_bf16 v[60:63], v[92:95], v[96:99], v[60:63]
    ds_read_b128 v[96:99], v0 offset:12288
    ds_read_b128 v[84:87], v1 offset:29696
    v_add_f32 v36, v36, v38
    v_add_f32 v37, v37, v39
    v_max3_f32 v9, v9, v36, v37
    v_mov_b64 v[44:45], s[48:49]
    v_mov_b64 v[46:47], s[48:49]
    v_mov_b64 v[104:105], 0
    v_max3_f32 v10, v60, v61, v62
    v_max3_f32 v32, v9, v10, v63
    v_max3_f32 v33, v9, v10, v63
    v_mov_b64 v[106:107], 0
    v_mov_b64 v[108:109], 0
    v_permlane32_swap_b32 v32, v33
    v_max_f32 v34, v32, v33
    v_max_f32 v35, v32, v33
    v_mov_b64 v[110:111], 0
    v_mov_b64 v[40:41], 0
    v_permlane16_swap_b32 v34, v35
    v_max_f32 v32, v34, v35
    v_mul_f32 v32, s98, v32
    v_pk_fma_f32 v[36:37], v[36:37], s[98:99], v[32:33] op_sel_hi:[1,1,0] neg_lo:[0,0,1] neg_hi:[0,0,1]
    v_pk_fma_f32 v[56:57], v[56:57], s[98:99], v[32:33] op_sel_hi:[1,1,0] neg_lo:[0,0,1] neg_hi:[0,0,1]
    v_exp_f32 v36, v36
    v_exp_f32 v37, v37
    s_waitcnt lgkmcnt(0)
    s_buffer_load_dwordx16 s[16:31], s[8:11], s85
    s_buffer_load_dwordx16 s[32:47], s[8:11], s85 offset:64
    v_pk_fma_f32 v[58:59], v[58:59], s[98:99], v[32:33] op_sel_hi:[1,1,0] neg_lo:[0,0,1] neg_hi:[0,0,1]
    v_pk_fma_f32 v[60:61], v[60:61], s[98:99], v[32:33] op_sel_hi:[1,1,0] neg_lo:[0,0,1] neg_hi:[0,0,1]
    v_pk_fma_f32 v[62:63], v[62:63], s[98:99], v[32:33] op_sel_hi:[1,1,0] neg_lo:[0,0,1] neg_hi:[0,0,1]
    v_cvt_pk_bf16_f32 v28, v36, v37
    v_cvt_pk_bf16_f32 v31, v36, v37
    v_exp_f32 v56, v56
    v_exp_f32 v57, v57
    v_mfma_f32_16x16x16_bf16 v[124:127], v[44:45], v[28:29], 0
    v_exp_f32 v58, v58
    v_exp_f32 v59, v59
    v_mfma_f32_16x16x16_bf16 v[112:115], v[42:43], v[28:29], 0
    v_exp_f32 v60, v60
    v_exp_f32 v61, v61
    v_mfma_f32_16x16x16_bf16 v[116:119], v[42:43], v[30:31], 0
    v_exp_f32 v62, v62
    v_exp_f32 v63, v63
    v_cvt_pk_bf16_f32 v120, v56, v57
    v_cvt_pk_bf16_f32 v121, v58, v59
    v_cvt_pk_bf16_f32 v122, v60, v61
    v_cvt_pk_bf16_f32 v123, v62, v63
    s_nop 1
    v_mfma_f32_16x16x32_bf16 v[124:127], v[44:47], v[120:123], v[124:127]
    ds_read_b128 v[72:75], v1 offset:26624
    ds_read_b128 v[76:79], v1 offset:27648
    v_mfma_f32_16x16x32_bf16 v[112:115], v[96:99], v[120:123], v[112:115]
    ds_read_b128 v[88:91], v1 offset:30720
    ds_read_b128 v[92:95], v1 offset:31744
    v_mfma_f32_16x16x32_bf16 v[116:119], v[100:103], v[120:123], v[116:119]
    v_rcp_f32 v124, v124
    v_mov_b64 v[42:43], 0
    s_nop 1
    v_pk_mul_f32 v[112:113], v[112:113], v[124:125] op_sel_hi:[1,0]
    v_pk_mul_f32 v[114:115], v[114:115], v[124:125] op_sel_hi:[1,0]
    v_cvt_pk_bf16_f32 v32, v112, v113
    v_cvt_pk_bf16_f32 v33, v114, v115
    v_pk_mul_f32 v[116:117], v[116:117], v[124:125] op_sel_hi:[1,0]
    s_nop 0
    v_pk_mul_f32 v[118:119], v[118:119], v[124:125] op_sel_hi:[1,0]
    v_cvt_pk_bf16_f32 v34, v116, v117
    v_cvt_pk_bf16_f32 v35, v118, v119
    ds_write_b128 v0, v[32:35] offset:14336
    s_nop 0
    v_smfmac_f32_16x16x64_bf16 v[48:51], v[32:35], a[160:167], v7
    s_add_u32 s77, s79, 1865
    v_smfmac_f32_16x16x64_bf16 v[52:55], v[32:35], a[176:183], v7
    s_add_u32 s65, s68, 65536
    s_add_u32 s66, s69, 65536
    v_smfmac_f32_16x16x64_bf16 v[104:107], v[32:35], v[64:71], v7
    v_smfmac_f32_16x16x64_bf16 v[108:111], v[32:35], v[80:87], v7
    s_waitcnt lgkmcnt(0)
    s_barrier
    ds_read_b128 v[36:39], v0 offset:10240
    v_mov_b64 v[124:125], 0
    ds_read_b128 v[96:99], v0 offset:6144
    v_mov_b64 v[126:127], 0
    ds_read_b128 v[100:103], v0 offset:2048
    v_mov_b64 v[32:33], 0
    s_max_u32 s16, s16, s17
    s_max_u32 s16, s16, s18
    s_max_u32 s16, s16, s19
    v_mov_b64 v[34:35], 0
    s_max_u32 s16, s16, s20
    s_max_u32 s16, s16, s21
    s_max_u32 s16, s16, s22
    v_mov_b64 v[44:45], 0
    s_waitcnt lgkmcnt(2)
    v_smfmac_f32_16x16x64_bf16 v[48:51], v[36:39], a[168:175], v7
    s_max_u32 s16, s16, s23
    s_max_u32 s16, s16, s24
    s_waitcnt lgkmcnt(0)
    v_smfmac_f32_16x16x64_bf16 v[48:51], v[96:99], a[192:199], v7
    s_max_u32 s16, s16, s25
    s_max_u32 s16, s16, s26
    s_max_u32 s16, s16, s27
    v_smfmac_f32_16x16x64_bf16 v[48:51], v[100:103], a[200:207], v7
    s_max_u32 s16, s16, s28
    s_max_u32 s16, s16, s29
    s_max_u32 s16, s16, s30
    v_smfmac_f32_16x16x64_bf16 v[52:55], v[36:39], a[184:191], v7
    s_max_u32 s16, s16, s31
    s_max_u32 s16, s16, s32
    s_max_u32 s16, s16, s33
    v_smfmac_f32_16x16x64_bf16 v[52:55], v[96:99], a[208:215], v7
    v_cvt_pk_bf16_f32 v56, v48, v50
    v_cvt_pk_bf16_f32 v57, v49, v51
    v_smfmac_f32_16x16x64_bf16 v[52:55], v[100:103], a[216:223], v7
    buffer_store_dwordx2 v[56:57], v5, s[8:11], s68 offen
    s_max_u32 s16, s16, s34
    s_max_u32 s16, s16, s35
    v_smfmac_f32_16x16x64_bf16 v[104:107], v[36:39], v[72:79], v7
    s_max_u32 s16, s16, s36
    s_max_u32 s16, s16, s37
    s_max_u32 s16, s16, s38
    v_smfmac_f32_16x16x64_bf16 v[104:107], v[96:99], a[224:231], v7
    v_cvt_pk_bf16_f32 v58, v52, v54
    v_cvt_pk_bf16_f32 v59, v53, v55
    v_smfmac_f32_16x16x64_bf16 v[104:107], v[100:103], a[232:239], v7
    buffer_store_dwordx2 v[58:59], v5, s[8:11], s65 offen
    s_memtime s[82:83]
    s_max_u32 s16, s16, s39
    v_smfmac_f32_16x16x64_bf16 v[108:111], v[36:39], v[88:95], v7
    s_max_u32 s16, s16, s40
    s_max_u32 s16, s16, s41
    s_max_u32 s16, s16, s42
    v_smfmac_f32_16x16x64_bf16 v[108:111], v[96:99], a[240:247], v7
    s_max_u32 s16, s16, s43
    v_cvt_pk_bf16_f32 v60, v104, v106
    v_cvt_pk_bf16_f32 v61, v105, v107
    v_smfmac_f32_16x16x64_bf16 v[108:111], v[100:103], a[248:255], v7
    s_max_u32 s16, s16, s44
    s_max_u32 s16, s16, s45
    s_max_u32 s16, s16, s46
    s_max_u32 s16, s16, s47
    s_waitcnt lgkmcnt(0)
    s_add_u32 s77, s16, s77
    s_sub_u32 s84, s77, s82
    s_cmp_lt_i32 s84, 24
    v_cvt_pk_bf16_f32 v62, v108, v110
    v_cvt_pk_bf16_f32 v63, v109, v111
    s_cbranch_scc0 CF3_wait
CF3_go:
    s_waitcnt vmcnt(7)
    ds_write_b128 v0, v[16:19] offset:12288
    ds_write_b128 v0, v[20:23] offset:13312
    ds_read_b128 v[64:67], v1 offset:0
    ds_read_b128 v[68:71], v1 offset:1024
    ds_read_b128 v[72:75], v1 offset:2048
    ds_read_b128 v[76:79], v1 offset:3072
    ds_read_b128 v[80:83], v1 offset:4096
    ds_read_b128 v[84:87], v1 offset:5120
    ds_read_b128 v[88:91], v1 offset:6144
    ds_read_b128 v[92:95], v1 offset:7168
    ds_read_b128 v[104:107], v1 offset:10240
    ds_read_b128 v[108:111], v1 offset:11264
    v_mov_b64 v[36:37], 0
    v_mov_b64 v[38:39], 0
    v_mov_b64 v[46:47], 0
    v_mov_b64 v[48:49], 0
    v_mov_b64 v[50:51], 0
    v_mov_b64 v[52:53], 0
    v_mov_b64 v[54:55], 0
    v_mov_b64 v[112:113], v[26:27]
    v_mov_b64 v[114:115], v[26:27]
    s_mov_b32 s72, s71
    s_add_u32 s71, s71, 8192
    s_cmp_eq_u32 s71, 0xe6000
    s_cselect_b32 s71, 0xe0000, s71
    s_add_u32 s73, s71, 0xfffe0000
    s_add_u32 s4, s73, 5120
    s_mov_b32 m0, s95
    v_xor_b32 v25, 8192, v25
    s_add_u32 s76, s74, 0x82000
    s_add_u32 s74, s74, 0x80000
    buffer_store_dwordx2 v[60:61], v5, s[8:11], s69 offen
    buffer_store_dwordx2 v[62:63], v5, s[8:11], s66 offen
    s_xor_b32 s94, s94, 8192
    s_add_u32 s85, s85, 128
    s_add_u32 s91, s91, 128
    s_add_u32 s75, s75, 8192
    s_mov_b32 s70, s93
    s_add_u32 s64, s64, 1
    s_add_u32 s68, s68, 262144
    s_cmp_eq_u32 s68, 0xe0000
    s_cselect_b32 s68, 0x20000, s68
    ds_read_b128 v[56:59], v1 offset:8192
    ds_read_b128 v[60:63], v1 offset:9216
    s_waitcnt lgkmcnt(0)
    s_memtime s[82:83]
    s_waitcnt lgkmcnt(0)
    s_sub_u32 s84, s77, s82
    s_add_u32 s84, s84, s86
    s_max_i32 s84, s84, 0
    s_sub_u32 s84, s84, 16
    s_cbranch_scc1 CF3_go1
    s_sub_u32 s84, s84, 16
    s_cbranch_scc1 CF3_go1
    s_sub_u32 s84, s84, 16
    s_cbranch_scc1 CF3_go1
    s_sub_u32 s84, s84, 16
    s_cbranch_scc1 CF3_go1
    s_sub_u32 s84, s84, 16
    s_cbranch_scc1 CF3_go1
    s_sub_u32 s84, s84, 16
    s_cbranch_scc1 CF3_go1
    s_sub_u32 s84, s84, 16
    s_cbranch_scc1 CF3_go1
    s_sub_u32 s84, s84, 16
    s_cbranch_scc1 CF3_go1
    s_sub_u32 s84, s84, 16
    s_cbranch_scc1 CF3_go1
    s_sub_u32 s84, s84, 16
    s_cbranch_scc1 CF3_go1
    s_sub_u32 s84, s84, 16
    s_cbranch_scc1 CF3_go1
    s_sub_u32 s84, s84, 16
    s_cbranch_scc1 CF3_go1
    s_sub_u32 s84, s84, 16
    s_cbranch_scc1 CF3_go1
    s_sub_u32 s84, s84, 16
    s_cbranch_scc1 CF3_go1
    s_sub_u32 s84, s84, 16
    s_cbranch_scc1 CF3_go1
    s_sub_u32 s84, s84, 16
    s_cbranch_scc1 CF3_go1
CF3_go1:
    buffer_load_dwordx4 v[116:119], v0, s[8:11], s93 offen offset:0 sc1
    buffer_load_dwordx4 v[120:123], v0, s[8:11], s93 offen offset:1024 sc1
    s_cmp_eq_u32 s64, 63
    s_cbranch_scc1 CF3_last
    s_add_u32 s93, s68, s5
    s_add_u32 s69, s68, 131072
    s_nop 15
    s_nop 10
    buffer_load_dwordx4 v[96:99], v0, s[8:11], s73 offen offset:3072 sc1
    s_branch CF3_p1w
CF3_entry:
    v_xor_b32 v25, 8192, v25
    s_add_u32 s76, s74, 0x82000
    s_add_u32 s74, s74, 0x80000
    s_xor_b32 s94, s94, 8192
    s_add_u32 s85, s85, 128
    s_add_u32 s91, s91, 128
    s_add_u32 s75, s75, 8192
    s_mov_b32 s70, s93
    s_add_u32 s64, s64, 1
    s_add_u32 s68, s68, 262144
    s_cmp_eq_u32 s68, 0xe0000
    s_cselect_b32 s68, 0x20000, s68
    s_add_u32 s93, s68, s5
    s_add_u32 s69, s68, 131072
    s_branch CF3_step2
CF3_last:
    s_waitcnt vmcnt(0)
    s_branch C_last1
CF3_p2retry:
    s_add_u32 s63, s63, 1
    s_cmp_gt_u32 s63, 400000
    s_cbranch_scc1 C_last
    v_cmp_le_u32 vcc, s78, v24
    s_cbranch_vccnz CF3_p1retry
    buffer_load_dwordx4 v[96:99], v0, s[8:11], s73 offen offset:3072 sc1
    buffer_load_dwordx4 v[112:115], v0, s[8:11], s4 offen offset:2048 sc1
    v_mov_b64 v[32:33], 0
    v_mov_b64 v[34:35], 0
    v_mov_b64 v[36:37], 0
    v_mov_b64 v[38:39], 0
    s_waitcnt vmcnt(0) lgkmcnt(0)
    v_max3_u32 v9, v112, v113, v114
    v_max_u32 v9, v9, v115
    v_cmp_le_u32 vcc, s78, v9
    s_cbranch_vccnz CF3_p2retry
    s_branch CF3_step2
CF3_wait:
    s_sub_u32 s84, s84, 64
    s_cbranch_scc1 CF3_go
CF3_twl:
    s_sub_u32 s84, s84, 16
    s_cbranch_scc1 CF3_go
    s_sub_u32 s84, s84, 16
    s_cbranch_scc1 CF3_go
    s_sub_u32 s84, s84, 16
    s_cbranch_scc1 CF3_go
    s_sub_u32 s84, s84, 16
    s_cbranch_scc1 CF3_go
    s_sub_u32 s84, s84, 16
    s_cbranch_scc1 CF3_go
    s_sub_u32 s84, s84, 16
    s_cbranch_scc1 CF3_go
    s_sub_u32 s84, s84, 16
    s_cbranch_scc1 CF3_go
    s_sub_u32 s84, s84, 16
    s_cbranch_scc1 CF3_go
    s_sub_u32 s84, s84, 16
    s_cbranch_scc1 CF3_go
    s_sub_u32 s84, s84, 16
    s_cbranch_scc1 CF3_go
    s_sub_u32 s84, s84, 16
    s_cbranch_scc1 CF3_go
    s_sub_u32 s84, s84, 16
    s_cbranch_scc1 CF3_go
    s_min_u32 s84, s84, 2000
    s_sub_u32 s84, s84, 36
    s_cbranch_scc0 CF3_twl
    s_branch CF3_go
CF3_ownretry:
    s_add_u32 s87, s64, 1
    buffer_load_dwordx4 v[112:115], v0, s[8:11], s4 offen offset:2048 sc1
    s_waitcnt vmcnt(0)
    v_max3_u32 v9, v112, v113, v114
    v_max_u32 v9, v9, v115
    ds_write_b128 v0, v[112:115] offset:14336
    v_cmp_le_u32 vcc, s78, v9
    s_add_u32 s63, s63, 1
    s_cmp_gt_u32 s63, 400000
    s_waitcnt lgkmcnt(0)
    s_cbranch_scc1 CF3_ownok
    s_cbranch_vccz CF3_ownok
    s_branch CF3_ownretry
CF3_p1retry:
    v_max3_u32 v9, v116, v117, v118
    v_max3_u32 v100, v119, v120, v121
    v_max3_u32 v9, v9, v122, v123
    v_max_u32 v9, v9, v100
    v_cmp_eq_u32 vcc, -1, v9
    v_mov_b64 v[124:125], 0
    v_mov_b64 v[126:127], 0
    v_mov_b64 v[112:113], v[26:27]
    v_mov_b64 v[114:115], v[26:27]
    s_cbranch_vccz CF3_p1nan
    buffer_load_dwordx4 v[116:119], v0, s[8:11], s70 offen offset:0 sc1
    buffer_load_dwordx4 v[120:123], v0, s[8:11], s70 offen offset:1024 sc1
    s_add_u32 s63, s63, 1
    s_waitcnt vmcnt(0)
    s_cmp_gt_u32 s63, 400000
    s_cbranch_scc0 CF3_p1retry
CF3_p1nan:
    s_nop 0
    v_smfmac_f32_16x16x64_bf16 v[124:127], v[112:115], v[116:123], v11
    s_nop 7
    v_add_f32_dpp v100, v124, v124 row_ror:8 row_mask:0xf bank_mask:0xf
    v_add_f32_dpp v101, v125, v125 row_ror:8 row_mask:0xf bank_mask:0xf
    s_nop 0
    v_add_f32_dpp v102, v100, v100 row_ror:4 row_mask:0xf bank_mask:0xf
    v_add_f32_dpp v103, v101, v101 row_ror:4 row_mask:0xf bank_mask:0xf
    v_cvt_pk_bf16_f32 v24, v102, v103
    v_min_u32 v24, 0xffbfffff, v24
    buffer_store_dword v24, v6, s[8:11], s71 offen
    s_branch CF3_p2retry
.p2align 6
    s_nop 0
    s_nop 0
    s_nop 0
    s_nop 0
    s_nop 0
    s_nop 0
    s_nop 0
    s_nop 0
CS0_step:
    s_waitcnt vmcnt(2) lgkmcnt(0)
CS0_step2:
    v_max3_u32 v9, v96, v97, v98
    v_max_u32 v9, v9, v99
    ds_write_b128 v0, v[96:99] offset:3072
    v_smfmac_f32_16x16x64_bf16 v[32:35], v[96:99], v[64:71], v7
    v_cmp_le_u32 vcc, s78, v9
    v_smfmac_f32_16x16x64_bf16 v[36:39], v[96:99], v[72:79], v7
    s_cbranch_vccnz CS0_p2retry
    v_smfmac_f32_16x16x64_bf16 v[48:51], v[96:99], v[80:87], v7
    v_smfmac_f32_16x16x64_bf16 v[52:55], v[96:99], v[88:95], v7
    s_waitcnt lgkmcnt(0)
    s_barrier
    ds_read_b128 v[100:103], v0 offset:7168
    buffer_load_dwordx4 v[112:115], v0, s[8:11], s4 offen offset:2048 sc1
    v_smfmac_f32_16x16x64_bf16 v[40:43], v[96:99], v[56:63], v7
    buffer_load_dwordx4 v0, s[8:11], s4 offen offset:2048 sc1 lds
    ds_read_b128 v[64:67], v1 offset:12288
    v_smfmac_f32_16x16x64_bf16 v[44:47], v[96:99], v[104:111], v7
    ds_read_b128 v[68:71], v1 offset:13312
    s_waitcnt lgkmcnt(2)
    v_smfmac_f32_16x16x64_bf16 v[32:35], v[100:103], v[128:135], v7
    ds_read_b128 v[104:107], v0 offset:11264
    ds_read_b128 v[72:75], v1 offset:14336
    v_smfmac_f32_16x16x64_bf16 v[36:39], v[100:103], v[136:143], v7
    s_mov_b32 m0, s94
    ds_read_b128 v[76:79], v1 offset:15360
    v_smfmac_f32_16x16x64_bf16 v[48:51], v[100:103], v[224:231], v7
    buffer_load_dwordx4 v0, s[8:11], s74 offen offset:0 sc1 lds
    ds_read_b128 v[80:83], v1 offset:16384
    v_smfmac_f32_16x16x64_bf16 v[52:55], v[100:103], v[232:239], v7
    buffer_load_dwordx4 v0, s[8:11], s74 offen offset:1024 sc1 lds
    v_smfmac_f32_16x16x64_bf16 v[40:43], v[100:103], a[64:71], v7
    ds_read_b128 v[108:111], v0 offset:15360
    buffer_load_dwordx4 v[16:19], v0, s[8:11], s76 offen offset:0 sc1
    v_smfmac_f32_16x16x64_bf16 v[44:47], v[100:103], a[72:79], v7
    ds_read_b128 v[84:87], v1 offset:17408
    s_waitcnt lgkmcnt(5)
    v_smfmac_f32_16x16x64_bf16 v[48:51], v[104:107], v[240:247], v7
    buffer_load_dwordx4 v[20:23], v0, s[8:11], s76 offen offset:1024 sc1
    v_smfmac_f32_16x16x64_bf16 v[52:55], v[104:107], v[248:255], v7
    ds_read_b128 v[88:91], v1 offset:18432
    s_waitcnt lgkmcnt(4)
    v_smfmac_f32_16x16x64_bf16 v[32:35], v[104:107], v[64:71], v7
    buffer_store_dword v24, v6, s[8:11], s75 offen sc1
    v_smfmac_f32_16x16x64_bf16 v[36:39], v[104:107], v[72:79], v7
    ds_read_b128 v[92:95], v1 offset:19456
    s_waitcnt lgkmcnt(3)
    v_smfmac_f32_16x16x64_bf16 v[32:35], v[108:111], v[144:151], v7
    buffer_load_dword v8, off, s[8:11], s92 sc1
    ds_read_b128 v[64:67], v1 offset:20480
    v_smfmac_f32_16x16x64_bf16 v[36:39], v[108:111], v[152:159], v7
    ds_read_b128 v[68:71], v1 offset:21504
    v_smfmac_f32_16x16x64_bf16 v[48:51], v[108:111], a[0:7], v7
    s_waitcnt vmcnt(6)
    v_max3_u32 v9, v112, v113, v114
    v_max_u32 v9, v9, v115
    v_smfmac_f32_16x16x64_bf16 v[52:55], v[108:111], a[8:15], v7
    ds_read_b128 v[72:75], v1 offset:22528
    s_waitcnt lgkmcnt(3)
    v_cmp_le_u32 vcc, s78, v9
    v_smfmac_f32_16x16x64_bf16 v[40:43], v[104:107], v[80:87], v7
    ds_read_b128 v[76:79], v1 offset:23552
    v_smfmac_f32_16x16x64_bf16 v[44:47], v[104:107], v[88:95], v7
    s_cbranch_vccnz CS0_ownretry
CS0_ownok:
    s_barrier
    v_smfmac_f32_16x16x64_bf16 v[32:35], v[112:115], v[160:167], v7
    ds_read_b128 v[116:119], v0 offset:6144
    ds_read_b128 v[120:123], v0 offset:10240
    v_smfmac_f32_16x16x64_bf16 v[36:39], v[112:115], v[168:175], v7
    ds_read_b128 v[124:127], v0 offset:14336
    s_waitcnt lgkmcnt(3)
    v_smfmac_f32_16x16x64_bf16 v[48:51], v[112:115], v[64:71], v7
    buffer_store_dwordx4 v[12:15], v0, s[8:11], s70 offen offset:0 sc1
    v_smfmac_f32_16x16x64_bf16 v[52:55], v[112:115], v[72:79], v7
    ds_read_b128 v[80:83], v25 offset:19456
    s_waitcnt lgkmcnt(3)
    v_smfmac_f32_16x16x64_bf16 v[32:35], v[116:119], v[176:183], v7
    ds_read_b128 v[84:87], v25 offset:21504
    s_waitcnt lgkmcnt(2)
    v_smfmac_f32_16x16x64_bf16 v[32:35], v[120:123], v[192:199], v7
    ds_read_b128 v[88:91], v25 offset:22528
    v_smfmac_f32_16x16x64_bf16 v[32:35], v[124:127], v[208:215], v7
    ds_read_b128 v[92:95], v25 offset:23552
    v_smfmac_f32_16x16x64_bf16 v[36:39], v[116:119], v[184:191], v7
    ds_read_b128 v[64:67], v25 offset:16384
    v_smfmac_f32_16x16x64_bf16 v[36:39], v[120:123], v[200:207], v7
    ds_read_b128 v[68:71], v25 offset:20480
    v_add_f32 v32, v32, v34
    v_smfmac_f32_16x16x64_bf16 v[36:39], v[124:127], v[216:223], v7
    ds_read_b128 v[72:75], v25 offset:17408
    v_add_f32 v33, v33, v35
    v_smfmac_f32_16x16x64_bf16 v[48:51], v[116:119], a[16:23], v7
    buffer_store_dwordx4 v[12:15], v0, s[8:11], s70 offen offset:1024 sc1
    v_smfmac_f32_16x16x64_bf16 v[48:51], v[120:123], a[32:39], v7
    ds_read_b128 v[76:79], v25 offset:18432
    v_add_f32 v36, v36, v38
    v_add_f32 v37, v37, v39
    v_smfmac_f32_16x16x64_bf16 v[48:51], v[124:127], a[48:55], v7
    v_cvt_pk_bf16_f32 v34, v32, v36
    v_cvt_pk_bf16_f32 v35, v33, v37
    v_smfmac_f32_16x16x64_bf16 v[52:55], v[116:119], a[24:31], v7
    ds_write2_b32 v2, v34, v35 offset0:0 offset1:4
    v_mov_b64 v[36:37], 0
    v_smfmac_f32_16x16x64_bf16 v[52:55], v[120:123], a[40:47], v7
    v_add_f32 v48, v48, v50
    v_smfmac_f32_16x16x64_bf16 v[52:55], v[124:127], a[56:63], v7
    v_add_f32 v49, v49, v51
    v_smfmac_f32_16x16x64_bf16 v[40:43], v[108:111], a[80:87], v7
    v_mov_b64 v[38:39], 0
    v_smfmac_f32_16x16x64_bf16 v[44:47], v[108:111], a[88:95], v7
    v_add_f32 v52, v52, v54
    v_add_f32 v53, v53, v55
    v_cvt_pk_bf16_f32 v32, v48, v52
    v_cvt_pk_bf16_f32 v33, v49, v53
    v_smfmac_f32_16x16x64_bf16 v[40:43], v[112:115], a[96:103], v7
    ds_write2_b32 v3, v32, v33 offset0:0 offset1:4
    v_mov_b64 v[48:49], 0
    v_smfmac_f32_16x16x64_bf16 v[44:47], v[112:115], a[104:111], v7
    v_mov_b64 v[50:51], 0
    v_smfmac_f32_16x16x64_bf16 v[40:43], v[116:119], a[112:119], v7
    ds_read_b128 v[96:99], v4 offset:3072
    v_mov_b64 v[52:53], 0
    v_smfmac_f32_16x16x64_bf16 v[44:47], v[116:119], a[120:127], v7
    v_mov_b64 v[54:55], 0
    v_smfmac_f32_16x16x64_bf16 v[40:43], v[120:123], a[128:135], v7
    s_waitcnt lgkmcnt(1)
    s_barrier
    ds_read_b128 v[100:103], v4 offset:3104
    v_smfmac_f32_16x16x64_bf16 v[44:47], v[120:123], a[136:143], v7
    ds_read_b128 v[104:107], v4 offset:7168
    v_smfmac_f32_16x16x64_bf16 v[40:43], v[124:127], a[144:151], v7
    ds_read_b128 v[108:111], v4 offset:7200
    v_smfmac_f32_16x16x64_bf16 v[44:47], v[124:127], a[152:159], v7
    ds_read_b128 v[112:115], v0 offset:11264
    s_waitcnt lgkmcnt(4)
    v_mfma_f32_16x16x32_bf16 v[56:59], v[64:67], v[96:99], 0
    ds_read_b128 v[116:119], v0 offset:15360
    v_mfma_f32_16x16x32_bf16 v[60:63], v[68:71], v[96:99], 0
    s_waitcnt lgkmcnt(4)
    v_mfma_f32_16x16x32_bf16 v[56:59], v[72:75], v[100:103], v[56:59]
    s_waitcnt lgkmcnt(3)
    v_mfma_f32_16x16x32_bf16 v[56:59], v[76:79], v[104:107], v[56:59]
    ds_read_b128 v[64:67], v1 offset:24576
    s_waitcnt lgkmcnt(3)
    v_mfma_f32_16x16x32_bf16 v[56:59], v[80:83], v[108:111], v[56:59]
    ds_read_b128 v[68:71], v1 offset:25600
    v_add_f32 v40, v40, v42
    v_add_f32 v41, v41, v43
    v_mfma_f32_16x16x32_bf16 v[60:63], v[84:87], v[100:103], v[60:63]
    s_waitcnt lgkmcnt(2)
    v_add_f32 v44, v44, v46
    v_add_f32 v45, v45, v47
    v_smfmac_f32_16x16x64_bf16 v[36:39], v[112:115], v[96:103], v7
    ds_read_b128 v[80:83], v1 offset:28672
    v_max3_f32 v9, v56, v57, v58
    v_smfmac_f32_16x16x64_bf16 v[36:39], v[116:119], v[104:111], v7
    ds_read_b128 v[96:99], v0 offset:0
    v_max_f32 v9, v9, v59
    v_mfma_f32_16x16x32_bf16 v[60:63], v[88:91], v[104:107], v[60:63]
    ds_read_b128 v[100:103], v0 offset:1024
    v_cvt_pk_bf16_f32 v42, v40, v41
    v_cvt_pk_bf16_f32 v43, v44, v45
    v_mfma_f32_16x16x32_bf16 v[60:63], v[92:95], v[108:111], v[60:63]
    ds_read_b128 v[84:87], v1 offset:29696
    v_add_f32 v36, v36, v38
    v_add_f32 v37, v37, v39
    v_max3_f32 v9, v9, v36, v37
    v_mov_b64 v[44:45], s[48:49]
    v_mov_b64 v[46:47], s[48:49]
    v_mov_b64 v[104:105], 0
    s_nop 0
    v_max3_f32 v10, v60, v61, v62
    v_max3_f32 v32, v9, v10, v63
    v_max3_f32 v33, v9, v10, v63
    v_mov_b64 v[106:107], 0
    v_mov_b64 v[108:109], 0
    v_permlane32_swap_b32 v32, v33
    v_max_f32 v34, v32, v33
    v_max_f32 v35, v32, v33
    v_mov_b64 v[110:111], 0
    v_mov_b64 v[40:41], 0
    v_permlane16_swap_b32 v34, v35
    v_max_f32 v32, v34, v35
    v_mul_f32 v32, s98, v32
    v_pk_fma_f32 v[36:37], v[36:37], s[98:99], v[32:33] op_sel_hi:[1,1,0] neg_lo:[0,0,1] neg_hi:[0,0,1]
    v_pk_fma_f32 v[56:57], v[56:57], s[98:99], v[32:33] op_sel_hi:[1,1,0] neg_lo:[0,0,1] neg_hi:[0,0,1]
    v_exp_f32 v36, v36
    v_exp_f32 v37, v37
    v_pk_fma_f32 v[58:59], v[58:59], s[98:99], v[32:33] op_sel_hi:[1,1,0] neg_lo:[0,0,1] neg_hi:[0,0,1]
    v_pk_fma_f32 v[60:61], v[60:61], s[98:99], v[32:33] op_sel_hi:[1,1,0] neg_lo:[0,0,1] neg_hi:[0,0,1]
    v_pk_fma_f32 v[62:63], v[62:63], s[98:99], v[32:33] op_sel_hi:[1,1,0] neg_lo:[0,0,1] neg_hi:[0,0,1]
    v_cvt_pk_bf16_f32 v28, v36, v37
    v_cvt_pk_bf16_f32 v31, v36, v37
    v_exp_f32 v56, v56
    v_exp_f32 v57, v57
    v_mfma_f32_16x16x16_bf16 v[124:127], v[44:45], v[28:29], 0
    v_exp_f32 v58, v58
    v_exp_f32 v59, v59
    v_mfma_f32_16x16x16_bf16 v[112:115], v[42:43], v[28:29], 0
    v_exp_f32 v60, v60
    v_exp_f32 v61, v61
    v_mfma_f32_16x16x16_bf16 v[116:119], v[42:43], v[30:31], 0
    v_exp_f32 v62, v62
    v_exp_f32 v63, v63
    v_cvt_pk_bf16_f32 v120, v56, v57
    v_cvt_pk_bf16_f32 v121, v58, v59
    v_cvt_pk_bf16_f32 v122, v60, v61
    v_cvt_pk_bf16_f32 v123, v62, v63
    s_waitcnt lgkmcnt(0)
    s_nop 0
    v_mfma_f32_16x16x32_bf16 v[124:127], v[44:47], v[120:123], v[124:127]
    ds_read_b128 v[72:75], v1 offset:26624
    ds_read_b128 v[76:79], v1 offset:27648
    v_mfma_f32_16x16x32_bf16 v[112:115], v[96:99], v[120:123], v[112:115]
    ds_read_b128 v[88:91], v1 offset:30720
    ds_read_b128 v[92:95], v1 offset:31744
    v_mfma_f32_16x16x32_bf16 v[116:119], v[100:103], v[120:123], v[116:119]
    v_rcp_f32 v124, v124
    v_mov_b64 v[42:43], 0
    s_nop 1
    v_pk_mul_f32 v[112:113], v[112:113], v[124:125] op_sel_hi:[1,0]
    v_pk_mul_f32 v[114:115], v[114:115], v[124:125] op_sel_hi:[1,0]
    v_cvt_pk_bf16_f32 v32, v112, v113
    v_cvt_pk_bf16_f32 v33, v114, v115
    v_pk_mul_f32 v[116:117], v[116:117], v[124:125] op_sel_hi:[1,0]
    s_nop 0
    v_pk_mul_f32 v[118:119], v[118:119], v[124:125] op_sel_hi:[1,0]
    v_cvt_pk_bf16_f32 v34, v116, v117
    v_cvt_pk_bf16_f32 v35, v118, v119
    ds_write_b128 v0, v[32:35] offset:2048
    s_nop 0
    v_smfmac_f32_16x16x64_bf16 v[48:51], v[32:35], a[160:167], v7
    v_smfmac_f32_16x16x64_bf16 v[52:55], v[32:35], a[176:183], v7
    s_add_u32 s65, s68, 65536
    s_add_u32 s66, s69, 65536
    v_smfmac_f32_16x16x64_bf16 v[104:107], v[32:35], v[64:71], v7
    v_smfmac_f32_16x16x64_bf16 v[108:111], v[32:35], v[80:87], v7
    s_waitcnt lgkmcnt(0)
    s_barrier
    ds_read_b128 v[36:39], v0 offset:6144
    v_mov_b64 v[124:125], 0
    ds_read_b128 v[96:99], v0 offset:10240
    v_mov_b64 v[126:127], 0
    ds_read_b128 v[100:103], v0 offset:14336
    v_mov_b64 v[32:33], 0
    s_nop 2
    v_mov_b64 v[34:35], 0
    s_nop 2
    v_mov_b64 v[44:45], 0
    s_waitcnt lgkmcnt(2)
    v_smfmac_f32_16x16x64_bf16 v[48:51], v[36:39], a[168:175], v7
    s_waitcnt lgkmcnt(0)
    v_smfmac_f32_16x16x64_bf16 v[48:51], v[96:99], a[192:199], v7
    v_smfmac_f32_16x16x64_bf16 v[48:51], v[100:103], a[200:207], v7
    v_smfmac_f32_16x16x64_bf16 v[52:55], v[36:39], a[184:191], v7
    v_smfmac_f32_16x16x64_bf16 v[52:55], v[96:99], a[208:215], v7
    v_cvt_pk_bf16_f32 v56, v48, v50
    v_cvt_pk_bf16_f32 v57, v49, v51
    v_smfmac_f32_16x16x64_bf16 v[52:55], v[100:103], a[216:223], v7
    buffer_store_dwordx2 v[56:57], v5, s[8:11], s68 offen sc1
    v_smfmac_f32_16x16x64_bf16 v[104:107], v[36:39], v[72:79], v7
    v_smfmac_f32_16x16x64_bf16 v[104:107], v[96:99], a[224:231], v7
    v_cvt_pk_bf16_f32 v58, v52, v54
    v_cvt_pk_bf16_f32 v59, v53, v55
    v_smfmac_f32_16x16x64_bf16 v[104:107], v[100:103], a[232:239], v7
    buffer_store_dwordx2 v[58:59], v5, s[8:11], s65 offen sc1
    v_smfmac_f32_16x16x64_bf16 v[108:111], v[36:39], v[88:95], v7
    v_smfmac_f32_16x16x64_bf16 v[108:111], v[96:99], a[240:247], v7
    v_cvt_pk_bf16_f32 v60, v104, v106
    v_cvt_pk_bf16_f32 v61, v105, v107
    v_smfmac_f32_16x16x64_bf16 v[108:111], v[100:103], a[248:255], v7
    buffer_store_dwordx2 v[60:61], v5, s[8:11], s69 offen sc1
    ds_read_b128 v[64:67], v1 offset:0
    ds_read_b128 v[68:71], v1 offset:1024
    ds_read_b128 v[72:75], v1 offset:2048
    ds_read_b128 v[76:79], v1 offset:3072
    s_nop 2
    v_cvt_pk_bf16_f32 v62, v108, v110
    v_cvt_pk_bf16_f32 v63, v109, v111
    buffer_store_dwordx2 v[62:63], v5, s[8:11], s66 offen sc1
    ds_read_b128 v[80:83], v1 offset:4096
    ds_read_b128 v[84:87], v1 offset:5120
    ds_read_b128 v[88:91], v1 offset:6144
    ds_read_b128 v[92:95], v1 offset:7168
    ds_read_b128 v[56:59], v1 offset:8192
    ds_read_b128 v[60:63], v1 offset:9216
    ds_read_b128 v[104:107], v1 offset:10240
    ds_read_b128 v[108:111], v1 offset:11264
    v_mov_b64 v[36:37], 0
    v_mov_b64 v[38:39], 0
    v_mov_b64 v[46:47], 0
    v_mov_b64 v[48:49], 0
    v_mov_b64 v[50:51], 0
    v_mov_b64 v[52:53], 0
    v_mov_b64 v[54:55], 0
    v_mov_b64 v[112:113], v[26:27]
    v_mov_b64 v[114:115], v[26:27]
    s_nop 13
    buffer_load_dwordx4 v[116:119], v0, s[8:11], s93 offen offset:0 sc1
    buffer_load_dwordx4 v[120:123], v0, s[8:11], s93 offen offset:1024 sc1
    s_mov_b32 s72, s71
    s_add_u32 s71, s71, 8192
    s_cmp_eq_u32 s71, 0xe6000
    s_cselect_b32 s71, 0xe0000, s71
    s_add_u32 s73, s71, 0xfffdf400
    s_add_u32 s4, s73, 5120
    s_mov_b32 m0, s95
    s_waitcnt vmcnt(10)
    ds_write_b128 v0, v[16:19] offset:0
    ds_write_b128 v0, v[20:23] offset:1024
    s_nop 15
    s_nop 3
    buffer_load_dwordx4 v[116:119], v0, s[8:11], s93 offen offset:0 sc1
    buffer_load_dwordx4 v[120:123], v0, s[8:11], s93 offen offset:1024 sc1
    s_waitcnt vmcnt(2)
CS0_p1:
    v_smfmac_f32_16x16x64_bf16 v[124:127], v[112:115], v[116:123], v11
    s_nop 7
    v_add_f32_dpp v100, v124, v124 row_ror:8 row_mask:0xf bank_mask:0xf
    v_add_f32_dpp v101, v125, v125 row_ror:8 row_mask:0xf bank_mask:0xf
    s_nop 0
    v_add_f32_dpp v102, v100, v100 row_ror:4 row_mask:0xf bank_mask:0xf
    v_add_f32_dpp v103, v101, v101 row_ror:4 row_mask:0xf bank_mask:0xf
    v_cvt_pk_bf16_f32 v24, v102, v103
    buffer_store_dword v24, v6, s[8:11], s71 offen sc1
    v_cmp_le_u32 vcc, s78, v24
    s_cbranch_vccnz CS0_p1retry
CS0_p1ok:
    s_cmp_eq_u32 s64, 62
    s_cbranch_scc1 C_last
    s_nop 15
    s_nop 15
    s_nop 3
    buffer_load_dwordx4 v[96:99], v0, s[8:11], s73 offen offset:3072 sc1
CS0_entry:
    buffer_store_dword v12, v6, s[8:11], s72 offen sc1
    s_nop 15
    s_nop 5
    buffer_load_dwordx4 v[96:99], v0, s[8:11], s73 offen offset:3072 sc1
    v_readfirstlane_b32 s66, v8
    v_xor_b32 v25, 8192, v25
    s_add_u32 s76, s74, 0x82000
    s_add_u32 s74, s74, 0x80000
    s_xor_b32 s94, s94, 8192
    s_cmp_gt_u32 s66, s96
    s_cbranch_scc0 CS0_kvslow
CS0_kvok:
    s_add_u32 s64, s64, 1
    s_add_u32 s75, s75, 8192
    s_mov_b32 s70, s93
    s_add_u32 s68, s68, 262144
    s_cmp_eq_u32 s68, 0xe0000
    s_cselect_b32 s68, 0x20000, s68
    s_add_u32 s93, s68, s5
    s_add_u32 s69, s68, 131072
    s_add_u32 s65, s64, 2
    s_lshr_b32 s96, s65, 2
    s_and_b32 s65, s65, 3
    s_lshl_b32 s65, s65, 7
    s_add_u32 s92, s97, s65
    s_branch CS0_step
CS0_p2retry:
    s_add_u32 s63, s63, 1
    s_cmp_gt_u32 s63, 400000
    s_cbranch_scc1 C_last
    buffer_load_dwordx4 v[96:99], v0, s[8:11], s73 offen offset:3072 sc1
    v_mov_b64 v[32:33], 0
    v_mov_b64 v[34:35], 0
    s_nop 0
    v_mov_b64 v[36:37], 0
    v_mov_b64 v[38:39], 0
    s_waitcnt vmcnt(1)
    s_branch CS0_step2
CS0_ownretry:
    buffer_load_dwordx4 v[112:115], v0, s[8:11], s4 offen offset:2048 sc1
    s_waitcnt vmcnt(0)
    v_max3_u32 v9, v112, v113, v114
    v_max_u32 v9, v9, v115
    ds_write_b128 v0, v[112:115] offset:2048
    v_cmp_le_u32 vcc, s78, v9
    s_add_u32 s63, s63, 1
    s_cmp_gt_u32 s63, 400000
    s_waitcnt lgkmcnt(0)
    s_cbranch_scc1 CS0_ownok
    s_cbranch_vccz CS0_ownok
    s_branch CS0_ownretry
CS0_p1retry:
    v_max3_u32 v9, v116, v117, v118
    v_max3_u32 v100, v119, v120, v121
    v_max3_u32 v9, v9, v122, v123
    v_max_u32 v9, v9, v100
    v_cmp_eq_u32 vcc, -1, v9
    v_mov_b64 v[124:125], 0
    v_mov_b64 v[126:127], 0
    v_mov_b64 v[112:113], v[26:27]
    v_mov_b64 v[114:115], v[26:27]
    s_cbranch_vccz CS0_p1nan
    buffer_load_dwordx4 v[116:119], v0, s[8:11], s93 offen offset:0 sc1
    buffer_load_dwordx4 v[120:123], v0, s[8:11], s93 offen offset:1024 sc1
    s_add_u32 s63, s63, 1
    s_waitcnt vmcnt(3)
    s_cmp_gt_u32 s63, 400000
    s_cbranch_scc0 CS0_p1
CS0_p1nan:
    s_nop 0
    v_smfmac_f32_16x16x64_bf16 v[124:127], v[112:115], v[116:123], v11
    s_nop 7
    v_add_f32_dpp v100, v124, v124 row_ror:8 row_mask:0xf bank_mask:0xf
    v_add_f32_dpp v101, v125, v125 row_ror:8 row_mask:0xf bank_mask:0xf
    s_nop 0
    v_add_f32_dpp v102, v100, v100 row_ror:4 row_mask:0xf bank_mask:0xf
    v_add_f32_dpp v103, v101, v101 row_ror:4 row_mask:0xf bank_mask:0xf
    v_cvt_pk_bf16_f32 v24, v102, v103
    v_min_u32 v24, 0xffbfffff, v24
    buffer_store_dword v24, v6, s[8:11], s71 offen sc1
    s_branch CS0_p1ok
CS0_kvslow:
    buffer_load_dword v8, off, s[8:11], s92 sc1
    s_waitcnt vmcnt(0)
    v_readfirstlane_b32 s66, v8
    s_nop 0
    s_cmp_gt_u32 s66, s96
    s_cbranch_scc1 CS0_kvok
    s_add_u32 s63, s63, 1
    s_cmp_gt_u32 s63, 400000
    s_cbranch_scc1 CS0_kvok
    s_sleep 1
    s_branch CS0_kvslow
.p2align 6
    s_nop 0
    s_nop 0
    s_nop 0
    s_nop 0
    s_nop 0
    s_nop 0
    s_nop 0
    s_nop 0
CS1_step:
    s_waitcnt vmcnt(2) lgkmcnt(0)
CS1_step2:
    v_max3_u32 v9, v96, v97, v98
    v_max_u32 v9, v9, v99
    ds_write_b128 v0, v[96:99] offset:7168
    v_smfmac_f32_16x16x64_bf16 v[32:35], v[96:99], v[64:71], v7
    v_cmp_le_u32 vcc, s78, v9
    v_smfmac_f32_16x16x64_bf16 v[36:39], v[96:99], v[72:79], v7
    s_cbranch_vccnz CS1_p2retry
    v_smfmac_f32_16x16x64_bf16 v[48:51], v[96:99], v[80:87], v7
    v_smfmac_f32_16x16x64_bf16 v[52:55], v[96:99], v[88:95], v7
    s_waitcnt lgkmcnt(0)
    s_barrier
    ds_read_b128 v[100:103], v0 offset:3072
    buffer_load_dwordx4 v[112:115], v0, s[8:11], s4 offen offset:2048 sc1
    v_smfmac_f32_16x16x64_bf16 v[40:43], v[96:99], v[56:63], v7
    buffer_load_dwordx4 v0, s[8:11], s4 offen offset:2048 sc1 lds
    ds_read_b128 v[64:67], v1 offset:12288
    v_smfmac_f32_16x16x64_bf16 v[44:47], v[96:99], v[104:111], v7
    ds_read_b128 v[68:71], v1 offset:13312
    s_waitcnt lgkmcnt(2)
    v_smfmac_f32_16x16x64_bf16 v[32:35], v[100:103], v[128:135], v7
    ds_read_b128 v[104:107], v0 offset:15360
    ds_read_b128 v[72:75], v1 offset:14336
    v_smfmac_f32_16x16x64_bf16 v[36:39], v[100:103], v[136:143], v7
    s_mov_b32 m0, s94
    ds_read_b128 v[76:79], v1 offset:15360
    v_smfmac_f32_16x16x64_bf16 v[48:51], v[100:103], v[224:231], v7
    buffer_load_dwordx4 v0, s[8:11], s74 offen offset:0 sc1 lds
    ds_read_b128 v[80:83], v1 offset:16384
    v_smfmac_f32_16x16x64_bf16 v[52:55], v[100:103], v[232:239], v7
    buffer_load_dwordx4 v0, s[8:11], s74 offen offset:1024 sc1 lds
    ds_read_b128 v[84:87], v1 offset:17408
    v_smfmac_f32_16x16x64_bf16 v[40:43], v[100:103], a[64:71], v7
    ds_read_b128 v[108:111], v0 offset:11264
    v_smfmac_f32_16x16x64_bf16 v[44:47], v[100:103], a[72:79], v7
    buffer_load_dwordx4 v[16:19], v0, s[8:11], s76 offen offset:0 sc1
    s_waitcnt lgkmcnt(5)
    v_smfmac_f32_16x16x64_bf16 v[48:51], v[104:107], v[240:247], v7
    ds_read_b128 v[88:91], v1 offset:18432
    v_smfmac_f32_16x16x64_bf16 v[52:55], v[104:107], v[248:255], v7
    buffer_load_dwordx4 v[20:23], v0, s[8:11], s76 offen offset:1024 sc1
    s_waitcnt lgkmcnt(4)
    v_smfmac_f32_16x16x64_bf16 v[32:35], v[104:107], v[64:71], v7
    ds_read_b128 v[92:95], v1 offset:19456
    v_smfmac_f32_16x16x64_bf16 v[36:39], v[104:107], v[72:79], v7
    buffer_store_dword v24, v6, s[8:11], s75 offen sc1
    s_waitcnt lgkmcnt(2)
    v_smfmac_f32_16x16x64_bf16 v[32:35], v[108:111], v[144:151], v7
    buffer_load_dword v8, off, s[8:11], s92 sc1
    ds_read_b128 v[64:67], v1 offset:20480
    v_smfmac_f32_16x16x64_bf16 v[36:39], v[108:111], v[152:159], v7
    ds_read_b128 v[68:71], v1 offset:21504
    v_smfmac_f32_16x16x64_bf16 v[48:51], v[108:111], a[0:7], v7
    s_waitcnt vmcnt(6)
    v_max3_u32 v9, v112, v113, v114
    v_max_u32 v9, v9, v115
    v_smfmac_f32_16x16x64_bf16 v[52:55], v[108:111], a[8:15], v7
    ds_read_b128 v[72:75], v1 offset:22528
    s_waitcnt lgkmcnt(3)
    v_cmp_le_u32 vcc, s78, v9
    v_smfmac_f32_16x16x64_bf16 v[40:43], v[104:107], v[80:87], v7
    ds_read_b128 v[76:79], v1 offset:23552
    v_smfmac_f32_16x16x64_bf16 v[44:47], v[104:107], v[88:95], v7
    s_cbranch_vccnz CS1_ownretry
CS1_ownok:
    s_barrier
    v_smfmac_f32_16x16x64_bf16 v[32:35], v[112:115], v[160:167], v7
    ds_read_b128 v[116:119], v0 offset:2048
    ds_read_b128 v[120:123], v0 offset:14336
    v_smfmac_f32_16x16x64_bf16 v[36:39], v[112:115], v[168:175], v7
    ds_read_b128 v[124:127], v0 offset:10240
    s_waitcnt lgkmcnt(3)
    v_smfmac_f32_16x16x64_bf16 v[48:51], v[112:115], v[64:71], v7
    ds_read_b128 v[80:83], v25 offset:18432
    v_smfmac_f32_16x16x64_bf16 v[52:55], v[112:115], v[72:79], v7
    buffer_store_dwordx4 v[12:15], v0, s[8:11], s70 offen offset:0 sc1
    s_waitcnt lgkmcnt(3)
    v_smfmac_f32_16x16x64_bf16 v[32:35], v[116:119], v[176:183], v7
    ds_read_b128 v[84:87], v25 offset:20480
    s_waitcnt lgkmcnt(2)
    v_smfmac_f32_16x16x64_bf16 v[32:35], v[120:123], v[192:199], v7
    ds_read_b128 v[88:91], v25 offset:23552
    v_smfmac_f32_16x16x64_bf16 v[32:35], v[124:127], v[208:215], v7
    ds_read_b128 v[92:95], v25 offset:22528
    v_smfmac_f32_16x16x64_bf16 v[36:39], v[116:119], v[184:191], v7
    ds_read_b128 v[64:67], v25 offset:17408
    v_smfmac_f32_16x16x64_bf16 v[36:39], v[120:123], v[200:207], v7
    ds_read_b128 v[68:71], v25 offset:21504
    v_add_f32 v32, v32, v34
    v_smfmac_f32_16x16x64_bf16 v[36:39], v[124:127], v[216:223], v7
    ds_read_b128 v[72:75], v25 offset:16384
    v_add_f32 v33, v33, v35
    v_smfmac_f32_16x16x64_bf16 v[48:51], v[116:119], a[16:23], v7
    ds_read_b128 v[76:79], v25 offset:19456
    v_smfmac_f32_16x16x64_bf16 v[48:51], v[120:123], a[32:39], v7
    buffer_store_dwordx4 v[12:15], v0, s[8:11], s70 offen offset:1024 sc1
    v_add_f32 v36, v36, v38
    v_add_f32 v37, v37, v39
    v_smfmac_f32_16x16x64_bf16 v[48:51], v[124:127], a[48:55], v7
    v_cvt_pk_bf16_f32 v34, v32, v36
    v_cvt_pk_bf16_f32 v35, v33, v37
    v_smfmac_f32_16x16x64_bf16 v[52:55], v[116:119], a[24:31], v7
    ds_write2_b32 v2, v34, v35 offset0:0 offset1:4
    v_mov_b64 v[36:37], 0
    v_smfmac_f32_16x16x64_bf16 v[52:55], v[120:123], a[40:47], v7
    v_add_f32 v48, v48, v50
    v_smfmac_f32_16x16x64_bf16 v[52:55], v[124:127], a[56:63], v7
    v_add_f32 v49, v49, v51
    v_smfmac_f32_16x16x64_bf16 v[40:43], v[108:111], a[80:87], v7
    v_mov_b64 v[38:39], 0
    v_smfmac_f32_16x16x64_bf16 v[44:47], v[108:111], a[88:95], v7
    v_add_f32 v52, v52, v54
    v_add_f32 v53, v53, v55
    v_cvt_pk_bf16_f32 v32, v48, v52
    v_cvt_pk_bf16_f32 v33, v49, v53
    v_smfmac_f32_16x16x64_bf16 v[40:43], v[112:115], a[96:103], v7
    ds_write2_b32 v3, v32, v33 offset0:0 offset1:4
    v_mov_b64 v[48:49], 0
    v_smfmac_f32_16x16x64_bf16 v[44:47], v[112:115], a[104:111], v7
    v_mov_b64 v[50:51], 0
    v_smfmac_f32_16x16x64_bf16 v[40:43], v[116:119], a[112:119], v7
    ds_read_b128 v[100:103], v4 offset:3104
    v_mov_b64 v[52:53], 0
    v_smfmac_f32_16x16x64_bf16 v[44:47], v[116:119], a[120:127], v7
    v_mov_b64 v[54:55], 0
    v_smfmac_f32_16x16x64_bf16 v[40:43], v[120:123], a[128:135], v7
    s_waitcnt lgkmcnt(1)
    s_barrier
    ds_read_b128 v[96:99], v4 offset:3072
    v_smfmac_f32_16x16x64_bf16 v[44:47], v[120:123], a[136:143], v7
    ds_read_b128 v[108:111], v4 offset:7200
    v_smfmac_f32_16x16x64_bf16 v[40:43], v[124:127], a[144:151], v7
    ds_read_b128 v[104:107], v4 offset:7168
    v_smfmac_f32_16x16x64_bf16 v[44:47], v[124:127], a[152:159], v7
    ds_read_b128 v[112:115], v0 offset:11264
    s_waitcnt lgkmcnt(4)
    v_mfma_f32_16x16x32_bf16 v[56:59], v[64:67], v[100:103], 0
    ds_read_b128 v[116:119], v0 offset:15360
    v_mfma_f32_16x16x32_bf16 v[60:63], v[68:71], v[100:103], 0
    s_waitcnt lgkmcnt(4)
    v_mfma_f32_16x16x32_bf16 v[56:59], v[72:75], v[96:99], v[56:59]
    s_waitcnt lgkmcnt(3)
    v_mfma_f32_16x16x32_bf16 v[56:59], v[76:79], v[108:111], v[56:59]
    ds_read_b128 v[64:67], v1 offset:24576
    s_waitcnt lgkmcnt(3)
    v_mfma_f32_16x16x32_bf16 v[56:59], v[80:83], v[104:107], v[56:59]
    ds_read_b128 v[68:71], v1 offset:25600
    v_add_f32 v40, v40, v42
    v_add_f32 v41, v41, v43
    v_mfma_f32_16x16x32_bf16 v[60:63], v[84:87], v[96:99], v[60:63]
    s_waitcnt lgkmcnt(2)
    v_add_f32 v44, v44, v46
    v_add_f32 v45, v45, v47
    v_smfmac_f32_16x16x64_bf16 v[36:39], v[112:115], v[96:103], v7
    ds_read_b128 v[80:83], v1 offset:28672
    v_max3_f32 v9, v56, v57, v58
    v_smfmac_f32_16x16x64_bf16 v[36:39], v[116:119], v[104:111], v7
    ds_read_b128 v[96:99], v0 offset:4096
    v_max_f32 v9, v9, v59
    v_mfma_f32_16x16x32_bf16 v[60:63], v[88:91], v[108:111], v[60:63]
    ds_read_b128 v[100:103], v0 offset:5120
    v_cvt_pk_bf16_f32 v42, v40, v41
    v_cvt_pk_bf16_f32 v43, v44, v45
    v_mfma_f32_16x16x32_bf16 v[60:63], v[92:95], v[104:107], v[60:63]
    ds_read_b128 v[84:87], v1 offset:29696
    v_add_f32 v36, v36, v38
    v_add_f32 v37, v37, v39
    v_max3_f32 v9, v9, v36, v37
    v_mov_b64 v[44:45], s[48:49]
    v_mov_b64 v[46:47], s[48:49]
    v_mov_b64 v[104:105], 0
    s_nop 0
    v_max3_f32 v10, v60, v61, v62
    v_max3_f32 v32, v9, v10, v63
    v_max3_f32 v33, v9, v10, v63
    v_mov_b64 v[106:107], 0
    v_mov_b64 v[108:109], 0
    v_permlane32_swap_b32 v32, v33
    v_max_f32 v34, v32, v33
    v_max_f32 v35, v32, v33
    v_mov_b64 v[110:111], 0
    v_mov_b64 v[40:41], 0
    v_permlane16_swap_b32 v34, v35
    v_max_f32 v32, v34, v35
    v_mul_f32 v32, s98, v32
    v_pk_fma_f32 v[36:37], v[36:37], s[98:99], v[32:33] op_sel_hi:[1,1,0] neg_lo:[0,0,1] neg_hi:[0,0,1]
    v_pk_fma_f32 v[56:57], v[56:57], s[98:99], v[32:33] op_sel_hi:[1,1,0] neg_lo:[0,0,1] neg_hi:[0,0,1]
    v_exp_f32 v36, v36
    v_exp_f32 v37, v37
    v_pk_fma_f32 v[58:59], v[58:59], s[98:99], v[32:33] op_sel_hi:[1,1,0] neg_lo:[0,0,1] neg_hi:[0,0,1]
    v_pk_fma_f32 v[60:61], v[60:61], s[98:99], v[32:33] op_sel_hi:[1,1,0] neg_lo:[0,0,1] neg_hi:[0,0,1]
    v_pk_fma_f32 v[62:63], v[62:63], s[98:99], v[32:33] op_sel_hi:[1,1,0] neg_lo:[0,0,1] neg_hi:[0,0,1]
    v_cvt_pk_bf16_f32 v28, v36, v37
    v_cvt_pk_bf16_f32 v31, v36, v37
    v_exp_f32 v56, v56
    v_exp_f32 v57, v57
    v_mfma_f32_16x16x16_bf16 v[124:127], v[44:45], v[28:29], 0
    v_exp_f32 v58, v58
    v_exp_f32 v59, v59
    v_mfma_f32_16x16x16_bf16 v[112:115], v[42:43], v[28:29], 0
    v_exp_f32 v60, v60
    v_exp_f32 v61, v61
    v_mfma_f32_16x16x16_bf16 v[116:119], v[42:43], v[30:31], 0
    v_exp_f32 v62, v62
    v_exp_f32 v63, v63
    v_cvt_pk_bf16_f32 v120, v56, v57
    v_cvt_pk_bf16_f32 v121, v58, v59
    v_cvt_pk_bf16_f32 v122, v60, v61
    v_cvt_pk_bf16_f32 v123, v62, v63
    s_waitcnt lgkmcnt(0)
    s_nop 0
    v_mfma_f32_16x16x32_bf16 v[124:127], v[44:47], v[120:123], v[124:127]
    ds_read_b128 v[72:75], v1 offset:26624
    ds_read_b128 v[76:79], v1 offset:27648
    v_mfma_f32_16x16x32_bf16 v[112:115], v[96:99], v[120:123], v[112:115]
    ds_read_b128 v[88:91], v1 offset:30720
    ds_read_b128 v[92:95], v1 offset:31744
    v_mfma_f32_16x16x32_bf16 v[116:119], v[100:103], v[120:123], v[116:119]
    v_rcp_f32 v124, v124
    v_mov_b64 v[42:43], 0
    s_nop 1
    v_pk_mul_f32 v[112:113], v[112:113], v[124:125] op_sel_hi:[1,0]
    v_pk_mul_f32 v[114:115], v[114:115], v[124:125] op_sel_hi:[1,0]
    v_cvt_pk_bf16_f32 v32, v112, v113
    v_cvt_pk_bf16_f32 v33, v114, v115
    v_pk_mul_f32 v[116:117], v[116:117], v[124:125] op_sel_hi:[1,0]
    s_nop 0
    v_pk_mul_f32 v[118:119], v[118:119], v[124:125] op_sel_hi:[1,0]
    v_cvt_pk_bf16_f32 v34, v116, v117
    v_cvt_pk_bf16_f32 v35, v118, v119
    ds_write_b128 v0, v[32:35] offset:6144
    s_nop 0
    v_smfmac_f32_16x16x64_bf16 v[48:51], v[32:35], a[160:167], v7
    v_smfmac_f32_16x16x64_bf16 v[52:55], v[32:35], a[176:183], v7
    s_add_u32 s65, s68, 65536
    s_add_u32 s66, s69, 65536
    v_smfmac_f32_16x16x64_bf16 v[104:107], v[32:35], v[64:71], v7
    v_smfmac_f32_16x16x64_bf16 v[108:111], v[32:35], v[80:87], v7
    s_waitcnt lgkmcnt(0)
    s_barrier
    ds_read_b128 v[36:39], v0 offset:2048
    v_mov_b64 v[124:125], 0
    ds_read_b128 v[96:99], v0 offset:14336
    v_mov_b64 v[126:127], 0
    ds_read_b128 v[100:103], v0 offset:10240
    v_mov_b64 v[32:33], 0
    s_nop 2
    v_mov_b64 v[34:35], 0
    s_nop 2
    v_mov_b64 v[44:45], 0
    s_waitcnt lgkmcnt(2)
    v_smfmac_f32_16x16x64_bf16 v[48:51], v[36:39], a[168:175], v7
    s_waitcnt lgkmcnt(0)
    v_smfmac_f32_16x16x64_bf16 v[48:51], v[96:99], a[192:199], v7
    v_smfmac_f32_16x16x64_bf16 v[48:51], v[100:103], a[200:207], v7
    v_smfmac_f32_16x16x64_bf16 v[52:55], v[36:39], a[184:191], v7
    v_smfmac_f32_16x16x64_bf16 v[52:55], v[96:99], a[208:215], v7
    v_cvt_pk_bf16_f32 v56, v48, v50
    v_cvt_pk_bf16_f32 v57, v49, v51
    v_smfmac_f32_16x16x64_bf16 v[52:55], v[100:103], a[216:223], v7
    buffer_store_dwordx2 v[56:57], v5, s[8:11], s68 offen sc1
    v_smfmac_f32_16x16x64_bf16 v[104:107], v[36:39], v[72:79], v7
    v_smfmac_f32_16x16x64_bf16 v[104:107], v[96:99], a[224:231], v7
    v_cvt_pk_bf16_f32 v58, v52, v54
    v_cvt_pk_bf16_f32 v59, v53, v55
    v_smfmac_f32_16x16x64_bf16 v[104:107], v[100:103], a[232:239], v7
    buffer_store_dwordx2 v[58:59], v5, s[8:11], s65 offen sc1
    v_smfmac_f32_16x16x64_bf16 v[108:111], v[36:39], v[88:95], v7
    v_smfmac_f32_16x16x64_bf16 v[108:111], v[96:99], a[240:247], v7
    v_cvt_pk_bf16_f32 v60, v104, v106
    v_cvt_pk_bf16_f32 v61, v105, v107
    v_smfmac_f32_16x16x64_bf16 v[108:111], v[100:103], a[248:255], v7
    buffer_store_dwordx2 v[60:61], v5, s[8:11], s69 offen sc1
    ds_read_b128 v[64:67], v1 offset:0
    ds_read_b128 v[68:71], v1 offset:1024
    ds_read_b128 v[72:75], v1 offset:2048
    ds_read_b128 v[76:79], v1 offset:3072
    s_nop 2
    v_cvt_pk_bf16_f32 v62, v108, v110
    v_cvt_pk_bf16_f32 v63, v109, v111
    buffer_store_dwordx2 v[62:63], v5, s[8:11], s66 offen sc1
    ds_read_b128 v[80:83], v1 offset:4096
    ds_read_b128 v[84:87], v1 offset:5120
    ds_read_b128 v[88:91], v1 offset:6144
    ds_read_b128 v[92:95], v1 offset:7168
    ds_read_b128 v[56:59], v1 offset:8192
    ds_read_b128 v[60:63], v1 offset:9216
    ds_read_b128 v[104:107], v1 offset:10240
    ds_read_b128 v[108:111], v1 offset:11264
    v_mov_b64 v[36:37], 0
    v_mov_b64 v[38:39], 0
    v_mov_b64 v[46:47], 0
    v_mov_b64 v[48:49], 0
    v_mov_b64 v[50:51], 0
    v_mov_b64 v[52:53], 0
    v_mov_b64 v[54:55], 0
    v_mov_b64 v[112:113], v[26:27]
    v_mov_b64 v[114:115], v[26:27]
    s_nop 15
    s_nop 2
    buffer_load_dwordx4 v[116:119], v0, s[8:11], s93 offen offset:0 sc1
    buffer_load_dwordx4 v[120:123], v0, s[8:11], s93 offen offset:1024 sc1
    s_mov_b32 s72, s71
    s_add_u32 s71, s71, 8192
    s_cmp_eq_u32 s71, 0xe6000
    s_cselect_b32 s71, 0xe0000, s71
    s_add_u32 s73, s71, 0xfffdf800
    s_add_u32 s4, s73, 5120
    s_mov_b32 m0, s95
    s_waitcnt vmcnt(10)
    ds_write_b128 v0, v[16:19] offset:4096
    ds_write_b128 v0, v[20:23] offset:5120
    s_nop 15
    s_nop 3
    buffer_load_dwordx4 v[116:119], v0, s[8:11], s93 offen offset:0 sc1
    buffer_load_dwordx4 v[120:123], v0, s[8:11], s93 offen offset:1024 sc1
    s_waitcnt vmcnt(2)
CS1_p1:
    v_smfmac_f32_16x16x64_bf16 v[124:127], v[112:115], v[116:123], v11
    s_nop 7
    v_add_f32_dpp v100, v124, v124 row_ror:8 row_mask:0xf bank_mask:0xf
    v_add_f32_dpp v101, v125, v125 row_ror:8 row_mask:0xf bank_mask:0xf
    s_nop 0
    v_add_f32_dpp v102, v100, v100 row_ror:4 row_mask:0xf bank_mask:0xf
    v_add_f32_dpp v103, v101, v101 row_ror:4 row_mask:0xf bank_mask:0xf
    v_cvt_pk_bf16_f32 v24, v102, v103
    buffer_store_dword v24, v6, s[8:11], s71 offen sc1
    v_cmp_le_u32 vcc, s78, v24
    s_cbranch_vccnz CS1_p1retry
CS1_p1ok:
    s_cmp_eq_u32 s64, 62
    s_cbranch_scc1 C_last
    s_nop 15
    s_nop 14
    buffer_load_dwordx4 v[96:99], v0, s[8:11], s73 offen offset:3072 sc1
CS1_entry:
    buffer_store_dword v12, v6, s[8:11], s72 offen sc1
    s_nop 15
    s_nop 5
    buffer_load_dwordx4 v[96:99], v0, s[8:11], s73 offen offset:3072 sc1
    v_readfirstlane_b32 s66, v8
    v_xor_b32 v25, 8192, v25
    s_add_u32 s76, s74, 0x82000
    s_add_u32 s74, s74, 0x80000
    s_xor_b32 s94, s94, 8192
    s_cmp_gt_u32 s66, s96
    s_cbranch_scc0 CS1_kvslow
CS1_kvok:
    s_add_u32 s64, s64, 1
    s_add_u32 s75, s75, 8192
    s_mov_b32 s70, s93
    s_add_u32 s68, s68, 262144
    s_cmp_eq_u32 s68, 0xe0000
    s_cselect_b32 s68, 0x20000, s68
    s_add_u32 s93, s68, s5
    s_add_u32 s69, s68, 131072
    s_add_u32 s65, s64, 2
    s_lshr_b32 s96, s65, 2
    s_and_b32 s65, s65, 3
    s_lshl_b32 s65, s65, 7
    s_add_u32 s92, s97, s65
    s_branch CS1_step
CS1_p2retry:
    s_add_u32 s63, s63, 1
    s_cmp_gt_u32 s63, 400000
    s_cbranch_scc1 C_last
    buffer_load_dwordx4 v[96:99], v0, s[8:11], s73 offen offset:3072 sc1
    v_mov_b64 v[32:33], 0
    v_mov_b64 v[34:35], 0
    s_nop 0
    v_mov_b64 v[36:37], 0
    v_mov_b64 v[38:39], 0
    s_waitcnt vmcnt(1)
    s_branch CS1_step2
CS1_ownretry:
    buffer_load_dwordx4 v[112:115], v0, s[8:11], s4 offen offset:2048 sc1
    s_waitcnt vmcnt(0)
    v_max3_u32 v9, v112, v113, v114
    v_max_u32 v9, v9, v115
    ds_write_b128 v0, v[112:115] offset:6144
    v_cmp_le_u32 vcc, s78, v9
    s_add_u32 s63, s63, 1
    s_cmp_gt_u32 s63, 400000
    s_waitcnt lgkmcnt(0)
    s_cbranch_scc1 CS1_ownok
    s_cbranch_vccz CS1_ownok
    s_branch CS1_ownretry
CS1_p1retry:
    v_max3_u32 v9, v116, v117, v118
    v_max3_u32 v100, v119, v120, v121
    v_max3_u32 v9, v9, v122, v123
    v_max_u32 v9, v9, v100
    v_cmp_eq_u32 vcc, -1, v9
    v_mov_b64 v[124:125], 0
    v_mov_b64 v[126:127], 0
    v_mov_b64 v[112:113], v[26:27]
    v_mov_b64 v[114:115], v[26:27]
    s_cbranch_vccz CS1_p1nan
    buffer_load_dwordx4 v[116:119], v0, s[8:11], s93 offen offset:0 sc1
    buffer_load_dwordx4 v[120:123], v0, s[8:11], s93 offen offset:1024 sc1
    s_add_u32 s63, s63, 1
    s_waitcnt vmcnt(3)
    s_cmp_gt_u32 s63, 400000
    s_cbranch_scc0 CS1_p1
CS1_p1nan:
    s_nop 0
    v_smfmac_f32_16x16x64_bf16 v[124:127], v[112:115], v[116:123], v11
    s_nop 7
    v_add_f32_dpp v100, v124, v124 row_ror:8 row_mask:0xf bank_mask:0xf
    v_add_f32_dpp v101, v125, v125 row_ror:8 row_mask:0xf bank_mask:0xf
    s_nop 0
    v_add_f32_dpp v102, v100, v100 row_ror:4 row_mask:0xf bank_mask:0xf
    v_add_f32_dpp v103, v101, v101 row_ror:4 row_mask:0xf bank_mask:0xf
    v_cvt_pk_bf16_f32 v24, v102, v103
    v_min_u32 v24, 0xffbfffff, v24
    buffer_store_dword v24, v6, s[8:11], s71 offen sc1
    s_branch CS1_p1ok
CS1_kvslow:
    buffer_load_dword v8, off, s[8:11], s92 sc1
    s_waitcnt vmcnt(0)
    v_readfirstlane_b32 s66, v8
    s_nop 0
    s_cmp_gt_u32 s66, s96
    s_cbranch_scc1 CS1_kvok
    s_add_u32 s63, s63, 1
    s_cmp_gt_u32 s63, 400000
    s_cbranch_scc1 CS1_kvok
    s_sleep 1
    s_branch CS1_kvslow
.p2align 6
    s_nop 0
    s_nop 0
    s_nop 0
    s_nop 0
    s_nop 0
    s_nop 0
    s_nop 0
    s_nop 0
CS2_step:
    s_waitcnt vmcnt(2) lgkmcnt(0)
CS2_step2:
    v_max3_u32 v9, v96, v97, v98
    v_max_u32 v9, v9, v99
    ds_write_b128 v0, v[96:99] offset:11264
    v_smfmac_f32_16x16x64_bf16 v[32:35], v[96:99], v[64:71], v7
    v_cmp_le_u32 vcc, s78, v9
    v_smfmac_f32_16x16x64_bf16 v[36:39], v[96:99], v[72:79], v7
    s_cbranch_vccnz CS2_p2retry
    v_smfmac_f32_16x16x64_bf16 v[48:51], v[96:99], v[80:87], v7
    v_smfmac_f32_16x16x64_bf16 v[52:55], v[96:99], v[88:95], v7
    s_waitcnt lgkmcnt(0)
    s_barrier
    ds_read_b128 v[100:103], v0 offset:15360
    buffer_load_dwordx4 v[112:115], v0, s[8:11], s4 offen offset:2048 sc1
    v_smfmac_f32_16x16x64_bf16 v[40:43], v[96:99], v[56:63], v7
    buffer_load_dwordx4 v0, s[8:11], s4 offen offset:2048 sc1 lds
    ds_read_b128 v[64:67], v1 offset:12288
    v_smfmac_f32_16x16x64_bf16 v[44:47], v[96:99], v[104:111], v7
    ds_read_b128 v[68:71], v1 offset:13312
    s_waitcnt lgkmcnt(2)
    v_smfmac_f32_16x16x64_bf16 v[32:35], v[100:103], v[128:135], v7
    ds_read_b128 v[104:107], v0 offset:3072
    ds_read_b128 v[72:75], v1 offset:14336
    v_smfmac_f32_16x16x64_bf16 v[36:39], v[100:103], v[136:143], v7
    s_mov_b32 m0, s94
    ds_read_b128 v[76:79], v1 offset:15360
    v_smfmac_f32_16x16x64_bf16 v[48:51], v[100:103], v[224:231], v7
    buffer_load_dwordx4 v0, s[8:11], s74 offen offset:0 sc1 lds
    ds_read_b128 v[80:83], v1 offset:16384
    v_smfmac_f32_16x16x64_bf16 v[52:55], v[100:103], v[232:239], v7
    buffer_load_dwordx4 v0, s[8:11], s74 offen offset:1024 sc1 lds
    v_smfmac_f32_16x16x64_bf16 v[40:43], v[100:103], a[64:71], v7
    ds_read_b128 v[108:111], v0 offset:7168
    buffer_load_dwordx4 v[16:19], v0, s[8:11], s76 offen offset:0 sc1
    v_smfmac_f32_16x16x64_bf16 v[44:47], v[100:103], a[72:79], v7
    ds_read_b128 v[84:87], v1 offset:17408
    s_waitcnt lgkmcnt(5)
    v_smfmac_f32_16x16x64_bf16 v[48:51], v[104:107], v[240:247], v7
    buffer_load_dwordx4 v[20:23], v0, s[8:11], s76 offen offset:1024 sc1
    v_smfmac_f32_16x16x64_bf16 v[52:55], v[104:107], v[248:255], v7
    ds_read_b128 v[88:91], v1 offset:18432
    s_waitcnt lgkmcnt(4)
    v_smfmac_f32_16x16x64_bf16 v[32:35], v[104:107], v[64:71], v7
    buffer_store_dword v24, v6, s[8:11], s75 offen sc1
    v_smfmac_f32_16x16x64_bf16 v[36:39], v[104:107], v[72:79], v7
    ds_read_b128 v[92:95], v1 offset:19456
    s_waitcnt lgkmcnt(3)
    v_smfmac_f32_16x16x64_bf16 v[32:35], v[108:111], v[144:151], v7
    buffer_load_dword v8, off, s[8:11], s92 sc1
    ds_read_b128 v[64:67], v1 offset:20480
    v_smfmac_f32_16x16x64_bf16 v[36:39], v[108:111], v[152:159], v7
    ds_read_b128 v[68:71], v1 offset:21504
    v_smfmac_f32_16x16x64_bf16 v[48:51], v[108:111], a[0:7], v7
    s_waitcnt vmcnt(6)
    v_max3_u32 v9, v112, v113, v114
    v_max_u32 v9, v9, v115
    v_smfmac_f32_16x16x64_bf16 v[52:55], v[108:111], a[8:15], v7
    ds_read_b128 v[72:75], v1 offset:22528
    s_waitcnt lgkmcnt(3)
    v_cmp_le_u32 vcc, s78, v9
    v_smfmac_f32_16x16x64_bf16 v[40:43], v[104:107], v[80:87], v7
    ds_read_b128 v[76:79], v1 offset:23552
    v_smfmac_f32_16x16x64_bf16 v[44:47], v[104:107], v[88:95], v7
    s_cbranch_vccnz CS2_ownretry
CS2_ownok:
    s_barrier
    v_smfmac_f32_16x16x64_bf16 v[32:35], v[112:115], v[160:167], v7
    ds_read_b128 v[116:119], v0 offset:14336
    ds_read_b128 v[120:123], v0 offset:2048
    v_smfmac_f32_16x16x64_bf16 v[36:39], v[112:115], v[168:175], v7
    ds_read_b128 v[124:127], v0 offset:6144
    s_waitcnt lgkmcnt(3)
    v_smfmac_f32_16x16x64_bf16 v[48:51], v[112:115], v[64:71], v7
    ds_read_b128 v[80:83], v25 offset:17408
    v_smfmac_f32_16x16x64_bf16 v[52:55], v[112:115], v[72:79], v7
    ds_read_b128 v[84:87], v25 offset:23552
    s_waitcnt lgkmcnt(4)
    v_smfmac_f32_16x16x64_bf16 v[32:35], v[116:119], v[176:183], v7
    buffer_store_dwordx4 v[12:15], v0, s[8:11], s70 offen offset:0 sc1
    s_waitcnt lgkmcnt(2)
    v_smfmac_f32_16x16x64_bf16 v[32:35], v[120:123], v[192:199], v7
    ds_read_b128 v[88:91], v25 offset:20480
    v_smfmac_f32_16x16x64_bf16 v[32:35], v[124:127], v[208:215], v7
    ds_read_b128 v[92:95], v25 offset:21504
    v_smfmac_f32_16x16x64_bf16 v[36:39], v[116:119], v[184:191], v7
    ds_read_b128 v[64:67], v25 offset:18432
    v_smfmac_f32_16x16x64_bf16 v[36:39], v[120:123], v[200:207], v7
    ds_read_b128 v[68:71], v25 offset:22528
    v_add_f32 v32, v32, v34
    v_smfmac_f32_16x16x64_bf16 v[36:39], v[124:127], v[216:223], v7
    ds_read_b128 v[72:75], v25 offset:19456
    v_add_f32 v33, v33, v35
    v_smfmac_f32_16x16x64_bf16 v[48:51], v[116:119], a[16:23], v7
    ds_read_b128 v[76:79], v25 offset:16384
    v_smfmac_f32_16x16x64_bf16 v[48:51], v[120:123], a[32:39], v7
    v_add_f32 v36, v36, v38
    v_add_f32 v37, v37, v39
    v_smfmac_f32_16x16x64_bf16 v[48:51], v[124:127], a[48:55], v7
    buffer_store_dwordx4 v[12:15], v0, s[8:11], s70 offen offset:1024 sc1
    v_cvt_pk_bf16_f32 v34, v32, v36
    v_cvt_pk_bf16_f32 v35, v33, v37
    v_smfmac_f32_16x16x64_bf16 v[52:55], v[116:119], a[24:31], v7
    ds_write2_b32 v2, v34, v35 offset0:0 offset1:4
    v_mov_b64 v[36:37], 0
    v_smfmac_f32_16x16x64_bf16 v[52:55], v[120:123], a[40:47], v7
    v_add_f32 v48, v48, v50
    v_smfmac_f32_16x16x64_bf16 v[52:55], v[124:127], a[56:63], v7
    v_add_f32 v49, v49, v51
    v_smfmac_f32_16x16x64_bf16 v[40:43], v[108:111], a[80:87], v7
    v_mov_b64 v[38:39], 0
    v_smfmac_f32_16x16x64_bf16 v[44:47], v[108:111], a[88:95], v7
    v_add_f32 v52, v52, v54
    v_add_f32 v53, v53, v55
    v_cvt_pk_bf16_f32 v32, v48, v52
    v_cvt_pk_bf16_f32 v33, v49, v53
    v_smfmac_f32_16x16x64_bf16 v[40:43], v[112:115], a[96:103], v7
    ds_write2_b32 v3, v32, v33 offset0:0 offset1:4
    v_mov_b64 v[48:49], 0
    v_smfmac_f32_16x16x64_bf16 v[44:47], v[112:115], a[104:111], v7
    v_mov_b64 v[50:51], 0
    v_smfmac_f32_16x16x64_bf16 v[40:43], v[116:119], a[112:119], v7
    ds_read_b128 v[104:107], v4 offset:7168
    v_mov_b64 v[52:53], 0
    v_smfmac_f32_16x16x64_bf16 v[44:47], v[116:119], a[120:127], v7
    v_mov_b64 v[54:55], 0
    v_smfmac_f32_16x16x64_bf16 v[40:43], v[120:123], a[128:135], v7
    s_waitcnt lgkmcnt(1)
    s_barrier
    ds_read_b128 v[108:111], v4 offset:7200
    v_smfmac_f32_16x16x64_bf16 v[44:47], v[120:123], a[136:143], v7
    ds_read_b128 v[96:99], v4 offset:3072
    v_smfmac_f32_16x16x64_bf16 v[40:43], v[124:127], a[144:151], v7
    ds_read_b128 v[100:103], v4 offset:3104
    v_smfmac_f32_16x16x64_bf16 v[44:47], v[124:127], a[152:159], v7
    ds_read_b128 v[112:115], v0 offset:11264
    s_waitcnt lgkmcnt(4)
    v_mfma_f32_16x16x32_bf16 v[56:59], v[64:67], v[104:107], 0
    ds_read_b128 v[116:119], v0 offset:15360
    v_mfma_f32_16x16x32_bf16 v[60:63], v[68:71], v[104:107], 0
    s_waitcnt lgkmcnt(4)
    v_mfma_f32_16x16x32_bf16 v[56:59], v[72:75], v[108:111], v[56:59]
    s_waitcnt lgkmcnt(3)
    v_mfma_f32_16x16x32_bf16 v[56:59], v[76:79], v[96:99], v[56:59]
    ds_read_b128 v[64:67], v1 offset:24576
    s_waitcnt lgkmcnt(3)
    v_mfma_f32_16x16x32_bf16 v[56:59], v[80:83], v[100:103], v[56:59]
    ds_read_b128 v[68:71], v1 offset:25600
    v_add_f32 v40, v40, v42
    v_add_f32 v41, v41, v43
    v_mfma_f32_16x16x32_bf16 v[60:63], v[84:87], v[108:111], v[60:63]
    s_waitcnt lgkmcnt(2)
    v_add_f32 v44, v44, v46
    v_add_f32 v45, v45, v47
    v_smfmac_f32_16x16x64_bf16 v[36:39], v[112:115], v[96:103], v7
    ds_read_b128 v[80:83], v1 offset:28672
    v_max3_f32 v9, v56, v57, v58
    v_smfmac_f32_16x16x64_bf16 v[36:39], v[116:119], v[104:111], v7
    v_max_f32 v9, v9, v59
    v_mfma_f32_16x16x32_bf16 v[60:63], v[88:91], v[96:99], v[60:63]
    ds_read_b128 v[96:99], v0 offset:8192
    v_cvt_pk_bf16_f32 v42, v40, v41
    v_cvt_pk_bf16_f32 v43, v44, v45
    v_mfma_f32_16x16x32_bf16 v[60:63], v[92:95], v[100:103], v[60:63]
    ds_read_b128 v[100:103], v0 offset:9216
    ds_read_b128 v[84:87], v1 offset:29696
    v_add_f32 v36, v36, v38
    v_add_f32 v37, v37, v39
    v_max3_f32 v9, v9, v36, v37
    v_mov_b64 v[44:45], s[48:49]
    v_mov_b64 v[46:47], s[48:49]
    v_mov_b64 v[104:105], 0
    v_max3_f32 v10, v60, v61, v62
    v_max3_f32 v32, v9, v10, v63
    v_max3_f32 v33, v9, v10, v63
    v_mov_b64 v[106:107], 0
    v_mov_b64 v[108:109], 0
    v_permlane32_swap_b32 v32, v33
    v_max_f32 v34, v32, v33
    v_max_f32 v35, v32, v33
    v_mov_b64 v[110:111], 0
    v_mov_b64 v[40:41], 0
    v_permlane16_swap_b32 v34, v35
    v_max_f32 v32, v34, v35
    v_mul_f32 v32, s98, v32
    v_pk_fma_f32 v[36:37], v[36:37], s[98:99], v[32:33] op_sel_hi:[1,1,0] neg_lo:[0,0,1] neg_hi:[0,0,1]
    v_pk_fma_f32 v[56:57], v[56:57], s[98:99], v[32:33] op_sel_hi:[1,1,0] neg_lo:[0,0,1] neg_hi:[0,0,1]
    v_exp_f32 v36, v36
    v_exp_f32 v37, v37
    v_pk_fma_f32 v[58:59], v[58:59], s[98:99], v[32:33] op_sel_hi:[1,1,0] neg_lo:[0,0,1] neg_hi:[0,0,1]
    v_pk_fma_f32 v[60:61], v[60:61], s[98:99], v[32:33] op_sel_hi:[1,1,0] neg_lo:[0,0,1] neg_hi:[0,0,1]
    v_pk_fma_f32 v[62:63], v[62:63], s[98:99], v[32:33] op_sel_hi:[1,1,0] neg_lo:[0,0,1] neg_hi:[0,0,1]
    v_cvt_pk_bf16_f32 v28, v36, v37
    v_cvt_pk_bf16_f32 v31, v36, v37
    v_exp_f32 v56, v56
    v_exp_f32 v57, v57
    v_mfma_f32_16x16x16_bf16 v[124:127], v[44:45], v[28:29], 0
    v_exp_f32 v58, v58
    v_exp_f32 v59, v59
    v_mfma_f32_16x16x16_bf16 v[112:115], v[42:43], v[28:29], 0
    v_exp_f32 v60, v60
    v_exp_f32 v61, v61
    v_mfma_f32_16x16x16_bf16 v[116:119], v[42:43], v[30:31], 0
    v_exp_f32 v62, v62
    v_exp_f32 v63, v63
    v_cvt_pk_bf16_f32 v120, v56, v57
    v_cvt_pk_bf16_f32 v121, v58, v59
    v_cvt_pk_bf16_f32 v122, v60, v61
    v_cvt_pk_bf16_f32 v123, v62, v63
    s_waitcnt lgkmcnt(0)
    s_nop 0
    v_mfma_f32_16x16x32_bf16 v[124:127], v[44:47], v[120:123], v[124:127]
    ds_read_b128 v[72:75], v1 offset:26624
    ds_read_b128 v[76:79], v1 offset:27648
    v_mfma_f32_16x16x32_bf16 v[112:115], v[96:99], v[120:123], v[112:115]
    ds_read_b128 v[88:91], v1 offset:30720
    ds_read_b128 v[92:95], v1 offset:31744
    v_mfma_f32_16x16x32_bf16 v[116:119], v[100:103], v[120:123], v[116:119]
    v_rcp_f32 v124, v124
    v_mov_b64 v[42:43], 0
    s_nop 1
    v_pk_mul_f32 v[112:113], v[112:113], v[124:125] op_sel_hi:[1,0]
    v_pk_mul_f32 v[114:115], v[114:115], v[124:125] op_sel_hi:[1,0]
    v_cvt_pk_bf16_f32 v32, v112, v113
    v_cvt_pk_bf16_f32 v33, v114, v115
    v_pk_mul_f32 v[116:117], v[116:117], v[124:125] op_sel_hi:[1,0]
    s_nop 0
    v_pk_mul_f32 v[118:119], v[118:119], v[124:125] op_sel_hi:[1,0]
    v_cvt_pk_bf16_f32 v34, v116, v117
    v_cvt_pk_bf16_f32 v35, v118, v119
    ds_write_b128 v0, v[32:35] offset:10240
    s_nop 0
    v_smfmac_f32_16x16x64_bf16 v[48:51], v[32:35], a[160:167], v7
    v_smfmac_f32_16x16x64_bf16 v[52:55], v[32:35], a[176:183], v7
    s_add_u32 s65, s68, 65536
    s_add_u32 s66, s69, 65536
    v_smfmac_f32_16x16x64_bf16 v[104:107], v[32:35], v[64:71], v7
    v_smfmac_f32_16x16x64_bf16 v[108:111], v[32:35], v[80:87], v7
    s_waitcnt lgkmcnt(0)
    s_barrier
    ds_read_b128 v[36:39], v0 offset:14336
    v_mov_b64 v[124:125], 0
    ds_read_b128 v[96:99], v0 offset:2048
    v_mov_b64 v[126:127], 0
    ds_read_b128 v[100:103], v0 offset:6144
    v_mov_b64 v[32:33], 0
    s_nop 2
    v_mov_b64 v[34:35], 0
    s_nop 2
    v_mov_b64 v[44:45], 0
    s_waitcnt lgkmcnt(2)
    v_smfmac_f32_16x16x64_bf16 v[48:51], v[36:39], a[168:175], v7
    s_waitcnt lgkmcnt(0)
    v_smfmac_f32_16x16x64_bf16 v[48:51], v[96:99], a[192:199], v7
    v_smfmac_f32_16x16x64_bf16 v[48:51], v[100:103], a[200:207], v7
    v_smfmac_f32_16x16x64_bf16 v[52:55], v[36:39], a[184:191], v7
    v_smfmac_f32_16x16x64_bf16 v[52:55], v[96:99], a[208:215], v7
    v_cvt_pk_bf16_f32 v56, v48, v50
    v_cvt_pk_bf16_f32 v57, v49, v51
    v_smfmac_f32_16x16x64_bf16 v[52:55], v[100:103], a[216:223], v7
    buffer_store_dwordx2 v[56:57], v5, s[8:11], s68 offen sc1
    v_smfmac_f32_16x16x64_bf16 v[104:107], v[36:39], v[72:79], v7
    v_smfmac_f32_16x16x64_bf16 v[104:107], v[96:99], a[224:231], v7
    v_cvt_pk_bf16_f32 v58, v52, v54
    v_cvt_pk_bf16_f32 v59, v53, v55
    v_smfmac_f32_16x16x64_bf16 v[104:107], v[100:103], a[232:239], v7
    buffer_store_dwordx2 v[58:59], v5, s[8:11], s65 offen sc1
    v_smfmac_f32_16x16x64_bf16 v[108:111], v[36:39], v[88:95], v7
    v_smfmac_f32_16x16x64_bf16 v[108:111], v[96:99], a[240:247], v7
    v_cvt_pk_bf16_f32 v60, v104, v106
    v_cvt_pk_bf16_f32 v61, v105, v107
    v_smfmac_f32_16x16x64_bf16 v[108:111], v[100:103], a[248:255], v7
    buffer_store_dwordx2 v[60:61], v5, s[8:11], s69 offen sc1
    ds_read_b128 v[64:67], v1 offset:0
    ds_read_b128 v[68:71], v1 offset:1024
    ds_read_b128 v[72:75], v1 offset:2048
    ds_read_b128 v[76:79], v1 offset:3072
    s_nop 2
    v_cvt_pk_bf16_f32 v62, v108, v110
    v_cvt_pk_bf16_f32 v63, v109, v111
    buffer_store_dwordx2 v[62:63], v5, s[8:11], s66 offen sc1
    ds_read_b128 v[80:83], v1 offset:4096
    ds_read_b128 v[84:87], v1 offset:5120
    ds_read_b128 v[88:91], v1 offset:6144
    ds_read_b128 v[92:95], v1 offset:7168
    ds_read_b128 v[56:59], v1 offset:8192
    ds_read_b128 v[60:63], v1 offset:9216
    ds_read_b128 v[104:107], v1 offset:10240
    ds_read_b128 v[108:111], v1 offset:11264
    v_mov_b64 v[36:37], 0
    v_mov_b64 v[38:39], 0
    v_mov_b64 v[46:47], 0
    v_mov_b64 v[48:49], 0
    v_mov_b64 v[50:51], 0
    v_mov_b64 v[52:53], 0
    v_mov_b64 v[54:55], 0
    v_mov_b64 v[112:113], v[26:27]
    v_mov_b64 v[114:115], v[26:27]
    s_nop 15
    s_nop 15
    s_nop 1
    buffer_load_dwordx4 v[116:119], v0, s[8:11], s93 offen offset:0 sc1
    buffer_load_dwordx4 v[120:123], v0, s[8:11], s93 offen offset:1024 sc1
    s_mov_b32 s72, s71
    s_add_u32 s71, s71, 8192
    s_cmp_eq_u32 s71, 0xe6000
    s_cselect_b32 s71, 0xe0000, s71
    s_add_u32 s73, s71, 0xfffdfc00
    s_add_u32 s4, s73, 5120
    s_mov_b32 m0, s95
    s_waitcnt vmcnt(10)
    ds_write_b128 v0, v[16:19] offset:8192
    ds_write_b128 v0, v[20:23] offset:9216
    s_nop 15
    s_nop 3
    buffer_load_dwordx4 v[116:119], v0, s[8:11], s93 offen offset:0 sc1
    buffer_load_dwordx4 v[120:123], v0, s[8:11], s93 offen offset:1024 sc1
    s_waitcnt vmcnt(2)
CS2_p1:
    v_smfmac_f32_16x16x64_bf16 v[124:127], v[112:115], v[116:123], v11
    s_nop 7
    v_add_f32_dpp v100, v124, v124 row_ror:8 row_mask:0xf bank_mask:0xf
    v_add_f32_dpp v101, v125, v125 row_ror:8 row_mask:0xf bank_mask:0xf
    s_nop 0
    v_add_f32_dpp v102, v100, v100 row_ror:4 row_mask:0xf bank_mask:0xf
    v_add_f32_dpp v103, v101, v101 row_ror:4 row_mask:0xf bank_mask:0xf
    v_cvt_pk_bf16_f32 v24, v102, v103
    buffer_store_dword v24, v6, s[8:11], s71 offen sc1
    v_cmp_le_u32 vcc, s78, v24
    s_cbranch_vccnz CS2_p1retry
CS2_p1ok:
    s_cmp_eq_u32 s64, 62
    s_cbranch_scc1 C_last
    s_nop 15
    s_nop 2
    buffer_load_dwordx4 v[96:99], v0, s[8:11], s73 offen offset:3072 sc1
CS2_entry:
    buffer_store_dword v12, v6, s[8:11], s72 offen sc1
    s_nop 15
    s_nop 5
    buffer_load_dwordx4 v[96:99], v0, s[8:11], s73 offen offset:3072 sc1
    v_readfirstlane_b32 s66, v8
    v_xor_b32 v25, 8192, v25
    s_add_u32 s76, s74, 0x82000
    s_add_u32 s74, s74, 0x80000
    s_xor_b32 s94, s94, 8192
    s_cmp_gt_u32 s66, s96
    s_cbranch_scc0 CS2_kvslow
CS2_kvok:
    s_add_u32 s64, s64, 1
    s_add_u32 s75, s75, 8192
    s_mov_b32 s70, s93
    s_add_u32 s68, s68, 262144
    s_cmp_eq_u32 s68, 0xe0000
    s_cselect_b32 s68, 0x20000, s68
    s_add_u32 s93, s68, s5
    s_add_u32 s69, s68, 131072
    s_add_u32 s65, s64, 2
    s_lshr_b32 s96, s65, 2
    s_and_b32 s65, s65, 3
    s_lshl_b32 s65, s65, 7
    s_add_u32 s92, s97, s65
    s_branch CS2_step
CS2_p2retry:
    s_add_u32 s63, s63, 1
    s_cmp_gt_u32 s63, 400000
    s_cbranch_scc1 C_last
    buffer_load_dwordx4 v[96:99], v0, s[8:11], s73 offen offset:3072 sc1
    v_mov_b64 v[32:33], 0
    v_mov_b64 v[34:35], 0
    s_nop 0
    v_mov_b64 v[36:37], 0
    v_mov_b64 v[38:39], 0
    s_waitcnt vmcnt(1)
    s_branch CS2_step2
CS2_ownretry:
    buffer_load_dwordx4 v[112:115], v0, s[8:11], s4 offen offset:2048 sc1
    s_waitcnt vmcnt(0)
    v_max3_u32 v9, v112, v113, v114
    v_max_u32 v9, v9, v115
    ds_write_b128 v0, v[112:115] offset:10240
    v_cmp_le_u32 vcc, s78, v9
    s_add_u32 s63, s63, 1
    s_cmp_gt_u32 s63, 400000
    s_waitcnt lgkmcnt(0)
    s_cbranch_scc1 CS2_ownok
    s_cbranch_vccz CS2_ownok
    s_branch CS2_ownretry
CS2_p1retry:
    v_max3_u32 v9, v116, v117, v118
    v_max3_u32 v100, v119, v120, v121
    v_max3_u32 v9, v9, v122, v123
    v_max_u32 v9, v9, v100
    v_cmp_eq_u32 vcc, -1, v9
    v_mov_b64 v[124:125], 0
    v_mov_b64 v[126:127], 0
    v_mov_b64 v[112:113], v[26:27]
    v_mov_b64 v[114:115], v[26:27]
    s_cbranch_vccz CS2_p1nan
    buffer_load_dwordx4 v[116:119], v0, s[8:11], s93 offen offset:0 sc1
    buffer_load_dwordx4 v[120:123], v0, s[8:11], s93 offen offset:1024 sc1
    s_add_u32 s63, s63, 1
    s_waitcnt vmcnt(3)
    s_cmp_gt_u32 s63, 400000
    s_cbranch_scc0 CS2_p1
CS2_p1nan:
    s_nop 0
    v_smfmac_f32_16x16x64_bf16 v[124:127], v[112:115], v[116:123], v11
    s_nop 7
    v_add_f32_dpp v100, v124, v124 row_ror:8 row_mask:0xf bank_mask:0xf
    v_add_f32_dpp v101, v125, v125 row_ror:8 row_mask:0xf bank_mask:0xf
    s_nop 0
    v_add_f32_dpp v102, v100, v100 row_ror:4 row_mask:0xf bank_mask:0xf
    v_add_f32_dpp v103, v101, v101 row_ror:4 row_mask:0xf bank_mask:0xf
    v_cvt_pk_bf16_f32 v24, v102, v103
    v_min_u32 v24, 0xffbfffff, v24
    buffer_store_dword v24, v6, s[8:11], s71 offen sc1
    s_branch CS2_p1ok
CS2_kvslow:
    buffer_load_dword v8, off, s[8:11], s92 sc1
    s_waitcnt vmcnt(0)
    v_readfirstlane_b32 s66, v8
    s_nop 0
    s_cmp_gt_u32 s66, s96
    s_cbranch_scc1 CS2_kvok
    s_add_u32 s63, s63, 1
    s_cmp_gt_u32 s63, 400000
    s_cbranch_scc1 CS2_kvok
    s_sleep 1
    s_branch CS2_kvslow
.p2align 6
    s_nop 0
    s_nop 0
    s_nop 0
    s_nop 0
    s_nop 0
    s_nop 0
    s_nop 0
    s_nop 0
CS3_step:
    s_waitcnt vmcnt(2) lgkmcnt(0)
CS3_step2:
    v_max3_u32 v9, v96, v97, v98
    v_max_u32 v9, v9, v99
    ds_write_b128 v0, v[96:99] offset:15360
    v_smfmac_f32_16x16x64_bf16 v[32:35], v[96:99], v[64:71], v7
    v_cmp_le_u32 vcc, s78, v9
    v_smfmac_f32_16x16x64_bf16 v[36:39], v[96:99], v[72:79], v7
    s_cbranch_vccnz CS3_p2retry
    v_smfmac_f32_16x16x64_bf16 v[48:51], v[96:99], v[80:87], v7
    v_smfmac_f32_16x16x64_bf16 v[52:55], v[96:99], v[88:95], v7
    s_waitcnt lgkmcnt(0)
    s_barrier
    ds_read_b128 v[100:103], v0 offset:11264
    buffer_load_dwordx4 v[112:115], v0, s[8:11], s4 offen offset:2048 sc1
    v_smfmac_f32_16x16x64_bf16 v[40:43], v[96:99], v[56:63], v7
    buffer_load_dwordx4 v0, s[8:11], s4 offen offset:2048 sc1 lds
    ds_read_b128 v[64:67], v1 offset:12288
    v_smfmac_f32_16x16x64_bf16 v[44:47], v[96:99], v[104:111], v7
    ds_read_b128 v[68:71], v1 offset:13312
    s_waitcnt lgkmcnt(2)
    v_smfmac_f32_16x16x64_bf16 v[32:35], v[100:103], v[128:135], v7
    ds_read_b128 v[104:107], v0 offset:7168
    ds_read_b128 v[72:75], v1 offset:14336
    v_smfmac_f32_16x16x64_bf16 v[36:39], v[100:103], v[136:143], v7
    s_mov_b32 m0, s94
    ds_read_b128 v[76:79], v1 offset:15360
    v_smfmac_f32_16x16x64_bf16 v[48:51], v[100:103], v[224:231], v7
    buffer_load_dwordx4 v0, s[8:11], s74 offen offset:0 sc1 lds
    ds_read_b128 v[80:83], v1 offset:16384
    v_smfmac_f32_16x16x64_bf16 v[52:55], v[100:103], v[232:239], v7
    buffer_load_dwordx4 v0, s[8:11], s74 offen offset:1024 sc1 lds
    ds_read_b128 v[84:87], v1 offset:17408
    v_smfmac_f32_16x16x64_bf16 v[40:43], v[100:103], a[64:71], v7
    ds_read_b128 v[108:111], v0 offset:3072
    v_smfmac_f32_16x16x64_bf16 v[44:47], v[100:103], a[72:79], v7
    buffer_load_dwordx4 v[16:19], v0, s[8:11], s76 offen offset:0 sc1
    s_waitcnt lgkmcnt(5)
    v_smfmac_f32_16x16x64_bf16 v[48:51], v[104:107], v[240:247], v7
    ds_read_b128 v[88:91], v1 offset:18432
    v_smfmac_f32_16x16x64_bf16 v[52:55], v[104:107], v[248:255], v7
    buffer_load_dwordx4 v[20:23], v0, s[8:11], s76 offen offset:1024 sc1
    s_waitcnt lgkmcnt(4)
    v_smfmac_f32_16x16x64_bf16 v[32:35], v[104:107], v[64:71], v7
    ds_read_b128 v[92:95], v1 offset:19456
    v_smfmac_f32_16x16x64_bf16 v[36:39], v[104:107], v[72:79], v7
    buffer_store_dword v24, v6, s[8:11], s75 offen sc1
    s_waitcnt lgkmcnt(2)
    v_smfmac_f32_16x16x64_bf16 v[32:35], v[108:111], v[144:151], v7
    buffer_load_dword v8, off, s[8:11], s92 sc1
    ds_read_b128 v[64:67], v1 offset:20480
    v_smfmac_f32_16x16x64_bf16 v[36:39], v[108:111], v[152:159], v7
    ds_read_b128 v[68:71], v1 offset:21504
    v_smfmac_f32_16x16x64_bf16 v[48:51], v[108:111], a[0:7], v7
    s_waitcnt vmcnt(6)
    v_max3_u32 v9, v112, v113, v114
    v_max_u32 v9, v9, v115
    v_smfmac_f32_16x16x64_bf16 v[52:55], v[108:111], a[8:15], v7
    ds_read_b128 v[72:75], v1 offset:22528
    s_waitcnt lgkmcnt(3)
    v_cmp_le_u32 vcc, s78, v9
    v_smfmac_f32_16x16x64_bf16 v[40:43], v[104:107], v[80:87], v7
    ds_read_b128 v[76:79], v1 offset:23552
    v_smfmac_f32_16x16x64_bf16 v[44:47], v[104:107], v[88:95], v7
    s_cbranch_vccnz CS3_ownretry
CS3_ownok:
    s_barrier
    v_smfmac_f32_16x16x64_bf16 v[32:35], v[112:115], v[160:167], v7
    ds_read_b128 v[116:119], v0 offset:10240
    ds_read_b128 v[120:123], v0 offset:6144
    v_smfmac_f32_16x16x64_bf16 v[36:39], v[112:115], v[168:175], v7
    ds_read_b128 v[124:127], v0 offset:2048
    s_waitcnt lgkmcnt(3)
    v_smfmac_f32_16x16x64_bf16 v[48:51], v[112:115], v[64:71], v7
    ds_read_b128 v[80:83], v25 offset:16384
    v_smfmac_f32_16x16x64_bf16 v[52:55], v[112:115], v[72:79], v7
    ds_read_b128 v[84:87], v25 offset:22528
    s_waitcnt lgkmcnt(4)
    v_smfmac_f32_16x16x64_bf16 v[32:35], v[116:119], v[176:183], v7
    ds_read_b128 v[88:91], v25 offset:21504
    s_waitcnt lgkmcnt(3)
    v_smfmac_f32_16x16x64_bf16 v[32:35], v[120:123], v[192:199], v7
    buffer_store_dwordx4 v[12:15], v0, s[8:11], s70 offen offset:0 sc1
    v_smfmac_f32_16x16x64_bf16 v[32:35], v[124:127], v[208:215], v7
    ds_read_b128 v[92:95], v25 offset:20480
    v_smfmac_f32_16x16x64_bf16 v[36:39], v[116:119], v[184:191], v7
    ds_read_b128 v[64:67], v25 offset:19456
    v_smfmac_f32_16x16x64_bf16 v[36:39], v[120:123], v[200:207], v7
    ds_read_b128 v[68:71], v25 offset:23552
    v_add_f32 v32, v32, v34
    v_smfmac_f32_16x16x64_bf16 v[36:39], v[124:127], v[216:223], v7
    ds_read_b128 v[72:75], v25 offset:18432
    v_add_f32 v33, v33, v35
    v_smfmac_f32_16x16x64_bf16 v[48:51], v[116:119], a[16:23], v7
    ds_read_b128 v[76:79], v25 offset:17408
    v_smfmac_f32_16x16x64_bf16 v[48:51], v[120:123], a[32:39], v7
    v_add_f32 v36, v36, v38
    v_add_f32 v37, v37, v39
    v_smfmac_f32_16x16x64_bf16 v[48:51], v[124:127], a[48:55], v7
    v_cvt_pk_bf16_f32 v34, v32, v36
    v_cvt_pk_bf16_f32 v35, v33, v37
    v_smfmac_f32_16x16x64_bf16 v[52:55], v[116:119], a[24:31], v7
    buffer_store_dwordx4 v[12:15], v0, s[8:11], s70 offen offset:1024 sc1
    ds_write2_b32 v2, v34, v35 offset0:0 offset1:4
    v_mov_b64 v[36:37], 0
    v_smfmac_f32_16x16x64_bf16 v[52:55], v[120:123], a[40:47], v7
    v_add_f32 v48, v48, v50
    v_smfmac_f32_16x16x64_bf16 v[52:55], v[124:127], a[56:63], v7
    v_add_f32 v49, v49, v51
    v_smfmac_f32_16x16x64_bf16 v[40:43], v[108:111], a[80:87], v7
    v_mov_b64 v[38:39], 0
    v_smfmac_f32_16x16x64_bf16 v[44:47], v[108:111], a[88:95], v7
    v_add_f32 v52, v52, v54
    v_add_f32 v53, v53, v55
    v_cvt_pk_bf16_f32 v32, v48, v52
    v_cvt_pk_bf16_f32 v33, v49, v53
    v_smfmac_f32_16x16x64_bf16 v[40:43], v[112:115], a[96:103], v7
    ds_write2_b32 v3, v32, v33 offset0:0 offset1:4
    v_mov_b64 v[48:49], 0
    v_smfmac_f32_16x16x64_bf16 v[44:47], v[112:115], a[104:111], v7
    v_mov_b64 v[50:51], 0
    v_smfmac_f32_16x16x64_bf16 v[40:43], v[116:119], a[112:119], v7
    ds_read_b128 v[108:111], v4 offset:7200
    v_mov_b64 v[52:53], 0
    v_smfmac_f32_16x16x64_bf16 v[44:47], v[116:119], a[120:127], v7
    v_mov_b64 v[54:55], 0
    v_smfmac_f32_16x16x64_bf16 v[40:43], v[120:123], a[128:135], v7
    s_waitcnt lgkmcnt(1)
    s_barrier
    ds_read_b128 v[104:107], v4 offset:7168
    v_smfmac_f32_16x16x64_bf16 v[44:47], v[120:123], a[136:143], v7
    ds_read_b128 v[100:103], v4 offset:3104
    v_smfmac_f32_16x16x64_bf16 v[40:43], v[124:127], a[144:151], v7
    ds_read_b128 v[96:99], v4 offset:3072
    v_smfmac_f32_16x16x64_bf16 v[44:47], v[124:127], a[152:159], v7
    ds_read_b128 v[112:115], v0 offset:11264
    s_waitcnt lgkmcnt(4)
    v_mfma_f32_16x16x32_bf16 v[56:59], v[64:67], v[108:111], 0
    ds_read_b128 v[116:119], v0 offset:15360
    v_mfma_f32_16x16x32_bf16 v[60:63], v[68:71], v[108:111], 0
    s_waitcnt lgkmcnt(4)
    v_mfma_f32_16x16x32_bf16 v[56:59], v[72:75], v[104:107], v[56:59]
    s_waitcnt lgkmcnt(3)
    v_mfma_f32_16x16x32_bf16 v[56:59], v[76:79], v[100:103], v[56:59]
    ds_read_b128 v[64:67], v1 offset:24576
    s_waitcnt lgkmcnt(3)
    v_mfma_f32_16x16x32_bf16 v[56:59], v[80:83], v[96:99], v[56:59]
    ds_read_b128 v[68:71], v1 offset:25600
    v_add_f32 v40, v40, v42
    v_add_f32 v41, v41, v43
    v_mfma_f32_16x16x32_bf16 v[60:63], v[84:87], v[104:107], v[60:63]
    s_waitcnt lgkmcnt(2)
    v_add_f32 v44, v44, v46
    v_add_f32 v45, v45, v47
    v_smfmac_f32_16x16x64_bf16 v[36:39], v[112:115], v[96:103], v7
    ds_read_b128 v[80:83], v1 offset:28672
    v_max3_f32 v9, v56, v57, v58
    v_smfmac_f32_16x16x64_bf16 v[36:39], v[116:119], v[104:111], v7
    v_max_f32 v9, v9, v59
    v_mfma_f32_16x16x32_bf16 v[60:63], v[88:91], v[100:103], v[60:63]
    ds_read_b128 v[100:103], v0 offset:13312
    v_cvt_pk_bf16_f32 v42, v40, v41
    v_cvt_pk_bf16_f32 v43, v44, v45
    v_mfma_f32_16x16x32_bf16 v[60:63], v[92:95], v[96:99], v[60:63]
    ds_read_b128 v[96:99], v0 offset:12288
    ds_read_b128 v[84:87], v1 offset:29696
    v_add_f32 v36, v36, v38
    v_add_f32 v37, v37, v39
    v_max3_f32 v9, v9, v36, v37
    v_mov_b64 v[44:45], s[48:49]
    v_mov_b64 v[46:47], s[48:49]
    v_mov_b64 v[104:105], 0
    v_max3_f32 v10, v60, v61, v62
    v_max3_f32 v32, v9, v10, v63
    v_max3_f32 v33, v9, v10, v63
    v_mov_b64 v[106:107], 0
    v_mov_b64 v[108:109], 0
    v_permlane32_swap_b32 v32, v33
    v_max_f32 v34, v32, v33
    v_max_f32 v35, v32, v33
    v_mov_b64 v[110:111], 0
    v_mov_b64 v[40:41], 0
    v_permlane16_swap_b32 v34, v35
    v_max_f32 v32, v34, v35
    v_mul_f32 v32, s98, v32
    v_pk_fma_f32 v[36:37], v[36:37], s[98:99], v[32:33] op_sel_hi:[1,1,0] neg_lo:[0,0,1] neg_hi:[0,0,1]
    v_pk_fma_f32 v[56:57], v[56:57], s[98:99], v[32:33] op_sel_hi:[1,1,0] neg_lo:[0,0,1] neg_hi:[0,0,1]
    v_exp_f32 v36, v36
    v_exp_f32 v37, v37
    v_pk_fma_f32 v[58:59], v[58:59], s[98:99], v[32:33] op_sel_hi:[1,1,0] neg_lo:[0,0,1] neg_hi:[0,0,1]
    v_pk_fma_f32 v[60:61], v[60:61], s[98:99], v[32:33] op_sel_hi:[1,1,0] neg_lo:[0,0,1] neg_hi:[0,0,1]
    v_pk_fma_f32 v[62:63], v[62:63], s[98:99], v[32:33] op_sel_hi:[1,1,0] neg_lo:[0,0,1] neg_hi:[0,0,1]
    v_cvt_pk_bf16_f32 v28, v36, v37
    v_cvt_pk_bf16_f32 v31, v36, v37
    v_exp_f32 v56, v56
    v_exp_f32 v57, v57
    v_mfma_f32_16x16x16_bf16 v[124:127], v[44:45], v[28:29], 0
    v_exp_f32 v58, v58
    v_exp_f32 v59, v59
    v_mfma_f32_16x16x16_bf16 v[112:115], v[42:43], v[28:29], 0
    v_exp_f32 v60, v60
    v_exp_f32 v61, v61
    v_mfma_f32_16x16x16_bf16 v[116:119], v[42:43], v[30:31], 0
    v_exp_f32 v62, v62
    v_exp_f32 v63, v63
    v_cvt_pk_bf16_f32 v120, v56, v57
    v_cvt_pk_bf16_f32 v121, v58, v59
    v_cvt_pk_bf16_f32 v122, v60, v61
    v_cvt_pk_bf16_f32 v123, v62, v63
    s_waitcnt lgkmcnt(0)
    s_nop 0
    v_mfma_f32_16x16x32_bf16 v[124:127], v[44:47], v[120:123], v[124:127]
    ds_read_b128 v[72:75], v1 offset:26624
    ds_read_b128 v[76:79], v1 offset:27648
    v_mfma_f32_16x16x32_bf16 v[112:115], v[96:99], v[120:123], v[112:115]
    ds_read_b128 v[88:91], v1 offset:30720
    ds_read_b128 v[92:95], v1 offset:31744
    v_mfma_f32_16x16x32_bf16 v[116:119], v[100:103], v[120:123], v[116:119]
    v_rcp_f32 v124, v124
    v_mov_b64 v[42:43], 0
    s_nop 1
    v_pk_mul_f32 v[112:113], v[112:113], v[124:125] op_sel_hi:[1,0]
    v_pk_mul_f32 v[114:115], v[114:115], v[124:125] op_sel_hi:[1,0]
    v_cvt_pk_bf16_f32 v32, v112, v113
    v_cvt_pk_bf16_f32 v33, v114, v115
    v_pk_mul_f32 v[116:117], v[116:117], v[124:125] op_sel_hi:[1,0]
    s_nop 0
    v_pk_mul_f32 v[118:119], v[118:119], v[124:125] op_sel_hi:[1,0]
    v_cvt_pk_bf16_f32 v34, v116, v117
    v_cvt_pk_bf16_f32 v35, v118, v119
    ds_write_b128 v0, v[32:35] offset:14336
    s_nop 0
    v_smfmac_f32_16x16x64_bf16 v[48:51], v[32:35], a[160:167], v7
    v_smfmac_f32_16x16x64_bf16 v[52:55], v[32:35], a[176:183], v7
    s_add_u32 s65, s68, 65536
    s_add_u32 s66, s69, 65536
    v_smfmac_f32_16x16x64_bf16 v[104:107], v[32:35], v[64:71], v7
    v_smfmac_f32_16x16x64_bf16 v[108:111], v[32:35], v[80:87], v7
    s_waitcnt lgkmcnt(0)
    s_barrier
    ds_read_b128 v[36:39], v0 offset:10240
    v_mov_b64 v[124:125], 0
    ds_read_b128 v[96:99], v0 offset:6144
    v_mov_b64 v[126:127], 0
    ds_read_b128 v[100:103], v0 offset:2048
    v_mov_b64 v[32:33], 0
    s_nop 2
    v_mov_b64 v[34:35], 0
    s_nop 2
    v_mov_b64 v[44:45], 0
    s_waitcnt lgkmcnt(2)
    v_smfmac_f32_16x16x64_bf16 v[48:51], v[36:39], a[168:175], v7
    s_waitcnt lgkmcnt(0)
    v_smfmac_f32_16x16x64_bf16 v[48:51], v[96:99], a[192:199], v7
    v_smfmac_f32_16x16x64_bf16 v[48:51], v[100:103], a[200:207], v7
    v_smfmac_f32_16x16x64_bf16 v[52:55], v[36:39], a[184:191], v7
    v_smfmac_f32_16x16x64_bf16 v[52:55], v[96:99], a[208:215], v7
    v_cvt_pk_bf16_f32 v56, v48, v50
    v_cvt_pk_bf16_f32 v57, v49, v51
    v_smfmac_f32_16x16x64_bf16 v[52:55], v[100:103], a[216:223], v7
    buffer_store_dwordx2 v[56:57], v5, s[8:11], s68 offen sc1
    v_smfmac_f32_16x16x64_bf16 v[104:107], v[36:39], v[72:79], v7
    v_smfmac_f32_16x16x64_bf16 v[104:107], v[96:99], a[224:231], v7
    v_cvt_pk_bf16_f32 v58, v52, v54
    v_cvt_pk_bf16_f32 v59, v53, v55
    v_smfmac_f32_16x16x64_bf16 v[104:107], v[100:103], a[232:239], v7
    buffer_store_dwordx2 v[58:59], v5, s[8:11], s65 offen sc1
    v_smfmac_f32_16x16x64_bf16 v[108:111], v[36:39], v[88:95], v7
    v_smfmac_f32_16x16x64_bf16 v[108:111], v[96:99], a[240:247], v7
    v_cvt_pk_bf16_f32 v60, v104, v106
    v_cvt_pk_bf16_f32 v61, v105, v107
    v_smfmac_f32_16x16x64_bf16 v[108:111], v[100:103], a[248:255], v7
    buffer_store_dwordx2 v[60:61], v5, s[8:11], s69 offen sc1
    ds_read_b128 v[64:67], v1 offset:0
    ds_read_b128 v[68:71], v1 offset:1024
    ds_read_b128 v[72:75], v1 offset:2048
    ds_read_b128 v[76:79], v1 offset:3072
    s_nop 2
    v_cvt_pk_bf16_f32 v62, v108, v110
    v_cvt_pk_bf16_f32 v63, v109, v111
    buffer_store_dwordx2 v[62:63], v5, s[8:11], s66 offen sc1
    ds_read_b128 v[80:83], v1 offset:4096
    ds_read_b128 v[84:87], v1 offset:5120
    ds_read_b128 v[88:91], v1 offset:6144
    ds_read_b128 v[92:95], v1 offset:7168
    ds_read_b128 v[56:59], v1 offset:8192
    ds_read_b128 v[60:63], v1 offset:9216
    ds_read_b128 v[104:107], v1 offset:10240
    ds_read_b128 v[108:111], v1 offset:11264
    v_mov_b64 v[36:37], 0
    v_mov_b64 v[38:39], 0
    v_mov_b64 v[46:47], 0
    v_mov_b64 v[48:49], 0
    v_mov_b64 v[50:51], 0
    v_mov_b64 v[52:53], 0
    v_mov_b64 v[54:55], 0
    v_mov_b64 v[112:113], v[26:27]
    v_mov_b64 v[114:115], v[26:27]
    s_nop 15
    s_nop 15
    s_nop 11
    buffer_load_dwordx4 v[116:119], v0, s[8:11], s93 offen offset:0 sc1
    buffer_load_dwordx4 v[120:123], v0, s[8:11], s93 offen offset:1024 sc1
    s_mov_b32 s72, s71
    s_add_u32 s71, s71, 8192
    s_cmp_eq_u32 s71, 0xe6000
    s_cselect_b32 s71, 0xe0000, s71
    s_add_u32 s73, s71, 0xfffe0000
    s_add_u32 s4, s73, 5120
    s_mov_b32 m0, s95
    s_waitcnt vmcnt(10)
    ds_write_b128 v0, v[16:19] offset:12288
    ds_write_b128 v0, v[20:23] offset:13312
    s_nop 15
    s_nop 3
    buffer_load_dwordx4 v[116:119], v0, s[8:11], s93 offen offset:0 sc1
    buffer_load_dwordx4 v[120:123], v0, s[8:11], s93 offen offset:1024 sc1
    s_waitcnt vmcnt(2)
CS3_p1:
    v_smfmac_f32_16x16x64_bf16 v[124:127], v[112:115], v[116:123], v11
    s_nop 7
    v_add_f32_dpp v100, v124, v124 row_ror:8 row_mask:0xf bank_mask:0xf
    v_add_f32_dpp v101, v125, v125 row_ror:8 row_mask:0xf bank_mask:0xf
    s_nop 0
    v_add_f32_dpp v102, v100, v100 row_ror:4 row_mask:0xf bank_mask:0xf
    v_add_f32_dpp v103, v101, v101 row_ror:4 row_mask:0xf bank_mask:0xf
    v_cvt_pk_bf16_f32 v24, v102, v103
    buffer_store_dword v24, v6, s[8:11], s71 offen sc1
    v_cmp_le_u32 vcc, s78, v24
    s_cbranch_vccnz CS3_p1retry
CS3_p1ok:
    s_cmp_eq_u32 s64, 62
    s_cbranch_scc1 C_last
    s_nop 8
    buffer_load_dwordx4 v[96:99], v0, s[8:11], s73 offen offset:3072 sc1
CS3_entry:
    buffer_store_dword v12, v6, s[8:11], s72 offen sc1
    s_nop 15
    s_nop 5
    buffer_load_dwordx4 v[96:99], v0, s[8:11], s73 offen offset:3072 sc1
    v_readfirstlane_b32 s66, v8
    v_xor_b32 v25, 8192, v25
    s_add_u32 s76, s74, 0x82000
    s_add_u32 s74, s74, 0x80000
    s_xor_b32 s94, s94, 8192
    s_cmp_gt_u32 s66, s96
    s_cbranch_scc0 CS3_kvslow
CS3_kvok:
    s_add_u32 s64, s64, 1
    s_add_u32 s75, s75, 8192
    s_mov_b32 s70, s93
    s_add_u32 s68, s68, 262144
    s_cmp_eq_u32 s68, 0xe0000
    s_cselect_b32 s68, 0x20000, s68
    s_add_u32 s93, s68, s5
    s_add_u32 s69, s68, 131072
    s_add_u32 s65, s64, 2
    s_lshr_b32 s96, s65, 2
    s_and_b32 s65, s65, 3
    s_lshl_b32 s65, s65, 7
    s_add_u32 s92, s97, s65
    s_branch CS3_step
CS3_p2retry:
    s_add_u32 s63, s63, 1
    s_cmp_gt_u32 s63, 400000
    s_cbranch_scc1 C_last
    buffer_load_dwordx4 v[96:99], v0, s[8:11], s73 offen offset:3072 sc1
    v_mov_b64 v[32:33], 0
    v_mov_b64 v[34:35], 0
    s_nop 0
    v_mov_b64 v[36:37], 0
    v_mov_b64 v[38:39], 0
    s_waitcnt vmcnt(1)
    s_branch CS3_step2
CS3_ownretry:
    buffer_load_dwordx4 v[112:115], v0, s[8:11], s4 offen offset:2048 sc1
    s_waitcnt vmcnt(0)
    v_max3_u32 v9, v112, v113, v114
    v_max_u32 v9, v9, v115
    ds_write_b128 v0, v[112:115] offset:14336
    v_cmp_le_u32 vcc, s78, v9
    s_add_u32 s63, s63, 1
    s_cmp_gt_u32 s63, 400000
    s_waitcnt lgkmcnt(0)
    s_cbranch_scc1 CS3_ownok
    s_cbranch_vccz CS3_ownok
    s_branch CS3_ownretry
CS3_p1retry:
    v_max3_u32 v9, v116, v117, v118
    v_max3_u32 v100, v119, v120, v121
    v_max3_u32 v9, v9, v122, v123
    v_max_u32 v9, v9, v100
    v_cmp_eq_u32 vcc, -1, v9
    v_mov_b64 v[124:125], 0
    v_mov_b64 v[126:127], 0
    v_mov_b64 v[112:113], v[26:27]
    v_mov_b64 v[114:115], v[26:27]
    s_cbranch_vccz CS3_p1nan
    buffer_load_dwordx4 v[116:119], v0, s[8:11], s93 offen offset:0 sc1
    buffer_load_dwordx4 v[120:123], v0, s[8:11], s93 offen offset:1024 sc1
    s_add_u32 s63, s63, 1
    s_waitcnt vmcnt(3)
    s_cmp_gt_u32 s63, 400000
    s_cbranch_scc0 CS3_p1
CS3_p1nan:
    s_nop 0
    v_smfmac_f32_16x16x64_bf16 v[124:127], v[112:115], v[116:123], v11
    s_nop 7
    v_add_f32_dpp v100, v124, v124 row_ror:8 row_mask:0xf bank_mask:0xf
    v_add_f32_dpp v101, v125, v125 row_ror:8 row_mask:0xf bank_mask:0xf
    s_nop 0
    v_add_f32_dpp v102, v100, v100 row_ror:4 row_mask:0xf bank_mask:0xf
    v_add_f32_dpp v103, v101, v101 row_ror:4 row_mask:0xf bank_mask:0xf
    v_cvt_pk_bf16_f32 v24, v102, v103
    v_min_u32 v24, 0xffbfffff, v24
    buffer_store_dword v24, v6, s[8:11], s71 offen sc1
    s_branch CS3_p1ok
CS3_kvslow:
    buffer_load_dword v8, off, s[8:11], s92 sc1
    s_waitcnt vmcnt(0)
    v_readfirstlane_b32 s66, v8
    s_nop 0
    s_cmp_gt_u32 s66, s96
    s_cbranch_scc1 CS3_kvok
    s_add_u32 s63, s63, 1
    s_cmp_gt_u32 s63, 400000
    s_cbranch_scc1 CS3_kvok
    s_sleep 1
    s_branch CS3_kvslow
C_last1:
    v_max3_u32 v9, v116, v117, v118
    v_max3_u32 v100, v119, v120, v121
    v_max3_u32 v9, v9, v122, v123
    v_max_u32 v9, v9, v100
    v_cmp_eq_u32 vcc, -1, v9
    v_mov_b64 v[124:125], 0
    v_mov_b64 v[126:127], 0
    v_mov_b64 v[112:113], v[26:27]
    v_mov_b64 v[114:115], v[26:27]
    s_cbranch_vccz C_last2
    buffer_load_dwordx4 v[116:119], v0, s[8:11], s70 offen offset:0 sc1
    buffer_load_dwordx4 v[120:123], v0, s[8:11], s70 offen offset:1024 sc1
    s_add_u32 s63, s63, 1
    s_waitcnt vmcnt(0)
    s_cmp_gt_u32 s63, 400000
    s_cbranch_scc0 C_last1
C_last2:
    s_nop 0
    v_smfmac_f32_16x16x64_bf16 v[124:127], v[112:115], v[116:123], v11
    s_nop 7
    v_add_f32_dpp v100, v124, v124 row_ror:8 row_mask:0xf bank_mask:0xf
    v_add_f32_dpp v101, v125, v125 row_ror:8 row_mask:0xf bank_mask:0xf
    s_nop 0
    v_add_f32_dpp v102, v100, v100 row_ror:4 row_mask:0xf bank_mask:0xf
    v_add_f32_dpp v103, v101, v101 row_ror:4 row_mask:0xf bank_mask:0xf
    v_cvt_pk_bf16_f32 v24, v102, v103
    v_min_u32 v24, 0xffbfffff, v24
    s_sub_u32 s75, s75, 8192
C_last:
    s_add_u32 s75, s75, 8192
    buffer_store_dword v24, v6, s[8:11], s75 offen sc1
    s_cmp_gt_u32 s63, 400000
    s_cbranch_scc0 fin_39
    v_mov_b32 v1, 0
    v_mov_b32 v3, s61
    v_add_u32 v3, 1000, v3
    buffer_store_dword v3, v1, s[12:15], 0 offen offset:200 sc1
fin_39:
    s_endpgm
.section .rodata,"a"
.p2align 6
.amdhsa_kernel recurrent_scan__memory_aug_recurrent_mem_tr__dense_activation_squared_relu__prompt_kernel
  .amdhsa_next_free_vgpr 512
  .amdhsa_next_free_sgpr 102
  .amdhsa_accum_offset 256
  .amdhsa_group_segment_fixed_size 0
  .amdhsa_kernarg_size 120
  .amdhsa_user_sgpr_count 2
  .amdhsa_user_sgpr_kernarg_segment_ptr 1
  .amdhsa_system_sgpr_workgroup_id_x 1
  .amdhsa_float_denorm_mode_32 3
.end_amdhsa_kernel
```
